```python
import torch

def _softmax(x, axis=-1):
    return torch.softmax(x, dim=axis)
def _gelu(x):
    return torch.nn.functional.gelu(x, approximate="tanh")
def _silu(x):
    return torch.nn.functional.silu(x)
def _sigmoid(x):
    return torch.sigmoid(x)
def _layernorm(x, axis=-1, eps=1e-5):
    m = x.mean(dim=axis, keepdim=True)
    v = x.var(dim=axis, keepdim=True, unbiased=False)
    return (x - m) / torch.sqrt(v + eps)
def _scatter_add(tgt, idx, src, axis=0):
    return tgt.clone().index_add_(axis, idx, src)
def _segment_sum(src, seg, n):
    out = torch.zeros((n,) + src.shape[1:], dtype=src.dtype)
    return out.index_add_(0, seg, src)
def _pad(x, pw):
    flat = tuple(v for pair in reversed(pw) for v in pair)
    return torch.nn.functional.pad(x, flat)

kernel_name = 'concat_heads__mha_block_cached__gqa_block_cached__near_ridge'

def setup_inputs():

    _w = (lambda a: (lambda t: t.to(torch.bfloat16) if t.is_floating_point() else t)(torch.as_tensor(a)))
    def _A_setup():
        B, Sq, D = 8, 304, 512
        H, Sk, Dh = 32, 1024, 128
        return {
            "x": _w((lambda *s: torch.randn(*s, dtype=torch.bfloat16) * 0.8)(B, Sq, D)),
            "k_cache": _w((lambda *s: torch.randn(*s, dtype=torch.bfloat16) * 0.8)(B, H, Sk, Dh)),
            "v_cache": _w((lambda *s: torch.randn(*s, dtype=torch.bfloat16) * 0.05)(B, H, Sk, Dh)),
            "wq": _w((lambda *s: torch.randn(*s, dtype=torch.bfloat16) * 0.8)(D, H * Dh) * (D ** -0.5)),
            "wo": _w((lambda *s: torch.randn(*s, dtype=torch.bfloat16) * 0.05)(H * Dh, D) * ((H * Dh) ** -0.5)),
        }
    _A_in = _A_setup()

    def _B_setup():
        B, Sq, D = 8, 304, 512
        Hq, Hkv, Sk, Dh = 32, 32, 1024, 128
        assert Hq % Hkv == 0, (Hq, Hkv)
        return {
            "x": _w((lambda *s: torch.randn(*s, dtype=torch.bfloat16) * 0.8)(B, Sq, D)),
            "k_cache": _w((lambda *s: torch.randn(*s, dtype=torch.bfloat16) * 0.8)(B, Hkv, Sk, Dh)),
            "v_cache": _w((lambda *s: torch.randn(*s, dtype=torch.bfloat16) * 0.05)(B, Hkv, Sk, Dh)),
            "wq": _w((lambda *s: torch.randn(*s, dtype=torch.bfloat16) * 0.8)(D, Hq * Dh) * (D ** -0.5)),
            "wo": _w((lambda *s: torch.randn(*s, dtype=torch.bfloat16) * 0.05)(Hq * Dh, D) * ((Hq * Dh) ** -0.5)),
        }
    _B_in = _B_setup()

    return {
        "A_x": _A_in["x"],
        "A_k_cache": _A_in["k_cache"],
        "A_v_cache": _A_in["v_cache"],
        "A_wq": _A_in["wq"],
        "A_wo": _A_in["wo"],
        "B_x": _B_in["x"],
        "B_k_cache": _B_in["k_cache"],
        "B_v_cache": _B_in["v_cache"],
        "B_wq": _B_in["wq"],
        "B_wo": _B_in["wo"],
    }

def reference(A_x, A_k_cache, A_v_cache, A_wq, A_wo, B_x, B_k_cache, B_v_cache, B_wq, B_wo):
    def _A_ref(x, k_cache, v_cache, wq, wo):
        B, Sq, D = x.shape
        H, Dh = 32, 128
        q = (lambda x, *d: x.permute(*d))((x @ wq).reshape(B, Sq, H, Dh), 0, 2, 1, 3)
        scores = torch.einsum("bhqd,bhkd->bhqk", q, k_cache) * (Dh ** -0.5)
        p = _softmax(scores, axis=-1)
        o = torch.einsum("bhqk,bhkd->bhqd", p, v_cache)
        return (lambda x, *d: x.permute(*d))(o, 0, 2, 1, 3).reshape(B, Sq, H * Dh) @ wo

    def _B_ref(x, k_cache, v_cache, wq, wo):
        B, Sq, D = x.shape
        Hq, Dh = 32, 128
        Hkv = k_cache.shape[1]
        rep = Hq // Hkv
        q = (lambda x, *d: x.permute(*d))((x @ wq).reshape(B, Sq, Hq, Dh), 0, 2, 1, 3)
        k = (lambda x, n, axis: torch.repeat_interleave(x, n, dim=axis))(k_cache, rep, axis=1)
        v = (lambda x, n, axis: torch.repeat_interleave(x, n, dim=axis))(v_cache, rep, axis=1)
        scores = torch.einsum("bhqd,bhkd->bhqk", q, k) * (Dh ** -0.5)
        p = _softmax(scores, axis=-1)
        o = torch.einsum("bhqk,bhkd->bhqd", p, v)
        return (lambda x, *d: x.permute(*d))(o, 0, 2, 1, 3).reshape(B, Sq, Hq * Dh) @ wo

    a = _A_ref(A_x, A_k_cache, A_v_cache, A_wq, A_wo)
    b = _B_ref(B_x, B_k_cache, B_v_cache, B_wq, B_wo)
    return torch.concatenate([a, b], axis=-1)
```

```asm
; @launch grid=(256,1,1) block=(256,1,1) lds=147520
.amdgcn_target "amdgcn-amd-amdhsa--gfx950"
.text
.globl concat_heads__mha_block_cached__gqa_block_cached__near_ridge_kernel
.p2align 8
.type concat_heads__mha_block_cached__gqa_block_cached__near_ridge_kernel,@function
concat_heads__mha_block_cached__gqa_block_cached__near_ridge_kernel:
    s_cmp_ge_u32 s2, 256
    s_cbranch_scc1 L_end
    s_nop 0
    s_load_dwordx8 s[84:91], s[0:1], 0
    s_load_dwordx2 s[92:93], s[0:1], 32
    s_load_dwordx8 s[40:47], s[0:1], 40
    s_load_dwordx2 s[94:95], s[0:1], 72
    s_load_dwordx2 s[58:59], s[0:1], 80
    s_load_dwordx2 s[56:57], s[0:1], 88
    s_load_dwordx2 s[60:61], s[0:1], 96
    v_lshrrev_b32 v2, 6, v0
    v_and_b32 v1, 63, v0
    v_readfirstlane_b32 s3, v2
    s_getpc_b64 s[96:97]
    s_bfe_u32 s48, s2, 0x20003
    s_lshl_b32 s48, s48, 15
    v_lshlrev_b32 v3, 7, v0
    v_add_u32_e64 v3, s48, v3
    v_min_u32 v3, CODE_SIZE, v3
    global_load_dword a240, v3, s[96:97]
    s_bfe_u32 s62, s2, 0x10002
    s_lshr_b32 s63, s2, 5
    s_and_b32 s64, s2, 3
    s_lshl_b32 s64, s64, 3
    s_nop 0
    s_bfe_u32 s48, s2, 0x20003
    s_lshl_b32 s48, s48, 1
    s_add_u32 s64, s64, s48
    v_and_b32 v30, 15, v1
    v_lshrrev_b32 v31, 4, v1
    v_and_b32 v33, 7, v1
    v_xor_b32 v33, v33, v31
    v_lshrrev_b32 v34, 3, v1
    v_xor_b32 v32, 0, v33
    v_lshlrev_b32_e64 v32, 4, v32
    v_lshl_add_u32 v32, v34, 10, v32
    v_add_u32 v24, 0, v32
    v_xor_b32 v32, 4, v33
    v_lshlrev_b32_e64 v32, 4, v32
    v_lshl_add_u32 v32, v34, 10, v32
    v_add_u32 v25, 7168, v32
    v_xor_b32 v32, 0, v33
    v_lshlrev_b32 v32, 4, v32
    v_lshl_add_u32 v32, v34, 10, v32
    v_add_u32 v26, 14336, v32
    v_xor_b32 v32, 4, v33
    v_lshlrev_b32 v32, 4, v32
    v_lshl_add_u32 v32, v34, 10, v32
    v_add_u32 v27, 21504, v32
    v_lshrrev_b32 v2, 1, v30
    v_xor_b32 v2, v2, v31
    v_and_b32 v3, 1, v30
    v_lshlrev_b32 v3, 4, v3
    v_lshl_add_u32 v3, v31, 13, v3
    v_xor_b32_e64 v32, 0, v2
    v_lshl_add_u32 v32, v32, 5, v3
    v_add_u32 v16, 0, v32
    v_xor_b32 v32, 0, v2
    v_lshl_add_u32 v32, v32, 5, v3
    v_add_u32 v17, 31744, v32
    v_xor_b32_e64 v32, 4, v2
    v_lshl_add_u32 v32, v32, 5, v3
    v_add_u32 v18, 63488, v32
    v_xor_b32_e64 v32, 4, v2
    v_lshl_add_u32 v32, v32, 5, v3
    v_add_u32 v19, 95232, v32
    s_mul_i32 s34, s3, 10240
    s_add_u32 s34, s34, 65536
    s_mul_i32 s33, s3, 81920
    s_mov_b32 s10, 311296
    s_mov_b32 s11, 0x20000
    s_mov_b32 s15, 0x20000
    s_lshl_b32 s99, s3, 12
    s_lshl_b32 s100, s3, 17
    s_mul_i32 s48, s63, 311296
    s_lshl_b32 s49, s64, 8
    s_nop 0
    s_sub_u32 s14, 0x400000, s49
    s_waitcnt lgkmcnt(0)
    s_cmp_eq_u32 s62, 1
    s_cselect_b32 s84, s40, s84
    s_cselect_b32 s85, s41, s85
    s_cselect_b32 s86, s42, s86
    s_cselect_b32 s87, s43, s87
    s_cselect_b32 s88, s44, s88
    s_cselect_b32 s89, s45, s89
    s_cselect_b32 s90, s46, s90
    s_cselect_b32 s91, s47, s91
    s_cselect_b32 s68, s94, s92
    s_cselect_b32 s69, s95, s93
    s_add_u32 s8, s84, s48
    s_addc_u32 s9, s85, 0
    s_add_u32 s12, s90, s49
    s_addc_u32 s13, s91, 0
    s_add_u32 m0, s99, 0
    s_add_u32 s98, s100, 0
    buffer_load_dwordx4 v16, s[12:15], s98 offen offset:0 nt lds
    buffer_load_dwordx4 v17, s[12:15], s98 offen offset:1024 nt lds
    v_accvgpr_write_b32 a248, 0
    v_accvgpr_write_b32 a249, 0
    v_accvgpr_write_b32 a250, 0
    v_accvgpr_write_b32 a251, 0
    v_or_b32 v2, 0, v31
    v_xor_b32 v2, v2, v30
    buffer_load_dwordx4 v18, s[12:15], s98 offen offset:2048 nt lds
    v_lshlrev_b32_e64 v2, 4, v2
    v_lshl_add_u32 v4, v30, 8, v2
    v_mfma_f32_32x32x16_bf16 v[240:255], a[248:251], a[248:251], 0
    v_or_b32 v2, 4, v31
    v_xor_b32 v2, v2, v30
    v_lshlrev_b32_e64 v2, 4, v2
    buffer_load_dwordx4 v19, s[12:15], s98 offen offset:3072 nt lds
    v_lshl_add_u32 v5, v30, 8, v2
    v_mfma_f32_32x32x16_bf16 v[224:239], a[248:251], a[248:251], 0
    v_or_b32 v2, 8, v31
    v_xor_b32 v2, v2, v30
    v_lshlrev_b32_e64 v2, 4, v2
    v_lshl_add_u32 v6, v30, 8, v2
    s_add_u32 m0, s34, 0
    s_add_u32 s98, s33, 0
    buffer_load_dwordx4 v24, s[8:11], s98 offen offset:0 nt lds
    v_mfma_f32_32x32x16_bf16 v[208:223], a[248:251], a[248:251], 0
    v_or_b32 v2, 12, v31
    v_xor_b32 v2, v2, v30
    v_lshlrev_b32_e64 v2, 4, v2
    v_lshl_add_u32 v7, v30, 8, v2
    v_mfma_f32_32x32x16_bf16 v[192:207], a[248:251], a[248:251], 0
    buffer_load_dwordx4 v25, s[8:11], s98 offen offset:1024 nt lds
    v_lshrrev_b32_e64 v2, 2, v30
    v_lshl_add_u32 v2, v31, 2, v2
    v_and_b32 v3, 7, v2
    v_lshlrev_b32 v2, 8, v2
    v_mfma_f32_32x32x16_bf16 v[176:191], a[248:251], a[248:251], 0
    v_and_b32_e64 v1, 3, v30
    buffer_load_dwordx4 v26, s[8:11], s98 offen offset:2048 nt lds
    v_lshl_add_u32 v2, v1, 3, v2
    v_xor_b32_e64 v1, 0, v3
    v_lshl_add_u32 v8, v1, 5, v2
    v_mfma_f32_32x32x16_bf16 v[160:175], a[248:251], a[248:251], 0
    v_xor_b32_e64 v1, 1, v3
    v_lshl_add_u32 v9, v1, 5, v2
    buffer_load_dwordx4 v27, s[8:11], s98 offen offset:3072 nt lds
    v_xor_b32_e64 v1, 2, v3
    v_lshl_add_u32 v10, v1, 5, v2
    v_mfma_f32_32x32x16_bf16 v[144:159], a[248:251], a[248:251], 0
    v_xor_b32_e64 v1, 3, v3
    v_lshl_add_u32 v11, v1, 5, v2
    v_xor_b32_e64 v1, 4, v3
    s_add_u32 m0, s34, 4096
    s_add_u32 s98, s33, 32768
    buffer_load_dwordx4 v24, s[8:11], s98 offen offset:0 nt lds
    v_lshl_add_u32 v12, v1, 5, v2
    v_mfma_f32_32x32x16_bf16 v[128:143], a[248:251], a[248:251], 0
    v_xor_b32_e64 v1, 5, v3
    v_lshl_add_u32 v13, v1, 5, v2
    v_xor_b32_e64 v1, 6, v3
    v_lshl_add_u32 v14, v1, 5, v2
    buffer_load_dwordx4 v25, s[8:11], s98 offen offset:1024 nt lds
    v_mfma_f32_32x32x16_bf16 v[112:127], a[248:251], a[248:251], 0
    v_xor_b32_e64 v1, 7, v3
    v_lshl_add_u32 v15, v1, 5, v2
    v_lshrrev_b32 v1, 4, v0
    v_xnor_b32 v1, v1, v0
    v_mfma_f32_32x32x16_bf16 v[96:111], a[248:251], a[248:251], 0
    buffer_load_dwordx4 v26, s[8:11], s98 offen offset:2048 nt lds
    v_bfe_i32 v1, v1, 1, 1
    v_and_b32 v1, 0x3f803f80, v1
    v_accvgpr_write_b32 a244, v1
    v_accvgpr_write_b32 a245, v1
    v_mfma_f32_32x32x16_bf16 v[80:95], a[248:251], a[248:251], 0
    v_accvgpr_write_b32 a246, v1
    buffer_load_dwordx4 v27, s[8:11], s98 offen offset:3072 nt lds
    v_accvgpr_write_b32 a247, v1
    v_lshrrev_b32 v3, 1, v30
    v_xor_b32 v3, v3, v31
    v_mfma_f32_32x32x16_bf16 v[64:79], a[248:251], a[248:251], 0
    v_xor_b32 v2, 0, v3
    v_lshlrev_b32 v2, 4, v2
    s_add_u32 m0, s34, 8192
    s_add_u32 s98, s33, 65536
    buffer_load_dwordx4 v24, s[8:11], s98 offen offset:0 nt lds
    v_lshl_add_u32 v2, v30, 7, v2
    v_add_u32_e64 v28, s34, v2
    v_mfma_f32_32x32x16_bf16 v[48:63], a[248:251], a[248:251], 0
    v_xor_b32 v2, 4, v3
    v_lshlrev_b32 v2, 4, v2
    v_lshl_add_u32 v2, v30, 7, v2
    buffer_load_dwordx4 v25, s[8:11], s98 offen offset:1024 nt lds
    s_add_u32 s33, s33, 128
    v_add_u32_e64 v29, s34, v2
    v_mfma_f32_32x32x16_bf16 v[32:47], a[248:251], a[248:251], 0
    s_lshl_b32 s48, s63, 5
    s_add_u32 s48, s48, s64
    s_lshl_b32 s48, s48, 18
    s_add_u32 s24, s86, s48
    s_addc_u32 s25, s87, 0
    s_nop 0
    s_add_u32 m0, s99, 16384
    s_add_u32 s98, s100, 256
    buffer_load_dwordx4 v16, s[12:15], s98 offen offset:0 nt lds
    v_mfma_f32_32x32x16_bf16 a[0:15], a[248:251], a[248:251], 0
    s_add_u32 s28, s88, s48
    s_addc_u32 s29, s89, 0
    s_mov_b32 s20, s60
    s_mov_b32 s21, s61
    s_mov_b32 s22, 53820160
    v_mfma_f32_32x32x16_bf16 a[16:31], a[248:251], a[248:251], 0
    buffer_load_dwordx4 v17, s[12:15], s98 offen offset:1024 nt lds
    s_mov_b32 s23, 0x20000
    s_lshl_b32 s48, s62, 3
    s_add_u32 s48, s48, s63
    s_mul_i32 s48, s48, 2495232
    v_mfma_f32_32x32x16_bf16 a[32:47], a[248:251], a[248:251], 0
    s_mul_i32 s50, s3, 656640
    buffer_load_dwordx4 v18, s[12:15], s98 offen offset:2048 nt lds
    s_add_u32 s50, s50, s48
    s_nop 0
    s_add_u32 s50, s50, 256
    s_lshl_b32 s48, s64, 12
    s_nop 0
    v_mfma_f32_32x32x16_bf16 a[48:63], a[248:251], a[248:251], 0
    s_add_u32 s50, s50, s48
    s_nop 0
    s_mov_b32 s38, 0x3e0293ee
    buffer_load_dwordx4 v19, s[12:15], s98 offen offset:3072 nt lds
    s_mov_b32 s39, 0x3e0293ee
    s_mov_b32 s51, 0x4f800000
    v_mfma_f32_32x32x16_bf16 a[64:79], a[248:251], a[248:251], 0
    s_mov_b32 s7, 0x20000
    s_and_b32 s65, s2, 2
    s_lshl_b32 s65, s65, 1
    s_add_u32 m0, s99, 32768
    s_add_u32 s98, s100, 524288
    buffer_load_dwordx4 v16, s[12:15], s98 offen offset:0 nt lds
    s_lshr_b32 s48, s2, 6
    s_nop 0
    v_mfma_f32_32x32x16_bf16 a[80:95], a[248:251], a[248:251], 0
    s_add_u32 s65, s65, s48
    s_nop 0
    s_bfe_u32 s66, s2, 0x10005
    s_lshl_b32 s66, s66, 1
    s_and_b32 s48, s2, 1
    buffer_load_dwordx4 v17, s[12:15], s98 offen offset:1024 nt lds
    v_mfma_f32_32x32x16_bf16 a[224:239], a[248:251], a[248:251], 0
    s_add_u32 s66, s66, s48
    s_nop 0
    s_bfe_u32 s67, s2, 0x20003
    s_movk_i32 s31, 256
    s_nop 0
    s_mov_b32 s32, 524032
    s_mov_b32 s52, 0x20000
    buffer_load_dwordx4 v18, s[12:15], s98 offen offset:2048 nt lds
    s_mov_b32 s53, 0x40000
    s_mov_b32 s54, 0x60000
    s_mov_b32 s16, s12
    s_mov_b32 s17, s13
    s_mov_b32 s18, s14
    s_nop 0
    s_mov_b32 s19, 0x20000
    buffer_load_dwordx4 v19, s[12:15], s98 offen offset:3072 nt lds
    s_mov_b32 s0, 0x80100
    s_mov_b32 s30, 0x80100
    s_mov_b32 s44, -1
    s_mov_b32 s45, 0
    s_lshl_b32 s48, s63, 4
    s_lshr_b32 s49, s64, 1
    s_add_u32 m0, s34, 40960
    s_add_u32 s98, s33, 0
    s_nop 0
    buffer_load_dwordx4 v24, s[8:11], s98 offen offset:0 nt lds
    s_add_u32 s49, s48, s49
    s_and_b32 s48, s49, 3
    s_mul_i32 s71, s48, 1048832
    s_lshl_b32 s70, s48, 8
    s_lshr_b32 s49, s49, 2
    s_lshl_b32 s49, s49, 1
    s_nop 0
    buffer_load_dwordx4 v25, s[8:11], s98 offen offset:1024 nt lds
    s_and_b32 s48, s3, 1
    s_add_u32 s49, s49, s48
    s_lshl_b32 s48, s49, 14
    s_add_u32 s71, s71, s48
    s_lshl_b32 s49, s49, 16
    s_add_u32 s70, s70, s49
    buffer_load_dwordx4 v26, s[8:11], s98 offen offset:2048 nt lds
    s_add_u32 s6, s49, 0x10000
    s_mov_b32 s4, s68
    s_mov_b32 s5, s69
    s_lshr_b32 s48, s3, 1
    s_lshl_b32 s49, s48, 7
    s_add_u32 s70, s70, s49
    s_nop 0
    buffer_load_dwordx4 v27, s[8:11], s98 offen offset:3072 nt lds
    s_lshl_b32 s49, s48, 12
    s_add_u32 s71, s71, s49
    s_mul_i32 s46, s62, 4195328
    s_add_u32 s46, s46, 40186624
    s_add_u32 s71, s71, s46
    s_nop 0
    s_mul_i32 s48, s67, 1048832
    s_add_u32 s46, s46, s48
    s_and_b32 s48, s66, 1
    s_lshl_b32 s48, s48, 19
    s_add_u32 s46, s46, s48
    s_mul_i32 s96, s3, 20480
    s_add_u32 s96, s96, 65536
    s_mov_b32 s27, 6
    s_mov_b32 s36, 0
    s_mov_b32 s37, 0
    s_movk_i32 s26, 0xfe
    s_lshl_b32 s49, s3, 3
    s_nop 0
    s_lshr_b32 s97, 0x1e0e0e0e, s49
    s_and_b32 s97, s97, 0xff
    s_lshl_b32 s97, s97, 1
    s_lshl_b32 s49, s3, 16
    s_lshl_b32 s55, s62, 3
    s_add_u32 s55, s55, s65
    s_mul_i32 s55, s55, 2495232
    s_add_u32 s48, s3, 1
    s_and_b32 s48, s48, 3
    s_lshl_b32 s48, s48, 11
    s_add_u32 s92, s48, s49
    s_add_u32 s48, s3, 2
    s_and_b32 s48, s48, 3
    s_lshl_b32 s48, s48, 11
    s_add_u32 s93, s48, s49
    s_add_u32 s48, s3, 3
    s_and_b32 s48, s48, 3
    s_lshl_b32 s48, s48, 11
    s_add_u32 s94, s48, s49
    s_add_u32 s48, s3, 4
    s_and_b32 s48, s48, 3
    s_lshl_b32 s48, s48, 11
    s_add_u32 s95, s48, s49
    s_lshr_b32 s1, s2, 5
    s_xor_b32 s1, s1, s2
    s_and_b32 s1, s1, 31
    s_lshl_b32 s1, s1, 13
    s_cmp_eq_u32 s3, 3
    s_cbranch_scc1 L_var4
    v_lshrrev_b32 v2, 2, v30
    v_and_b32 v3, 1, v31
    v_lshl_add_u32 v3, v3, 2, v2
    v_bfe_u32 v1, v30, 1, 1
    v_xor_b32_e64 v3, v3, v1
    v_lshl_add_u32 v2, v31, 3, v2
    v_lshlrev_b32 v2, 8, v2
    v_and_b32 v1, 1, v30
    v_lshl_add_u32 v2, v1, 4, v2
    v_xor_b32_e64 v1, 0, v3
    v_lshl_add_u32 v20, v1, 5, v2
    v_xor_b32_e64 v1, 2, v3
    v_lshl_add_u32 v21, v1, 5, v2
    v_xor_b32_e64 v1, 4, v3
    v_lshl_add_u32 v22, v1, 5, v2
    v_xor_b32_e64 v1, 6, v3
    v_lshl_add_u32 v23, v1, 5, v2
    v_bfe_u32 v1, v0, 2, 4
    v_lshrrev_b32 v2, 1, v1
    v_and_b32 v3, 3, v0
    v_xor_b32 v2, v2, v3
    v_lshlrev_b32 v2, 4, v2
    v_lshl_add_u32 v2, v1, 7, v2
    v_add_u32 v2, s34, v2
    v_xor_b32 v3, 64, v2
    s_waitcnt vmcnt(12) lgkmcnt(0)
    s_barrier
    ds_read_b128 a[96:99], v28 offset:0
    ds_read_b128 a[100:103], v29 offset:0
    ds_read_b128 a[104:107], v28 offset:2048
    ds_read_b128 a[108:111], v29 offset:2048
    ds_read_b128 a[112:115], v28 offset:4096
    ds_read_b128 a[116:119], v29 offset:4096
    ds_read_b128 a[120:123], v28 offset:6144
    ds_read_b128 a[124:127], v29 offset:6144
    ds_read_b128 a[128:131], v28 offset:8192
    ds_read_b128 a[132:135], v29 offset:8192
    ds_read_b64_tr_b16 a[176:177], v20 offset:0
    ds_read_b64_tr_b16 a[178:179], v20 offset:1024
    ds_read_b64_tr_b16 a[180:181], v20 offset:8192
    ds_read_b64_tr_b16 a[182:183], v20 offset:9216
    ds_read_b64_tr_b16 a[184:185], v20 offset:8
    ds_read_b64_tr_b16 a[186:187], v20 offset:1032
    ds_read_b64_tr_b16 a[188:189], v20 offset:8200
    ds_read_b64_tr_b16 a[190:191], v20 offset:9224
    s_add_u32 m0, s34, 45056
    s_add_u32 s98, s33, 32768
    buffer_load_dwordx4 v24, s[8:11], s98 offen offset:0 nt lds
    buffer_load_dwordx4 v25, s[8:11], s98 offen offset:1024 nt lds
    buffer_load_dwordx4 v26, s[8:11], s98 offen offset:2048 nt lds
    buffer_load_dwordx4 v27, s[8:11], s98 offen offset:3072 nt lds
    s_add_u32 m0, s34, 49152
    s_add_u32 s98, s33, 65536
    buffer_load_dwordx4 v24, s[8:11], s98 offen offset:0 nt lds
    buffer_load_dwordx4 v25, s[8:11], s98 offen offset:1024 nt lds
    s_add_u32 s33, s33, 128
    s_lshl_b32 s48, s3, 13
    s_and_b32 s49, s66, 1
    s_lshl_b32 s49, s49, 16
    s_add_u32 s48, s48, s49
    s_mul_i32 s99, s66, 656640
    s_add_u32 s99, s99, s48
    s_xor_b32 s98, s66, 1
    s_mul_i32 s98, s98, 656640
    s_add_u32 s98, s98, s48
    s_mov_b32 s35, 3
    s_waitcnt lgkmcnt(0)
    s_nop 0
    s_nop 0
L_q5:
    s_cmp_eq_u32 s35, 0
    s_cselect_b32 s8, s4, s8
    s_cselect_b32 s9, s5, s9
    s_cselect_b32 s10, s6, s10
    s_cselect_b32 s33, s70, s33
    s_waitcnt lgkmcnt(11)
    v_mfma_f32_16x16x32_bf16 v[96:99], a[176:179], a[96:99], v[96:99]
    s_waitcnt lgkmcnt(9)
    v_mfma_f32_16x16x32_bf16 v[96:99], a[180:183], a[100:103], v[96:99]
    ds_read_b64_tr_b16 a[192:193], v21 offset:0
    v_mfma_f32_16x16x32_bf16 v[128:131], a[176:179], a[104:107], v[128:131]
    ds_read_b64_tr_b16 a[194:195], v21 offset:1024
    v_mfma_f32_16x16x32_bf16 v[128:131], a[180:183], a[108:111], v[128:131]
    ds_read_b64_tr_b16 a[196:197], v21 offset:8192
    v_mfma_f32_16x16x32_bf16 v[160:163], a[176:179], a[112:115], v[160:163]
    ds_read_b64_tr_b16 a[198:199], v21 offset:9216
    s_waitcnt lgkmcnt(12)
    v_mfma_f32_16x16x32_bf16 v[160:163], a[180:183], a[116:119], v[160:163]
    s_add_u32 m0, s34, 0
    s_add_u32 s48, s33, 0
    s_waitcnt lgkmcnt(11)
    v_mfma_f32_16x16x32_bf16 v[192:195], a[176:179], a[120:123], v[192:195]
    s_waitcnt lgkmcnt(10)
    v_mfma_f32_16x16x32_bf16 v[192:195], a[180:183], a[124:127], v[192:195]
    s_waitcnt lgkmcnt(9)
    v_mfma_f32_16x16x32_bf16 v[224:227], a[176:179], a[128:131], v[224:227]
    s_waitcnt lgkmcnt(8)
    v_mfma_f32_16x16x32_bf16 v[224:227], a[180:183], a[132:135], v[224:227]
    buffer_load_dwordx4 v24, s[8:11], s48 offen offset:0 nt lds
    s_waitcnt lgkmcnt(6)
    v_mfma_f32_16x16x32_bf16 v[100:103], a[184:187], a[96:99], v[100:103]
    s_waitcnt lgkmcnt(4)
    v_mfma_f32_16x16x32_bf16 v[100:103], a[188:191], a[100:103], v[100:103]
    ds_read_b64_tr_b16 a[200:201], v21 offset:8
    v_mfma_f32_16x16x32_bf16 v[132:135], a[184:187], a[104:107], v[132:135]
    ds_read_b64_tr_b16 a[202:203], v21 offset:1032
    v_mfma_f32_16x16x32_bf16 v[132:135], a[188:191], a[108:111], v[132:135]
    ds_read_b64_tr_b16 a[204:205], v21 offset:8200
    v_mfma_f32_16x16x32_bf16 v[164:167], a[184:187], a[112:115], v[164:167]
    ds_read_b64_tr_b16 a[206:207], v21 offset:9224
    v_mfma_f32_16x16x32_bf16 v[164:167], a[188:191], a[116:119], v[164:167]
    v_mfma_f32_16x16x32_bf16 v[196:199], a[184:187], a[120:123], v[196:199]
    buffer_load_dwordx4 v25, s[8:11], s48 offen offset:1024 nt lds
    v_mfma_f32_16x16x32_bf16 v[196:199], a[188:191], a[124:127], v[196:199]
    v_mfma_f32_16x16x32_bf16 v[228:231], a[184:187], a[128:131], v[228:231]
    v_mfma_f32_16x16x32_bf16 v[228:231], a[188:191], a[132:135], v[228:231]
    s_waitcnt lgkmcnt(6)
    v_mfma_f32_16x16x32_bf16 v[104:107], a[192:195], a[96:99], v[104:107]
    s_waitcnt lgkmcnt(4)
    v_mfma_f32_16x16x32_bf16 v[104:107], a[196:199], a[100:103], v[104:107]
    ds_read_b64_tr_b16 a[176:177], v22 offset:0
    v_mfma_f32_16x16x32_bf16 v[136:139], a[192:195], a[104:107], v[136:139]
    ds_read_b64_tr_b16 a[178:179], v22 offset:1024
    v_mfma_f32_16x16x32_bf16 v[136:139], a[196:199], a[108:111], v[136:139]
    ds_read_b64_tr_b16 a[180:181], v22 offset:8192
    v_mfma_f32_16x16x32_bf16 v[168:171], a[192:195], a[112:115], v[168:171]
    ds_read_b64_tr_b16 a[182:183], v22 offset:9216
    v_mfma_f32_16x16x32_bf16 v[168:171], a[196:199], a[116:119], v[168:171]
    buffer_load_dwordx4 v26, s[8:11], s48 offen offset:2048 nt lds
    v_mfma_f32_16x16x32_bf16 v[200:203], a[192:195], a[120:123], v[200:203]
    v_mfma_f32_16x16x32_bf16 v[200:203], a[196:199], a[124:127], v[200:203]
    v_mfma_f32_16x16x32_bf16 v[232:235], a[192:195], a[128:131], v[232:235]
    v_mfma_f32_16x16x32_bf16 v[232:235], a[196:199], a[132:135], v[232:235]
    s_waitcnt lgkmcnt(6)
    v_mfma_f32_16x16x32_bf16 v[108:111], a[200:203], a[96:99], v[108:111]
    buffer_load_dwordx4 v27, s[8:11], s48 offen offset:3072 nt lds
    s_waitcnt lgkmcnt(4)
    v_mfma_f32_16x16x32_bf16 v[108:111], a[204:207], a[100:103], v[108:111]
    ds_read_b64_tr_b16 a[184:185], v22 offset:8
    v_mfma_f32_16x16x32_bf16 v[140:143], a[200:203], a[104:107], v[140:143]
    ds_read_b64_tr_b16 a[186:187], v22 offset:1032
    v_mfma_f32_16x16x32_bf16 v[140:143], a[204:207], a[108:111], v[140:143]
    ds_read_b64_tr_b16 a[188:189], v22 offset:8200
    v_mfma_f32_16x16x32_bf16 v[172:175], a[200:203], a[112:115], v[172:175]
    ds_read_b64_tr_b16 a[190:191], v22 offset:9224
    v_mfma_f32_16x16x32_bf16 v[172:175], a[204:207], a[116:119], v[172:175]
    v_mfma_f32_16x16x32_bf16 v[204:207], a[200:203], a[120:123], v[204:207]
    v_mfma_f32_16x16x32_bf16 v[204:207], a[204:207], a[124:127], v[204:207]
    s_add_u32 m0, s34, 4096
    s_add_u32 s48, s33, 32768
    v_mfma_f32_16x16x32_bf16 v[236:239], a[200:203], a[128:131], v[236:239]
    v_mfma_f32_16x16x32_bf16 v[236:239], a[204:207], a[132:135], v[236:239]
    s_waitcnt lgkmcnt(6)
    v_mfma_f32_16x16x32_bf16 v[112:115], a[176:179], a[96:99], v[112:115]
    s_waitcnt lgkmcnt(4)
    v_mfma_f32_16x16x32_bf16 v[112:115], a[180:183], a[100:103], v[112:115]
    ds_read_b64_tr_b16 a[192:193], v23 offset:0
    v_mfma_f32_16x16x32_bf16 v[144:147], a[176:179], a[104:107], v[144:147]
    ds_read_b64_tr_b16 a[194:195], v23 offset:1024
    v_mfma_f32_16x16x32_bf16 v[144:147], a[180:183], a[108:111], v[144:147]
    ds_read_b64_tr_b16 a[196:197], v23 offset:8192
    v_mfma_f32_16x16x32_bf16 v[176:179], a[176:179], a[112:115], v[176:179]
    ds_read_b64_tr_b16 a[198:199], v23 offset:9216
    v_mfma_f32_16x16x32_bf16 v[176:179], a[180:183], a[116:119], v[176:179]
    buffer_load_dwordx4 v24, s[8:11], s48 offen offset:0 nt lds
    v_mfma_f32_16x16x32_bf16 v[208:211], a[176:179], a[120:123], v[208:211]
    v_mfma_f32_16x16x32_bf16 v[208:211], a[180:183], a[124:127], v[208:211]
    v_mfma_f32_16x16x32_bf16 v[240:243], a[176:179], a[128:131], v[240:243]
    v_mfma_f32_16x16x32_bf16 v[240:243], a[180:183], a[132:135], v[240:243]
    s_waitcnt lgkmcnt(6)
    v_mfma_f32_16x16x32_bf16 v[116:119], a[184:187], a[96:99], v[116:119]
    s_waitcnt lgkmcnt(4)
    v_mfma_f32_16x16x32_bf16 v[116:119], a[188:191], a[100:103], v[116:119]
    ds_read_b64_tr_b16 a[200:201], v23 offset:8
    v_mfma_f32_16x16x32_bf16 v[148:151], a[184:187], a[104:107], v[148:151]
    ds_read_b64_tr_b16 a[202:203], v23 offset:1032
    v_mfma_f32_16x16x32_bf16 v[148:151], a[188:191], a[108:111], v[148:151]
    ds_read_b64_tr_b16 a[204:205], v23 offset:8200
    v_mfma_f32_16x16x32_bf16 v[180:183], a[184:187], a[112:115], v[180:183]
    ds_read_b64_tr_b16 a[206:207], v23 offset:9224
    v_mfma_f32_16x16x32_bf16 v[180:183], a[188:191], a[116:119], v[180:183]
    v_mfma_f32_16x16x32_bf16 v[212:215], a[184:187], a[120:123], v[212:215]
    v_mfma_f32_16x16x32_bf16 v[212:215], a[188:191], a[124:127], v[212:215]
    v_mfma_f32_16x16x32_bf16 v[244:247], a[184:187], a[128:131], v[244:247]
    v_mfma_f32_16x16x32_bf16 v[244:247], a[188:191], a[132:135], v[244:247]
    s_waitcnt vmcnt(19) lgkmcnt(0)
    s_barrier
    v_mfma_f32_16x16x32_bf16 v[120:123], a[192:195], a[96:99], v[120:123]
    v_mfma_f32_16x16x32_bf16 v[120:123], a[196:199], a[100:103], v[120:123]
    ds_read_b64_tr_b16 a[176:177], v20 offset:16384
    v_mfma_f32_16x16x32_bf16 v[152:155], a[192:195], a[104:107], v[152:155]
    ds_read_b64_tr_b16 a[178:179], v20 offset:17408
    v_mfma_f32_16x16x32_bf16 v[152:155], a[196:199], a[108:111], v[152:155]
    ds_read_b64_tr_b16 a[180:181], v20 offset:24576
    v_mfma_f32_16x16x32_bf16 v[184:187], a[192:195], a[112:115], v[184:187]
    ds_read_b64_tr_b16 a[182:183], v20 offset:25600
    v_mfma_f32_16x16x32_bf16 v[184:187], a[196:199], a[116:119], v[184:187]
    v_mfma_f32_16x16x32_bf16 v[216:219], a[192:195], a[120:123], v[216:219]
    v_mfma_f32_16x16x32_bf16 v[216:219], a[196:199], a[124:127], v[216:219]
    v_mfma_f32_16x16x32_bf16 v[248:251], a[192:195], a[128:131], v[248:251]
    v_mfma_f32_16x16x32_bf16 v[248:251], a[196:199], a[132:135], v[248:251]
    v_mfma_f32_16x16x32_bf16 v[124:127], a[200:203], a[96:99], v[124:127]
    v_mfma_f32_16x16x32_bf16 v[124:127], a[204:207], a[100:103], v[124:127]
    ds_read_b64_tr_b16 a[184:185], v20 offset:16392
    v_mfma_f32_16x16x32_bf16 v[156:159], a[200:203], a[104:107], v[156:159]
    ds_read_b64_tr_b16 a[186:187], v20 offset:17416
    v_mfma_f32_16x16x32_bf16 v[156:159], a[204:207], a[108:111], v[156:159]
    ds_read_b64_tr_b16 a[188:189], v20 offset:24584
    v_mfma_f32_16x16x32_bf16 v[188:191], a[200:203], a[112:115], v[188:191]
    ds_read_b64_tr_b16 a[190:191], v20 offset:25608
    v_mfma_f32_16x16x32_bf16 v[188:191], a[204:207], a[116:119], v[188:191]
    v_mfma_f32_16x16x32_bf16 v[220:223], a[200:203], a[120:123], v[220:223]
    v_mfma_f32_16x16x32_bf16 v[220:223], a[204:207], a[124:127], v[220:223]
    v_mfma_f32_16x16x32_bf16 v[252:255], a[200:203], a[128:131], v[252:255]
    v_mfma_f32_16x16x32_bf16 v[252:255], a[204:207], a[132:135], v[252:255]
    s_waitcnt lgkmcnt(6)
    v_mfma_f32_16x16x32_bf16 a[0:3], a[176:179], a[96:99], a[0:3]
    s_waitcnt lgkmcnt(4)
    v_mfma_f32_16x16x32_bf16 a[0:3], a[180:183], a[100:103], a[0:3]
    ds_read_b64_tr_b16 a[192:193], v21 offset:16384
    v_mfma_f32_16x16x32_bf16 a[32:35], a[176:179], a[104:107], a[32:35]
    ds_read_b64_tr_b16 a[194:195], v21 offset:17408
    v_mfma_f32_16x16x32_bf16 a[32:35], a[180:183], a[108:111], a[32:35]
    ds_read_b64_tr_b16 a[196:197], v21 offset:24576
    v_mfma_f32_16x16x32_bf16 a[64:67], a[176:179], a[112:115], a[64:67]
    ds_read_b64_tr_b16 a[198:199], v21 offset:25600
    v_mfma_f32_16x16x32_bf16 a[64:67], a[180:183], a[116:119], a[64:67]
    s_add_u32 m0, s34, 4096
    s_add_u32 s48, s33, 32768
    v_mfma_f32_16x16x32_bf16 v[32:35], a[176:179], a[120:123], v[32:35]
    v_mfma_f32_16x16x32_bf16 v[32:35], a[180:183], a[124:127], v[32:35]
    v_mfma_f32_16x16x32_bf16 v[64:67], a[176:179], a[128:131], v[64:67]
    v_mfma_f32_16x16x32_bf16 v[64:67], a[180:183], a[132:135], v[64:67]
    buffer_load_dwordx4 v25, s[8:11], s48 offen offset:1024 nt lds
    s_waitcnt lgkmcnt(6)
    v_mfma_f32_16x16x32_bf16 a[4:7], a[184:187], a[96:99], a[4:7]
    s_waitcnt lgkmcnt(4)
    v_mfma_f32_16x16x32_bf16 a[4:7], a[188:191], a[100:103], a[4:7]
    ds_read_b64_tr_b16 a[200:201], v21 offset:16392
    v_mfma_f32_16x16x32_bf16 a[36:39], a[184:187], a[104:107], a[36:39]
    ds_read_b64_tr_b16 a[202:203], v21 offset:17416
    v_mfma_f32_16x16x32_bf16 a[36:39], a[188:191], a[108:111], a[36:39]
    ds_read_b64_tr_b16 a[204:205], v21 offset:24584
    v_mfma_f32_16x16x32_bf16 a[68:71], a[184:187], a[112:115], a[68:71]
    ds_read_b64_tr_b16 a[206:207], v21 offset:25608
    v_mfma_f32_16x16x32_bf16 a[68:71], a[188:191], a[116:119], a[68:71]
    v_mfma_f32_16x16x32_bf16 v[36:39], a[184:187], a[120:123], v[36:39]
    buffer_load_dwordx4 v26, s[8:11], s48 offen offset:2048 nt lds
    v_mfma_f32_16x16x32_bf16 v[36:39], a[188:191], a[124:127], v[36:39]
    v_mfma_f32_16x16x32_bf16 v[68:71], a[184:187], a[128:131], v[68:71]
    v_mfma_f32_16x16x32_bf16 v[68:71], a[188:191], a[132:135], v[68:71]
    s_waitcnt lgkmcnt(6)
    v_mfma_f32_16x16x32_bf16 a[8:11], a[192:195], a[96:99], a[8:11]
    s_waitcnt lgkmcnt(4)
    v_mfma_f32_16x16x32_bf16 a[8:11], a[196:199], a[100:103], a[8:11]
    ds_read_b64_tr_b16 a[176:177], v22 offset:16384
    v_mfma_f32_16x16x32_bf16 a[40:43], a[192:195], a[104:107], a[40:43]
    ds_read_b64_tr_b16 a[178:179], v22 offset:17408
    v_mfma_f32_16x16x32_bf16 a[40:43], a[196:199], a[108:111], a[40:43]
    ds_read_b64_tr_b16 a[180:181], v22 offset:24576
    v_mfma_f32_16x16x32_bf16 a[72:75], a[192:195], a[112:115], a[72:75]
    ds_read_b64_tr_b16 a[182:183], v22 offset:25600
    v_mfma_f32_16x16x32_bf16 a[72:75], a[196:199], a[116:119], a[72:75]
    buffer_load_dwordx4 v27, s[8:11], s48 offen offset:3072 nt lds
    v_mfma_f32_16x16x32_bf16 v[40:43], a[192:195], a[120:123], v[40:43]
    v_mfma_f32_16x16x32_bf16 v[40:43], a[196:199], a[124:127], v[40:43]
    v_mfma_f32_16x16x32_bf16 v[72:75], a[192:195], a[128:131], v[72:75]
    v_mfma_f32_16x16x32_bf16 v[72:75], a[196:199], a[132:135], v[72:75]
    s_waitcnt vmcnt(8)
    s_waitcnt lgkmcnt(6)
    v_mfma_f32_16x16x32_bf16 a[12:15], a[200:203], a[96:99], a[12:15]
    s_add_u32 m0, s34, 8192
    s_add_u32 s48, s33, 65536
    s_waitcnt lgkmcnt(4)
    v_mfma_f32_16x16x32_bf16 a[12:15], a[204:207], a[100:103], a[12:15]
    ds_read_b64_tr_b16 a[184:185], v22 offset:16392
    v_mfma_f32_16x16x32_bf16 a[44:47], a[200:203], a[104:107], a[44:47]
    ds_read_b64_tr_b16 a[186:187], v22 offset:17416
    v_mfma_f32_16x16x32_bf16 a[44:47], a[204:207], a[108:111], a[44:47]
    ds_read_b64_tr_b16 a[188:189], v22 offset:24584
    v_mfma_f32_16x16x32_bf16 a[76:79], a[200:203], a[112:115], a[76:79]
    ds_read_b64_tr_b16 a[190:191], v22 offset:25608
    v_mfma_f32_16x16x32_bf16 a[76:79], a[204:207], a[116:119], a[76:79]
    ds_read_b128 a[136:139], v28 offset:40960
    v_mfma_f32_16x16x32_bf16 v[44:47], a[200:203], a[120:123], v[44:47]
    ds_read_b128 a[140:143], v29 offset:40960
    v_mfma_f32_16x16x32_bf16 v[44:47], a[204:207], a[124:127], v[44:47]
    buffer_load_dwordx4 v24, s[8:11], s48 offen offset:0 nt lds
    v_mfma_f32_16x16x32_bf16 v[76:79], a[200:203], a[128:131], v[76:79]
    ds_read_b128 a[144:147], v28 offset:43008
    v_mfma_f32_16x16x32_bf16 v[76:79], a[204:207], a[132:135], v[76:79]
    ds_read_b128 a[148:151], v29 offset:43008
    s_waitcnt lgkmcnt(10)
    v_mfma_f32_16x16x32_bf16 a[16:19], a[176:179], a[96:99], a[16:19]
    ds_read_b128 a[152:155], v28 offset:45056
    s_waitcnt lgkmcnt(9)
    v_mfma_f32_16x16x32_bf16 a[16:19], a[180:183], a[100:103], a[16:19]
    ds_read_b64_tr_b16 a[192:193], v23 offset:16384
    v_mfma_f32_16x16x32_bf16 a[48:51], a[176:179], a[104:107], a[48:51]
    ds_read_b64_tr_b16 a[194:195], v23 offset:17408
    v_mfma_f32_16x16x32_bf16 a[48:51], a[180:183], a[108:111], a[48:51]
    ds_read_b64_tr_b16 a[196:197], v23 offset:24576
    v_mfma_f32_16x16x32_bf16 a[80:83], a[176:179], a[112:115], a[80:83]
    ds_read_b64_tr_b16 a[198:199], v23 offset:25600
    v_mfma_f32_16x16x32_bf16 a[80:83], a[180:183], a[116:119], a[80:83]
    buffer_load_dwordx4 v25, s[8:11], s48 offen offset:1024 nt lds
    s_add_u32 s33, s33, 128
    v_mfma_f32_16x16x32_bf16 v[48:51], a[176:179], a[120:123], v[48:51]
    v_mfma_f32_16x16x32_bf16 v[48:51], a[180:183], a[124:127], v[48:51]
    v_mfma_f32_16x16x32_bf16 v[80:83], a[176:179], a[128:131], v[80:83]
    v_mfma_f32_16x16x32_bf16 v[80:83], a[180:183], a[132:135], v[80:83]
    s_waitcnt lgkmcnt(11)
    v_mfma_f32_16x16x32_bf16 a[20:23], a[184:187], a[96:99], a[20:23]
    s_waitcnt lgkmcnt(9)
    v_mfma_f32_16x16x32_bf16 a[20:23], a[188:191], a[100:103], a[20:23]
    ds_read_b64_tr_b16 a[200:201], v23 offset:16392
    v_mfma_f32_16x16x32_bf16 a[52:55], a[184:187], a[104:107], a[52:55]
    ds_read_b64_tr_b16 a[202:203], v23 offset:17416
    v_mfma_f32_16x16x32_bf16 a[52:55], a[188:191], a[108:111], a[52:55]
    ds_read_b64_tr_b16 a[204:205], v23 offset:24584
    v_mfma_f32_16x16x32_bf16 a[84:87], a[184:187], a[112:115], a[84:87]
    ds_read_b64_tr_b16 a[206:207], v23 offset:25608
    v_mfma_f32_16x16x32_bf16 a[84:87], a[188:191], a[116:119], a[84:87]
    v_mfma_f32_16x16x32_bf16 v[52:55], a[184:187], a[120:123], v[52:55]
    v_mfma_f32_16x16x32_bf16 v[52:55], a[188:191], a[124:127], v[52:55]
    v_mfma_f32_16x16x32_bf16 v[84:87], a[184:187], a[128:131], v[84:87]
    v_mfma_f32_16x16x32_bf16 v[84:87], a[188:191], a[132:135], v[84:87]
    s_waitcnt lgkmcnt(0)
    s_barrier
    v_mfma_f32_16x16x32_bf16 a[24:27], a[192:195], a[96:99], a[24:27]
    v_mfma_f32_16x16x32_bf16 a[24:27], a[196:199], a[100:103], a[24:27]
    ds_read_b64_tr_b16 a[176:177], v20 offset:32768
    v_mfma_f32_16x16x32_bf16 a[56:59], a[192:195], a[104:107], a[56:59]
    ds_read_b64_tr_b16 a[178:179], v20 offset:33792
    v_mfma_f32_16x16x32_bf16 a[56:59], a[196:199], a[108:111], a[56:59]
    ds_read_b64_tr_b16 a[180:181], v20 offset:40960
    v_mfma_f32_16x16x32_bf16 a[88:91], a[192:195], a[112:115], a[88:91]
    ds_read_b64_tr_b16 a[182:183], v20 offset:41984
    v_mfma_f32_16x16x32_bf16 a[88:91], a[196:199], a[116:119], a[88:91]
    ds_read_b128 a[156:159], v29 offset:45056
    v_mfma_f32_16x16x32_bf16 v[56:59], a[192:195], a[120:123], v[56:59]
    ds_read_b128 a[160:163], v28 offset:47104
    v_mfma_f32_16x16x32_bf16 v[56:59], a[196:199], a[124:127], v[56:59]
    ds_read_b128 a[164:167], v29 offset:47104
    v_mfma_f32_16x16x32_bf16 v[88:91], a[192:195], a[128:131], v[88:91]
    ds_read_b128 a[168:171], v28 offset:49152
    v_mfma_f32_16x16x32_bf16 v[88:91], a[196:199], a[132:135], v[88:91]
    ds_read_b128 a[172:175], v29 offset:49152
    v_mfma_f32_16x16x32_bf16 a[28:31], a[200:203], a[96:99], a[28:31]
    v_mfma_f32_16x16x32_bf16 a[28:31], a[204:207], a[100:103], a[28:31]
    ds_read_b64_tr_b16 a[184:185], v20 offset:32776
    v_mfma_f32_16x16x32_bf16 a[60:63], a[200:203], a[104:107], a[60:63]
    ds_read_b64_tr_b16 a[186:187], v20 offset:33800
    v_mfma_f32_16x16x32_bf16 a[60:63], a[204:207], a[108:111], a[60:63]
    ds_read_b64_tr_b16 a[188:189], v20 offset:40968
    v_mfma_f32_16x16x32_bf16 a[92:95], a[200:203], a[112:115], a[92:95]
    ds_read_b64_tr_b16 a[190:191], v20 offset:41992
    v_mfma_f32_16x16x32_bf16 a[92:95], a[204:207], a[116:119], a[92:95]
    v_mfma_f32_16x16x32_bf16 v[60:63], a[200:203], a[120:123], v[60:63]
    v_mfma_f32_16x16x32_bf16 v[60:63], a[204:207], a[124:127], v[60:63]
    v_mfma_f32_16x16x32_bf16 v[92:95], a[200:203], a[128:131], v[92:95]
    v_mfma_f32_16x16x32_bf16 v[92:95], a[204:207], a[132:135], v[92:95]
    s_sub_u32 s35, s35, 1
    s_cbranch_scc1 L_ql5
    s_waitcnt lgkmcnt(11)
    v_mfma_f32_16x16x32_bf16 v[96:99], a[176:179], a[136:139], v[96:99]
    s_waitcnt lgkmcnt(9)
    v_mfma_f32_16x16x32_bf16 v[96:99], a[180:183], a[140:143], v[96:99]
    ds_read_b64_tr_b16 a[192:193], v21 offset:32768
    v_mfma_f32_16x16x32_bf16 v[128:131], a[176:179], a[144:147], v[128:131]
    ds_read_b64_tr_b16 a[194:195], v21 offset:33792
    v_mfma_f32_16x16x32_bf16 v[128:131], a[180:183], a[148:151], v[128:131]
    ds_read_b64_tr_b16 a[196:197], v21 offset:40960
    v_mfma_f32_16x16x32_bf16 v[160:163], a[176:179], a[152:155], v[160:163]
    ds_read_b64_tr_b16 a[198:199], v21 offset:41984
    s_waitcnt lgkmcnt(12)
    v_mfma_f32_16x16x32_bf16 v[160:163], a[180:183], a[156:159], v[160:163]
    s_add_u32 m0, s34, 40960
    s_add_u32 s48, s33, 0
    s_waitcnt lgkmcnt(11)
    v_mfma_f32_16x16x32_bf16 v[192:195], a[176:179], a[160:163], v[192:195]
    s_waitcnt lgkmcnt(10)
    v_mfma_f32_16x16x32_bf16 v[192:195], a[180:183], a[164:167], v[192:195]
    s_waitcnt lgkmcnt(9)
    v_mfma_f32_16x16x32_bf16 v[224:227], a[176:179], a[168:171], v[224:227]
    s_waitcnt lgkmcnt(8)
    v_mfma_f32_16x16x32_bf16 v[224:227], a[180:183], a[172:175], v[224:227]
    buffer_load_dwordx4 v24, s[8:11], s48 offen offset:0 nt lds
    s_waitcnt lgkmcnt(6)
    v_mfma_f32_16x16x32_bf16 v[100:103], a[184:187], a[136:139], v[100:103]
    s_waitcnt lgkmcnt(4)
    v_mfma_f32_16x16x32_bf16 v[100:103], a[188:191], a[140:143], v[100:103]
    ds_read_b64_tr_b16 a[200:201], v21 offset:32776
    v_mfma_f32_16x16x32_bf16 v[132:135], a[184:187], a[144:147], v[132:135]
    ds_read_b64_tr_b16 a[202:203], v21 offset:33800
    v_mfma_f32_16x16x32_bf16 v[132:135], a[188:191], a[148:151], v[132:135]
    ds_read_b64_tr_b16 a[204:205], v21 offset:40968
    v_mfma_f32_16x16x32_bf16 v[164:167], a[184:187], a[152:155], v[164:167]
    ds_read_b64_tr_b16 a[206:207], v21 offset:41992
    v_mfma_f32_16x16x32_bf16 v[164:167], a[188:191], a[156:159], v[164:167]
    v_mfma_f32_16x16x32_bf16 v[196:199], a[184:187], a[160:163], v[196:199]
    buffer_load_dwordx4 v25, s[8:11], s48 offen offset:1024 nt lds
    v_mfma_f32_16x16x32_bf16 v[196:199], a[188:191], a[164:167], v[196:199]
    v_mfma_f32_16x16x32_bf16 v[228:231], a[184:187], a[168:171], v[228:231]
    v_mfma_f32_16x16x32_bf16 v[228:231], a[188:191], a[172:175], v[228:231]
    s_waitcnt lgkmcnt(6)
    v_mfma_f32_16x16x32_bf16 v[104:107], a[192:195], a[136:139], v[104:107]
    s_waitcnt lgkmcnt(4)
    v_mfma_f32_16x16x32_bf16 v[104:107], a[196:199], a[140:143], v[104:107]
    ds_read_b64_tr_b16 a[176:177], v22 offset:32768
    v_mfma_f32_16x16x32_bf16 v[136:139], a[192:195], a[144:147], v[136:139]
    ds_read_b64_tr_b16 a[178:179], v22 offset:33792
    v_mfma_f32_16x16x32_bf16 v[136:139], a[196:199], a[148:151], v[136:139]
    ds_read_b64_tr_b16 a[180:181], v22 offset:40960
    v_mfma_f32_16x16x32_bf16 v[168:171], a[192:195], a[152:155], v[168:171]
    ds_read_b64_tr_b16 a[182:183], v22 offset:41984
    v_mfma_f32_16x16x32_bf16 v[168:171], a[196:199], a[156:159], v[168:171]
    buffer_load_dwordx4 v26, s[8:11], s48 offen offset:2048 nt lds
    v_mfma_f32_16x16x32_bf16 v[200:203], a[192:195], a[160:163], v[200:203]
    v_mfma_f32_16x16x32_bf16 v[200:203], a[196:199], a[164:167], v[200:203]
    v_mfma_f32_16x16x32_bf16 v[232:235], a[192:195], a[168:171], v[232:235]
    v_mfma_f32_16x16x32_bf16 v[232:235], a[196:199], a[172:175], v[232:235]
    s_waitcnt lgkmcnt(6)
    v_mfma_f32_16x16x32_bf16 v[108:111], a[200:203], a[136:139], v[108:111]
    buffer_load_dwordx4 v27, s[8:11], s48 offen offset:3072 nt lds
    s_waitcnt lgkmcnt(4)
    v_mfma_f32_16x16x32_bf16 v[108:111], a[204:207], a[140:143], v[108:111]
    ds_read_b64_tr_b16 a[184:185], v22 offset:32776
    v_mfma_f32_16x16x32_bf16 v[140:143], a[200:203], a[144:147], v[140:143]
    ds_read_b64_tr_b16 a[186:187], v22 offset:33800
    v_mfma_f32_16x16x32_bf16 v[140:143], a[204:207], a[148:151], v[140:143]
    ds_read_b64_tr_b16 a[188:189], v22 offset:40968
    v_mfma_f32_16x16x32_bf16 v[172:175], a[200:203], a[152:155], v[172:175]
    ds_read_b64_tr_b16 a[190:191], v22 offset:41992
    v_mfma_f32_16x16x32_bf16 v[172:175], a[204:207], a[156:159], v[172:175]
    v_mfma_f32_16x16x32_bf16 v[204:207], a[200:203], a[160:163], v[204:207]
    v_mfma_f32_16x16x32_bf16 v[204:207], a[204:207], a[164:167], v[204:207]
    s_add_u32 m0, s34, 45056
    s_add_u32 s48, s33, 32768
    v_mfma_f32_16x16x32_bf16 v[236:239], a[200:203], a[168:171], v[236:239]
    v_mfma_f32_16x16x32_bf16 v[236:239], a[204:207], a[172:175], v[236:239]
    s_waitcnt lgkmcnt(6)
    v_mfma_f32_16x16x32_bf16 v[112:115], a[176:179], a[136:139], v[112:115]
    s_waitcnt lgkmcnt(4)
    v_mfma_f32_16x16x32_bf16 v[112:115], a[180:183], a[140:143], v[112:115]
    ds_read_b64_tr_b16 a[192:193], v23 offset:32768
    v_mfma_f32_16x16x32_bf16 v[144:147], a[176:179], a[144:147], v[144:147]
    ds_read_b64_tr_b16 a[194:195], v23 offset:33792
    v_mfma_f32_16x16x32_bf16 v[144:147], a[180:183], a[148:151], v[144:147]
    ds_read_b64_tr_b16 a[196:197], v23 offset:40960
    v_mfma_f32_16x16x32_bf16 v[176:179], a[176:179], a[152:155], v[176:179]
    ds_read_b64_tr_b16 a[198:199], v23 offset:41984
    v_mfma_f32_16x16x32_bf16 v[176:179], a[180:183], a[156:159], v[176:179]
    buffer_load_dwordx4 v24, s[8:11], s48 offen offset:0 nt lds
    v_mfma_f32_16x16x32_bf16 v[208:211], a[176:179], a[160:163], v[208:211]
    v_mfma_f32_16x16x32_bf16 v[208:211], a[180:183], a[164:167], v[208:211]
    v_mfma_f32_16x16x32_bf16 v[240:243], a[176:179], a[168:171], v[240:243]
    v_mfma_f32_16x16x32_bf16 v[240:243], a[180:183], a[172:175], v[240:243]
    s_waitcnt lgkmcnt(6)
    v_mfma_f32_16x16x32_bf16 v[116:119], a[184:187], a[136:139], v[116:119]
    s_waitcnt lgkmcnt(4)
    v_mfma_f32_16x16x32_bf16 v[116:119], a[188:191], a[140:143], v[116:119]
    ds_read_b64_tr_b16 a[200:201], v23 offset:32776
    v_mfma_f32_16x16x32_bf16 v[148:151], a[184:187], a[144:147], v[148:151]
    ds_read_b64_tr_b16 a[202:203], v23 offset:33800
    v_mfma_f32_16x16x32_bf16 v[148:151], a[188:191], a[148:151], v[148:151]
    ds_read_b64_tr_b16 a[204:205], v23 offset:40968
    v_mfma_f32_16x16x32_bf16 v[180:183], a[184:187], a[152:155], v[180:183]
    ds_read_b64_tr_b16 a[206:207], v23 offset:41992
    v_mfma_f32_16x16x32_bf16 v[180:183], a[188:191], a[156:159], v[180:183]
    v_mfma_f32_16x16x32_bf16 v[212:215], a[184:187], a[160:163], v[212:215]
    v_mfma_f32_16x16x32_bf16 v[212:215], a[188:191], a[164:167], v[212:215]
    v_mfma_f32_16x16x32_bf16 v[244:247], a[184:187], a[168:171], v[244:247]
    v_mfma_f32_16x16x32_bf16 v[244:247], a[188:191], a[172:175], v[244:247]
    s_waitcnt lgkmcnt(0)
    s_barrier
    v_mfma_f32_16x16x32_bf16 v[120:123], a[192:195], a[136:139], v[120:123]
    v_mfma_f32_16x16x32_bf16 v[120:123], a[196:199], a[140:143], v[120:123]
    ds_read_b64_tr_b16 a[176:177], v20 offset:49152
    v_mfma_f32_16x16x32_bf16 v[152:155], a[192:195], a[144:147], v[152:155]
    ds_read_b64_tr_b16 a[178:179], v20 offset:50176
    v_mfma_f32_16x16x32_bf16 v[152:155], a[196:199], a[148:151], v[152:155]
    ds_read_b64_tr_b16 a[180:181], v20 offset:57344
    v_mfma_f32_16x16x32_bf16 v[184:187], a[192:195], a[152:155], v[184:187]
    ds_read_b64_tr_b16 a[182:183], v20 offset:58368
    v_mfma_f32_16x16x32_bf16 v[184:187], a[196:199], a[156:159], v[184:187]
    v_mfma_f32_16x16x32_bf16 v[216:219], a[192:195], a[160:163], v[216:219]
    v_mfma_f32_16x16x32_bf16 v[216:219], a[196:199], a[164:167], v[216:219]
    v_mfma_f32_16x16x32_bf16 v[248:251], a[192:195], a[168:171], v[248:251]
    v_mfma_f32_16x16x32_bf16 v[248:251], a[196:199], a[172:175], v[248:251]
    v_mfma_f32_16x16x32_bf16 v[124:127], a[200:203], a[136:139], v[124:127]
    v_mfma_f32_16x16x32_bf16 v[124:127], a[204:207], a[140:143], v[124:127]
    ds_read_b64_tr_b16 a[184:185], v20 offset:49160
    v_mfma_f32_16x16x32_bf16 v[156:159], a[200:203], a[144:147], v[156:159]
    ds_read_b64_tr_b16 a[186:187], v20 offset:50184
    v_mfma_f32_16x16x32_bf16 v[156:159], a[204:207], a[148:151], v[156:159]
    ds_read_b64_tr_b16 a[188:189], v20 offset:57352
    v_mfma_f32_16x16x32_bf16 v[188:191], a[200:203], a[152:155], v[188:191]
    ds_read_b64_tr_b16 a[190:191], v20 offset:58376
    v_mfma_f32_16x16x32_bf16 v[188:191], a[204:207], a[156:159], v[188:191]
    v_mfma_f32_16x16x32_bf16 v[220:223], a[200:203], a[160:163], v[220:223]
    v_mfma_f32_16x16x32_bf16 v[220:223], a[204:207], a[164:167], v[220:223]
    v_mfma_f32_16x16x32_bf16 v[252:255], a[200:203], a[168:171], v[252:255]
    v_mfma_f32_16x16x32_bf16 v[252:255], a[204:207], a[172:175], v[252:255]
    s_waitcnt lgkmcnt(6)
    v_mfma_f32_16x16x32_bf16 a[0:3], a[176:179], a[136:139], a[0:3]
    s_waitcnt lgkmcnt(4)
    v_mfma_f32_16x16x32_bf16 a[0:3], a[180:183], a[140:143], a[0:3]
    ds_read_b64_tr_b16 a[192:193], v21 offset:49152
    v_mfma_f32_16x16x32_bf16 a[32:35], a[176:179], a[144:147], a[32:35]
    ds_read_b64_tr_b16 a[194:195], v21 offset:50176
    v_mfma_f32_16x16x32_bf16 a[32:35], a[180:183], a[148:151], a[32:35]
    ds_read_b64_tr_b16 a[196:197], v21 offset:57344
    v_mfma_f32_16x16x32_bf16 a[64:67], a[176:179], a[152:155], a[64:67]
    ds_read_b64_tr_b16 a[198:199], v21 offset:58368
    v_mfma_f32_16x16x32_bf16 a[64:67], a[180:183], a[156:159], a[64:67]
    s_add_u32 m0, s34, 45056
    s_add_u32 s48, s33, 32768
    v_mfma_f32_16x16x32_bf16 v[32:35], a[176:179], a[160:163], v[32:35]
    v_mfma_f32_16x16x32_bf16 v[32:35], a[180:183], a[164:167], v[32:35]
    v_mfma_f32_16x16x32_bf16 v[64:67], a[176:179], a[168:171], v[64:67]
    v_mfma_f32_16x16x32_bf16 v[64:67], a[180:183], a[172:175], v[64:67]
    buffer_load_dwordx4 v25, s[8:11], s48 offen offset:1024 nt lds
    s_waitcnt lgkmcnt(6)
    v_mfma_f32_16x16x32_bf16 a[4:7], a[184:187], a[136:139], a[4:7]
    s_waitcnt lgkmcnt(4)
    v_mfma_f32_16x16x32_bf16 a[4:7], a[188:191], a[140:143], a[4:7]
    ds_read_b64_tr_b16 a[200:201], v21 offset:49160
    v_mfma_f32_16x16x32_bf16 a[36:39], a[184:187], a[144:147], a[36:39]
    ds_read_b64_tr_b16 a[202:203], v21 offset:50184
    v_mfma_f32_16x16x32_bf16 a[36:39], a[188:191], a[148:151], a[36:39]
    ds_read_b64_tr_b16 a[204:205], v21 offset:57352
    v_mfma_f32_16x16x32_bf16 a[68:71], a[184:187], a[152:155], a[68:71]
    ds_read_b64_tr_b16 a[206:207], v21 offset:58376
    v_mfma_f32_16x16x32_bf16 a[68:71], a[188:191], a[156:159], a[68:71]
    v_mfma_f32_16x16x32_bf16 v[36:39], a[184:187], a[160:163], v[36:39]
    buffer_load_dwordx4 v26, s[8:11], s48 offen offset:2048 nt lds
    v_mfma_f32_16x16x32_bf16 v[36:39], a[188:191], a[164:167], v[36:39]
    v_mfma_f32_16x16x32_bf16 v[68:71], a[184:187], a[168:171], v[68:71]
    v_mfma_f32_16x16x32_bf16 v[68:71], a[188:191], a[172:175], v[68:71]
    s_waitcnt lgkmcnt(6)
    v_mfma_f32_16x16x32_bf16 a[8:11], a[192:195], a[136:139], a[8:11]
    s_waitcnt lgkmcnt(4)
    v_mfma_f32_16x16x32_bf16 a[8:11], a[196:199], a[140:143], a[8:11]
    ds_read_b64_tr_b16 a[176:177], v22 offset:49152
    v_mfma_f32_16x16x32_bf16 a[40:43], a[192:195], a[144:147], a[40:43]
    ds_read_b64_tr_b16 a[178:179], v22 offset:50176
    v_mfma_f32_16x16x32_bf16 a[40:43], a[196:199], a[148:151], a[40:43]
    ds_read_b64_tr_b16 a[180:181], v22 offset:57344
    v_mfma_f32_16x16x32_bf16 a[72:75], a[192:195], a[152:155], a[72:75]
    ds_read_b64_tr_b16 a[182:183], v22 offset:58368
    v_mfma_f32_16x16x32_bf16 a[72:75], a[196:199], a[156:159], a[72:75]
    buffer_load_dwordx4 v27, s[8:11], s48 offen offset:3072 nt lds
    v_mfma_f32_16x16x32_bf16 v[40:43], a[192:195], a[160:163], v[40:43]
    v_mfma_f32_16x16x32_bf16 v[40:43], a[196:199], a[164:167], v[40:43]
    v_mfma_f32_16x16x32_bf16 v[72:75], a[192:195], a[168:171], v[72:75]
    v_mfma_f32_16x16x32_bf16 v[72:75], a[196:199], a[172:175], v[72:75]
    s_waitcnt vmcnt(8)
    s_waitcnt lgkmcnt(6)
    v_mfma_f32_16x16x32_bf16 a[12:15], a[200:203], a[136:139], a[12:15]
    s_add_u32 m0, s34, 49152
    s_add_u32 s48, s33, 65536
    s_waitcnt lgkmcnt(4)
    v_mfma_f32_16x16x32_bf16 a[12:15], a[204:207], a[140:143], a[12:15]
    ds_read_b64_tr_b16 a[184:185], v22 offset:49160
    v_mfma_f32_16x16x32_bf16 a[44:47], a[200:203], a[144:147], a[44:47]
    ds_read_b64_tr_b16 a[186:187], v22 offset:50184
    v_mfma_f32_16x16x32_bf16 a[44:47], a[204:207], a[148:151], a[44:47]
    ds_read_b64_tr_b16 a[188:189], v22 offset:57352
    v_mfma_f32_16x16x32_bf16 a[76:79], a[200:203], a[152:155], a[76:79]
    ds_read_b64_tr_b16 a[190:191], v22 offset:58376
    v_mfma_f32_16x16x32_bf16 a[76:79], a[204:207], a[156:159], a[76:79]
    ds_read_b128 a[96:99], v28 offset:0
    v_mfma_f32_16x16x32_bf16 v[44:47], a[200:203], a[160:163], v[44:47]
    ds_read_b128 a[100:103], v29 offset:0
    v_mfma_f32_16x16x32_bf16 v[44:47], a[204:207], a[164:167], v[44:47]
    buffer_load_dwordx4 v24, s[8:11], s48 offen offset:0 nt lds
    v_mfma_f32_16x16x32_bf16 v[76:79], a[200:203], a[168:171], v[76:79]
    ds_read_b128 a[104:107], v28 offset:2048
    v_mfma_f32_16x16x32_bf16 v[76:79], a[204:207], a[172:175], v[76:79]
    ds_read_b128 a[108:111], v29 offset:2048
    s_waitcnt lgkmcnt(10)
    v_mfma_f32_16x16x32_bf16 a[16:19], a[176:179], a[136:139], a[16:19]
    ds_read_b128 a[112:115], v28 offset:4096
    s_waitcnt lgkmcnt(9)
    v_mfma_f32_16x16x32_bf16 a[16:19], a[180:183], a[140:143], a[16:19]
    ds_read_b64_tr_b16 a[192:193], v23 offset:49152
    v_mfma_f32_16x16x32_bf16 a[48:51], a[176:179], a[144:147], a[48:51]
    ds_read_b64_tr_b16 a[194:195], v23 offset:50176
    v_mfma_f32_16x16x32_bf16 a[48:51], a[180:183], a[148:151], a[48:51]
    ds_read_b64_tr_b16 a[196:197], v23 offset:57344
    v_mfma_f32_16x16x32_bf16 a[80:83], a[176:179], a[152:155], a[80:83]
    ds_read_b64_tr_b16 a[198:199], v23 offset:58368
    v_mfma_f32_16x16x32_bf16 a[80:83], a[180:183], a[156:159], a[80:83]
    buffer_load_dwordx4 v25, s[8:11], s48 offen offset:1024 nt lds
    s_add_u32 s33, s33, 128
    v_mfma_f32_16x16x32_bf16 v[48:51], a[176:179], a[160:163], v[48:51]
    v_mfma_f32_16x16x32_bf16 v[48:51], a[180:183], a[164:167], v[48:51]
    v_mfma_f32_16x16x32_bf16 v[80:83], a[176:179], a[168:171], v[80:83]
    v_mfma_f32_16x16x32_bf16 v[80:83], a[180:183], a[172:175], v[80:83]
    s_waitcnt lgkmcnt(11)
    v_mfma_f32_16x16x32_bf16 a[20:23], a[184:187], a[136:139], a[20:23]
    s_waitcnt lgkmcnt(9)
    v_mfma_f32_16x16x32_bf16 a[20:23], a[188:191], a[140:143], a[20:23]
    ds_read_b64_tr_b16 a[200:201], v23 offset:49160
    v_mfma_f32_16x16x32_bf16 a[52:55], a[184:187], a[144:147], a[52:55]
    ds_read_b64_tr_b16 a[202:203], v23 offset:50184
    v_mfma_f32_16x16x32_bf16 a[52:55], a[188:191], a[148:151], a[52:55]
    ds_read_b64_tr_b16 a[204:205], v23 offset:57352
    v_mfma_f32_16x16x32_bf16 a[84:87], a[184:187], a[152:155], a[84:87]
    ds_read_b64_tr_b16 a[206:207], v23 offset:58376
    v_mfma_f32_16x16x32_bf16 a[84:87], a[188:191], a[156:159], a[84:87]
    v_mfma_f32_16x16x32_bf16 v[52:55], a[184:187], a[160:163], v[52:55]
    v_mfma_f32_16x16x32_bf16 v[52:55], a[188:191], a[164:167], v[52:55]
    v_mfma_f32_16x16x32_bf16 v[84:87], a[184:187], a[168:171], v[84:87]
    v_mfma_f32_16x16x32_bf16 v[84:87], a[188:191], a[172:175], v[84:87]
    s_waitcnt lgkmcnt(0)
    s_barrier
    v_mfma_f32_16x16x32_bf16 a[24:27], a[192:195], a[136:139], a[24:27]
    v_mfma_f32_16x16x32_bf16 a[24:27], a[196:199], a[140:143], a[24:27]
    ds_read_b64_tr_b16 a[176:177], v20 offset:0
    v_mfma_f32_16x16x32_bf16 a[56:59], a[192:195], a[144:147], a[56:59]
    ds_read_b64_tr_b16 a[178:179], v20 offset:1024
    v_mfma_f32_16x16x32_bf16 a[56:59], a[196:199], a[148:151], a[56:59]
    ds_read_b64_tr_b16 a[180:181], v20 offset:8192
    v_mfma_f32_16x16x32_bf16 a[88:91], a[192:195], a[152:155], a[88:91]
    ds_read_b64_tr_b16 a[182:183], v20 offset:9216
    v_mfma_f32_16x16x32_bf16 a[88:91], a[196:199], a[156:159], a[88:91]
    ds_read_b128 a[116:119], v29 offset:4096
    v_mfma_f32_16x16x32_bf16 v[56:59], a[192:195], a[160:163], v[56:59]
    ds_read_b128 a[120:123], v28 offset:6144
    v_mfma_f32_16x16x32_bf16 v[56:59], a[196:199], a[164:167], v[56:59]
    ds_read_b128 a[124:127], v29 offset:6144
    v_mfma_f32_16x16x32_bf16 v[88:91], a[192:195], a[168:171], v[88:91]
    ds_read_b128 a[128:131], v28 offset:8192
    v_mfma_f32_16x16x32_bf16 v[88:91], a[196:199], a[172:175], v[88:91]
    ds_read_b128 a[132:135], v29 offset:8192
    v_mfma_f32_16x16x32_bf16 a[28:31], a[200:203], a[136:139], a[28:31]
    v_mfma_f32_16x16x32_bf16 a[28:31], a[204:207], a[140:143], a[28:31]
    ds_read_b64_tr_b16 a[184:185], v20 offset:8
    v_mfma_f32_16x16x32_bf16 a[60:63], a[200:203], a[144:147], a[60:63]
    ds_read_b64_tr_b16 a[186:187], v20 offset:1032
    v_mfma_f32_16x16x32_bf16 a[60:63], a[204:207], a[148:151], a[60:63]
    ds_read_b64_tr_b16 a[188:189], v20 offset:8200
    v_mfma_f32_16x16x32_bf16 a[92:95], a[200:203], a[152:155], a[92:95]
    ds_read_b64_tr_b16 a[190:191], v20 offset:9224
    v_mfma_f32_16x16x32_bf16 a[92:95], a[204:207], a[156:159], a[92:95]
    v_mfma_f32_16x16x32_bf16 v[60:63], a[200:203], a[160:163], v[60:63]
    v_mfma_f32_16x16x32_bf16 v[60:63], a[204:207], a[164:167], v[60:63]
    v_mfma_f32_16x16x32_bf16 v[92:95], a[200:203], a[168:171], v[92:95]
    v_mfma_f32_16x16x32_bf16 v[92:95], a[204:207], a[172:175], v[92:95]
    s_branch L_q5
L_ql5:
    s_waitcnt lgkmcnt(11)
    v_mfma_f32_16x16x32_bf16 v[96:99], a[176:179], a[136:139], v[96:99]
    s_waitcnt lgkmcnt(9)
    v_mfma_f32_16x16x32_bf16 v[96:99], a[180:183], a[140:143], v[96:99]
    ds_read_b64_tr_b16 a[192:193], v21 offset:32768
    v_mfma_f32_16x16x32_bf16 v[128:131], a[176:179], a[144:147], v[128:131]
    ds_read_b64_tr_b16 a[194:195], v21 offset:33792
    v_mfma_f32_16x16x32_bf16 v[128:131], a[180:183], a[148:151], v[128:131]
    ds_read_b64_tr_b16 a[196:197], v21 offset:40960
    v_and_b32 v1, 63, v0
    v_lshlrev_b32 v24, 4, v1
    v_mfma_f32_16x16x32_bf16 v[160:163], a[176:179], a[152:155], v[160:163]
    ds_read_b64_tr_b16 a[198:199], v21 offset:41984
    s_waitcnt lgkmcnt(12)
    v_mfma_f32_16x16x32_bf16 v[160:163], a[180:183], a[156:159], v[160:163]
    s_add_u32 s70, s71, 8192
    s_add_u32 s68, s50, 525312
    s_waitcnt lgkmcnt(11)
    v_mfma_f32_16x16x32_bf16 v[192:195], a[176:179], a[160:163], v[192:195]
    s_waitcnt lgkmcnt(10)
    v_mfma_f32_16x16x32_bf16 v[192:195], a[180:183], a[164:167], v[192:195]
    v_add_u32 v27, s96, v24
    v_add_u32 v25, 12288, v27
    s_waitcnt lgkmcnt(9)
    v_mfma_f32_16x16x32_bf16 v[224:227], a[176:179], a[168:171], v[224:227]
    s_waitcnt lgkmcnt(8)
    v_mfma_f32_16x16x32_bf16 v[224:227], a[180:183], a[172:175], v[224:227]
    v_mul_f32 v128, s38, v128
    s_waitcnt lgkmcnt(4)
    v_mfma_f32_16x16x32_bf16 v[100:103], a[184:187], a[136:139], v[100:103]
    s_add_u32 s4, s60, s46
    s_addc_u32 s5, s61, 0
    v_mfma_f32_16x16x32_bf16 v[100:103], a[188:191], a[140:143], v[100:103]
    ds_read_b64_tr_b16 a[200:201], v21 offset:32776
    v_mul_f32 v160, s38, v160
    v_mfma_f32_16x16x32_bf16 v[132:135], a[184:187], a[144:147], v[132:135]
    ds_read_b64_tr_b16 a[202:203], v21 offset:33800
    v_mul_f32 v161, s38, v161
    v_mfma_f32_16x16x32_bf16 v[132:135], a[188:191], a[148:151], v[132:135]
    ds_read_b64_tr_b16 a[204:205], v21 offset:40968
    v_mul_f32 v192, s38, v192
    v_mfma_f32_16x16x32_bf16 v[164:167], a[184:187], a[152:155], v[164:167]
    ds_read_b64_tr_b16 a[206:207], v21 offset:41992
    s_add_u32 s8, s60, s55
    s_addc_u32 s9, s61, 0
    v_mfma_f32_16x16x32_bf16 v[164:167], a[188:191], a[156:159], v[164:167]
    s_mov_b32 s6, 0x80000
    s_mov_b32 s10, 2495232
    v_mfma_f32_16x16x32_bf16 v[196:199], a[184:187], a[160:163], v[196:199]
    v_mul_f32 v224, s38, v224
    v_mul_f32 v225, s38, v225
    v_mfma_f32_16x16x32_bf16 v[196:199], a[188:191], a[164:167], v[196:199]
    v_mul_f32 v226, s38, v226
    v_mul_f32 v227, s38, v227
    v_mfma_f32_16x16x32_bf16 v[228:231], a[184:187], a[168:171], v[228:231]
    s_mov_b32 s35, 8
    v_mfma_f32_16x16x32_bf16 v[228:231], a[188:191], a[172:175], v[228:231]
    v_mul_f32 v193, s38, v193
    s_waitcnt lgkmcnt(4)
    v_mfma_f32_16x16x32_bf16 v[104:107], a[192:195], a[136:139], v[104:107]
    v_mul_f32 v194, s38, v194
    v_mul_f32 v195, s38, v195
    v_mfma_f32_16x16x32_bf16 v[104:107], a[196:199], a[140:143], v[104:107]
    ds_read_b64_tr_b16 a[176:177], v22 offset:32768
    v_mul_f32 v162, s38, v162
    v_mfma_f32_16x16x32_bf16 v[136:139], a[192:195], a[144:147], v[136:139]
    ds_read_b64_tr_b16 a[178:179], v22 offset:33792
    v_mul_f32 v163, s38, v163
    v_mfma_f32_16x16x32_bf16 v[136:139], a[196:199], a[148:151], v[136:139]
    ds_read_b64_tr_b16 a[180:181], v22 offset:40960
    v_mul_f32 v196, s38, v196
    v_mfma_f32_16x16x32_bf16 v[168:171], a[192:195], a[152:155], v[168:171]
    ds_read_b64_tr_b16 a[182:183], v22 offset:41984
    v_mul_f32 v197, s38, v197
    v_mfma_f32_16x16x32_bf16 v[168:171], a[196:199], a[156:159], v[168:171]
    v_mul_f32 v228, s38, v228
    v_mul_f32 v229, s38, v229
    v_mfma_f32_16x16x32_bf16 v[200:203], a[192:195], a[160:163], v[200:203]
    v_mul_f32 v230, s38, v230
    v_mul_f32 v231, s38, v231
    v_mfma_f32_16x16x32_bf16 v[200:203], a[196:199], a[164:167], v[200:203]
    v_mul_f32 v198, s38, v198
    v_mul_f32 v199, s38, v199
    v_mfma_f32_16x16x32_bf16 v[232:235], a[192:195], a[168:171], v[232:235]
    v_mul_f32 v164, s38, v164
    v_mul_f32 v165, s38, v165
    v_mfma_f32_16x16x32_bf16 v[232:235], a[196:199], a[172:175], v[232:235]
    v_mul_f32 v166, s38, v166
    s_waitcnt vmcnt(0) lgkmcnt(4)
    v_mfma_f32_16x16x32_bf16 v[108:111], a[200:203], a[136:139], v[108:111]
    v_mul_f32 v167, s38, v167
    v_mul_f32 v136, s38, v136
    v_mfma_f32_16x16x32_bf16 v[108:111], a[204:207], a[140:143], v[108:111]
    ds_read_b64_tr_b16 a[184:185], v22 offset:32776
    v_mul_f32 v168, s38, v168
    v_mfma_f32_16x16x32_bf16 v[140:143], a[200:203], a[144:147], v[140:143]
    ds_read_b64_tr_b16 a[186:187], v22 offset:33800
    v_mul_f32 v169, s38, v169
    v_mfma_f32_16x16x32_bf16 v[140:143], a[204:207], a[148:151], v[140:143]
    ds_read_b64_tr_b16 a[188:189], v22 offset:40968
    v_mul_f32 v200, s38, v200
    v_mfma_f32_16x16x32_bf16 v[172:175], a[200:203], a[152:155], v[172:175]
    ds_read_b64_tr_b16 a[190:191], v22 offset:41992
    v_mul_f32 v201, s38, v201
    v_mfma_f32_16x16x32_bf16 v[172:175], a[204:207], a[156:159], v[172:175]
    ds_read_b64_tr_b16 a[96:97], v2 offset:0
    v_mul_f32 v232, s38, v232
    v_mfma_f32_16x16x32_bf16 v[204:207], a[200:203], a[160:163], v[204:207]
    ds_read_b64_tr_b16 a[98:99], v2 offset:2048
    v_mul_f32 v233, s38, v233
    v_mfma_f32_16x16x32_bf16 v[204:207], a[204:207], a[164:167], v[204:207]
    ds_read_b64_tr_b16 a[100:101], v2 offset:8
    v_mul_f32 v234, s38, v234
    v_mfma_f32_16x16x32_bf16 v[236:239], a[200:203], a[168:171], v[236:239]
    ds_read_b64_tr_b16 a[102:103], v2 offset:2056
    v_mul_f32 v235, s38, v235
    v_mfma_f32_16x16x32_bf16 v[236:239], a[204:207], a[172:175], v[236:239]
    v_mul_f32 v202, s38, v202
    s_waitcnt lgkmcnt(4)
    v_mfma_f32_16x16x32_bf16 v[112:115], a[176:179], a[136:139], v[112:115]
    v_mul_f32 v203, s38, v203
    v_mul_f32 v170, s38, v170
    v_mfma_f32_16x16x32_bf16 v[112:115], a[180:183], a[140:143], v[112:115]
    ds_read_b64_tr_b16 a[192:193], v23 offset:32768
    v_mul_f32 v171, s38, v171
    v_mfma_f32_16x16x32_bf16 v[144:147], a[176:179], a[144:147], v[144:147]
    ds_read_b64_tr_b16 a[194:195], v23 offset:33792
    v_mul_f32 v172, s38, v172
    v_mfma_f32_16x16x32_bf16 v[144:147], a[180:183], a[148:151], v[144:147]
    ds_read_b64_tr_b16 a[196:197], v23 offset:40960
    v_mul_f32 v204, s38, v204
    v_mfma_f32_16x16x32_bf16 v[176:179], a[176:179], a[152:155], v[176:179]
    ds_read_b64_tr_b16 a[198:199], v23 offset:41984
    v_mul_f32 v205, s38, v205
    v_mfma_f32_16x16x32_bf16 v[176:179], a[180:183], a[156:159], v[176:179]
    ds_read_b64_tr_b16 a[104:105], v3 offset:0
    v_mul_f32 v236, s38, v236
    v_mfma_f32_16x16x32_bf16 v[208:211], a[176:179], a[160:163], v[208:211]
    ds_read_b64_tr_b16 a[106:107], v3 offset:2048
    v_mul_f32 v237, s38, v237
    v_mfma_f32_16x16x32_bf16 v[208:211], a[180:183], a[164:167], v[208:211]
    ds_read_b64_tr_b16 a[108:109], v3 offset:8
    v_mul_f32 v238, s38, v238
    v_mfma_f32_16x16x32_bf16 v[240:243], a[176:179], a[168:171], v[240:243]
    ds_read_b64_tr_b16 a[110:111], v3 offset:2056
    v_mul_f32 v239, s38, v239
    v_mfma_f32_16x16x32_bf16 v[240:243], a[180:183], a[172:175], v[240:243]
    v_mul_f32 v206, s38, v206
    s_waitcnt lgkmcnt(4)
    v_mfma_f32_16x16x32_bf16 v[116:119], a[184:187], a[136:139], v[116:119]
    buffer_store_dwordx4 a[96:99], v24, s[20:23], s71 offen offset:0 sc1
    v_mfma_f32_16x16x32_bf16 v[116:119], a[188:191], a[140:143], v[116:119]
    ds_read_b64_tr_b16 a[200:201], v23 offset:32776
    v_mul_f32 v207, s38, v207
    v_mfma_f32_16x16x32_bf16 v[148:151], a[184:187], a[144:147], v[148:151]
    ds_read_b64_tr_b16 a[202:203], v23 offset:33800
    v_mul_f32 v176, s38, v176
    v_mfma_f32_16x16x32_bf16 v[148:151], a[188:191], a[148:151], v[148:151]
    ds_read_b64_tr_b16 a[204:205], v23 offset:40968
    v_mul_f32 v208, s38, v208
    v_mfma_f32_16x16x32_bf16 v[180:183], a[184:187], a[152:155], v[180:183]
    ds_read_b64_tr_b16 a[206:207], v23 offset:41992
    v_mul_f32 v209, s38, v209
    v_mfma_f32_16x16x32_bf16 v[180:183], a[188:191], a[156:159], v[180:183]
    v_mul_f32 v240, s38, v240
    v_mul_f32 v241, s38, v241
    v_mfma_f32_16x16x32_bf16 v[212:215], a[184:187], a[160:163], v[212:215]
    v_mul_f32 v242, s38, v242
    v_mul_f32 v243, s38, v243
    v_mfma_f32_16x16x32_bf16 v[212:215], a[188:191], a[164:167], v[212:215]
    v_mul_f32 v210, s38, v210
    v_mul_f32 v211, s38, v211
    v_mfma_f32_16x16x32_bf16 v[244:247], a[184:187], a[168:171], v[244:247]
    v_mul_f32 v177, s38, v177
    v_mul_f32 v178, s38, v178
    v_mfma_f32_16x16x32_bf16 v[244:247], a[188:191], a[172:175], v[244:247]
    s_waitcnt lgkmcnt(0)
    s_barrier
    v_mfma_f32_16x16x32_bf16 v[120:123], a[192:195], a[136:139], v[120:123]
    v_mul_f32 v179, s38, v179
    v_mul_f32 v173, s38, v173
    v_mfma_f32_16x16x32_bf16 v[120:123], a[196:199], a[140:143], v[120:123]
    ds_read_b64_tr_b16 a[176:177], v20 offset:49152
    v_mul_f32 v180, s38, v180
    v_mfma_f32_16x16x32_bf16 v[152:155], a[192:195], a[144:147], v[152:155]
    ds_read_b64_tr_b16 a[178:179], v20 offset:50176
    v_mul_f32 v181, s38, v181
    v_mfma_f32_16x16x32_bf16 v[152:155], a[196:199], a[148:151], v[152:155]
    ds_read_b64_tr_b16 a[180:181], v20 offset:57344
    v_mul_f32 v212, s38, v212
    v_mfma_f32_16x16x32_bf16 v[184:187], a[192:195], a[152:155], v[184:187]
    ds_read_b64_tr_b16 a[182:183], v20 offset:58368
    v_mul_f32 v213, s38, v213
    v_mfma_f32_16x16x32_bf16 v[184:187], a[196:199], a[156:159], v[184:187]
    ds_read_b64_tr_b16 a[208:209], v2 offset:4096
    v_mul_f32 v244, s38, v244
    v_mfma_f32_16x16x32_bf16 v[216:219], a[192:195], a[160:163], v[216:219]
    ds_read_b64_tr_b16 a[210:211], v2 offset:6144
    v_mul_f32 v245, s38, v245
    v_mfma_f32_16x16x32_bf16 v[216:219], a[196:199], a[164:167], v[216:219]
    ds_read_b64_tr_b16 a[212:213], v2 offset:4104
    v_mul_f32 v246, s38, v246
    v_mfma_f32_16x16x32_bf16 v[248:251], a[192:195], a[168:171], v[248:251]
    ds_read_b64_tr_b16 a[214:215], v2 offset:6152
    v_mul_f32 v247, s38, v247
    v_mfma_f32_16x16x32_bf16 v[248:251], a[196:199], a[172:175], v[248:251]
    v_mul_f32 v214, s38, v214
    v_mul_f32 v215, s38, v215
    v_mfma_f32_16x16x32_bf16 v[124:127], a[200:203], a[136:139], v[124:127]
    buffer_store_dwordx4 a[100:103], v24, s[20:23], s71 offen offset:1024 sc1
    v_mfma_f32_16x16x32_bf16 v[124:127], a[204:207], a[140:143], v[124:127]
    ds_read_b64_tr_b16 a[184:185], v20 offset:49160
    v_mul_f32 v184, s38, v184
    v_mfma_f32_16x16x32_bf16 v[156:159], a[200:203], a[144:147], v[156:159]
    ds_read_b64_tr_b16 a[186:187], v20 offset:50184
    v_mul_f32 v185, s38, v185
    v_mfma_f32_16x16x32_bf16 v[156:159], a[204:207], a[148:151], v[156:159]
    ds_read_b64_tr_b16 a[188:189], v20 offset:57352
    v_mul_f32 v216, s38, v216
    v_mfma_f32_16x16x32_bf16 v[188:191], a[200:203], a[152:155], v[188:191]
    ds_read_b64_tr_b16 a[190:191], v20 offset:58376
    v_mul_f32 v217, s38, v217
    v_mfma_f32_16x16x32_bf16 v[188:191], a[204:207], a[156:159], v[188:191]
    ds_read_b64_tr_b16 a[216:217], v3 offset:4096
    v_mul_f32 v248, s38, v248
    v_mfma_f32_16x16x32_bf16 v[220:223], a[200:203], a[160:163], v[220:223]
    ds_read_b64_tr_b16 a[218:219], v3 offset:6144
    v_mul_f32 v249, s38, v249
    v_mfma_f32_16x16x32_bf16 v[220:223], a[204:207], a[164:167], v[220:223]
    ds_read_b64_tr_b16 a[220:221], v3 offset:4104
    v_mul_f32 v250, s38, v250
    v_mfma_f32_16x16x32_bf16 v[252:255], a[200:203], a[168:171], v[252:255]
    ds_read_b64_tr_b16 a[222:223], v3 offset:6152
    v_mul_f32 v251, s38, v251
    v_mfma_f32_16x16x32_bf16 v[252:255], a[204:207], a[172:175], v[252:255]
    v_mul_f32 v218, s38, v218
    s_waitcnt lgkmcnt(4)
    v_mfma_f32_16x16x32_bf16 a[0:3], a[176:179], a[136:139], a[0:3]
    v_mul_f32 v219, s38, v219
    v_mul_f32 v186, s38, v186
    v_mfma_f32_16x16x32_bf16 a[0:3], a[180:183], a[140:143], a[0:3]
    ds_read_b64_tr_b16 a[192:193], v21 offset:49152
    v_mul_f32 v187, s38, v187
    v_mfma_f32_16x16x32_bf16 a[32:35], a[176:179], a[144:147], a[32:35]
    ds_read_b64_tr_b16 a[194:195], v21 offset:50176
    v_mul_f32 v188, s38, v188
    v_mfma_f32_16x16x32_bf16 a[32:35], a[180:183], a[148:151], a[32:35]
    ds_read_b64_tr_b16 a[196:197], v21 offset:57344
    v_mul_f32 v220, s38, v220
    v_mfma_f32_16x16x32_bf16 a[64:67], a[176:179], a[152:155], a[64:67]
    ds_read_b64_tr_b16 a[198:199], v21 offset:58368
    v_mul_f32 v221, s38, v221
    v_mfma_f32_16x16x32_bf16 a[64:67], a[180:183], a[156:159], a[64:67]
    v_mul_f32 v252, s38, v252
    v_mul_f32 v253, s38, v253
    v_mfma_f32_16x16x32_bf16 v[32:35], a[176:179], a[160:163], v[32:35]
    v_mul_f32 v254, s38, v254
    v_mul_f32 v255, s38, v255
    v_mfma_f32_16x16x32_bf16 v[32:35], a[180:183], a[164:167], v[32:35]
    v_cvt_pk_bf16_f32 v255, v254, v255
    v_cvt_pk_bf16_f32 v254, v252, v253
    v_mfma_f32_16x16x32_bf16 v[64:67], a[176:179], a[168:171], v[64:67]
    v_cvt_pk_bf16_f32 v253, v250, v251
    v_cvt_pk_bf16_f32 v252, v248, v249
    v_mfma_f32_16x16x32_bf16 v[64:67], a[180:183], a[172:175], v[64:67]
    v_cvt_pk_bf16_f32 v251, v246, v247
    s_waitcnt lgkmcnt(4)
    v_mfma_f32_16x16x32_bf16 a[4:7], a[184:187], a[136:139], a[4:7]
    v_cvt_pk_bf16_f32 v250, v244, v245
    v_cvt_pk_bf16_f32 v249, v242, v243
    v_mfma_f32_16x16x32_bf16 a[4:7], a[188:191], a[140:143], a[4:7]
    ds_read_b64_tr_b16 a[200:201], v21 offset:49160
    v_cvt_pk_bf16_f32 v248, v240, v241
    v_mfma_f32_16x16x32_bf16 a[36:39], a[184:187], a[144:147], a[36:39]
    ds_read_b64_tr_b16 a[202:203], v21 offset:50184
    v_cvt_pk_bf16_f32 v247, v238, v239
    v_mfma_f32_16x16x32_bf16 a[36:39], a[188:191], a[148:151], a[36:39]
    ds_read_b64_tr_b16 a[204:205], v21 offset:57352
    v_cvt_pk_bf16_f32 v246, v236, v237
    v_mfma_f32_16x16x32_bf16 a[68:71], a[184:187], a[152:155], a[68:71]
    ds_read_b64_tr_b16 a[206:207], v21 offset:58376
    v_cvt_pk_bf16_f32 v245, v234, v235
    v_mfma_f32_16x16x32_bf16 a[68:71], a[188:191], a[156:159], a[68:71]
    buffer_store_dwordx4 a[104:107], v24, s[20:23], s71 offen offset:2048 sc1
    v_mfma_f32_16x16x32_bf16 v[36:39], a[184:187], a[160:163], v[36:39]
    v_cvt_pk_bf16_f32 v244, v232, v233
    v_cvt_pk_bf16_f32 v243, v230, v231
    v_mfma_f32_16x16x32_bf16 v[36:39], a[188:191], a[164:167], v[36:39]
    v_cvt_pk_bf16_f32 v242, v228, v229
    v_cvt_pk_bf16_f32 v241, v226, v227
    v_mfma_f32_16x16x32_bf16 v[68:71], a[184:187], a[168:171], v[68:71]
    v_cvt_pk_bf16_f32 v240, v224, v225
    v_mul_f32 v222, s38, v222
    v_mfma_f32_16x16x32_bf16 v[68:71], a[188:191], a[172:175], v[68:71]
    v_mul_f32 v223, s38, v223
    s_waitcnt lgkmcnt(4)
    v_mfma_f32_16x16x32_bf16 a[8:11], a[192:195], a[136:139], a[8:11]
    v_cvt_pk_bf16_f32 v239, v222, v223
    v_cvt_pk_bf16_f32 v238, v220, v221
    v_mfma_f32_16x16x32_bf16 a[8:11], a[196:199], a[140:143], a[8:11]
    ds_read_b64_tr_b16 a[176:177], v22 offset:49152
    v_cvt_pk_bf16_f32 v237, v218, v219
    v_mfma_f32_16x16x32_bf16 a[40:43], a[192:195], a[144:147], a[40:43]
    ds_read_b64_tr_b16 a[178:179], v22 offset:50176
    v_cvt_pk_bf16_f32 v236, v216, v217
    v_mfma_f32_16x16x32_bf16 a[40:43], a[196:199], a[148:151], a[40:43]
    ds_read_b64_tr_b16 a[180:181], v22 offset:57344
    v_cvt_pk_bf16_f32 v235, v214, v215
    v_mfma_f32_16x16x32_bf16 a[72:75], a[192:195], a[152:155], a[72:75]
    ds_read_b64_tr_b16 a[182:183], v22 offset:58368
    v_cvt_pk_bf16_f32 v234, v212, v213
    v_mfma_f32_16x16x32_bf16 a[72:75], a[196:199], a[156:159], a[72:75]
    v_cvt_pk_bf16_f32 v233, v210, v211
    v_cvt_pk_bf16_f32 v232, v208, v209
    v_mfma_f32_16x16x32_bf16 v[40:43], a[192:195], a[160:163], v[40:43]
    v_cvt_pk_bf16_f32 v231, v206, v207
    v_cvt_pk_bf16_f32 v230, v204, v205
    v_mfma_f32_16x16x32_bf16 v[40:43], a[196:199], a[164:167], v[40:43]
    v_cvt_pk_bf16_f32 v229, v202, v203
    v_cvt_pk_bf16_f32 v228, v200, v201
    v_mfma_f32_16x16x32_bf16 v[72:75], a[192:195], a[168:171], v[72:75]
    v_cvt_pk_bf16_f32 v227, v198, v199
    v_cvt_pk_bf16_f32 v226, v196, v197
    v_mfma_f32_16x16x32_bf16 v[72:75], a[196:199], a[172:175], v[72:75]
    v_cvt_pk_bf16_f32 v225, v194, v195
    s_waitcnt lgkmcnt(4)
    v_mfma_f32_16x16x32_bf16 a[12:15], a[200:203], a[136:139], a[12:15]
    v_cvt_pk_bf16_f32 v224, v192, v193
    v_mul_f32 v189, s38, v189
    v_mfma_f32_16x16x32_bf16 a[12:15], a[204:207], a[140:143], a[12:15]
    ds_read_b64_tr_b16 a[184:185], v22 offset:49160
    v_mul_f32 v190, s38, v190
    v_mfma_f32_16x16x32_bf16 a[44:47], a[200:203], a[144:147], a[44:47]
    ds_read_b64_tr_b16 a[186:187], v22 offset:50184
    v_mul_f32 v191, s38, v191
    v_mfma_f32_16x16x32_bf16 a[44:47], a[204:207], a[148:151], a[44:47]
    ds_read_b64_tr_b16 a[188:189], v22 offset:57352
    v_cvt_pk_bf16_f32 v223, v190, v191
    v_mfma_f32_16x16x32_bf16 a[76:79], a[200:203], a[152:155], a[76:79]
    ds_read_b64_tr_b16 a[190:191], v22 offset:58376
    v_cvt_pk_bf16_f32 v222, v188, v189
    v_mfma_f32_16x16x32_bf16 a[76:79], a[204:207], a[156:159], a[76:79]
    buffer_store_dwordx4 a[108:111], v24, s[20:23], s71 offen offset:3072 sc1
    v_mfma_f32_16x16x32_bf16 v[44:47], a[200:203], a[160:163], v[44:47]
    v_cvt_pk_bf16_f32 v221, v186, v187
    v_cvt_pk_bf16_f32 v220, v184, v185
    v_mfma_f32_16x16x32_bf16 v[44:47], a[204:207], a[164:167], v[44:47]
    v_mul_f32 v182, s38, v182
    v_mul_f32 v183, s38, v183
    v_mfma_f32_16x16x32_bf16 v[76:79], a[200:203], a[168:171], v[76:79]
    v_cvt_pk_bf16_f32 v219, v182, v183
    v_cvt_pk_bf16_f32 v218, v180, v181
    v_mfma_f32_16x16x32_bf16 v[76:79], a[204:207], a[172:175], v[76:79]
    v_cvt_pk_bf16_f32 v217, v178, v179
    s_waitcnt lgkmcnt(4)
    v_mfma_f32_16x16x32_bf16 a[16:19], a[176:179], a[136:139], a[16:19]
    v_cvt_pk_bf16_f32 v216, v176, v177
    v_mul_f32 v174, s38, v174
    v_mfma_f32_16x16x32_bf16 a[16:19], a[180:183], a[140:143], a[16:19]
    ds_read_b64_tr_b16 a[192:193], v23 offset:49152
    v_mul_f32 v175, s38, v175
    v_mfma_f32_16x16x32_bf16 a[48:51], a[176:179], a[144:147], a[48:51]
    ds_read_b64_tr_b16 a[194:195], v23 offset:50176
    v_cvt_pk_bf16_f32 v215, v174, v175
    v_mfma_f32_16x16x32_bf16 a[48:51], a[180:183], a[148:151], a[48:51]
    ds_read_b64_tr_b16 a[196:197], v23 offset:57344
    v_cvt_pk_bf16_f32 v214, v172, v173
    v_mfma_f32_16x16x32_bf16 a[80:83], a[176:179], a[152:155], a[80:83]
    ds_read_b64_tr_b16 a[198:199], v23 offset:58368
    v_cvt_pk_bf16_f32 v213, v170, v171
    v_mfma_f32_16x16x32_bf16 a[80:83], a[180:183], a[156:159], a[80:83]
    v_cvt_pk_bf16_f32 v212, v168, v169
    v_cvt_pk_bf16_f32 v211, v166, v167
    v_mfma_f32_16x16x32_bf16 v[48:51], a[176:179], a[160:163], v[48:51]
    v_cvt_pk_bf16_f32 v210, v164, v165
    v_cvt_pk_bf16_f32 v209, v162, v163
    v_mfma_f32_16x16x32_bf16 v[48:51], a[180:183], a[164:167], v[48:51]
    v_cvt_pk_bf16_f32 v208, v160, v161
    v_mul_f32 v152, s38, v152
    v_mfma_f32_16x16x32_bf16 v[80:83], a[176:179], a[168:171], v[80:83]
    v_mul_f32 v153, s38, v153
    v_mul_f32 v154, s38, v154
    v_mfma_f32_16x16x32_bf16 v[80:83], a[180:183], a[172:175], v[80:83]
    v_mul_f32 v155, s38, v155
    s_waitcnt lgkmcnt(4)
    v_mfma_f32_16x16x32_bf16 a[20:23], a[184:187], a[136:139], a[20:23]
    v_mul_f32 v156, s38, v156
    v_mul_f32 v157, s38, v157
    v_mfma_f32_16x16x32_bf16 a[20:23], a[188:191], a[140:143], a[20:23]
    ds_read_b64_tr_b16 a[200:201], v23 offset:49160
    v_mul_f32 v158, s38, v158
    v_mfma_f32_16x16x32_bf16 a[52:55], a[184:187], a[144:147], a[52:55]
    ds_read_b64_tr_b16 a[202:203], v23 offset:50184
    v_mul_f32 v159, s38, v159
    v_mfma_f32_16x16x32_bf16 a[52:55], a[188:191], a[148:151], a[52:55]
    ds_read_b64_tr_b16 a[204:205], v23 offset:57352
    v_cvt_pk_bf16_f32 v207, v158, v159
    v_mfma_f32_16x16x32_bf16 a[84:87], a[184:187], a[152:155], a[84:87]
    ds_read_b64_tr_b16 a[206:207], v23 offset:58376
    v_cvt_pk_bf16_f32 v206, v156, v157
    v_mfma_f32_16x16x32_bf16 a[84:87], a[188:191], a[156:159], a[84:87]
    v_cvt_pk_bf16_f32 v205, v154, v155
    v_cvt_pk_bf16_f32 v204, v152, v153
    v_mfma_f32_16x16x32_bf16 v[52:55], a[184:187], a[160:163], v[52:55]
    v_mul_f32 v144, s38, v144
    v_mul_f32 v145, s38, v145
    v_mfma_f32_16x16x32_bf16 v[52:55], a[188:191], a[164:167], v[52:55]
    buffer_store_dwordx4 a[208:211], v24, s[20:23], s70 offen offset:0 sc1
    v_mfma_f32_16x16x32_bf16 v[84:87], a[184:187], a[168:171], v[84:87]
    v_mul_f32 v146, s38, v146
    v_mul_f32 v147, s38, v147
    v_mfma_f32_16x16x32_bf16 v[84:87], a[188:191], a[172:175], v[84:87]
    s_waitcnt lgkmcnt(0)
    s_barrier
    v_mfma_f32_16x16x32_bf16 a[24:27], a[192:195], a[136:139], a[24:27]
    v_mul_f32 v148, s38, v148
    v_mul_f32 v149, s38, v149
    v_mfma_f32_16x16x32_bf16 a[24:27], a[196:199], a[140:143], a[24:27]
    v_mul_f32 v150, s38, v150
    v_mul_f32 v151, s38, v151
    v_mfma_f32_16x16x32_bf16 a[56:59], a[192:195], a[144:147], a[56:59]
    v_cvt_pk_bf16_f32 v203, v150, v151
    v_cvt_pk_bf16_f32 v202, v148, v149
    v_mfma_f32_16x16x32_bf16 a[56:59], a[196:199], a[148:151], a[56:59]
    v_cvt_pk_bf16_f32 v201, v146, v147
    v_cvt_pk_bf16_f32 v200, v144, v145
    v_mfma_f32_16x16x32_bf16 a[88:91], a[192:195], a[152:155], a[88:91]
    v_mul_f32 v137, s38, v137
    v_mul_f32 v138, s38, v138
    v_mfma_f32_16x16x32_bf16 a[88:91], a[196:199], a[156:159], a[88:91]
    v_mul_f32 v139, s38, v139
    v_mul_f32 v140, s38, v140
    v_mfma_f32_16x16x32_bf16 v[56:59], a[192:195], a[160:163], v[56:59]
    v_mul_f32 v141, s38, v141
    v_mul_f32 v142, s38, v142
    v_mfma_f32_16x16x32_bf16 v[56:59], a[196:199], a[164:167], v[56:59]
    v_mul_f32 v143, s38, v143
    v_cvt_pk_bf16_f32 v199, v142, v143
    v_mfma_f32_16x16x32_bf16 v[88:91], a[192:195], a[168:171], v[88:91]
    v_cvt_pk_bf16_f32 v198, v140, v141
    v_cvt_pk_bf16_f32 v197, v138, v139
    v_mfma_f32_16x16x32_bf16 v[88:91], a[196:199], a[172:175], v[88:91]
    v_cvt_pk_bf16_f32 v196, v136, v137
    v_mul_f32 v129, s38, v129
    v_mfma_f32_16x16x32_bf16 a[28:31], a[200:203], a[136:139], a[28:31]
    v_mul_f32 v130, s38, v130
    v_mul_f32 v131, s38, v131
    v_mfma_f32_16x16x32_bf16 a[28:31], a[204:207], a[140:143], a[28:31]
    v_mul_f32 v132, s38, v132
    v_mul_f32 v133, s38, v133
    v_mfma_f32_16x16x32_bf16 a[60:63], a[200:203], a[144:147], a[60:63]
    v_mul_f32 v134, s38, v134
    v_mul_f32 v135, s38, v135
    v_mfma_f32_16x16x32_bf16 a[60:63], a[204:207], a[148:151], a[60:63]
    v_cvt_pk_bf16_f32 v195, v134, v135
    v_cvt_pk_bf16_f32 v194, v132, v133
    v_mfma_f32_16x16x32_bf16 a[92:95], a[200:203], a[152:155], a[92:95]
    v_cvt_pk_bf16_f32 v193, v130, v131
    v_cvt_pk_bf16_f32 v192, v128, v129
    v_mfma_f32_16x16x32_bf16 a[92:95], a[204:207], a[156:159], a[92:95]
    v_mfma_f32_16x16x32_bf16 v[60:63], a[200:203], a[160:163], v[60:63]
    v_mfma_f32_16x16x32_bf16 v[60:63], a[204:207], a[164:167], v[60:63]
    v_mfma_f32_16x16x32_bf16 v[92:95], a[200:203], a[168:171], v[92:95]
    v_mfma_f32_16x16x32_bf16 v[92:95], a[204:207], a[172:175], v[92:95]
    v_pk_mul_f32 v[120:121], v[120:121], s[38:39]
    v_pk_mul_f32 v[122:123], v[122:123], s[38:39]
    v_pk_mul_f32 v[124:125], v[124:125], s[38:39]
    v_pk_mul_f32 v[126:127], v[126:127], s[38:39]
    v_pk_mul_f32 v[112:113], v[112:113], s[38:39]
    v_pk_mul_f32 v[114:115], v[114:115], s[38:39]
    v_pk_mul_f32 v[116:117], v[116:117], s[38:39]
    v_pk_mul_f32 v[118:119], v[118:119], s[38:39]
    v_pk_mul_f32 v[104:105], v[104:105], s[38:39]
    v_pk_mul_f32 v[106:107], v[106:107], s[38:39]
    v_pk_mul_f32 v[108:109], v[108:109], s[38:39]
    v_pk_mul_f32 v[110:111], v[110:111], s[38:39]
    v_pk_mul_f32 v[96:97], v[96:97], s[38:39]
    v_pk_mul_f32 v[98:99], v[98:99], s[38:39]
    v_pk_mul_f32 v[100:101], v[100:101], s[38:39]
    v_pk_mul_f32 v[102:103], v[102:103], s[38:39]
    v_mfma_f32_32x32x16_bf16 a[96:111], a[248:251], a[248:251], 0
    v_cvt_pk_bf16_f32 v191, v126, v127
    v_cvt_pk_bf16_f32 v190, v124, v125
    ds_read_b128 a[160:163], v4 offset:0
    v_cvt_pk_bf16_f32 v189, v122, v123
    v_cvt_pk_bf16_f32 v188, v120, v121
    ds_read_b128 a[164:167], v5 offset:0
    v_cvt_pk_bf16_f32 v187, v118, v119
    v_cvt_pk_bf16_f32 v186, v116, v117
    v_cvt_pk_bf16_f32 v185, v114, v115
    v_cvt_pk_bf16_f32 v184, v112, v113
    v_cvt_pk_bf16_f32 v183, v110, v111
    v_cvt_pk_bf16_f32 v182, v108, v109
    v_cvt_pk_bf16_f32 v181, v106, v107
    v_cvt_pk_bf16_f32 v180, v104, v105
    v_cvt_pk_bf16_f32 v179, v102, v103
    v_cvt_pk_bf16_f32 v178, v100, v101
    v_cvt_pk_bf16_f32 v177, v98, v99
    v_cvt_pk_bf16_f32 v176, v96, v97
    v_pk_mul_f32 v[88:89], v[88:89], s[38:39]
    v_pk_mul_f32 v[90:91], v[90:91], s[38:39]
    v_pk_mul_f32 v[92:93], v[92:93], s[38:39]
    v_pk_mul_f32 v[94:95], v[94:95], s[38:39]
    v_pk_mul_f32 v[80:81], v[80:81], s[38:39]
    v_pk_mul_f32 v[82:83], v[82:83], s[38:39]
    v_pk_mul_f32 v[84:85], v[84:85], s[38:39]
    v_pk_mul_f32 v[86:87], v[86:87], s[38:39]
    v_pk_mul_f32 v[72:73], v[72:73], s[38:39]
    v_pk_mul_f32 v[74:75], v[74:75], s[38:39]
    v_pk_mul_f32 v[76:77], v[76:77], s[38:39]
    v_pk_mul_f32 v[78:79], v[78:79], s[38:39]
    v_pk_mul_f32 v[64:65], v[64:65], s[38:39]
    v_pk_mul_f32 v[66:67], v[66:67], s[38:39]
    v_pk_mul_f32 v[68:69], v[68:69], s[38:39]
    v_pk_mul_f32 v[70:71], v[70:71], s[38:39]
    v_mfma_f32_32x32x16_bf16 a[112:127], a[248:251], a[248:251], 0
    v_cvt_pk_bf16_f32 v175, v94, v95
    v_cvt_pk_bf16_f32 v174, v92, v93
    ds_read_b128 a[168:171], v6 offset:0
    v_cvt_pk_bf16_f32 v173, v90, v91
    v_cvt_pk_bf16_f32 v172, v88, v89
    ds_read_b128 a[172:175], v7 offset:0
    v_cvt_pk_bf16_f32 v171, v86, v87
    v_cvt_pk_bf16_f32 v170, v84, v85
    ds_read_b128 a[176:179], v4 offset:4096
    v_cvt_pk_bf16_f32 v169, v82, v83
    v_cvt_pk_bf16_f32 v168, v80, v81
    v_cvt_pk_bf16_f32 v167, v78, v79
    v_cvt_pk_bf16_f32 v166, v76, v77
    v_cvt_pk_bf16_f32 v165, v74, v75
    v_cvt_pk_bf16_f32 v164, v72, v73
    v_cvt_pk_bf16_f32 v163, v70, v71
    v_cvt_pk_bf16_f32 v162, v68, v69
    v_cvt_pk_bf16_f32 v161, v66, v67
    v_cvt_pk_bf16_f32 v160, v64, v65
    v_pk_mul_f32 v[56:57], v[56:57], s[38:39]
    v_pk_mul_f32 v[58:59], v[58:59], s[38:39]
    v_pk_mul_f32 v[60:61], v[60:61], s[38:39]
    v_pk_mul_f32 v[62:63], v[62:63], s[38:39]
    v_pk_mul_f32 v[48:49], v[48:49], s[38:39]
    v_pk_mul_f32 v[50:51], v[50:51], s[38:39]
    v_pk_mul_f32 v[52:53], v[52:53], s[38:39]
    v_pk_mul_f32 v[54:55], v[54:55], s[38:39]
    v_pk_mul_f32 v[40:41], v[40:41], s[38:39]
    v_pk_mul_f32 v[42:43], v[42:43], s[38:39]
    v_pk_mul_f32 v[44:45], v[44:45], s[38:39]
    v_pk_mul_f32 v[46:47], v[46:47], s[38:39]
    v_pk_mul_f32 v[32:33], v[32:33], s[38:39]
    v_pk_mul_f32 v[34:35], v[34:35], s[38:39]
    v_pk_mul_f32 v[36:37], v[36:37], s[38:39]
    v_pk_mul_f32 v[38:39], v[38:39], s[38:39]
    v_mfma_f32_32x32x16_bf16 a[128:143], a[248:251], a[248:251], 0
    v_cvt_pk_bf16_f32 v159, v62, v63
    v_cvt_pk_bf16_f32 v158, v60, v61
    ds_read_b128 a[180:183], v5 offset:4096
    v_mfma_f32_32x32x16_bf16 a[144:159], a[248:251], a[248:251], 0
    v_cvt_pk_bf16_f32 v157, v58, v59
    v_cvt_pk_bf16_f32 v156, v56, v57
    ds_read_b128 a[184:187], v6 offset:4096
    v_cvt_pk_bf16_f32 v155, v54, v55
    v_cvt_pk_bf16_f32 v154, v52, v53
    ds_read_b128 a[188:191], v7 offset:4096
    v_cvt_pk_bf16_f32 v153, v50, v51
    v_cvt_pk_bf16_f32 v152, v48, v49
    v_cvt_pk_bf16_f32 v151, v46, v47
    v_cvt_pk_bf16_f32 v150, v44, v45
    v_cvt_pk_bf16_f32 v149, v42, v43
    v_cvt_pk_bf16_f32 v148, v40, v41
    v_cvt_pk_bf16_f32 v147, v38, v39
    v_cvt_pk_bf16_f32 v146, v36, v37
    v_cvt_pk_bf16_f32 v145, v34, v35
    v_cvt_pk_bf16_f32 v144, v32, v33
    v_and_b32 v1, 3, v0
    v_xor_b32 v2, v31, v1
    v_lshlrev_b32_e64 v2, 4, v2
    v_lshl_add_u32 v72, v1, 8, v2
    ds_read_b128 v[48:51], v72 offset:0
    ds_read_b128 v[52:55], v72 offset:64
    ds_read_b128 v[56:59], v72 offset:128
    ds_read_b128 v[60:63], v72 offset:192
    v_bfe_i32 v74, v0, 0, 1
    v_and_b32 v74, 0xaaaaaaaa, v74
    v_or_b32 v74, 0x44444444, v74
    v_accvgpr_read_b32 v32, a0
    v_accvgpr_read_b32 v33, a1
    v_accvgpr_read_b32 v34, a2
    v_accvgpr_read_b32 v35, a3
    v_accvgpr_read_b32 v36, a4
    v_accvgpr_read_b32 v37, a5
    v_accvgpr_read_b32 v38, a6
    v_accvgpr_read_b32 v39, a7
    v_accvgpr_read_b32 v40, a8
    v_accvgpr_read_b32 v41, a9
    v_accvgpr_read_b32 v42, a10
    v_accvgpr_read_b32 v43, a11
    v_accvgpr_read_b32 v44, a12
    v_accvgpr_read_b32 v45, a13
    v_accvgpr_read_b32 v46, a14
    v_accvgpr_read_b32 v47, a15
    v_pk_mul_f32 v[32:33], v[32:33], s[38:39]
    v_pk_mul_f32 v[34:35], v[34:35], s[38:39]
    v_pk_mul_f32 v[36:37], v[36:37], s[38:39]
    v_pk_mul_f32 v[38:39], v[38:39], s[38:39]
    v_pk_mul_f32 v[40:41], v[40:41], s[38:39]
    v_pk_mul_f32 v[42:43], v[42:43], s[38:39]
    v_pk_mul_f32 v[44:45], v[44:45], s[38:39]
    v_pk_mul_f32 v[46:47], v[46:47], s[38:39]
    s_waitcnt lgkmcnt(0)
    s_nop 0
    v_mfma_f32_16x16x32_bf16 v[76:79], v[48:51], v[176:179], 0
    v_cvt_pk_bf16_f32 v99, v38, v39
    v_cvt_pk_bf16_f32 v98, v36, v37
    v_mfma_f32_16x16x32_bf16 v[76:79], v[52:55], v[180:183], v[76:79]
    v_cvt_pk_bf16_f32 v97, v34, v35
    v_cvt_pk_bf16_f32 v96, v32, v33
    v_mfma_f32_16x16x32_bf16 v[76:79], v[56:59], v[184:187], v[76:79]
    v_cvt_pk_bf16_f32 v103, v46, v47
    v_cvt_pk_bf16_f32 v102, v44, v45
    v_mfma_f32_16x16x32_bf16 v[76:79], v[60:63], v[188:191], v[76:79]
    v_cvt_pk_bf16_f32 v101, v42, v43
    v_cvt_pk_bf16_f32 v100, v40, v41
    v_mfma_f32_32x32x16_bf16 a[0:15], a[248:251], a[248:251], 0
    v_accvgpr_read_b32 v32, a16
    v_accvgpr_read_b32 v33, a17
    v_accvgpr_read_b32 v34, a18
    v_accvgpr_read_b32 v35, a19
    v_accvgpr_read_b32 v36, a20
    v_accvgpr_read_b32 v37, a21
    v_accvgpr_read_b32 v38, a22
    v_accvgpr_read_b32 v39, a23
    v_accvgpr_read_b32 v40, a24
    v_accvgpr_read_b32 v41, a25
    v_accvgpr_read_b32 v42, a26
    v_accvgpr_read_b32 v43, a27
    v_accvgpr_read_b32 v44, a28
    v_accvgpr_read_b32 v45, a29
    v_accvgpr_read_b32 v46, a30
    v_accvgpr_read_b32 v47, a31
    v_pk_mul_f32 v[32:33], v[32:33], s[38:39]
    v_pk_mul_f32 v[34:35], v[34:35], s[38:39]
    v_pk_mul_f32 v[36:37], v[36:37], s[38:39]
    v_pk_mul_f32 v[38:39], v[38:39], s[38:39]
    v_pk_mul_f32 v[40:41], v[40:41], s[38:39]
    v_pk_mul_f32 v[42:43], v[42:43], s[38:39]
    v_pk_mul_f32 v[44:45], v[44:45], s[38:39]
    v_pk_mul_f32 v[46:47], v[46:47], s[38:39]
    v_mfma_f32_16x16x32_bf16 v[80:83], v[48:51], v[192:195], 0
    buffer_store_dwordx4 a[212:215], v24, s[20:23], s70 offen offset:1024 sc1
    v_mfma_f32_16x16x32_bf16 v[80:83], v[52:55], v[196:199], v[80:83]
    ds_write_b128 v27, v[96:99] offset:0
    v_mfma_f32_16x16x32_bf16 v[80:83], v[56:59], v[200:203], v[80:83]
    v_cvt_pk_bf16_f32 v107, v38, v39
    v_cvt_pk_bf16_f32 v106, v36, v37
    v_mfma_f32_16x16x32_bf16 v[80:83], v[60:63], v[204:207], v[80:83]
    v_cvt_pk_bf16_f32 v105, v34, v35
    v_cvt_pk_bf16_f32 v104, v32, v33
    v_mfma_f32_32x32x16_bf16 a[16:31], a[248:251], a[248:251], 0
    ds_write_b128 v27, v[100:103] offset:1024
    v_cvt_pk_bf16_f32 v111, v46, v47
    v_cvt_pk_bf16_f32 v110, v44, v45
    v_cvt_pk_bf16_f32 v109, v42, v43
    v_cvt_pk_bf16_f32 v108, v40, v41
    v_accvgpr_read_b32 v32, a32
    v_accvgpr_read_b32 v33, a33
    v_accvgpr_read_b32 v34, a34
    v_accvgpr_read_b32 v35, a35
    v_accvgpr_read_b32 v36, a36
    v_accvgpr_read_b32 v37, a37
    v_accvgpr_read_b32 v38, a38
    v_accvgpr_read_b32 v39, a39
    v_accvgpr_read_b32 v40, a40
    v_accvgpr_read_b32 v41, a41
    v_accvgpr_read_b32 v42, a42
    v_accvgpr_read_b32 v43, a43
    v_accvgpr_read_b32 v44, a44
    v_accvgpr_read_b32 v45, a45
    v_accvgpr_read_b32 v46, a46
    v_accvgpr_read_b32 v47, a47
    v_pk_mul_f32 v[32:33], v[32:33], s[38:39]
    v_pk_mul_f32 v[34:35], v[34:35], s[38:39]
    v_pk_mul_f32 v[36:37], v[36:37], s[38:39]
    v_pk_mul_f32 v[38:39], v[38:39], s[38:39]
    v_pk_mul_f32 v[40:41], v[40:41], s[38:39]
    v_pk_mul_f32 v[42:43], v[42:43], s[38:39]
    v_pk_mul_f32 v[44:45], v[44:45], s[38:39]
    v_pk_mul_f32 v[46:47], v[46:47], s[38:39]
    v_mfma_f32_16x16x32_bf16 v[84:87], v[48:51], v[208:211], 0
    ds_write_b128 v27, v[104:107] offset:2048
    v_mfma_f32_16x16x32_bf16 v[84:87], v[52:55], v[212:215], v[84:87]
    v_cvt_pk_bf16_f32 v115, v38, v39
    v_cvt_pk_bf16_f32 v114, v36, v37
    v_mfma_f32_16x16x32_bf16 v[84:87], v[56:59], v[216:219], v[84:87]
    v_cvt_pk_bf16_f32 v113, v34, v35
    v_cvt_pk_bf16_f32 v112, v32, v33
    v_mfma_f32_16x16x32_bf16 v[84:87], v[60:63], v[220:223], v[84:87]
    ds_write_b128 v27, v[108:111] offset:3072
    v_mfma_f32_32x32x16_bf16 a[32:47], a[248:251], a[248:251], 0
    v_cvt_pk_bf16_f32 v119, v46, v47
    v_cvt_pk_bf16_f32 v118, v44, v45
    v_cvt_pk_bf16_f32 v117, v42, v43
    v_cvt_pk_bf16_f32 v116, v40, v41
    v_accvgpr_read_b32 v32, a48
    v_accvgpr_read_b32 v33, a49
    v_accvgpr_read_b32 v34, a50
    v_accvgpr_read_b32 v35, a51
    v_accvgpr_read_b32 v36, a52
    v_accvgpr_read_b32 v37, a53
    v_accvgpr_read_b32 v38, a54
    v_accvgpr_read_b32 v39, a55
    v_accvgpr_read_b32 v40, a56
    v_accvgpr_read_b32 v41, a57
    v_accvgpr_read_b32 v42, a58
    v_accvgpr_read_b32 v43, a59
    v_accvgpr_read_b32 v44, a60
    v_accvgpr_read_b32 v45, a61
    v_accvgpr_read_b32 v46, a62
    v_accvgpr_read_b32 v47, a63
    v_pk_mul_f32 v[32:33], v[32:33], s[38:39]
    v_pk_mul_f32 v[34:35], v[34:35], s[38:39]
    v_pk_mul_f32 v[36:37], v[36:37], s[38:39]
    v_pk_mul_f32 v[38:39], v[38:39], s[38:39]
    v_pk_mul_f32 v[40:41], v[40:41], s[38:39]
    v_pk_mul_f32 v[42:43], v[42:43], s[38:39]
    v_pk_mul_f32 v[44:45], v[44:45], s[38:39]
    v_pk_mul_f32 v[46:47], v[46:47], s[38:39]
    v_mfma_f32_16x16x32_bf16 v[88:91], v[48:51], v[224:227], 0
    buffer_store_dwordx4 a[216:219], v24, s[20:23], s70 offen offset:2048 sc1
    v_mfma_f32_16x16x32_bf16 v[88:91], v[52:55], v[228:231], v[88:91]
    v_cvt_pk_bf16_f32 v123, v38, v39
    v_cvt_pk_bf16_f32 v122, v36, v37
    v_mfma_f32_16x16x32_bf16 v[88:91], v[56:59], v[232:235], v[88:91]
    v_cvt_pk_bf16_f32 v121, v34, v35
    v_cvt_pk_bf16_f32 v120, v32, v33
    v_mfma_f32_16x16x32_bf16 v[88:91], v[60:63], v[236:239], v[88:91]
    v_cvt_pk_bf16_f32 v127, v46, v47
    v_cvt_pk_bf16_f32 v126, v44, v45
    v_mfma_f32_32x32x16_bf16 a[48:63], a[248:251], a[248:251], 0
    v_cvt_pk_bf16_f32 v125, v42, v43
    v_cvt_pk_bf16_f32 v124, v40, v41
    v_accvgpr_read_b32 v32, a64
    v_accvgpr_read_b32 v33, a65
    v_accvgpr_read_b32 v34, a66
    v_accvgpr_read_b32 v35, a67
    v_accvgpr_read_b32 v36, a68
    v_accvgpr_read_b32 v37, a69
    v_accvgpr_read_b32 v38, a70
    v_accvgpr_read_b32 v39, a71
    v_accvgpr_read_b32 v40, a72
    v_accvgpr_read_b32 v41, a73
    v_accvgpr_read_b32 v42, a74
    v_accvgpr_read_b32 v43, a75
    v_accvgpr_read_b32 v44, a76
    v_accvgpr_read_b32 v45, a77
    v_accvgpr_read_b32 v46, a78
    v_accvgpr_read_b32 v47, a79
    v_pk_mul_f32 v[32:33], v[32:33], s[38:39]
    v_pk_mul_f32 v[34:35], v[34:35], s[38:39]
    v_pk_mul_f32 v[36:37], v[36:37], s[38:39]
    v_pk_mul_f32 v[38:39], v[38:39], s[38:39]
    v_pk_mul_f32 v[40:41], v[40:41], s[38:39]
    v_pk_mul_f32 v[42:43], v[42:43], s[38:39]
    v_pk_mul_f32 v[44:45], v[44:45], s[38:39]
    v_pk_mul_f32 v[46:47], v[46:47], s[38:39]
    v_mfma_f32_16x16x32_bf16 v[92:95], v[48:51], v[240:243], 0
    v_mov_b64_e64 v[96:97], 0
    v_cvt_pk_bf16_f32 v131, v38, v39
    v_mfma_f32_16x16x32_bf16 v[92:95], v[52:55], v[244:247], v[92:95]
    v_cvt_pk_bf16_f32 v130, v36, v37
    v_cvt_pk_bf16_f32 v129, v34, v35
    v_mfma_f32_16x16x32_bf16 v[92:95], v[56:59], v[248:251], v[92:95]
    v_cvt_pk_bf16_f32 v128, v32, v33
    v_mov_b64_e64 v[98:99], 0
    v_mfma_f32_16x16x32_bf16 v[92:95], v[60:63], v[252:255], v[92:95]
    v_mov_b64 v[100:101], 0
    v_mov_b64 v[102:103], 0
    v_mfma_f32_32x32x16_bf16 a[64:79], a[248:251], a[248:251], 0
    v_mov_b64 v[104:105], 0
    v_mov_b64 v[106:107], 0
    v_mov_b64 v[108:109], 0
    v_mov_b64 v[110:111], 0
    v_mov_b64 v[20:21], 0
    v_mov_b64 v[22:23], 0
    v_cvt_pk_bf16_f32 v135, v46, v47
    v_cvt_pk_bf16_f32 v134, v44, v45
    v_cvt_pk_bf16_f32 v133, v42, v43
    v_cvt_pk_bf16_f32 v132, v40, v41
    v_accvgpr_read_b32 v32, a80
    v_accvgpr_read_b32 v33, a81
    v_accvgpr_read_b32 v34, a82
    v_accvgpr_read_b32 v35, a83
    v_accvgpr_read_b32 v36, a84
    v_accvgpr_read_b32 v37, a85
    v_accvgpr_read_b32 v38, a86
    v_accvgpr_read_b32 v39, a87
    v_accvgpr_read_b32 v40, a88
    v_accvgpr_read_b32 v41, a89
    v_accvgpr_read_b32 v42, a90
    v_accvgpr_read_b32 v43, a91
    v_accvgpr_read_b32 v44, a92
    v_accvgpr_read_b32 v45, a93
    v_accvgpr_read_b32 v46, a94
    v_accvgpr_read_b32 v47, a95
    v_pk_mul_f32 v[32:33], v[32:33], s[38:39]
    v_pk_mul_f32 v[34:35], v[34:35], s[38:39]
    v_pk_mul_f32 v[36:37], v[36:37], s[38:39]
    v_pk_mul_f32 v[38:39], v[38:39], s[38:39]
    v_pk_mul_f32 v[40:41], v[40:41], s[38:39]
    v_pk_mul_f32 v[42:43], v[42:43], s[38:39]
    v_pk_mul_f32 v[44:45], v[44:45], s[38:39]
    v_pk_mul_f32 v[46:47], v[46:47], s[38:39]
    v_mfma_f32_32x32x16_bf16 a[80:95], a[248:251], a[248:251], 0
    buffer_store_dwordx4 a[220:223], v24, s[20:23], s70 offen offset:3072 sc1
    v_cvt_pk_bf16_f32 v139, v38, v39
    v_cvt_pk_bf16_f32 v138, v36, v37
    v_cvt_pk_bf16_f32 v137, v34, v35
    v_cvt_pk_bf16_f32 v136, v32, v33
    v_cvt_pk_bf16_f32 v143, v46, v47
    v_cvt_pk_bf16_f32 v142, v44, v45
    v_cvt_pk_bf16_f32 v141, v42, v43
    v_cvt_pk_bf16_f32 v140, v40, v41
    ds_read_b64_tr_b16 a[192:193], v8 offset:8192
    ds_read_b64_tr_b16 a[194:195], v8 offset:12288
    ds_read_b64_tr_b16 a[196:197], v9 offset:8192
    ds_read_b64_tr_b16 a[198:199], v9 offset:12288
    ds_read_b64_tr_b16 a[200:201], v10 offset:8192
    ds_read_b64_tr_b16 a[202:203], v10 offset:12288
    ds_read_b64_tr_b16 a[204:205], v11 offset:8192
    ds_read_b64_tr_b16 a[206:207], v11 offset:12288
    v_max3_f32 v76, v76, v77, v78
    v_max3_f32 v80, v80, v81, v82
    v_max3_f32 v84, v84, v85, v86
    v_max3_f32 v88, v88, v89, v90
    v_max3_f32 v92, v92, v93, v94
    v_max_f32 v76, v76, v79
    v_max_f32 v80, v80, v83
    v_max_f32 v84, v84, v87
    v_max_f32 v88, v88, v91
    v_max_f32_e64 v92, v92, v95
    v_pk_mul_f32 v[78:79], v[76:77], -1.0 op_sel_hi:[0,0]
    v_pk_mul_f32 v[82:83], v[80:81], -1.0 op_sel_hi:[0,0]
    v_pk_mul_f32 v[86:87], v[84:85], -1.0 op_sel_hi:[0,0]
    v_pk_mul_f32 v[90:91], v[88:89], -1.0 op_sel_hi:[0,0]
    v_pk_mul_f32 v[94:95], v[92:93], -1.0 op_sel_hi:[0,0]
    v_pk_mul_f32 v[76:77], v[76:77], -1.0 op_sel_hi:[0,0]
    v_pk_mul_f32 v[80:81], v[80:81], -1.0 op_sel_hi:[0,0]
    v_pk_mul_f32 v[84:85], v[84:85], -1.0 op_sel_hi:[0,0]
    v_pk_mul_f32 v[88:89], v[88:89], -1.0 op_sel_hi:[0,0]
    v_pk_mul_f32 v[92:93], v[92:93], -1.0 op_sel_hi:[0,0]
    s_mov_b32 s70, s98
    s_mov_b32 s71, s99
    s_nop 0
    s_nop 0
    s_nop 0
    s_nop 0
    s_nop 0
    s_nop 0
    s_nop 0
L_loop5:
    s_waitcnt lgkmcnt(8)
    v_mfma_f32_16x16x32_bf16 v[32:35], a[160:163], v[176:179], v[76:79]
    ds_read_b64_tr_b16 a[236:237], v12 offset:8192
    v_mfma_f32_16x16x32_bf16 v[32:35], a[164:167], v[180:183], v[32:35]
    ds_read_b64_tr_b16 a[238:239], v12 offset:12288
    v_mfma_f32_16x16x32_bf16 v[32:35], a[168:171], v[184:187], v[32:35]
    ds_read_b64_tr_b16 a[240:241], v13 offset:8192
    v_mfma_f32_16x16x32_bf16 v[32:35], a[172:175], v[188:191], v[32:35]
    ds_read_b64_tr_b16 a[242:243], v13 offset:12288
    v_mfma_f32_16x16x32_bf16 v[36:39], a[176:179], v[176:179], v[76:79]
    ds_read_b64_tr_b16 a[248:249], v14 offset:8192
    v_mfma_f32_16x16x32_bf16 v[36:39], a[180:183], v[180:183], v[36:39]
    ds_read_b64_tr_b16 a[250:251], v14 offset:12288
    v_mfma_f32_16x16x32_bf16 v[36:39], a[184:187], v[184:187], v[36:39]
    ds_read_b64_tr_b16 a[252:253], v15 offset:8192
    v_mfma_f32_16x16x32_bf16 v[36:39], a[188:191], v[188:191], v[36:39]
    ds_read_b64_tr_b16 a[254:255], v15 offset:12288
    v_mfma_f32_16x16x32_bf16 v[40:43], a[160:163], v[192:195], v[80:83]
    v_exp_f32 v32, v32
    v_mfma_f32_16x16x32_bf16 v[40:43], a[164:167], v[196:199], v[40:43]
    v_exp_f32 v33, v33
    v_mfma_f32_16x16x32_bf16 v[40:43], a[168:171], v[200:203], v[40:43]
    v_exp_f32 v34, v34
    v_mfma_f32_16x16x32_bf16 v[40:43], a[172:175], v[204:207], v[40:43]
    v_exp_f32 v35, v35
    v_mfma_f32_16x16x32_bf16 v[44:47], a[176:179], v[192:195], v[80:83]
    v_cvt_pk_bf16_f32 v56, v32, v33
    v_cvt_pk_bf16_f32 v57, v34, v35
    v_mfma_f32_16x16x32_bf16 v[44:47], a[180:183], v[196:199], v[44:47]
    v_exp_f32 v36, v36
    v_mfma_f32_16x16x32_bf16 v[44:47], a[184:187], v[200:203], v[44:47]
    v_exp_f32 v37, v37
    v_mfma_f32_16x16x32_bf16 v[44:47], a[188:191], v[204:207], v[44:47]
    v_exp_f32 v38, v38
    v_mfma_f32_16x16x32_bf16 v[48:51], a[160:163], v[208:211], v[84:87]
    v_exp_f32 v39, v39
    v_mfma_f32_16x16x32_bf16 v[48:51], a[164:167], v[212:215], v[48:51]
    v_cvt_pk_bf16_f32 v58, v36, v37
    v_cvt_pk_bf16_f32 v59, v38, v39
    v_mfma_f32_16x16x32_bf16 v[48:51], a[168:171], v[216:219], v[48:51]
    v_exp_f32 v40, v40
    v_mfma_f32_16x16x32_bf16 v[48:51], a[172:175], v[220:223], v[48:51]
    v_exp_f32 v41, v41
    v_mfma_f32_16x16x32_bf16 v[52:55], a[176:179], v[208:211], v[84:87]
    v_exp_f32 v42, v42
    v_mfma_f32_16x16x32_bf16 v[52:55], a[180:183], v[212:215], v[52:55]
    v_exp_f32 v43, v43
    v_mfma_f32_16x16x32_bf16 v[52:55], a[184:187], v[216:219], v[52:55]
    v_cvt_pk_bf16_f32 v60, v40, v41
    v_cvt_pk_bf16_f32 v61, v42, v43
    v_mfma_f32_16x16x32_bf16 v[52:55], a[188:191], v[220:223], v[52:55]
    v_exp_f32 v44, v44
    v_mfma_f32_16x16x32_bf16 v[32:35], a[160:163], v[224:227], v[88:91]
    v_exp_f32 v45, v45
    v_mfma_f32_16x16x32_bf16 v[32:35], a[164:167], v[228:231], v[32:35]
    v_exp_f32 v46, v46
    v_mfma_f32_16x16x32_bf16 v[32:35], a[168:171], v[232:235], v[32:35]
    v_exp_f32 v47, v47
    v_mfma_f32_16x16x32_bf16 v[32:35], a[172:175], v[236:239], v[32:35]
    v_cvt_pk_bf16_f32 v62, v44, v45
    v_cvt_pk_bf16_f32 v63, v46, v47
    v_mfma_f32_16x16x32_bf16 v[36:39], a[176:179], v[224:227], v[88:91]
    v_exp_f32 v48, v48
    v_mfma_f32_16x16x32_bf16 v[36:39], a[180:183], v[228:231], v[36:39]
    v_exp_f32 v49, v49
    v_mfma_f32_16x16x32_bf16 v[36:39], a[184:187], v[232:235], v[36:39]
    v_exp_f32 v50, v50
    v_mfma_f32_16x16x32_bf16 v[36:39], a[188:191], v[236:239], v[36:39]
    v_exp_f32 v51, v51
    v_mfma_f32_16x16x32_bf16 v[40:43], a[160:163], v[240:243], v[92:95]
    v_exp_f32 v52, v52
    v_mfma_f32_16x16x32_bf16 v[40:43], a[164:167], v[244:247], v[40:43]
    v_exp_f32 v53, v53
    v_mfma_f32_16x16x32_bf16 v[40:43], a[168:171], v[248:251], v[40:43]
    v_exp_f32 v54, v54
    v_mfma_f32_16x16x32_bf16 v[40:43], a[172:175], v[252:255], v[40:43]
    v_exp_f32 v55, v55
    v_mfma_f32_16x16x32_bf16 v[44:47], a[176:179], v[240:243], v[92:95]
    v_cvt_pk_bf16_f32 v64, v48, v49
    v_cvt_pk_bf16_f32 v65, v50, v51
    v_mfma_f32_16x16x32_bf16 v[44:47], a[180:183], v[244:247], v[44:47]
    v_cvt_pk_bf16_f32 v66, v52, v53
    v_cvt_pk_bf16_f32 v67, v54, v55
    v_mfma_f32_16x16x32_bf16 v[44:47], a[184:187], v[248:251], v[44:47]
    v_exp_f32 v32, v32
    v_mfma_f32_16x16x32_bf16 v[44:47], a[188:191], v[252:255], v[44:47]
    s_waitcnt lgkmcnt(0)
    s_barrier
    v_mfma_f32_16x16x32_bf16 a[0:3], a[208:211], v[96:99], a[0:3]
    v_exp_f32 v33, v33
    v_mfma_f32_16x16x32_bf16 a[0:3], a[192:195], v[56:59], a[0:3]
    v_exp_f32 v34, v34
    v_mfma_f32_16x16x32_bf16 a[4:7], a[212:215], v[96:99], a[4:7]
    v_exp_f32 v35, v35
    v_mfma_f32_16x16x32_bf16 a[4:7], a[196:199], v[56:59], a[4:7]
    v_exp_f32 v36, v36
    v_mfma_f32_16x16x32_bf16 a[8:11], a[216:219], v[96:99], a[8:11]
    v_exp_f32 v37, v37
    v_mfma_f32_16x16x32_bf16 a[8:11], a[200:203], v[56:59], a[8:11]
    v_exp_f32 v38, v38
    v_mfma_f32_16x16x32_bf16 a[12:15], a[220:223], v[96:99], a[12:15]
    v_exp_f32 v39, v39
    v_mfma_f32_16x16x32_bf16 a[12:15], a[204:207], v[56:59], a[12:15]
    v_cvt_pk_bf16_f32 v68, v32, v33
    v_cvt_pk_bf16_f32 v69, v34, v35
    v_mfma_f32_16x16x32_bf16 a[32:35], a[208:211], v[100:103], a[32:35]
    v_cvt_pk_bf16_f32 v70, v36, v37
    v_cvt_pk_bf16_f32 v71, v38, v39
    v_mfma_f32_16x16x32_bf16 a[32:35], a[192:195], v[60:63], a[32:35]
    v_exp_f32 v40, v40
    v_mfma_f32_16x16x32_bf16 a[36:39], a[212:215], v[100:103], a[36:39]
    v_exp_f32 v41, v41
    v_mfma_f32_16x16x32_bf16 a[36:39], a[196:199], v[60:63], a[36:39]
    v_exp_f32 v42, v42
    v_mfma_f32_16x16x32_bf16 a[40:43], a[216:219], v[100:103], a[40:43]
    v_exp_f32 v43, v43
    v_mfma_f32_16x16x32_bf16 a[40:43], a[200:203], v[60:63], a[40:43]
    v_exp_f32 v44, v44
    v_mfma_f32_16x16x32_bf16 a[44:47], a[220:223], v[100:103], a[44:47]
    v_exp_f32 v45, v45
    v_mfma_f32_16x16x32_bf16 a[44:47], a[204:207], v[60:63], a[44:47]
    v_exp_f32 v46, v46
    v_smfmac_f32_16x16x64_bf16 a[224:227], a[244:247], v[56:63], v74
    v_cvt_pk_bf16_f32 v16, v40, v41
    v_mfma_f32_16x16x32_bf16 a[64:67], a[208:211], v[104:107], a[64:67]
    v_exp_f32 v47, v47
    v_mfma_f32_16x16x32_bf16 a[64:67], a[192:195], v[64:67], a[64:67]
    v_cvt_pk_bf16_f32 v17, v42, v43
    v_cvt_pk_bf16_f32 v18, v44, v45
    v_mfma_f32_16x16x32_bf16 a[68:71], a[212:215], v[104:107], a[68:71]
    v_cvt_pk_bf16_f32 v19, v46, v47
    v_mfma_f32_16x16x32_bf16 a[68:71], a[196:199], v[64:67], a[68:71]
    ds_read_b128 a[160:163], v4 offset:16384
    v_mfma_f32_16x16x32_bf16 a[72:75], a[216:219], v[104:107], a[72:75]
    ds_read_b128 a[164:167], v5 offset:16384
    v_mfma_f32_16x16x32_bf16 a[72:75], a[200:203], v[64:67], a[72:75]
    ds_read_b128 a[168:171], v6 offset:16384
    v_mfma_f32_16x16x32_bf16 a[76:79], a[220:223], v[104:107], a[76:79]
    ds_read_b128 a[172:175], v7 offset:16384
    v_mfma_f32_16x16x32_bf16 a[76:79], a[204:207], v[64:67], a[76:79]
    ds_read_b128 a[176:179], v4 offset:20480
    v_mfma_f32_16x16x32_bf16 a[96:99], a[208:211], v[108:111], a[96:99]
    ds_read_b128 a[180:183], v5 offset:20480
    v_mfma_f32_16x16x32_bf16 a[96:99], a[192:195], v[68:71], a[96:99]
    ds_read_b128 a[184:187], v6 offset:20480
    v_mfma_f32_16x16x32_bf16 a[100:103], a[212:215], v[108:111], a[100:103]
    ds_read_b128 a[188:191], v7 offset:20480
    v_mfma_f32_16x16x32_bf16 a[100:103], a[196:199], v[68:71], a[100:103]
    v_mfma_f32_16x16x32_bf16 a[104:107], a[216:219], v[108:111], a[104:107]
    v_mfma_f32_16x16x32_bf16 a[104:107], a[200:203], v[68:71], a[104:107]
    v_mfma_f32_16x16x32_bf16 a[108:111], a[220:223], v[108:111], a[108:111]
    v_mfma_f32_16x16x32_bf16 a[108:111], a[204:207], v[68:71], a[108:111]
    v_mfma_f32_16x16x32_bf16 a[128:131], a[208:211], v[20:23], a[128:131]
    v_mfma_f32_16x16x32_bf16 a[128:131], a[192:195], v[16:19], a[128:131]
    ds_read_b64_tr_b16 a[192:193], v12 offset:24576
    v_mfma_f32_16x16x32_bf16 a[132:135], a[212:215], v[20:23], a[132:135]
    ds_read_b64_tr_b16 a[194:195], v12 offset:28672
    v_mfma_f32_16x16x32_bf16 a[132:135], a[196:199], v[16:19], a[132:135]
    ds_read_b64_tr_b16 a[196:197], v13 offset:24576
    v_mfma_f32_16x16x32_bf16 a[136:139], a[216:219], v[20:23], a[136:139]
    ds_read_b64_tr_b16 a[198:199], v13 offset:28672
    v_mfma_f32_16x16x32_bf16 a[136:139], a[200:203], v[16:19], a[136:139]
    ds_read_b64_tr_b16 a[200:201], v14 offset:24576
    v_mfma_f32_16x16x32_bf16 a[140:143], a[220:223], v[20:23], a[140:143]
    ds_read_b64_tr_b16 a[202:203], v14 offset:28672
    v_mfma_f32_16x16x32_bf16 a[140:143], a[204:207], v[16:19], a[140:143]
    ds_read_b64_tr_b16 a[204:205], v15 offset:24576
    v_smfmac_f32_16x16x64_bf16 a[228:231], a[244:247], v[64:71], v74
    ds_read_b64_tr_b16 a[206:207], v15 offset:28672
    s_waitcnt lgkmcnt(8)
    v_mfma_f32_16x16x32_bf16 v[32:35], a[160:163], v[176:179], v[76:79]
    ds_read_b64_tr_b16 a[208:209], v8 offset:24576
    v_mfma_f32_16x16x32_bf16 v[32:35], a[164:167], v[180:183], v[32:35]
    ds_read_b64_tr_b16 a[210:211], v8 offset:28672
    v_mfma_f32_16x16x32_bf16 v[32:35], a[168:171], v[184:187], v[32:35]
    ds_read_b64_tr_b16 a[212:213], v9 offset:24576
    v_mfma_f32_16x16x32_bf16 v[32:35], a[172:175], v[188:191], v[32:35]
    ds_read_b64_tr_b16 a[214:215], v9 offset:28672
    v_mfma_f32_16x16x32_bf16 v[36:39], a[176:179], v[176:179], v[76:79]
    ds_read_b64_tr_b16 a[216:217], v10 offset:24576
    v_mfma_f32_16x16x32_bf16 v[36:39], a[180:183], v[180:183], v[36:39]
    ds_read_b64_tr_b16 a[218:219], v10 offset:28672
    v_mfma_f32_16x16x32_bf16 v[36:39], a[184:187], v[184:187], v[36:39]
    ds_read_b64_tr_b16 a[220:221], v11 offset:24576
    v_mfma_f32_16x16x32_bf16 v[36:39], a[188:191], v[188:191], v[36:39]
    ds_read_b64_tr_b16 a[222:223], v11 offset:28672
    v_mfma_f32_16x16x32_bf16 v[40:43], a[160:163], v[192:195], v[80:83]
    v_exp_f32 v32, v32
    v_mfma_f32_16x16x32_bf16 v[40:43], a[164:167], v[196:199], v[40:43]
    v_exp_f32 v33, v33
    v_mfma_f32_16x16x32_bf16 v[40:43], a[168:171], v[200:203], v[40:43]
    v_exp_f32 v34, v34
    v_mfma_f32_16x16x32_bf16 v[40:43], a[172:175], v[204:207], v[40:43]
    v_exp_f32 v35, v35
    v_mfma_f32_16x16x32_bf16 v[44:47], a[176:179], v[192:195], v[80:83]
    v_cvt_pk_bf16_f32 v96, v32, v33
    v_cvt_pk_bf16_f32 v97, v34, v35
    v_mfma_f32_16x16x32_bf16 v[44:47], a[180:183], v[196:199], v[44:47]
    v_exp_f32 v36, v36
    v_mfma_f32_16x16x32_bf16 v[44:47], a[184:187], v[200:203], v[44:47]
    v_exp_f32 v37, v37
    v_mfma_f32_16x16x32_bf16 v[44:47], a[188:191], v[204:207], v[44:47]
    v_exp_f32 v38, v38
    v_mfma_f32_16x16x32_bf16 v[48:51], a[160:163], v[208:211], v[84:87]
    v_exp_f32 v39, v39
    v_mfma_f32_16x16x32_bf16 v[48:51], a[164:167], v[212:215], v[48:51]
    v_cvt_pk_bf16_f32 v98, v36, v37
    v_cvt_pk_bf16_f32 v99, v38, v39
    v_mfma_f32_16x16x32_bf16 v[48:51], a[168:171], v[216:219], v[48:51]
    v_exp_f32 v40, v40
    v_mfma_f32_16x16x32_bf16 v[48:51], a[172:175], v[220:223], v[48:51]
    v_exp_f32 v41, v41
    v_mfma_f32_16x16x32_bf16 v[52:55], a[176:179], v[208:211], v[84:87]
    v_exp_f32 v42, v42
    v_mfma_f32_16x16x32_bf16 v[52:55], a[180:183], v[212:215], v[52:55]
    v_exp_f32 v43, v43
    v_mfma_f32_16x16x32_bf16 v[52:55], a[184:187], v[216:219], v[52:55]
    v_cvt_pk_bf16_f32 v100, v40, v41
    v_cvt_pk_bf16_f32 v101, v42, v43
    v_mfma_f32_16x16x32_bf16 v[52:55], a[188:191], v[220:223], v[52:55]
    v_exp_f32 v44, v44
    v_mfma_f32_16x16x32_bf16 v[32:35], a[160:163], v[224:227], v[88:91]
    v_exp_f32 v45, v45
    v_mfma_f32_16x16x32_bf16 v[32:35], a[164:167], v[228:231], v[32:35]
    v_exp_f32 v46, v46
    v_mfma_f32_16x16x32_bf16 v[32:35], a[168:171], v[232:235], v[32:35]
    v_exp_f32 v47, v47
    v_mfma_f32_16x16x32_bf16 v[32:35], a[172:175], v[236:239], v[32:35]
    v_cvt_pk_bf16_f32 v102, v44, v45
    v_cvt_pk_bf16_f32 v103, v46, v47
    v_mfma_f32_16x16x32_bf16 v[36:39], a[176:179], v[224:227], v[88:91]
    v_exp_f32 v48, v48
    v_mfma_f32_16x16x32_bf16 v[36:39], a[180:183], v[228:231], v[36:39]
    v_exp_f32 v49, v49
    v_mfma_f32_16x16x32_bf16 v[36:39], a[184:187], v[232:235], v[36:39]
    v_exp_f32 v50, v50
    v_mfma_f32_16x16x32_bf16 v[36:39], a[188:191], v[236:239], v[36:39]
    v_exp_f32 v51, v51
    v_mfma_f32_16x16x32_bf16 v[40:43], a[160:163], v[240:243], v[92:95]
    v_exp_f32 v52, v52
    v_mfma_f32_16x16x32_bf16 v[40:43], a[164:167], v[244:247], v[40:43]
    v_exp_f32 v53, v53
    v_mfma_f32_16x16x32_bf16 v[40:43], a[168:171], v[248:251], v[40:43]
    v_exp_f32 v54, v54
    v_mfma_f32_16x16x32_bf16 v[40:43], a[172:175], v[252:255], v[40:43]
    v_exp_f32 v55, v55
    v_mfma_f32_16x16x32_bf16 v[44:47], a[176:179], v[240:243], v[92:95]
    v_cvt_pk_bf16_f32 v104, v48, v49
    v_cvt_pk_bf16_f32 v105, v50, v51
    v_mfma_f32_16x16x32_bf16 v[44:47], a[180:183], v[244:247], v[44:47]
    v_cvt_pk_bf16_f32 v106, v52, v53
    v_cvt_pk_bf16_f32 v107, v54, v55
    v_mfma_f32_16x16x32_bf16 v[44:47], a[184:187], v[248:251], v[44:47]
    v_exp_f32 v32, v32
    v_mfma_f32_16x16x32_bf16 v[44:47], a[188:191], v[252:255], v[44:47]
    s_waitcnt lgkmcnt(0)
    s_barrier
    v_mfma_f32_16x16x32_bf16 a[16:19], a[236:239], v[56:59], a[16:19]
    v_exp_f32 v33, v33
    v_mfma_f32_16x16x32_bf16 a[16:19], a[192:195], v[96:99], a[16:19]
    v_exp_f32 v34, v34
    v_mfma_f32_16x16x32_bf16 a[20:23], a[240:243], v[56:59], a[20:23]
    v_exp_f32 v35, v35
    v_mfma_f32_16x16x32_bf16 a[20:23], a[196:199], v[96:99], a[20:23]
    v_exp_f32 v36, v36
    v_mfma_f32_16x16x32_bf16 a[24:27], a[248:251], v[56:59], a[24:27]
    v_exp_f32 v37, v37
    v_mfma_f32_16x16x32_bf16 a[24:27], a[200:203], v[96:99], a[24:27]
    v_exp_f32 v38, v38
    v_mfma_f32_16x16x32_bf16 a[28:31], a[252:255], v[56:59], a[28:31]
    v_exp_f32 v39, v39
    v_mfma_f32_16x16x32_bf16 a[28:31], a[204:207], v[96:99], a[28:31]
    v_cvt_pk_bf16_f32 v108, v32, v33
    v_cvt_pk_bf16_f32 v109, v34, v35
    v_mfma_f32_16x16x32_bf16 a[48:51], a[236:239], v[60:63], a[48:51]
    v_cvt_pk_bf16_f32 v110, v36, v37
    v_cvt_pk_bf16_f32 v111, v38, v39
    v_mfma_f32_16x16x32_bf16 a[48:51], a[192:195], v[100:103], a[48:51]
    v_exp_f32 v40, v40
    v_mfma_f32_16x16x32_bf16 a[52:55], a[240:243], v[60:63], a[52:55]
    v_exp_f32 v41, v41
    v_mfma_f32_16x16x32_bf16 a[52:55], a[196:199], v[100:103], a[52:55]
    v_exp_f32 v42, v42
    v_mfma_f32_16x16x32_bf16 a[56:59], a[248:251], v[60:63], a[56:59]
    v_exp_f32 v43, v43
    v_mfma_f32_16x16x32_bf16 a[56:59], a[200:203], v[100:103], a[56:59]
    v_exp_f32 v44, v44
    v_mfma_f32_16x16x32_bf16 a[60:63], a[252:255], v[60:63], a[60:63]
    v_exp_f32 v45, v45
    v_mfma_f32_16x16x32_bf16 a[60:63], a[204:207], v[100:103], a[60:63]
    v_exp_f32 v46, v46
    v_smfmac_f32_16x16x64_bf16 a[224:227], a[244:247], v[96:103], v74
    v_cvt_pk_bf16_f32 v20, v40, v41
    v_mfma_f32_16x16x32_bf16 a[80:83], a[236:239], v[64:67], a[80:83]
    v_exp_f32 v47, v47
    v_mfma_f32_16x16x32_bf16 a[80:83], a[192:195], v[104:107], a[80:83]
    v_cvt_pk_bf16_f32 v21, v42, v43
    v_cvt_pk_bf16_f32 v22, v44, v45
    v_mfma_f32_16x16x32_bf16 a[84:87], a[240:243], v[64:67], a[84:87]
    v_cvt_pk_bf16_f32 v23, v46, v47
    v_mfma_f32_16x16x32_bf16 a[84:87], a[196:199], v[104:107], a[84:87]
    ds_read_b128 a[160:163], v4 offset:32768
    v_mfma_f32_16x16x32_bf16 a[88:91], a[248:251], v[64:67], a[88:91]
    ds_read_b128 a[164:167], v5 offset:32768
    v_mfma_f32_16x16x32_bf16 a[88:91], a[200:203], v[104:107], a[88:91]
    ds_read_b128 a[168:171], v6 offset:32768
    v_mfma_f32_16x16x32_bf16 a[92:95], a[252:255], v[64:67], a[92:95]
    ds_read_b128 a[172:175], v7 offset:32768
    v_mfma_f32_16x16x32_bf16 a[92:95], a[204:207], v[104:107], a[92:95]
    ds_read_b128 a[176:179], v4 offset:36864
    v_mfma_f32_16x16x32_bf16 a[112:115], a[236:239], v[68:71], a[112:115]
    ds_read_b128 a[180:183], v5 offset:36864
    v_mfma_f32_16x16x32_bf16 a[112:115], a[192:195], v[108:111], a[112:115]
    ds_read_b128 a[184:187], v6 offset:36864
    v_mfma_f32_16x16x32_bf16 a[116:119], a[240:243], v[68:71], a[116:119]
    ds_read_b128 a[188:191], v7 offset:36864
    v_mfma_f32_16x16x32_bf16 a[116:119], a[196:199], v[108:111], a[116:119]
    v_mfma_f32_16x16x32_bf16 a[120:123], a[248:251], v[68:71], a[120:123]
    v_mfma_f32_16x16x32_bf16 a[120:123], a[200:203], v[108:111], a[120:123]
    v_mfma_f32_16x16x32_bf16 a[124:127], a[252:255], v[68:71], a[124:127]
    v_mfma_f32_16x16x32_bf16 a[124:127], a[204:207], v[108:111], a[124:127]
    v_mfma_f32_16x16x32_bf16 a[144:147], a[236:239], v[16:19], a[144:147]
    v_mfma_f32_16x16x32_bf16 a[144:147], a[192:195], v[20:23], a[144:147]
    ds_read_b64_tr_b16 a[192:193], v8 offset:40960
    v_mfma_f32_16x16x32_bf16 a[148:151], a[240:243], v[16:19], a[148:151]
    ds_read_b64_tr_b16 a[194:195], v8 offset:45056
    v_mfma_f32_16x16x32_bf16 a[148:151], a[196:199], v[20:23], a[148:151]
    ds_read_b64_tr_b16 a[196:197], v9 offset:40960
    v_mfma_f32_16x16x32_bf16 a[152:155], a[248:251], v[16:19], a[152:155]
    ds_read_b64_tr_b16 a[198:199], v9 offset:45056
    v_mfma_f32_16x16x32_bf16 a[152:155], a[200:203], v[20:23], a[152:155]
    ds_read_b64_tr_b16 a[200:201], v10 offset:40960
    v_mfma_f32_16x16x32_bf16 a[156:159], a[252:255], v[16:19], a[156:159]
    ds_read_b64_tr_b16 a[202:203], v10 offset:45056
    v_mfma_f32_16x16x32_bf16 a[156:159], a[204:207], v[20:23], a[156:159]
    ds_read_b64_tr_b16 a[204:205], v11 offset:40960
    v_smfmac_f32_16x16x64_bf16 a[228:231], a[244:247], v[104:111], v74
    ds_read_b64_tr_b16 a[206:207], v11 offset:45056
    v_smfmac_f32_16x16x64_bf16 a[232:235], a[244:247], v[16:23], v74
    s_waitcnt lgkmcnt(8)
    v_mfma_f32_16x16x32_bf16 v[32:35], a[160:163], v[176:179], v[76:79]
    ds_read_b64_tr_b16 a[236:237], v12 offset:40960
    v_mfma_f32_16x16x32_bf16 v[32:35], a[164:167], v[180:183], v[32:35]
    ds_read_b64_tr_b16 a[238:239], v12 offset:45056
    v_mfma_f32_16x16x32_bf16 v[32:35], a[168:171], v[184:187], v[32:35]
    ds_read_b64_tr_b16 a[240:241], v13 offset:40960
    v_mfma_f32_16x16x32_bf16 v[32:35], a[172:175], v[188:191], v[32:35]
    ds_read_b64_tr_b16 a[242:243], v13 offset:45056
    v_mfma_f32_16x16x32_bf16 v[36:39], a[176:179], v[176:179], v[76:79]
    ds_read_b64_tr_b16 a[248:249], v14 offset:40960
    v_mfma_f32_16x16x32_bf16 v[36:39], a[180:183], v[180:183], v[36:39]
    ds_read_b64_tr_b16 a[250:251], v14 offset:45056
    v_mfma_f32_16x16x32_bf16 v[36:39], a[184:187], v[184:187], v[36:39]
    ds_read_b64_tr_b16 a[252:253], v15 offset:40960
    v_mfma_f32_16x16x32_bf16 v[36:39], a[188:191], v[188:191], v[36:39]
    ds_read_b64_tr_b16 a[254:255], v15 offset:45056
    v_mfma_f32_16x16x32_bf16 v[40:43], a[160:163], v[192:195], v[80:83]
    v_exp_f32 v32, v32
    v_mfma_f32_16x16x32_bf16 v[40:43], a[164:167], v[196:199], v[40:43]
    v_exp_f32 v33, v33
    v_mfma_f32_16x16x32_bf16 v[40:43], a[168:171], v[200:203], v[40:43]
    v_exp_f32 v34, v34
    v_mfma_f32_16x16x32_bf16 v[40:43], a[172:175], v[204:207], v[40:43]
    v_exp_f32 v35, v35
    v_mfma_f32_16x16x32_bf16 v[44:47], a[176:179], v[192:195], v[80:83]
    v_cvt_pk_bf16_f32 v56, v32, v33
    v_cvt_pk_bf16_f32 v57, v34, v35
    v_mfma_f32_16x16x32_bf16 v[44:47], a[180:183], v[196:199], v[44:47]
    v_exp_f32 v36, v36
    v_mfma_f32_16x16x32_bf16 v[44:47], a[184:187], v[200:203], v[44:47]
    v_exp_f32 v37, v37
    v_mfma_f32_16x16x32_bf16 v[44:47], a[188:191], v[204:207], v[44:47]
    v_exp_f32 v38, v38
    v_mfma_f32_16x16x32_bf16 v[48:51], a[160:163], v[208:211], v[84:87]
    v_exp_f32 v39, v39
    v_mfma_f32_16x16x32_bf16 v[48:51], a[164:167], v[212:215], v[48:51]
    v_cvt_pk_bf16_f32 v58, v36, v37
    v_cvt_pk_bf16_f32 v59, v38, v39
    v_mfma_f32_16x16x32_bf16 v[48:51], a[168:171], v[216:219], v[48:51]
    v_exp_f32 v40, v40
    v_mfma_f32_16x16x32_bf16 v[48:51], a[172:175], v[220:223], v[48:51]
    v_exp_f32 v41, v41
    v_mfma_f32_16x16x32_bf16 v[52:55], a[176:179], v[208:211], v[84:87]
    v_exp_f32 v42, v42
    v_mfma_f32_16x16x32_bf16 v[52:55], a[180:183], v[212:215], v[52:55]
    v_exp_f32 v43, v43
    v_mfma_f32_16x16x32_bf16 v[52:55], a[184:187], v[216:219], v[52:55]
    v_cvt_pk_bf16_f32 v60, v40, v41
    v_cvt_pk_bf16_f32 v61, v42, v43
    v_mfma_f32_16x16x32_bf16 v[52:55], a[188:191], v[220:223], v[52:55]
    v_exp_f32 v44, v44
    v_mfma_f32_16x16x32_bf16 v[32:35], a[160:163], v[224:227], v[88:91]
    v_exp_f32 v45, v45
    v_mfma_f32_16x16x32_bf16 v[32:35], a[164:167], v[228:231], v[32:35]
    v_exp_f32 v46, v46
    v_mfma_f32_16x16x32_bf16 v[32:35], a[168:171], v[232:235], v[32:35]
    v_exp_f32 v47, v47
    v_mfma_f32_16x16x32_bf16 v[32:35], a[172:175], v[236:239], v[32:35]
    v_cvt_pk_bf16_f32 v62, v44, v45
    v_cvt_pk_bf16_f32 v63, v46, v47
    v_mfma_f32_16x16x32_bf16 v[36:39], a[176:179], v[224:227], v[88:91]
    v_exp_f32 v48, v48
    v_mfma_f32_16x16x32_bf16 v[36:39], a[180:183], v[228:231], v[36:39]
    v_exp_f32 v49, v49
    v_mfma_f32_16x16x32_bf16 v[36:39], a[184:187], v[232:235], v[36:39]
    v_exp_f32 v50, v50
    v_mfma_f32_16x16x32_bf16 v[36:39], a[188:191], v[236:239], v[36:39]
    v_exp_f32 v51, v51
    v_mfma_f32_16x16x32_bf16 v[40:43], a[160:163], v[240:243], v[92:95]
    v_exp_f32 v52, v52
    v_mfma_f32_16x16x32_bf16 v[40:43], a[164:167], v[244:247], v[40:43]
    v_exp_f32 v53, v53
    v_mfma_f32_16x16x32_bf16 v[40:43], a[168:171], v[248:251], v[40:43]
    v_exp_f32 v54, v54
    v_mfma_f32_16x16x32_bf16 v[40:43], a[172:175], v[252:255], v[40:43]
    v_exp_f32 v55, v55
    v_mfma_f32_16x16x32_bf16 v[44:47], a[176:179], v[240:243], v[92:95]
    v_cvt_pk_bf16_f32 v64, v48, v49
    v_cvt_pk_bf16_f32 v65, v50, v51
    v_mfma_f32_16x16x32_bf16 v[44:47], a[180:183], v[244:247], v[44:47]
    v_cvt_pk_bf16_f32 v66, v52, v53
    v_cvt_pk_bf16_f32 v67, v54, v55
    v_mfma_f32_16x16x32_bf16 v[44:47], a[184:187], v[248:251], v[44:47]
    v_exp_f32 v32, v32
    v_mfma_f32_16x16x32_bf16 v[44:47], a[188:191], v[252:255], v[44:47]
    s_waitcnt vmcnt(0) lgkmcnt(0)
    s_barrier
    v_mfma_f32_16x16x32_bf16 a[0:3], a[208:211], v[96:99], a[0:3]
    v_exp_f32 v33, v33
    v_mfma_f32_16x16x32_bf16 a[0:3], a[192:195], v[56:59], a[0:3]
    v_exp_f32 v34, v34
    v_mfma_f32_16x16x32_bf16 a[4:7], a[212:215], v[96:99], a[4:7]
    v_exp_f32 v35, v35
    v_mfma_f32_16x16x32_bf16 a[4:7], a[196:199], v[56:59], a[4:7]
    v_exp_f32 v36, v36
    v_mfma_f32_16x16x32_bf16 a[8:11], a[216:219], v[96:99], a[8:11]
    v_exp_f32 v37, v37
    v_mfma_f32_16x16x32_bf16 a[8:11], a[200:203], v[56:59], a[8:11]
    v_exp_f32 v38, v38
    v_mfma_f32_16x16x32_bf16 a[12:15], a[220:223], v[96:99], a[12:15]
    v_exp_f32 v39, v39
    v_mfma_f32_16x16x32_bf16 a[12:15], a[204:207], v[56:59], a[12:15]
    v_cvt_pk_bf16_f32 v68, v32, v33
    v_cvt_pk_bf16_f32 v69, v34, v35
    v_mfma_f32_16x16x32_bf16 a[32:35], a[208:211], v[100:103], a[32:35]
    v_cvt_pk_bf16_f32 v70, v36, v37
    v_cvt_pk_bf16_f32 v71, v38, v39
    v_mfma_f32_16x16x32_bf16 a[32:35], a[192:195], v[60:63], a[32:35]
    v_exp_f32 v40, v40
    v_mfma_f32_16x16x32_bf16 a[36:39], a[212:215], v[100:103], a[36:39]
    v_exp_f32 v41, v41
    v_mfma_f32_16x16x32_bf16 a[36:39], a[196:199], v[60:63], a[36:39]
    v_exp_f32 v42, v42
    v_mfma_f32_16x16x32_bf16 a[40:43], a[216:219], v[100:103], a[40:43]
    v_exp_f32 v43, v43
    v_mfma_f32_16x16x32_bf16 a[40:43], a[200:203], v[60:63], a[40:43]
    v_exp_f32 v44, v44
    v_mfma_f32_16x16x32_bf16 a[44:47], a[220:223], v[100:103], a[44:47]
    v_exp_f32 v45, v45
    v_mfma_f32_16x16x32_bf16 a[44:47], a[204:207], v[60:63], a[44:47]
    v_exp_f32 v46, v46
    v_smfmac_f32_16x16x64_bf16 a[224:227], a[244:247], v[56:63], v74
    v_cvt_pk_bf16_f32 v16, v40, v41
    v_mfma_f32_16x16x32_bf16 a[64:67], a[208:211], v[104:107], a[64:67]
    v_exp_f32 v47, v47
    v_mfma_f32_16x16x32_bf16 a[64:67], a[192:195], v[64:67], a[64:67]
    v_cvt_pk_bf16_f32 v17, v42, v43
    v_cvt_pk_bf16_f32 v18, v44, v45
    v_mfma_f32_16x16x32_bf16 a[68:71], a[212:215], v[104:107], a[68:71]
    v_cvt_pk_bf16_f32 v19, v46, v47
    v_mfma_f32_16x16x32_bf16 a[68:71], a[196:199], v[64:67], a[68:71]
    ds_read_b128 a[160:163], v4 offset:49152
    v_mfma_f32_16x16x32_bf16 a[72:75], a[216:219], v[104:107], a[72:75]
    ds_read_b128 a[164:167], v5 offset:49152
    v_mfma_f32_16x16x32_bf16 a[72:75], a[200:203], v[64:67], a[72:75]
    ds_read_b128 a[168:171], v6 offset:49152
    v_mfma_f32_16x16x32_bf16 a[76:79], a[220:223], v[104:107], a[76:79]
    ds_read_b128 a[172:175], v7 offset:49152
    v_mfma_f32_16x16x32_bf16 a[76:79], a[204:207], v[64:67], a[76:79]
    ds_read_b128 a[176:179], v4 offset:53248
    v_mfma_f32_16x16x32_bf16 a[96:99], a[208:211], v[108:111], a[96:99]
    ds_read_b128 a[180:183], v5 offset:53248
    v_mfma_f32_16x16x32_bf16 a[96:99], a[192:195], v[68:71], a[96:99]
    ds_read_b128 a[184:187], v6 offset:53248
    v_mfma_f32_16x16x32_bf16 a[100:103], a[212:215], v[108:111], a[100:103]
    ds_read_b128 a[188:191], v7 offset:53248
    v_mfma_f32_16x16x32_bf16 a[100:103], a[196:199], v[68:71], a[100:103]
    v_mfma_f32_16x16x32_bf16 a[104:107], a[216:219], v[108:111], a[104:107]
    v_mfma_f32_16x16x32_bf16 a[104:107], a[200:203], v[68:71], a[104:107]
    v_mfma_f32_16x16x32_bf16 a[108:111], a[220:223], v[108:111], a[108:111]
    v_mfma_f32_16x16x32_bf16 a[108:111], a[204:207], v[68:71], a[108:111]
    v_mfma_f32_16x16x32_bf16 a[128:131], a[208:211], v[20:23], a[128:131]
    v_mfma_f32_16x16x32_bf16 a[128:131], a[192:195], v[16:19], a[128:131]
    ds_read_b64_tr_b16 a[192:193], v12 offset:57344
    v_mfma_f32_16x16x32_bf16 a[132:135], a[212:215], v[20:23], a[132:135]
    ds_read_b64_tr_b16 a[194:195], v12 offset:61440
    v_mfma_f32_16x16x32_bf16 a[132:135], a[196:199], v[16:19], a[132:135]
    ds_read_b64_tr_b16 a[196:197], v13 offset:57344
    v_mfma_f32_16x16x32_bf16 a[136:139], a[216:219], v[20:23], a[136:139]
    ds_read_b64_tr_b16 a[198:199], v13 offset:61440
    v_mfma_f32_16x16x32_bf16 a[136:139], a[200:203], v[16:19], a[136:139]
    ds_read_b64_tr_b16 a[200:201], v14 offset:57344
    v_mfma_f32_16x16x32_bf16 a[140:143], a[220:223], v[20:23], a[140:143]
    ds_read_b64_tr_b16 a[202:203], v14 offset:61440
    v_mfma_f32_16x16x32_bf16 a[140:143], a[204:207], v[16:19], a[140:143]
    ds_read_b64_tr_b16 a[204:205], v15 offset:57344
    v_smfmac_f32_16x16x64_bf16 a[228:231], a[244:247], v[64:71], v74
    ds_read_b64_tr_b16 a[206:207], v15 offset:61440
    s_waitcnt lgkmcnt(8)
    v_mfma_f32_16x16x32_bf16 v[32:35], a[160:163], v[176:179], v[76:79]
    ds_read_b64_tr_b16 a[208:209], v8 offset:57344
    v_mfma_f32_16x16x32_bf16 v[32:35], a[164:167], v[180:183], v[32:35]
    ds_read_b64_tr_b16 a[210:211], v8 offset:61440
    v_mfma_f32_16x16x32_bf16 v[32:35], a[168:171], v[184:187], v[32:35]
    ds_read_b64_tr_b16 a[212:213], v9 offset:57344
    v_mfma_f32_16x16x32_bf16 v[32:35], a[172:175], v[188:191], v[32:35]
    ds_read_b64_tr_b16 a[214:215], v9 offset:61440
    v_mfma_f32_16x16x32_bf16 v[36:39], a[176:179], v[176:179], v[76:79]
    ds_read_b64_tr_b16 a[216:217], v10 offset:57344
    v_mfma_f32_16x16x32_bf16 v[36:39], a[180:183], v[180:183], v[36:39]
    ds_read_b64_tr_b16 a[218:219], v10 offset:61440
    v_mfma_f32_16x16x32_bf16 v[36:39], a[184:187], v[184:187], v[36:39]
    ds_read_b64_tr_b16 a[220:221], v11 offset:57344
    v_mfma_f32_16x16x32_bf16 v[36:39], a[188:191], v[188:191], v[36:39]
    ds_read_b64_tr_b16 a[222:223], v11 offset:61440
    v_mfma_f32_16x16x32_bf16 v[40:43], a[160:163], v[192:195], v[80:83]
    v_exp_f32 v32, v32
    v_mfma_f32_16x16x32_bf16 v[40:43], a[164:167], v[196:199], v[40:43]
    v_exp_f32 v33, v33
    v_mfma_f32_16x16x32_bf16 v[40:43], a[168:171], v[200:203], v[40:43]
    v_exp_f32 v34, v34
    v_mfma_f32_16x16x32_bf16 v[40:43], a[172:175], v[204:207], v[40:43]
    v_exp_f32 v35, v35
    v_mfma_f32_16x16x32_bf16 v[44:47], a[176:179], v[192:195], v[80:83]
    v_cvt_pk_bf16_f32 v96, v32, v33
    v_cvt_pk_bf16_f32 v97, v34, v35
    v_mfma_f32_16x16x32_bf16 v[44:47], a[180:183], v[196:199], v[44:47]
    v_exp_f32 v36, v36
    v_mfma_f32_16x16x32_bf16 v[44:47], a[184:187], v[200:203], v[44:47]
    v_exp_f32 v37, v37
    v_mfma_f32_16x16x32_bf16 v[44:47], a[188:191], v[204:207], v[44:47]
    v_exp_f32 v38, v38
    v_mfma_f32_16x16x32_bf16 v[48:51], a[160:163], v[208:211], v[84:87]
    v_exp_f32 v39, v39
    v_mfma_f32_16x16x32_bf16 v[48:51], a[164:167], v[212:215], v[48:51]
    v_cvt_pk_bf16_f32 v98, v36, v37
    v_cvt_pk_bf16_f32 v99, v38, v39
    v_mfma_f32_16x16x32_bf16 v[48:51], a[168:171], v[216:219], v[48:51]
    v_exp_f32 v40, v40
    v_mfma_f32_16x16x32_bf16 v[48:51], a[172:175], v[220:223], v[48:51]
    v_exp_f32 v41, v41
    v_mfma_f32_16x16x32_bf16 v[52:55], a[176:179], v[208:211], v[84:87]
    v_exp_f32 v42, v42
    v_mfma_f32_16x16x32_bf16 v[52:55], a[180:183], v[212:215], v[52:55]
    v_exp_f32 v43, v43
    v_mfma_f32_16x16x32_bf16 v[52:55], a[184:187], v[216:219], v[52:55]
    v_cvt_pk_bf16_f32 v100, v40, v41
    v_cvt_pk_bf16_f32 v101, v42, v43
    v_mfma_f32_16x16x32_bf16 v[52:55], a[188:191], v[220:223], v[52:55]
    v_exp_f32 v44, v44
    v_mfma_f32_16x16x32_bf16 v[32:35], a[160:163], v[224:227], v[88:91]
    v_exp_f32 v45, v45
    v_mfma_f32_16x16x32_bf16 v[32:35], a[164:167], v[228:231], v[32:35]
    v_exp_f32 v46, v46
    v_mfma_f32_16x16x32_bf16 v[32:35], a[168:171], v[232:235], v[32:35]
    v_exp_f32 v47, v47
    v_mfma_f32_16x16x32_bf16 v[32:35], a[172:175], v[236:239], v[32:35]
    v_cvt_pk_bf16_f32 v102, v44, v45
    v_cvt_pk_bf16_f32 v103, v46, v47
    v_mfma_f32_16x16x32_bf16 v[36:39], a[176:179], v[224:227], v[88:91]
    v_exp_f32 v48, v48
    v_mfma_f32_16x16x32_bf16 v[36:39], a[180:183], v[228:231], v[36:39]
    v_exp_f32 v49, v49
    v_mfma_f32_16x16x32_bf16 v[36:39], a[184:187], v[232:235], v[36:39]
    v_exp_f32 v50, v50
    v_mfma_f32_16x16x32_bf16 v[36:39], a[188:191], v[236:239], v[36:39]
    v_exp_f32 v51, v51
    v_mfma_f32_16x16x32_bf16 v[40:43], a[160:163], v[240:243], v[92:95]
    v_exp_f32 v52, v52
    v_mfma_f32_16x16x32_bf16 v[40:43], a[164:167], v[244:247], v[40:43]
    v_exp_f32 v53, v53
    v_mfma_f32_16x16x32_bf16 v[40:43], a[168:171], v[248:251], v[40:43]
    v_exp_f32 v54, v54
    v_mfma_f32_16x16x32_bf16 v[40:43], a[172:175], v[252:255], v[40:43]
    v_exp_f32 v55, v55
    v_mfma_f32_16x16x32_bf16 v[44:47], a[176:179], v[240:243], v[92:95]
    v_cvt_pk_bf16_f32 v104, v48, v49
    v_cvt_pk_bf16_f32 v105, v50, v51
    v_mfma_f32_16x16x32_bf16 v[44:47], a[180:183], v[244:247], v[44:47]
    v_cvt_pk_bf16_f32 v106, v52, v53
    v_cvt_pk_bf16_f32 v107, v54, v55
    v_mfma_f32_16x16x32_bf16 v[44:47], a[184:187], v[248:251], v[44:47]
    v_exp_f32 v32, v32
    v_mfma_f32_16x16x32_bf16 v[44:47], a[188:191], v[252:255], v[44:47]
    s_waitcnt lgkmcnt(0)
    s_barrier
    v_mfma_f32_16x16x32_bf16 a[16:19], a[236:239], v[56:59], a[16:19]
    v_exp_f32 v33, v33
    v_mfma_f32_16x16x32_bf16 a[16:19], a[192:195], v[96:99], a[16:19]
    v_exp_f32 v34, v34
    v_mfma_f32_16x16x32_bf16 a[20:23], a[240:243], v[56:59], a[20:23]
    v_exp_f32 v35, v35
    v_mfma_f32_16x16x32_bf16 a[20:23], a[196:199], v[96:99], a[20:23]
    v_exp_f32 v36, v36
    v_mfma_f32_16x16x32_bf16 a[24:27], a[248:251], v[56:59], a[24:27]
    v_exp_f32 v37, v37
    v_mfma_f32_16x16x32_bf16 a[24:27], a[200:203], v[96:99], a[24:27]
    v_exp_f32 v38, v38
    v_mfma_f32_16x16x32_bf16 a[28:31], a[252:255], v[56:59], a[28:31]
    v_exp_f32 v39, v39
    v_mfma_f32_16x16x32_bf16 a[28:31], a[204:207], v[96:99], a[28:31]
    v_cvt_pk_bf16_f32 v108, v32, v33
    v_cvt_pk_bf16_f32 v109, v34, v35
    v_mfma_f32_16x16x32_bf16 a[48:51], a[236:239], v[60:63], a[48:51]
    v_cvt_pk_bf16_f32 v110, v36, v37
    v_cvt_pk_bf16_f32 v111, v38, v39
    v_mfma_f32_16x16x32_bf16 a[48:51], a[192:195], v[100:103], a[48:51]
    v_exp_f32 v40, v40
    v_mfma_f32_16x16x32_bf16 a[52:55], a[240:243], v[60:63], a[52:55]
    v_exp_f32 v41, v41
    v_mfma_f32_16x16x32_bf16 a[52:55], a[196:199], v[100:103], a[52:55]
    v_exp_f32 v42, v42
    v_mfma_f32_16x16x32_bf16 a[56:59], a[248:251], v[60:63], a[56:59]
    v_exp_f32 v43, v43
    v_mfma_f32_16x16x32_bf16 a[56:59], a[200:203], v[100:103], a[56:59]
    v_exp_f32 v44, v44
    v_mfma_f32_16x16x32_bf16 a[60:63], a[252:255], v[60:63], a[60:63]
    v_exp_f32 v45, v45
    v_mfma_f32_16x16x32_bf16 a[60:63], a[204:207], v[100:103], a[60:63]
    v_exp_f32 v46, v46
    v_smfmac_f32_16x16x64_bf16 a[224:227], a[244:247], v[96:103], v74
    v_cvt_pk_bf16_f32 v20, v40, v41
    v_mfma_f32_16x16x32_bf16 a[80:83], a[236:239], v[64:67], a[80:83]
    v_exp_f32 v47, v47
    v_mfma_f32_16x16x32_bf16 a[80:83], a[192:195], v[104:107], a[80:83]
    v_cvt_pk_bf16_f32 v21, v42, v43
    v_cvt_pk_bf16_f32 v22, v44, v45
    v_mfma_f32_16x16x32_bf16 a[84:87], a[240:243], v[64:67], a[84:87]
    v_cvt_pk_bf16_f32 v23, v46, v47
    v_mfma_f32_16x16x32_bf16 a[84:87], a[196:199], v[104:107], a[84:87]
    ds_read_b128 a[160:163], v4 offset:0
    v_mfma_f32_16x16x32_bf16 a[88:91], a[248:251], v[64:67], a[88:91]
    ds_read_b128 a[164:167], v5 offset:0
    v_mfma_f32_16x16x32_bf16 a[88:91], a[200:203], v[104:107], a[88:91]
    ds_read_b128 a[168:171], v6 offset:0
    v_mfma_f32_16x16x32_bf16 a[92:95], a[252:255], v[64:67], a[92:95]
    ds_read_b128 a[172:175], v7 offset:0
    v_mfma_f32_16x16x32_bf16 a[92:95], a[204:207], v[104:107], a[92:95]
    ds_read_b128 a[176:179], v4 offset:4096
    v_mfma_f32_16x16x32_bf16 a[112:115], a[236:239], v[68:71], a[112:115]
    ds_read_b128 a[180:183], v5 offset:4096
    v_mfma_f32_16x16x32_bf16 a[112:115], a[192:195], v[108:111], a[112:115]
    ds_read_b128 a[184:187], v6 offset:4096
    v_mfma_f32_16x16x32_bf16 a[116:119], a[240:243], v[68:71], a[116:119]
    ds_read_b128 a[188:191], v7 offset:4096
    v_mfma_f32_16x16x32_bf16 a[116:119], a[196:199], v[108:111], a[116:119]
    s_sub_u32 s35, s35, 1
    s_bitcmp1_b32 s26, s35
    v_mfma_f32_16x16x32_bf16 a[120:123], a[248:251], v[68:71], a[120:123]
    v_mfma_f32_16x16x32_bf16 a[120:123], a[200:203], v[108:111], a[120:123]
    v_mfma_f32_16x16x32_bf16 a[124:127], a[252:255], v[68:71], a[124:127]
    v_mfma_f32_16x16x32_bf16 a[124:127], a[204:207], v[108:111], a[124:127]
    v_mfma_f32_16x16x32_bf16 a[144:147], a[236:239], v[16:19], a[144:147]
    v_mfma_f32_16x16x32_bf16 a[144:147], a[192:195], v[20:23], a[144:147]
    ds_read_b64_tr_b16 a[192:193], v8 offset:8192
    v_mfma_f32_16x16x32_bf16 a[148:151], a[240:243], v[16:19], a[148:151]
    ds_read_b64_tr_b16 a[194:195], v8 offset:12288
    v_mfma_f32_16x16x32_bf16 a[148:151], a[196:199], v[20:23], a[148:151]
    ds_read_b64_tr_b16 a[196:197], v9 offset:8192
    v_mfma_f32_16x16x32_bf16 a[152:155], a[248:251], v[16:19], a[152:155]
    ds_read_b64_tr_b16 a[198:199], v9 offset:12288
    v_mfma_f32_16x16x32_bf16 a[152:155], a[200:203], v[20:23], a[152:155]
    ds_read_b64_tr_b16 a[200:201], v10 offset:8192
    v_mfma_f32_16x16x32_bf16 a[156:159], a[252:255], v[16:19], a[156:159]
    ds_read_b64_tr_b16 a[202:203], v10 offset:12288
    v_mfma_f32_16x16x32_bf16 a[156:159], a[204:207], v[20:23], a[156:159]
    ds_read_b64_tr_b16 a[204:205], v11 offset:8192
    v_smfmac_f32_16x16x64_bf16 a[228:231], a[244:247], v[104:111], v74
    ds_read_b64_tr_b16 a[206:207], v11 offset:12288
    v_smfmac_f32_16x16x64_bf16 a[232:235], a[244:247], v[16:23], v74
    s_cbranch_scc1 L_loop5
    s_cmp_gt_u32 s35, 1
    s_cbranch_scc1 L_loopS5
    s_cmp_eq_u32 s35, 0
    s_cbranch_scc1 L_t15
    s_waitcnt lgkmcnt(8)
    v_mfma_f32_16x16x32_bf16 v[32:35], a[160:163], v[176:179], v[76:79]
    ds_read_b64_tr_b16 a[236:237], v12 offset:8192
    v_mfma_f32_16x16x32_bf16 v[32:35], a[164:167], v[180:183], v[32:35]
    ds_read_b64_tr_b16 a[238:239], v12 offset:12288
    v_mfma_f32_16x16x32_bf16 v[32:35], a[168:171], v[184:187], v[32:35]
    ds_read_b64_tr_b16 a[240:241], v13 offset:8192
    v_mfma_f32_16x16x32_bf16 v[32:35], a[172:175], v[188:191], v[32:35]
    ds_read_b64_tr_b16 a[242:243], v13 offset:12288
    v_mfma_f32_16x16x32_bf16 v[36:39], a[176:179], v[176:179], v[76:79]
    ds_read_b64_tr_b16 a[248:249], v14 offset:8192
    v_mfma_f32_16x16x32_bf16 v[36:39], a[180:183], v[180:183], v[36:39]
    ds_read_b64_tr_b16 a[250:251], v14 offset:12288
    v_mfma_f32_16x16x32_bf16 v[36:39], a[184:187], v[184:187], v[36:39]
    ds_read_b64_tr_b16 a[252:253], v15 offset:8192
    v_mfma_f32_16x16x32_bf16 v[36:39], a[188:191], v[188:191], v[36:39]
    ds_read_b64_tr_b16 a[254:255], v15 offset:12288
    v_mfma_f32_16x16x32_bf16 v[40:43], a[160:163], v[192:195], v[80:83]
    v_exp_f32 v32, v32
    v_mfma_f32_16x16x32_bf16 v[40:43], a[164:167], v[196:199], v[40:43]
    v_exp_f32 v33, v33
    v_mfma_f32_16x16x32_bf16 v[40:43], a[168:171], v[200:203], v[40:43]
    v_exp_f32 v34, v34
    v_mfma_f32_16x16x32_bf16 v[40:43], a[172:175], v[204:207], v[40:43]
    v_exp_f32 v35, v35
    v_mfma_f32_16x16x32_bf16 v[44:47], a[176:179], v[192:195], v[80:83]
    v_cvt_pk_bf16_f32 v56, v32, v33
    v_cvt_pk_bf16_f32 v57, v34, v35
    v_mfma_f32_16x16x32_bf16 v[44:47], a[180:183], v[196:199], v[44:47]
    v_exp_f32 v36, v36
    v_mfma_f32_16x16x32_bf16 v[44:47], a[184:187], v[200:203], v[44:47]
    v_exp_f32 v37, v37
    v_mfma_f32_16x16x32_bf16 v[44:47], a[188:191], v[204:207], v[44:47]
    v_exp_f32 v38, v38
    v_mfma_f32_16x16x32_bf16 v[48:51], a[160:163], v[208:211], v[84:87]
    v_exp_f32 v39, v39
    v_mfma_f32_16x16x32_bf16 v[48:51], a[164:167], v[212:215], v[48:51]
    v_cvt_pk_bf16_f32 v58, v36, v37
    v_cvt_pk_bf16_f32 v59, v38, v39
    v_mfma_f32_16x16x32_bf16 v[48:51], a[168:171], v[216:219], v[48:51]
    v_exp_f32 v40, v40
    v_mfma_f32_16x16x32_bf16 v[48:51], a[172:175], v[220:223], v[48:51]
    v_exp_f32 v41, v41
    v_mfma_f32_16x16x32_bf16 v[52:55], a[176:179], v[208:211], v[84:87]
    v_exp_f32 v42, v42
    v_mfma_f32_16x16x32_bf16 v[52:55], a[180:183], v[212:215], v[52:55]
    v_exp_f32 v43, v43
    v_mfma_f32_16x16x32_bf16 v[52:55], a[184:187], v[216:219], v[52:55]
    v_cvt_pk_bf16_f32 v60, v40, v41
    v_cvt_pk_bf16_f32 v61, v42, v43
    v_mfma_f32_16x16x32_bf16 v[52:55], a[188:191], v[220:223], v[52:55]
    v_exp_f32 v44, v44
    v_mfma_f32_16x16x32_bf16 v[32:35], a[160:163], v[224:227], v[88:91]
    v_exp_f32 v45, v45
    v_mfma_f32_16x16x32_bf16 v[32:35], a[164:167], v[228:231], v[32:35]
    v_exp_f32 v46, v46
    v_mfma_f32_16x16x32_bf16 v[32:35], a[168:171], v[232:235], v[32:35]
    v_exp_f32 v47, v47
    v_mfma_f32_16x16x32_bf16 v[32:35], a[172:175], v[236:239], v[32:35]
    v_cvt_pk_bf16_f32 v62, v44, v45
    v_cvt_pk_bf16_f32 v63, v46, v47
    v_mfma_f32_16x16x32_bf16 v[36:39], a[176:179], v[224:227], v[88:91]
    v_exp_f32 v48, v48
    v_mfma_f32_16x16x32_bf16 v[36:39], a[180:183], v[228:231], v[36:39]
    v_exp_f32 v49, v49
    v_mfma_f32_16x16x32_bf16 v[36:39], a[184:187], v[232:235], v[36:39]
    v_exp_f32 v50, v50
    v_mfma_f32_16x16x32_bf16 v[36:39], a[188:191], v[236:239], v[36:39]
    v_exp_f32 v51, v51
    v_mfma_f32_16x16x32_bf16 v[40:43], a[160:163], v[240:243], v[92:95]
    v_exp_f32 v52, v52
    v_mfma_f32_16x16x32_bf16 v[40:43], a[164:167], v[244:247], v[40:43]
    v_exp_f32 v53, v53
    v_mfma_f32_16x16x32_bf16 v[40:43], a[168:171], v[248:251], v[40:43]
    v_exp_f32 v54, v54
    v_mfma_f32_16x16x32_bf16 v[40:43], a[172:175], v[252:255], v[40:43]
    v_exp_f32 v55, v55
    v_mfma_f32_16x16x32_bf16 v[44:47], a[176:179], v[240:243], v[92:95]
    v_cvt_pk_bf16_f32 v64, v48, v49
    v_cvt_pk_bf16_f32 v65, v50, v51
    v_mfma_f32_16x16x32_bf16 v[44:47], a[180:183], v[244:247], v[44:47]
    v_cvt_pk_bf16_f32 v66, v52, v53
    v_cvt_pk_bf16_f32 v67, v54, v55
    v_mfma_f32_16x16x32_bf16 v[44:47], a[184:187], v[248:251], v[44:47]
    v_exp_f32 v32, v32
    v_mfma_f32_16x16x32_bf16 v[44:47], a[188:191], v[252:255], v[44:47]
    s_waitcnt lgkmcnt(0)
    s_barrier
    v_mfma_f32_16x16x32_bf16 a[0:3], a[208:211], v[96:99], a[0:3]
    v_exp_f32 v33, v33
    v_mfma_f32_16x16x32_bf16 a[0:3], a[192:195], v[56:59], a[0:3]
    v_exp_f32 v34, v34
    v_mfma_f32_16x16x32_bf16 a[4:7], a[212:215], v[96:99], a[4:7]
    v_exp_f32 v35, v35
    v_mfma_f32_16x16x32_bf16 a[4:7], a[196:199], v[56:59], a[4:7]
    v_exp_f32 v36, v36
    v_mfma_f32_16x16x32_bf16 a[8:11], a[216:219], v[96:99], a[8:11]
    v_exp_f32 v37, v37
    v_mfma_f32_16x16x32_bf16 a[8:11], a[200:203], v[56:59], a[8:11]
    v_exp_f32 v38, v38
    v_mfma_f32_16x16x32_bf16 a[12:15], a[220:223], v[96:99], a[12:15]
    v_exp_f32 v39, v39
    v_mfma_f32_16x16x32_bf16 a[12:15], a[204:207], v[56:59], a[12:15]
    v_cvt_pk_bf16_f32 v68, v32, v33
    v_cvt_pk_bf16_f32 v69, v34, v35
    v_mfma_f32_16x16x32_bf16 a[32:35], a[208:211], v[100:103], a[32:35]
    v_cvt_pk_bf16_f32 v70, v36, v37
    v_cvt_pk_bf16_f32 v71, v38, v39
    v_mfma_f32_16x16x32_bf16 a[32:35], a[192:195], v[60:63], a[32:35]
    v_exp_f32 v40, v40
    v_mfma_f32_16x16x32_bf16 a[36:39], a[212:215], v[100:103], a[36:39]
    v_exp_f32 v41, v41
    v_mfma_f32_16x16x32_bf16 a[36:39], a[196:199], v[60:63], a[36:39]
    v_exp_f32 v42, v42
    v_mfma_f32_16x16x32_bf16 a[40:43], a[216:219], v[100:103], a[40:43]
    v_exp_f32 v43, v43
    v_mfma_f32_16x16x32_bf16 a[40:43], a[200:203], v[60:63], a[40:43]
    v_exp_f32 v44, v44
    v_mfma_f32_16x16x32_bf16 a[44:47], a[220:223], v[100:103], a[44:47]
    v_exp_f32 v45, v45
    v_mfma_f32_16x16x32_bf16 a[44:47], a[204:207], v[60:63], a[44:47]
    v_exp_f32 v46, v46
    v_smfmac_f32_16x16x64_bf16 a[224:227], a[244:247], v[56:63], v74
    v_cvt_pk_bf16_f32 v16, v40, v41
    v_mfma_f32_16x16x32_bf16 a[64:67], a[208:211], v[104:107], a[64:67]
    v_exp_f32 v47, v47
    v_mfma_f32_16x16x32_bf16 a[64:67], a[192:195], v[64:67], a[64:67]
    v_cvt_pk_bf16_f32 v17, v42, v43
    v_cvt_pk_bf16_f32 v18, v44, v45
    v_mfma_f32_16x16x32_bf16 a[68:71], a[212:215], v[104:107], a[68:71]
    v_cvt_pk_bf16_f32 v19, v46, v47
    v_mfma_f32_16x16x32_bf16 a[68:71], a[196:199], v[64:67], a[68:71]
    ds_read_b128 a[160:163], v4 offset:16384
    v_mfma_f32_16x16x32_bf16 a[72:75], a[216:219], v[104:107], a[72:75]
    ds_read_b128 a[164:167], v5 offset:16384
    v_mfma_f32_16x16x32_bf16 a[72:75], a[200:203], v[64:67], a[72:75]
    ds_read_b128 a[168:171], v6 offset:16384
    v_mfma_f32_16x16x32_bf16 a[76:79], a[220:223], v[104:107], a[76:79]
    ds_read_b128 a[172:175], v7 offset:16384
    v_mfma_f32_16x16x32_bf16 a[76:79], a[204:207], v[64:67], a[76:79]
    ds_read_b128 a[176:179], v4 offset:20480
    v_mfma_f32_16x16x32_bf16 a[96:99], a[208:211], v[108:111], a[96:99]
    ds_read_b128 a[180:183], v5 offset:20480
    v_mfma_f32_16x16x32_bf16 a[96:99], a[192:195], v[68:71], a[96:99]
    ds_read_b128 a[184:187], v6 offset:20480
    v_mfma_f32_16x16x32_bf16 a[100:103], a[212:215], v[108:111], a[100:103]
    ds_read_b128 a[188:191], v7 offset:20480
    v_mfma_f32_16x16x32_bf16 a[100:103], a[196:199], v[68:71], a[100:103]
    v_mfma_f32_16x16x32_bf16 a[104:107], a[216:219], v[108:111], a[104:107]
    v_mfma_f32_16x16x32_bf16 a[104:107], a[200:203], v[68:71], a[104:107]
    v_mfma_f32_16x16x32_bf16 a[108:111], a[220:223], v[108:111], a[108:111]
    v_mfma_f32_16x16x32_bf16 a[108:111], a[204:207], v[68:71], a[108:111]
    v_mfma_f32_16x16x32_bf16 a[128:131], a[208:211], v[20:23], a[128:131]
    v_mfma_f32_16x16x32_bf16 a[128:131], a[192:195], v[16:19], a[128:131]
    ds_read_b64_tr_b16 a[192:193], v12 offset:24576
    v_mfma_f32_16x16x32_bf16 a[132:135], a[212:215], v[20:23], a[132:135]
    ds_read_b64_tr_b16 a[194:195], v12 offset:28672
    v_mfma_f32_16x16x32_bf16 a[132:135], a[196:199], v[16:19], a[132:135]
    ds_read_b64_tr_b16 a[196:197], v13 offset:24576
    v_mfma_f32_16x16x32_bf16 a[136:139], a[216:219], v[20:23], a[136:139]
    ds_read_b64_tr_b16 a[198:199], v13 offset:28672
    v_mfma_f32_16x16x32_bf16 a[136:139], a[200:203], v[16:19], a[136:139]
    ds_read_b64_tr_b16 a[200:201], v14 offset:24576
    v_mfma_f32_16x16x32_bf16 a[140:143], a[220:223], v[20:23], a[140:143]
    ds_read_b64_tr_b16 a[202:203], v14 offset:28672
    v_mfma_f32_16x16x32_bf16 a[140:143], a[204:207], v[16:19], a[140:143]
    ds_read_b64_tr_b16 a[204:205], v15 offset:24576
    v_smfmac_f32_16x16x64_bf16 a[228:231], a[244:247], v[64:71], v74
    ds_read_b64_tr_b16 a[206:207], v15 offset:28672
    s_waitcnt lgkmcnt(8)
    v_mfma_f32_16x16x32_bf16 v[32:35], a[160:163], v[176:179], v[76:79]
    ds_read_b64_tr_b16 a[208:209], v8 offset:24576
    v_mfma_f32_16x16x32_bf16 v[32:35], a[164:167], v[180:183], v[32:35]
    ds_read_b64_tr_b16 a[210:211], v8 offset:28672
    v_mfma_f32_16x16x32_bf16 v[32:35], a[168:171], v[184:187], v[32:35]
    ds_read_b64_tr_b16 a[212:213], v9 offset:24576
    v_mfma_f32_16x16x32_bf16 v[32:35], a[172:175], v[188:191], v[32:35]
    ds_read_b64_tr_b16 a[214:215], v9 offset:28672
    v_mfma_f32_16x16x32_bf16 v[36:39], a[176:179], v[176:179], v[76:79]
    ds_read_b64_tr_b16 a[216:217], v10 offset:24576
    v_mfma_f32_16x16x32_bf16 v[36:39], a[180:183], v[180:183], v[36:39]
    ds_read_b64_tr_b16 a[218:219], v10 offset:28672
    v_mfma_f32_16x16x32_bf16 v[36:39], a[184:187], v[184:187], v[36:39]
    ds_read_b64_tr_b16 a[220:221], v11 offset:24576
    v_mfma_f32_16x16x32_bf16 v[36:39], a[188:191], v[188:191], v[36:39]
    ds_read_b64_tr_b16 a[222:223], v11 offset:28672
    v_mfma_f32_16x16x32_bf16 v[40:43], a[160:163], v[192:195], v[80:83]
    v_exp_f32 v32, v32
    v_mfma_f32_16x16x32_bf16 v[40:43], a[164:167], v[196:199], v[40:43]
    v_exp_f32 v33, v33
    v_mfma_f32_16x16x32_bf16 v[40:43], a[168:171], v[200:203], v[40:43]
    v_exp_f32 v34, v34
    v_mfma_f32_16x16x32_bf16 v[40:43], a[172:175], v[204:207], v[40:43]
    v_exp_f32 v35, v35
    v_mfma_f32_16x16x32_bf16 v[44:47], a[176:179], v[192:195], v[80:83]
    v_cvt_pk_bf16_f32 v96, v32, v33
    v_cvt_pk_bf16_f32 v97, v34, v35
    v_mfma_f32_16x16x32_bf16 v[44:47], a[180:183], v[196:199], v[44:47]
    v_exp_f32 v36, v36
    v_mfma_f32_16x16x32_bf16 v[44:47], a[184:187], v[200:203], v[44:47]
    v_exp_f32 v37, v37
    v_mfma_f32_16x16x32_bf16 v[44:47], a[188:191], v[204:207], v[44:47]
    v_exp_f32 v38, v38
    v_mfma_f32_16x16x32_bf16 v[48:51], a[160:163], v[208:211], v[84:87]
    v_exp_f32 v39, v39
    v_mfma_f32_16x16x32_bf16 v[48:51], a[164:167], v[212:215], v[48:51]
    v_cvt_pk_bf16_f32 v98, v36, v37
    v_cvt_pk_bf16_f32 v99, v38, v39
    v_mfma_f32_16x16x32_bf16 v[48:51], a[168:171], v[216:219], v[48:51]
    v_exp_f32 v40, v40
    v_mfma_f32_16x16x32_bf16 v[48:51], a[172:175], v[220:223], v[48:51]
    v_exp_f32 v41, v41
    v_mfma_f32_16x16x32_bf16 v[52:55], a[176:179], v[208:211], v[84:87]
    v_exp_f32 v42, v42
    v_mfma_f32_16x16x32_bf16 v[52:55], a[180:183], v[212:215], v[52:55]
    v_exp_f32 v43, v43
    v_mfma_f32_16x16x32_bf16 v[52:55], a[184:187], v[216:219], v[52:55]
    v_cvt_pk_bf16_f32 v100, v40, v41
    v_cvt_pk_bf16_f32 v101, v42, v43
    v_mfma_f32_16x16x32_bf16 v[52:55], a[188:191], v[220:223], v[52:55]
    v_exp_f32 v44, v44
    v_mfma_f32_16x16x32_bf16 v[32:35], a[160:163], v[224:227], v[88:91]
    v_exp_f32 v45, v45
    v_mfma_f32_16x16x32_bf16 v[32:35], a[164:167], v[228:231], v[32:35]
    v_exp_f32 v46, v46
    v_mfma_f32_16x16x32_bf16 v[32:35], a[168:171], v[232:235], v[32:35]
    v_exp_f32 v47, v47
    v_mfma_f32_16x16x32_bf16 v[32:35], a[172:175], v[236:239], v[32:35]
    v_cvt_pk_bf16_f32 v102, v44, v45
    v_cvt_pk_bf16_f32 v103, v46, v47
    v_mfma_f32_16x16x32_bf16 v[36:39], a[176:179], v[224:227], v[88:91]
    v_exp_f32 v48, v48
    v_mfma_f32_16x16x32_bf16 v[36:39], a[180:183], v[228:231], v[36:39]
    v_exp_f32 v49, v49
    v_mfma_f32_16x16x32_bf16 v[36:39], a[184:187], v[232:235], v[36:39]
    v_exp_f32 v50, v50
    v_mfma_f32_16x16x32_bf16 v[36:39], a[188:191], v[236:239], v[36:39]
    v_exp_f32 v51, v51
    v_mfma_f32_16x16x32_bf16 v[40:43], a[160:163], v[240:243], v[92:95]
    v_exp_f32 v52, v52
    v_mfma_f32_16x16x32_bf16 v[40:43], a[164:167], v[244:247], v[40:43]
    v_exp_f32 v53, v53
    v_mfma_f32_16x16x32_bf16 v[40:43], a[168:171], v[248:251], v[40:43]
    v_exp_f32 v54, v54
    v_mfma_f32_16x16x32_bf16 v[40:43], a[172:175], v[252:255], v[40:43]
    v_exp_f32 v55, v55
    v_mfma_f32_16x16x32_bf16 v[44:47], a[176:179], v[240:243], v[92:95]
    v_cvt_pk_bf16_f32 v104, v48, v49
    v_cvt_pk_bf16_f32 v105, v50, v51
    v_mfma_f32_16x16x32_bf16 v[44:47], a[180:183], v[244:247], v[44:47]
    v_cvt_pk_bf16_f32 v106, v52, v53
    v_cvt_pk_bf16_f32 v107, v54, v55
    v_mfma_f32_16x16x32_bf16 v[44:47], a[184:187], v[248:251], v[44:47]
    v_exp_f32 v32, v32
    v_mfma_f32_16x16x32_bf16 v[44:47], a[188:191], v[252:255], v[44:47]
    s_waitcnt lgkmcnt(0)
    s_barrier
    v_mfma_f32_16x16x32_bf16 a[16:19], a[236:239], v[56:59], a[16:19]
    v_exp_f32 v33, v33
    v_mfma_f32_16x16x32_bf16 a[16:19], a[192:195], v[96:99], a[16:19]
    v_exp_f32 v34, v34
    v_mfma_f32_16x16x32_bf16 a[20:23], a[240:243], v[56:59], a[20:23]
    v_exp_f32 v35, v35
    v_mfma_f32_16x16x32_bf16 a[20:23], a[196:199], v[96:99], a[20:23]
    v_exp_f32 v36, v36
    v_mfma_f32_16x16x32_bf16 a[24:27], a[248:251], v[56:59], a[24:27]
    v_exp_f32 v37, v37
    v_mfma_f32_16x16x32_bf16 a[24:27], a[200:203], v[96:99], a[24:27]
    v_exp_f32 v38, v38
    v_mfma_f32_16x16x32_bf16 a[28:31], a[252:255], v[56:59], a[28:31]
    v_exp_f32 v39, v39
    v_mfma_f32_16x16x32_bf16 a[28:31], a[204:207], v[96:99], a[28:31]
    v_cvt_pk_bf16_f32 v108, v32, v33
    v_cvt_pk_bf16_f32 v109, v34, v35
    v_mfma_f32_16x16x32_bf16 a[48:51], a[236:239], v[60:63], a[48:51]
    v_cvt_pk_bf16_f32 v110, v36, v37
    v_cvt_pk_bf16_f32 v111, v38, v39
    v_mfma_f32_16x16x32_bf16 a[48:51], a[192:195], v[100:103], a[48:51]
    v_exp_f32 v40, v40
    v_mfma_f32_16x16x32_bf16 a[52:55], a[240:243], v[60:63], a[52:55]
    v_exp_f32 v41, v41
    v_mfma_f32_16x16x32_bf16 a[52:55], a[196:199], v[100:103], a[52:55]
    v_exp_f32 v42, v42
    v_mfma_f32_16x16x32_bf16 a[56:59], a[248:251], v[60:63], a[56:59]
    v_exp_f32 v43, v43
    v_mfma_f32_16x16x32_bf16 a[56:59], a[200:203], v[100:103], a[56:59]
    v_exp_f32 v44, v44
    v_mfma_f32_16x16x32_bf16 a[60:63], a[252:255], v[60:63], a[60:63]
    v_exp_f32 v45, v45
    v_mfma_f32_16x16x32_bf16 a[60:63], a[204:207], v[100:103], a[60:63]
    v_exp_f32 v46, v46
    v_smfmac_f32_16x16x64_bf16 a[224:227], a[244:247], v[96:103], v74
    v_cvt_pk_bf16_f32 v20, v40, v41
    v_mfma_f32_16x16x32_bf16 a[80:83], a[236:239], v[64:67], a[80:83]
    v_exp_f32 v47, v47
    v_mfma_f32_16x16x32_bf16 a[80:83], a[192:195], v[104:107], a[80:83]
    v_cvt_pk_bf16_f32 v21, v42, v43
    v_cvt_pk_bf16_f32 v22, v44, v45
    v_mfma_f32_16x16x32_bf16 a[84:87], a[240:243], v[64:67], a[84:87]
    v_cvt_pk_bf16_f32 v23, v46, v47
    v_mfma_f32_16x16x32_bf16 a[84:87], a[196:199], v[104:107], a[84:87]
    ds_read_b128 a[160:163], v4 offset:32768
    v_mfma_f32_16x16x32_bf16 a[88:91], a[248:251], v[64:67], a[88:91]
    ds_read_b128 a[164:167], v5 offset:32768
    v_mfma_f32_16x16x32_bf16 a[88:91], a[200:203], v[104:107], a[88:91]
    ds_read_b128 a[168:171], v6 offset:32768
    v_mfma_f32_16x16x32_bf16 a[92:95], a[252:255], v[64:67], a[92:95]
    ds_read_b128 a[172:175], v7 offset:32768
    v_mfma_f32_16x16x32_bf16 a[92:95], a[204:207], v[104:107], a[92:95]
    ds_read_b128 a[176:179], v4 offset:36864
    v_mfma_f32_16x16x32_bf16 a[112:115], a[236:239], v[68:71], a[112:115]
    ds_read_b128 a[180:183], v5 offset:36864
    v_mfma_f32_16x16x32_bf16 a[112:115], a[192:195], v[108:111], a[112:115]
    ds_read_b128 a[184:187], v6 offset:36864
    v_mfma_f32_16x16x32_bf16 a[116:119], a[240:243], v[68:71], a[116:119]
    ds_read_b128 a[188:191], v7 offset:36864
    v_mfma_f32_16x16x32_bf16 a[116:119], a[196:199], v[108:111], a[116:119]
    s_add_u32 m0, s96, 0
    s_add_u32 s49, s70, 256
    v_mfma_f32_16x16x32_bf16 a[120:123], a[248:251], v[68:71], a[120:123]
    buffer_load_dwordx4 v24, s[8:11], s49 offen offset:0 sc1 lds
    v_mfma_f32_16x16x32_bf16 a[120:123], a[200:203], v[108:111], a[120:123]
    buffer_load_dwordx4 v24, s[8:11], s49 offen offset:1024 sc1 lds
    v_mfma_f32_16x16x32_bf16 a[124:127], a[252:255], v[68:71], a[124:127]
    v_mfma_f32_16x16x32_bf16 a[124:127], a[204:207], v[108:111], a[124:127]
    v_mfma_f32_16x16x32_bf16 a[144:147], a[236:239], v[16:19], a[144:147]
    v_mfma_f32_16x16x32_bf16 a[144:147], a[192:195], v[20:23], a[144:147]
    ds_read_b64_tr_b16 a[192:193], v8 offset:40960
    v_mfma_f32_16x16x32_bf16 a[148:151], a[240:243], v[16:19], a[148:151]
    ds_read_b64_tr_b16 a[194:195], v8 offset:45056
    v_mfma_f32_16x16x32_bf16 a[148:151], a[196:199], v[20:23], a[148:151]
    ds_read_b64_tr_b16 a[196:197], v9 offset:40960
    v_mfma_f32_16x16x32_bf16 a[152:155], a[248:251], v[16:19], a[152:155]
    ds_read_b64_tr_b16 a[198:199], v9 offset:45056
    v_mfma_f32_16x16x32_bf16 a[152:155], a[200:203], v[20:23], a[152:155]
    ds_read_b64_tr_b16 a[200:201], v10 offset:40960
    v_mfma_f32_16x16x32_bf16 a[156:159], a[252:255], v[16:19], a[156:159]
    ds_read_b64_tr_b16 a[202:203], v10 offset:45056
    v_mfma_f32_16x16x32_bf16 a[156:159], a[204:207], v[20:23], a[156:159]
    ds_read_b64_tr_b16 a[204:205], v11 offset:40960
    v_smfmac_f32_16x16x64_bf16 a[228:231], a[244:247], v[104:111], v74
    ds_read_b64_tr_b16 a[206:207], v11 offset:45056
    v_smfmac_f32_16x16x64_bf16 a[232:235], a[244:247], v[16:23], v74
    s_waitcnt lgkmcnt(8)
    v_mfma_f32_16x16x32_bf16 v[32:35], a[160:163], v[176:179], v[76:79]
    ds_read_b64_tr_b16 a[236:237], v12 offset:40960
    v_mfma_f32_16x16x32_bf16 v[32:35], a[164:167], v[180:183], v[32:35]
    ds_read_b64_tr_b16 a[238:239], v12 offset:45056
    v_mfma_f32_16x16x32_bf16 v[32:35], a[168:171], v[184:187], v[32:35]
    ds_read_b64_tr_b16 a[240:241], v13 offset:40960
    v_mfma_f32_16x16x32_bf16 v[32:35], a[172:175], v[188:191], v[32:35]
    ds_read_b64_tr_b16 a[242:243], v13 offset:45056
    v_mfma_f32_16x16x32_bf16 v[36:39], a[176:179], v[176:179], v[76:79]
    ds_read_b64_tr_b16 a[248:249], v14 offset:40960
    v_mfma_f32_16x16x32_bf16 v[36:39], a[180:183], v[180:183], v[36:39]
    ds_read_b64_tr_b16 a[250:251], v14 offset:45056
    v_mfma_f32_16x16x32_bf16 v[36:39], a[184:187], v[184:187], v[36:39]
    ds_read_b64_tr_b16 a[252:253], v15 offset:40960
    v_mfma_f32_16x16x32_bf16 v[36:39], a[188:191], v[188:191], v[36:39]
    ds_read_b64_tr_b16 a[254:255], v15 offset:45056
    v_mfma_f32_16x16x32_bf16 v[40:43], a[160:163], v[192:195], v[80:83]
    v_exp_f32 v32, v32
    v_mfma_f32_16x16x32_bf16 v[40:43], a[164:167], v[196:199], v[40:43]
    v_exp_f32 v33, v33
    v_mfma_f32_16x16x32_bf16 v[40:43], a[168:171], v[200:203], v[40:43]
    v_exp_f32 v34, v34
    v_mfma_f32_16x16x32_bf16 v[40:43], a[172:175], v[204:207], v[40:43]
    v_exp_f32 v35, v35
    v_mfma_f32_16x16x32_bf16 v[44:47], a[176:179], v[192:195], v[80:83]
    v_cvt_pk_bf16_f32 v56, v32, v33
    v_cvt_pk_bf16_f32 v57, v34, v35
    v_mfma_f32_16x16x32_bf16 v[44:47], a[180:183], v[196:199], v[44:47]
    v_exp_f32 v36, v36
    v_mfma_f32_16x16x32_bf16 v[44:47], a[184:187], v[200:203], v[44:47]
    v_exp_f32 v37, v37
    v_mfma_f32_16x16x32_bf16 v[44:47], a[188:191], v[204:207], v[44:47]
    v_exp_f32 v38, v38
    v_mfma_f32_16x16x32_bf16 v[48:51], a[160:163], v[208:211], v[84:87]
    v_exp_f32 v39, v39
    v_mfma_f32_16x16x32_bf16 v[48:51], a[164:167], v[212:215], v[48:51]
    v_cvt_pk_bf16_f32 v58, v36, v37
    v_cvt_pk_bf16_f32 v59, v38, v39
    v_mfma_f32_16x16x32_bf16 v[48:51], a[168:171], v[216:219], v[48:51]
    v_exp_f32 v40, v40
    v_mfma_f32_16x16x32_bf16 v[48:51], a[172:175], v[220:223], v[48:51]
    v_exp_f32 v41, v41
    v_mfma_f32_16x16x32_bf16 v[52:55], a[176:179], v[208:211], v[84:87]
    v_exp_f32 v42, v42
    v_mfma_f32_16x16x32_bf16 v[52:55], a[180:183], v[212:215], v[52:55]
    v_exp_f32 v43, v43
    v_mfma_f32_16x16x32_bf16 v[52:55], a[184:187], v[216:219], v[52:55]
    v_cvt_pk_bf16_f32 v60, v40, v41
    v_cvt_pk_bf16_f32 v61, v42, v43
    v_mfma_f32_16x16x32_bf16 v[52:55], a[188:191], v[220:223], v[52:55]
    v_exp_f32 v44, v44
    v_mfma_f32_16x16x32_bf16 v[32:35], a[160:163], v[224:227], v[88:91]
    v_exp_f32 v45, v45
    v_mfma_f32_16x16x32_bf16 v[32:35], a[164:167], v[228:231], v[32:35]
    v_exp_f32 v46, v46
    v_mfma_f32_16x16x32_bf16 v[32:35], a[168:171], v[232:235], v[32:35]
    v_exp_f32 v47, v47
    v_mfma_f32_16x16x32_bf16 v[32:35], a[172:175], v[236:239], v[32:35]
    v_cvt_pk_bf16_f32 v62, v44, v45
    v_cvt_pk_bf16_f32 v63, v46, v47
    v_mfma_f32_16x16x32_bf16 v[36:39], a[176:179], v[224:227], v[88:91]
    v_exp_f32 v48, v48
    v_mfma_f32_16x16x32_bf16 v[36:39], a[180:183], v[228:231], v[36:39]
    v_exp_f32 v49, v49
    v_mfma_f32_16x16x32_bf16 v[36:39], a[184:187], v[232:235], v[36:39]
    v_exp_f32 v50, v50
    v_mfma_f32_16x16x32_bf16 v[36:39], a[188:191], v[236:239], v[36:39]
    v_exp_f32 v51, v51
    v_mfma_f32_16x16x32_bf16 v[40:43], a[160:163], v[240:243], v[92:95]
    v_exp_f32 v52, v52
    v_mfma_f32_16x16x32_bf16 v[40:43], a[164:167], v[244:247], v[40:43]
    v_exp_f32 v53, v53
    v_mfma_f32_16x16x32_bf16 v[40:43], a[168:171], v[248:251], v[40:43]
    v_exp_f32 v54, v54
    v_mfma_f32_16x16x32_bf16 v[40:43], a[172:175], v[252:255], v[40:43]
    v_exp_f32 v55, v55
    v_mfma_f32_16x16x32_bf16 v[44:47], a[176:179], v[240:243], v[92:95]
    v_cvt_pk_bf16_f32 v64, v48, v49
    v_cvt_pk_bf16_f32 v65, v50, v51
    v_mfma_f32_16x16x32_bf16 v[44:47], a[180:183], v[244:247], v[44:47]
    v_cvt_pk_bf16_f32 v66, v52, v53
    v_cvt_pk_bf16_f32 v67, v54, v55
    v_mfma_f32_16x16x32_bf16 v[44:47], a[184:187], v[248:251], v[44:47]
    v_exp_f32 v32, v32
    v_mfma_f32_16x16x32_bf16 v[44:47], a[188:191], v[252:255], v[44:47]
    s_waitcnt lgkmcnt(0)
    s_barrier
    v_mfma_f32_16x16x32_bf16 a[0:3], a[208:211], v[96:99], a[0:3]
    v_exp_f32 v33, v33
    v_mfma_f32_16x16x32_bf16 a[0:3], a[192:195], v[56:59], a[0:3]
    v_exp_f32 v34, v34
    v_mfma_f32_16x16x32_bf16 a[4:7], a[212:215], v[96:99], a[4:7]
    v_exp_f32 v35, v35
    v_mfma_f32_16x16x32_bf16 a[4:7], a[196:199], v[56:59], a[4:7]
    v_exp_f32 v36, v36
    v_mfma_f32_16x16x32_bf16 a[8:11], a[216:219], v[96:99], a[8:11]
    v_exp_f32 v37, v37
    v_mfma_f32_16x16x32_bf16 a[8:11], a[200:203], v[56:59], a[8:11]
    v_exp_f32 v38, v38
    v_mfma_f32_16x16x32_bf16 a[12:15], a[220:223], v[96:99], a[12:15]
    v_exp_f32 v39, v39
    v_mfma_f32_16x16x32_bf16 a[12:15], a[204:207], v[56:59], a[12:15]
    v_cvt_pk_bf16_f32 v68, v32, v33
    v_cvt_pk_bf16_f32 v69, v34, v35
    v_mfma_f32_16x16x32_bf16 a[32:35], a[208:211], v[100:103], a[32:35]
    v_cvt_pk_bf16_f32 v70, v36, v37
    v_cvt_pk_bf16_f32 v71, v38, v39
    v_mfma_f32_16x16x32_bf16 a[32:35], a[192:195], v[60:63], a[32:35]
    v_exp_f32 v40, v40
    v_mfma_f32_16x16x32_bf16 a[36:39], a[212:215], v[100:103], a[36:39]
    v_exp_f32 v41, v41
    v_mfma_f32_16x16x32_bf16 a[36:39], a[196:199], v[60:63], a[36:39]
    v_exp_f32 v42, v42
    v_mfma_f32_16x16x32_bf16 a[40:43], a[216:219], v[100:103], a[40:43]
    v_exp_f32 v43, v43
    v_mfma_f32_16x16x32_bf16 a[40:43], a[200:203], v[60:63], a[40:43]
    v_exp_f32 v44, v44
    v_mfma_f32_16x16x32_bf16 a[44:47], a[220:223], v[100:103], a[44:47]
    v_exp_f32 v45, v45
    v_mfma_f32_16x16x32_bf16 a[44:47], a[204:207], v[60:63], a[44:47]
    v_exp_f32 v46, v46
    v_smfmac_f32_16x16x64_bf16 a[224:227], a[244:247], v[56:63], v74
    v_cvt_pk_bf16_f32 v16, v40, v41
    v_mfma_f32_16x16x32_bf16 a[64:67], a[208:211], v[104:107], a[64:67]
    v_exp_f32 v47, v47
    v_mfma_f32_16x16x32_bf16 a[64:67], a[192:195], v[64:67], a[64:67]
    v_cvt_pk_bf16_f32 v17, v42, v43
    v_cvt_pk_bf16_f32 v18, v44, v45
    v_mfma_f32_16x16x32_bf16 a[68:71], a[212:215], v[104:107], a[68:71]
    v_cvt_pk_bf16_f32 v19, v46, v47
    v_mfma_f32_16x16x32_bf16 a[68:71], a[196:199], v[64:67], a[68:71]
    ds_read_b128 a[160:163], v4 offset:49152
    v_mfma_f32_16x16x32_bf16 a[72:75], a[216:219], v[104:107], a[72:75]
    ds_read_b128 a[164:167], v5 offset:49152
    v_mfma_f32_16x16x32_bf16 a[72:75], a[200:203], v[64:67], a[72:75]
    ds_read_b128 a[168:171], v6 offset:49152
    v_mfma_f32_16x16x32_bf16 a[76:79], a[220:223], v[104:107], a[76:79]
    ds_read_b128 a[172:175], v7 offset:49152
    v_mfma_f32_16x16x32_bf16 a[76:79], a[204:207], v[64:67], a[76:79]
    ds_read_b128 a[176:179], v4 offset:53248
    v_mfma_f32_16x16x32_bf16 a[96:99], a[208:211], v[108:111], a[96:99]
    ds_read_b128 a[180:183], v5 offset:53248
    v_mfma_f32_16x16x32_bf16 a[96:99], a[192:195], v[68:71], a[96:99]
    ds_read_b128 a[184:187], v6 offset:53248
    v_mfma_f32_16x16x32_bf16 a[100:103], a[212:215], v[108:111], a[100:103]
    ds_read_b128 a[188:191], v7 offset:53248
    v_mfma_f32_16x16x32_bf16 a[100:103], a[196:199], v[68:71], a[100:103]
    s_add_u32 m0, s96, 2048
    s_add_u32 s49, s70, 131584
    v_mfma_f32_16x16x32_bf16 a[104:107], a[216:219], v[108:111], a[104:107]
    buffer_load_dwordx4 v24, s[8:11], s49 offen offset:0 sc1 lds
    v_mfma_f32_16x16x32_bf16 a[104:107], a[200:203], v[68:71], a[104:107]
    buffer_load_dwordx4 v24, s[8:11], s49 offen offset:1024 sc1 lds
    v_mfma_f32_16x16x32_bf16 a[108:111], a[220:223], v[108:111], a[108:111]
    s_add_u32 m0, s96, 4096
    s_add_u32 s49, s70, 262912
    v_mfma_f32_16x16x32_bf16 a[108:111], a[204:207], v[68:71], a[108:111]
    buffer_load_dwordx4 v24, s[8:11], s49 offen offset:0 sc1 lds
    v_mfma_f32_16x16x32_bf16 a[128:131], a[208:211], v[20:23], a[128:131]
    buffer_load_dwordx4 v24, s[8:11], s49 offen offset:1024 sc1 lds
    v_mfma_f32_16x16x32_bf16 a[128:131], a[192:195], v[16:19], a[128:131]
    ds_read_b64_tr_b16 a[192:193], v12 offset:57344
    v_mfma_f32_16x16x32_bf16 a[132:135], a[212:215], v[20:23], a[132:135]
    ds_read_b64_tr_b16 a[194:195], v12 offset:61440
    v_mfma_f32_16x16x32_bf16 a[132:135], a[196:199], v[16:19], a[132:135]
    ds_read_b64_tr_b16 a[196:197], v13 offset:57344
    v_mfma_f32_16x16x32_bf16 a[136:139], a[216:219], v[20:23], a[136:139]
    ds_read_b64_tr_b16 a[198:199], v13 offset:61440
    v_mfma_f32_16x16x32_bf16 a[136:139], a[200:203], v[16:19], a[136:139]
    ds_read_b64_tr_b16 a[200:201], v14 offset:57344
    v_mfma_f32_16x16x32_bf16 a[140:143], a[220:223], v[20:23], a[140:143]
    ds_read_b64_tr_b16 a[202:203], v14 offset:61440
    v_mfma_f32_16x16x32_bf16 a[140:143], a[204:207], v[16:19], a[140:143]
    ds_read_b64_tr_b16 a[204:205], v15 offset:57344
    v_smfmac_f32_16x16x64_bf16 a[228:231], a[244:247], v[64:71], v74
    ds_read_b64_tr_b16 a[206:207], v15 offset:61440
    s_waitcnt lgkmcnt(8)
    v_mfma_f32_16x16x32_bf16 v[32:35], a[160:163], v[176:179], v[76:79]
    ds_read_b64_tr_b16 a[208:209], v8 offset:57344
    v_mfma_f32_16x16x32_bf16 v[32:35], a[164:167], v[180:183], v[32:35]
    ds_read_b64_tr_b16 a[210:211], v8 offset:61440
    v_mfma_f32_16x16x32_bf16 v[32:35], a[168:171], v[184:187], v[32:35]
    ds_read_b64_tr_b16 a[212:213], v9 offset:57344
    v_mfma_f32_16x16x32_bf16 v[32:35], a[172:175], v[188:191], v[32:35]
    ds_read_b64_tr_b16 a[214:215], v9 offset:61440
    v_mfma_f32_16x16x32_bf16 v[36:39], a[176:179], v[176:179], v[76:79]
    ds_read_b64_tr_b16 a[216:217], v10 offset:57344
    v_mfma_f32_16x16x32_bf16 v[36:39], a[180:183], v[180:183], v[36:39]
    ds_read_b64_tr_b16 a[218:219], v10 offset:61440
    v_mfma_f32_16x16x32_bf16 v[36:39], a[184:187], v[184:187], v[36:39]
    ds_read_b64_tr_b16 a[220:221], v11 offset:57344
    v_mfma_f32_16x16x32_bf16 v[36:39], a[188:191], v[188:191], v[36:39]
    ds_read_b64_tr_b16 a[222:223], v11 offset:61440
    v_mfma_f32_16x16x32_bf16 v[40:43], a[160:163], v[192:195], v[80:83]
    v_exp_f32 v32, v32
    v_mfma_f32_16x16x32_bf16 v[40:43], a[164:167], v[196:199], v[40:43]
    v_exp_f32 v33, v33
    v_mfma_f32_16x16x32_bf16 v[40:43], a[168:171], v[200:203], v[40:43]
    v_exp_f32 v34, v34
    v_mfma_f32_16x16x32_bf16 v[40:43], a[172:175], v[204:207], v[40:43]
    v_exp_f32 v35, v35
    v_mfma_f32_16x16x32_bf16 v[44:47], a[176:179], v[192:195], v[80:83]
    v_cvt_pk_bf16_f32 v96, v32, v33
    v_cvt_pk_bf16_f32 v97, v34, v35
    v_mfma_f32_16x16x32_bf16 v[44:47], a[180:183], v[196:199], v[44:47]
    v_exp_f32 v36, v36
    v_mfma_f32_16x16x32_bf16 v[44:47], a[184:187], v[200:203], v[44:47]
    v_exp_f32 v37, v37
    v_mfma_f32_16x16x32_bf16 v[44:47], a[188:191], v[204:207], v[44:47]
    v_exp_f32 v38, v38
    v_mfma_f32_16x16x32_bf16 v[48:51], a[160:163], v[208:211], v[84:87]
    v_exp_f32 v39, v39
    v_mfma_f32_16x16x32_bf16 v[48:51], a[164:167], v[212:215], v[48:51]
    v_cvt_pk_bf16_f32 v98, v36, v37
    v_cvt_pk_bf16_f32 v99, v38, v39
    v_mfma_f32_16x16x32_bf16 v[48:51], a[168:171], v[216:219], v[48:51]
    v_exp_f32 v40, v40
    v_mfma_f32_16x16x32_bf16 v[48:51], a[172:175], v[220:223], v[48:51]
    v_exp_f32 v41, v41
    v_mfma_f32_16x16x32_bf16 v[52:55], a[176:179], v[208:211], v[84:87]
    v_exp_f32 v42, v42
    v_mfma_f32_16x16x32_bf16 v[52:55], a[180:183], v[212:215], v[52:55]
    v_exp_f32 v43, v43
    v_mfma_f32_16x16x32_bf16 v[52:55], a[184:187], v[216:219], v[52:55]
    v_cvt_pk_bf16_f32 v100, v40, v41
    v_cvt_pk_bf16_f32 v101, v42, v43
    v_mfma_f32_16x16x32_bf16 v[52:55], a[188:191], v[220:223], v[52:55]
    v_exp_f32 v44, v44
    v_mfma_f32_16x16x32_bf16 v[32:35], a[160:163], v[224:227], v[88:91]
    v_exp_f32 v45, v45
    v_mfma_f32_16x16x32_bf16 v[32:35], a[164:167], v[228:231], v[32:35]
    v_exp_f32 v46, v46
    v_mfma_f32_16x16x32_bf16 v[32:35], a[168:171], v[232:235], v[32:35]
    v_exp_f32 v47, v47
    v_mfma_f32_16x16x32_bf16 v[32:35], a[172:175], v[236:239], v[32:35]
    v_cvt_pk_bf16_f32 v102, v44, v45
    v_cvt_pk_bf16_f32 v103, v46, v47
    v_mfma_f32_16x16x32_bf16 v[36:39], a[176:179], v[224:227], v[88:91]
    v_exp_f32 v48, v48
    v_mfma_f32_16x16x32_bf16 v[36:39], a[180:183], v[228:231], v[36:39]
    v_exp_f32 v49, v49
    v_mfma_f32_16x16x32_bf16 v[36:39], a[184:187], v[232:235], v[36:39]
    v_exp_f32 v50, v50
    v_mfma_f32_16x16x32_bf16 v[36:39], a[188:191], v[236:239], v[36:39]
    v_exp_f32 v51, v51
    v_mfma_f32_16x16x32_bf16 v[40:43], a[160:163], v[240:243], v[92:95]
    v_exp_f32 v52, v52
    v_mfma_f32_16x16x32_bf16 v[40:43], a[164:167], v[244:247], v[40:43]
    v_exp_f32 v53, v53
    v_mfma_f32_16x16x32_bf16 v[40:43], a[168:171], v[248:251], v[40:43]
    v_exp_f32 v54, v54
    v_mfma_f32_16x16x32_bf16 v[40:43], a[172:175], v[252:255], v[40:43]
    v_exp_f32 v55, v55
    v_mfma_f32_16x16x32_bf16 v[44:47], a[176:179], v[240:243], v[92:95]
    v_cvt_pk_bf16_f32 v104, v48, v49
    v_cvt_pk_bf16_f32 v105, v50, v51
    v_mfma_f32_16x16x32_bf16 v[44:47], a[180:183], v[244:247], v[44:47]
    v_cvt_pk_bf16_f32 v106, v52, v53
    v_cvt_pk_bf16_f32 v107, v54, v55
    v_mfma_f32_16x16x32_bf16 v[44:47], a[184:187], v[248:251], v[44:47]
    v_exp_f32 v32, v32
    v_mfma_f32_16x16x32_bf16 v[44:47], a[188:191], v[252:255], v[44:47]
    s_waitcnt lgkmcnt(0)
    s_barrier
    v_mfma_f32_16x16x32_bf16 a[16:19], a[236:239], v[56:59], a[16:19]
    v_exp_f32 v33, v33
    v_mfma_f32_16x16x32_bf16 a[16:19], a[192:195], v[96:99], a[16:19]
    v_exp_f32 v34, v34
    v_mfma_f32_16x16x32_bf16 a[20:23], a[240:243], v[56:59], a[20:23]
    v_exp_f32 v35, v35
    v_mfma_f32_16x16x32_bf16 a[20:23], a[196:199], v[96:99], a[20:23]
    v_exp_f32 v36, v36
    v_mfma_f32_16x16x32_bf16 a[24:27], a[248:251], v[56:59], a[24:27]
    v_exp_f32 v37, v37
    v_mfma_f32_16x16x32_bf16 a[24:27], a[200:203], v[96:99], a[24:27]
    v_exp_f32 v38, v38
    v_mfma_f32_16x16x32_bf16 a[28:31], a[252:255], v[56:59], a[28:31]
    v_exp_f32 v39, v39
    v_mfma_f32_16x16x32_bf16 a[28:31], a[204:207], v[96:99], a[28:31]
    v_cvt_pk_bf16_f32 v108, v32, v33
    v_cvt_pk_bf16_f32 v109, v34, v35
    v_mfma_f32_16x16x32_bf16 a[48:51], a[236:239], v[60:63], a[48:51]
    v_cvt_pk_bf16_f32 v110, v36, v37
    v_cvt_pk_bf16_f32 v111, v38, v39
    v_mfma_f32_16x16x32_bf16 a[48:51], a[192:195], v[100:103], a[48:51]
    v_exp_f32 v40, v40
    v_mfma_f32_16x16x32_bf16 a[52:55], a[240:243], v[60:63], a[52:55]
    v_exp_f32 v41, v41
    v_mfma_f32_16x16x32_bf16 a[52:55], a[196:199], v[100:103], a[52:55]
    v_exp_f32 v42, v42
    v_mfma_f32_16x16x32_bf16 a[56:59], a[248:251], v[60:63], a[56:59]
    v_exp_f32 v43, v43
    v_mfma_f32_16x16x32_bf16 a[56:59], a[200:203], v[100:103], a[56:59]
    v_exp_f32 v44, v44
    v_mfma_f32_16x16x32_bf16 a[60:63], a[252:255], v[60:63], a[60:63]
    v_exp_f32 v45, v45
    v_mfma_f32_16x16x32_bf16 a[60:63], a[204:207], v[100:103], a[60:63]
    v_exp_f32 v46, v46
    v_smfmac_f32_16x16x64_bf16 a[224:227], a[244:247], v[96:103], v74
    v_cvt_pk_bf16_f32 v20, v40, v41
    v_mfma_f32_16x16x32_bf16 a[80:83], a[236:239], v[64:67], a[80:83]
    v_exp_f32 v47, v47
    v_mfma_f32_16x16x32_bf16 a[80:83], a[192:195], v[104:107], a[80:83]
    v_cvt_pk_bf16_f32 v21, v42, v43
    v_cvt_pk_bf16_f32 v22, v44, v45
    v_mfma_f32_16x16x32_bf16 a[84:87], a[240:243], v[64:67], a[84:87]
    v_cvt_pk_bf16_f32 v23, v46, v47
    v_mfma_f32_16x16x32_bf16 a[84:87], a[196:199], v[104:107], a[84:87]
    s_add_u32 m0, s96, 6144
    s_add_u32 s49, s70, 394240
    v_mfma_f32_16x16x32_bf16 a[88:91], a[248:251], v[64:67], a[88:91]
    buffer_load_dwordx4 v24, s[8:11], s49 offen offset:0 sc1 lds
    v_mfma_f32_16x16x32_bf16 a[88:91], a[200:203], v[104:107], a[88:91]
    buffer_load_dwordx4 v24, s[8:11], s49 offen offset:1024 sc1 lds
    v_mfma_f32_16x16x32_bf16 a[92:95], a[252:255], v[64:67], a[92:95]
    s_add_u32 m0, s96, 8192
    s_add_u32 s49, s70, 525568
    v_mfma_f32_16x16x32_bf16 a[92:95], a[204:207], v[104:107], a[92:95]
    buffer_load_dwordx4 v24, s[8:11], s49 offen offset:0 sc1 lds
    v_mfma_f32_16x16x32_bf16 a[112:115], a[236:239], v[68:71], a[112:115]
    buffer_load_dwordx4 v24, s[8:11], s49 offen offset:1024 sc1 lds
    v_mfma_f32_16x16x32_bf16 a[112:115], a[192:195], v[108:111], a[112:115]
    s_add_u32 m0, s96, 10240
    s_add_u32 s49, s71, 256
    v_mfma_f32_16x16x32_bf16 a[116:119], a[240:243], v[68:71], a[116:119]
    buffer_load_dwordx4 v24, s[8:11], s49 offen offset:0 sc1 lds
    v_mfma_f32_16x16x32_bf16 a[116:119], a[196:199], v[108:111], a[116:119]
    buffer_load_dwordx4 v24, s[8:11], s49 offen offset:1024 sc1 lds
    v_mfma_f32_16x16x32_bf16 a[120:123], a[248:251], v[68:71], a[120:123]
    s_add_u32 m0, s96, 12288
    s_add_u32 s49, s71, 131584
    v_mfma_f32_16x16x32_bf16 a[120:123], a[200:203], v[108:111], a[120:123]
    buffer_load_dwordx4 v24, s[8:11], s49 offen offset:0 sc1 lds
    v_mfma_f32_16x16x32_bf16 a[124:127], a[252:255], v[68:71], a[124:127]
    buffer_load_dwordx4 v24, s[8:11], s49 offen offset:1024 sc1 lds
    v_mfma_f32_16x16x32_bf16 a[124:127], a[204:207], v[108:111], a[124:127]
    s_add_u32 m0, s96, 14336
    s_add_u32 s49, s71, 262912
    v_mfma_f32_16x16x32_bf16 a[144:147], a[236:239], v[16:19], a[144:147]
    buffer_load_dwordx4 v24, s[8:11], s49 offen offset:0 sc1 lds
    v_mfma_f32_16x16x32_bf16 a[144:147], a[192:195], v[20:23], a[144:147]
    buffer_load_dwordx4 v24, s[8:11], s49 offen offset:1024 sc1 lds
    v_mfma_f32_16x16x32_bf16 a[148:151], a[240:243], v[16:19], a[148:151]
    s_add_u32 m0, s96, 16384
    s_add_u32 s49, s71, 394240
    v_mfma_f32_16x16x32_bf16 a[148:151], a[196:199], v[20:23], a[148:151]
    buffer_load_dwordx4 v24, s[8:11], s49 offen offset:0 sc1 lds
    v_mfma_f32_16x16x32_bf16 a[152:155], a[248:251], v[16:19], a[152:155]
    buffer_load_dwordx4 v24, s[8:11], s49 offen offset:1024 sc1 lds
    v_mfma_f32_16x16x32_bf16 a[152:155], a[200:203], v[20:23], a[152:155]
    s_add_u32 m0, s96, 18432
    s_add_u32 s49, s71, 525568
    v_mfma_f32_16x16x32_bf16 a[156:159], a[252:255], v[16:19], a[156:159]
    buffer_load_dwordx4 v24, s[8:11], s49 offen offset:0 sc1 lds
    v_mfma_f32_16x16x32_bf16 a[156:159], a[204:207], v[20:23], a[156:159]
    buffer_load_dwordx4 v24, s[8:11], s49 offen offset:1024 sc1 lds
    v_smfmac_f32_16x16x64_bf16 a[228:231], a[244:247], v[104:111], v74
    v_smfmac_f32_16x16x64_bf16 a[232:235], a[244:247], v[16:23], v74
    s_nop 0
    v_mfma_f32_16x16x32_bf16 a[0:3], a[208:211], v[96:99], a[0:3]
    v_mfma_f32_16x16x32_bf16 a[4:7], a[212:215], v[96:99], a[4:7]
    v_mfma_f32_16x16x32_bf16 a[8:11], a[216:219], v[96:99], a[8:11]
    v_mfma_f32_16x16x32_bf16 a[12:15], a[220:223], v[96:99], a[12:15]
    v_mov_b32 v1, 147460
    v_mov_b32_e64 v2, 1
    v_mfma_f32_16x16x32_bf16 a[32:35], a[208:211], v[100:103], a[32:35]
    v_accvgpr_read_b32 v32, a224
    v_accvgpr_read_b32 v33, a225
    v_mfma_f32_16x16x32_bf16 a[36:39], a[212:215], v[100:103], a[36:39]
    v_accvgpr_read_b32 v34, a226
    v_accvgpr_read_b32 v35, a227
    v_mfma_f32_16x16x32_bf16 a[40:43], a[216:219], v[100:103], a[40:43]
    v_accvgpr_read_b32 v36, a228
    v_accvgpr_read_b32 v37, a229
    v_mfma_f32_16x16x32_bf16 a[44:47], a[220:223], v[100:103], a[44:47]
    v_accvgpr_read_b32 v38, a230
    v_accvgpr_read_b32 v39, a231
    v_mfma_f32_16x16x32_bf16 a[64:67], a[208:211], v[104:107], a[64:67]
    v_accvgpr_read_b32 v40, a232
    v_accvgpr_read_b32 v41, a233
    v_mfma_f32_16x16x32_bf16 a[68:71], a[212:215], v[104:107], a[68:71]
    v_accvgpr_read_b32 v42, a234
    v_accvgpr_read_b32 v43, a235
    v_mfma_f32_16x16x32_bf16 a[72:75], a[216:219], v[104:107], a[72:75]
    v_add_f32 v26, v32, v33
    v_add_f32 v28, v34, v35
    v_mfma_f32_16x16x32_bf16 a[76:79], a[220:223], v[104:107], a[76:79]
    v_add_f32 v30, v36, v37
    v_add_f32 v16, v38, v39
    v_mfma_f32_16x16x32_bf16 a[96:99], a[208:211], v[108:111], a[96:99]
    v_add_f32 v18, v40, v41
    v_add_f32 v3, v26, v28
    v_mfma_f32_16x16x32_bf16 a[100:103], a[212:215], v[108:111], a[100:103]
    v_add_f32 v32, v30, v16
    v_add_f32 v42, v42, v43
    v_mfma_f32_16x16x32_bf16 a[104:107], a[216:219], v[108:111], a[104:107]
    v_add_f32 v18, v18, v42
    v_add_f32 v3, v3, v18
    v_mfma_f32_16x16x32_bf16 a[108:111], a[220:223], v[108:111], a[108:111]
    v_add_f32 v3, v3, v32
    v_cmp_ngt_f32 vcc, s51, v3
    v_mfma_f32_16x16x32_bf16 a[128:131], a[208:211], v[20:23], a[128:131]
    v_rcp_f32 v26, v26
    v_rcp_f32 v28, v28
    v_mfma_f32_16x16x32_bf16 a[132:135], a[212:215], v[20:23], a[132:135]
    v_rcp_f32 v30, v30
    v_rcp_f32 v16, v16
    v_mfma_f32_16x16x32_bf16 a[136:139], a[216:219], v[20:23], a[136:139]
    v_rcp_f32_e64 v18, v18
    v_mfma_f32_16x16x32_bf16 a[140:143], a[220:223], v[20:23], a[140:143]
    s_cbranch_vccnz L_ovf15
L_nof15:
    s_waitcnt lgkmcnt(0)
    s_barrier
    s_nop 0
    ds_read_b32 v3, v1
    v_accvgpr_read_b32 v32, a0
    v_accvgpr_read_b32 v33, a1
    v_accvgpr_read_b32 v34, a2
    v_accvgpr_read_b32 v35, a3
    v_accvgpr_read_b32 v36, a4
    v_accvgpr_read_b32 v37, a5
    v_accvgpr_read_b32 v38, a6
    v_accvgpr_read_b32 v39, a7
    v_accvgpr_read_b32 v40, a8
    v_accvgpr_read_b32 v41, a9
    v_accvgpr_read_b32 v42, a10
    v_accvgpr_read_b32 v43, a11
    v_accvgpr_read_b32 v44, a12
    v_accvgpr_read_b32 v45, a13
    v_accvgpr_read_b32 v46, a14
    v_accvgpr_read_b32 v47, a15
    v_pk_mul_f32 v[32:33], v[32:33], v[26:27] op_sel_hi:[1,0]
    v_pk_mul_f32 v[34:35], v[34:35], v[26:27] op_sel_hi:[1,0]
    v_pk_mul_f32 v[36:37], v[36:37], v[26:27] op_sel_hi:[1,0]
    v_pk_mul_f32 v[38:39], v[38:39], v[26:27] op_sel_hi:[1,0]
    v_pk_mul_f32 v[40:41], v[40:41], v[26:27] op_sel_hi:[1,0]
    v_pk_mul_f32 v[42:43], v[42:43], v[26:27] op_sel_hi:[1,0]
    v_pk_mul_f32 v[44:45], v[44:45], v[26:27] op_sel_hi:[1,0]
    v_pk_mul_f32 v[46:47], v[46:47], v[26:27] op_sel_hi:[1,0]
    v_accvgpr_read_b32 v48, a16
    v_accvgpr_read_b32 v49, a17
    v_accvgpr_read_b32 v50, a18
    v_accvgpr_read_b32 v51, a19
    v_accvgpr_read_b32 v52, a20
    v_accvgpr_read_b32 v53, a21
    v_accvgpr_read_b32 v54, a22
    v_accvgpr_read_b32 v55, a23
    v_accvgpr_read_b32 v56, a24
    v_accvgpr_read_b32 v57, a25
    v_accvgpr_read_b32 v58, a26
    v_accvgpr_read_b32 v59, a27
    s_waitcnt lgkmcnt(0)
    v_readfirstlane_b32 s48, v3
    v_accvgpr_read_b32 v60, a28
    v_accvgpr_read_b32 v61, a29
    v_accvgpr_read_b32 v62, a30
    v_accvgpr_read_b32 v63, a31
    s_andn2_b32 s48, s48, s37
    s_cbranch_scc1 L_redo5
    s_add_u32 s30, s50, 4096
    s_add_u32 s31, s50, 135424
    s_add_u32 s32, s50, 266752
    s_add_u32 s33, s50, 398080
    s_add_u32 s34, s50, 529408
    v_cvt_pk_bf16_f32 v84, v32, v33
    v_cvt_pk_bf16_f32 v85, v34, v35
    v_cvt_pk_bf16_f32 v86, v36, v37
    v_cvt_pk_bf16_f32 v87, v38, v39
    buffer_store_dwordx4 v[84:87], v24, s[20:23], s30 offen offset:0 sc1
    v_cvt_pk_bf16_f32 v88, v40, v41
    v_cvt_pk_bf16_f32 v89, v42, v43
    v_cvt_pk_bf16_f32 v90, v44, v45
    v_cvt_pk_bf16_f32 v91, v46, v47
    buffer_store_dwordx4 v[88:91], v24, s[20:23], s30 offen offset:1024 sc1
    v_pk_mul_f32 v[48:49], v[48:49], v[26:27] op_sel_hi:[1,0]
    v_pk_mul_f32 v[50:51], v[50:51], v[26:27] op_sel_hi:[1,0]
    v_pk_mul_f32 v[52:53], v[52:53], v[26:27] op_sel_hi:[1,0]
    v_pk_mul_f32 v[54:55], v[54:55], v[26:27] op_sel_hi:[1,0]
    v_pk_mul_f32 v[56:57], v[56:57], v[26:27] op_sel_hi:[1,0]
    v_pk_mul_f32 v[58:59], v[58:59], v[26:27] op_sel_hi:[1,0]
    v_pk_mul_f32 v[60:61], v[60:61], v[26:27] op_sel_hi:[1,0]
    v_pk_mul_f32 v[62:63], v[62:63], v[26:27] op_sel_hi:[1,0]
    v_cvt_pk_bf16_f32 v92, v48, v49
    v_cvt_pk_bf16_f32 v93, v50, v51
    v_cvt_pk_bf16_f32 v94, v52, v53
    v_cvt_pk_bf16_f32 v95, v54, v55
    v_cvt_pk_bf16_f32 v96, v56, v57
    v_cvt_pk_bf16_f32 v97, v58, v59
    v_cvt_pk_bf16_f32 v98, v60, v61
    v_cvt_pk_bf16_f32 v99, v62, v63
    buffer_store_dwordx4 v[92:95], v24, s[20:23], s30 offen offset:2048 sc1
    v_accvgpr_read_b32 v32, a32
    v_accvgpr_read_b32 v33, a33
    v_accvgpr_read_b32 v34, a34
    v_accvgpr_read_b32 v35, a35
    v_accvgpr_read_b32 v36, a36
    v_accvgpr_read_b32 v37, a37
    v_accvgpr_read_b32 v38, a38
    v_accvgpr_read_b32 v39, a39
    v_accvgpr_read_b32 v40, a40
    v_accvgpr_read_b32 v41, a41
    v_accvgpr_read_b32 v42, a42
    v_accvgpr_read_b32 v43, a43
    v_accvgpr_read_b32 v44, a44
    v_accvgpr_read_b32 v45, a45
    v_accvgpr_read_b32 v46, a46
    v_accvgpr_read_b32 v47, a47
    v_pk_mul_f32 v[32:33], v[32:33], v[28:29] op_sel_hi:[1,0]
    v_pk_mul_f32 v[34:35], v[34:35], v[28:29] op_sel_hi:[1,0]
    v_pk_mul_f32 v[36:37], v[36:37], v[28:29] op_sel_hi:[1,0]
    v_pk_mul_f32 v[38:39], v[38:39], v[28:29] op_sel_hi:[1,0]
    v_pk_mul_f32 v[40:41], v[40:41], v[28:29] op_sel_hi:[1,0]
    v_pk_mul_f32 v[42:43], v[42:43], v[28:29] op_sel_hi:[1,0]
    v_pk_mul_f32 v[44:45], v[44:45], v[28:29] op_sel_hi:[1,0]
    v_pk_mul_f32 v[46:47], v[46:47], v[28:29] op_sel_hi:[1,0]
    v_cvt_pk_bf16_f32 v100, v32, v33
    v_cvt_pk_bf16_f32 v101, v34, v35
    v_cvt_pk_bf16_f32 v102, v36, v37
    v_cvt_pk_bf16_f32 v103, v38, v39
    v_cvt_pk_bf16_f32 v104, v40, v41
    v_cvt_pk_bf16_f32 v105, v42, v43
    v_cvt_pk_bf16_f32 v106, v44, v45
    v_cvt_pk_bf16_f32 v107, v46, v47
    buffer_store_dwordx4 v[96:99], v24, s[20:23], s30 offen offset:3072 sc1
    v_accvgpr_read_b32 v48, a48
    v_accvgpr_read_b32 v49, a49
    v_accvgpr_read_b32 v50, a50
    v_accvgpr_read_b32 v51, a51
    v_accvgpr_read_b32 v52, a52
    v_accvgpr_read_b32 v53, a53
    v_accvgpr_read_b32 v54, a54
    v_accvgpr_read_b32 v55, a55
    v_accvgpr_read_b32 v56, a56
    v_accvgpr_read_b32 v57, a57
    v_accvgpr_read_b32 v58, a58
    v_accvgpr_read_b32 v59, a59
    v_accvgpr_read_b32 v60, a60
    v_accvgpr_read_b32 v61, a61
    v_accvgpr_read_b32 v62, a62
    v_accvgpr_read_b32 v63, a63
    v_pk_mul_f32 v[48:49], v[48:49], v[28:29] op_sel_hi:[1,0]
    v_pk_mul_f32 v[50:51], v[50:51], v[28:29] op_sel_hi:[1,0]
    v_pk_mul_f32 v[52:53], v[52:53], v[28:29] op_sel_hi:[1,0]
    v_pk_mul_f32 v[54:55], v[54:55], v[28:29] op_sel_hi:[1,0]
    v_pk_mul_f32 v[56:57], v[56:57], v[28:29] op_sel_hi:[1,0]
    v_pk_mul_f32 v[58:59], v[58:59], v[28:29] op_sel_hi:[1,0]
    v_pk_mul_f32 v[60:61], v[60:61], v[28:29] op_sel_hi:[1,0]
    v_pk_mul_f32 v[62:63], v[62:63], v[28:29] op_sel_hi:[1,0]
    v_cvt_pk_bf16_f32 v108, v48, v49
    v_cvt_pk_bf16_f32 v109, v50, v51
    v_cvt_pk_bf16_f32 v110, v52, v53
    v_cvt_pk_bf16_f32 v111, v54, v55
    buffer_store_dwordx4 v[100:103], v24, s[20:23], s31 offen offset:0 sc1
    v_cvt_pk_bf16_f32 v84, v56, v57
    v_cvt_pk_bf16_f32 v85, v58, v59
    v_cvt_pk_bf16_f32 v86, v60, v61
    v_cvt_pk_bf16_f32 v87, v62, v63
    buffer_store_dwordx4 v[104:107], v24, s[20:23], s31 offen offset:1024 sc1
    v_accvgpr_read_b32 v32, a64
    v_accvgpr_read_b32 v33, a65
    v_accvgpr_read_b32 v34, a66
    v_accvgpr_read_b32 v35, a67
    v_accvgpr_read_b32 v36, a68
    v_accvgpr_read_b32 v37, a69
    v_accvgpr_read_b32 v38, a70
    v_accvgpr_read_b32 v39, a71
    v_accvgpr_read_b32 v40, a72
    v_accvgpr_read_b32 v41, a73
    v_accvgpr_read_b32 v42, a74
    v_accvgpr_read_b32 v43, a75
    v_accvgpr_read_b32 v44, a76
    v_accvgpr_read_b32 v45, a77
    v_accvgpr_read_b32 v46, a78
    v_accvgpr_read_b32 v47, a79
    v_pk_mul_f32 v[32:33], v[32:33], v[30:31] op_sel_hi:[1,0]
    v_pk_mul_f32 v[34:35], v[34:35], v[30:31] op_sel_hi:[1,0]
    v_pk_mul_f32 v[36:37], v[36:37], v[30:31] op_sel_hi:[1,0]
    v_pk_mul_f32 v[38:39], v[38:39], v[30:31] op_sel_hi:[1,0]
    v_pk_mul_f32 v[40:41], v[40:41], v[30:31] op_sel_hi:[1,0]
    v_pk_mul_f32 v[42:43], v[42:43], v[30:31] op_sel_hi:[1,0]
    v_pk_mul_f32 v[44:45], v[44:45], v[30:31] op_sel_hi:[1,0]
    v_pk_mul_f32 v[46:47], v[46:47], v[30:31] op_sel_hi:[1,0]
    v_cvt_pk_bf16_f32 v88, v32, v33
    v_cvt_pk_bf16_f32 v89, v34, v35
    v_cvt_pk_bf16_f32 v90, v36, v37
    v_cvt_pk_bf16_f32 v91, v38, v39
    buffer_store_dwordx4 v[108:111], v24, s[20:23], s31 offen offset:2048 sc1
    v_cvt_pk_bf16_f32 v92, v40, v41
    v_cvt_pk_bf16_f32 v93, v42, v43
    v_cvt_pk_bf16_f32 v94, v44, v45
    v_cvt_pk_bf16_f32 v95, v46, v47
    buffer_store_dwordx4 v[84:87], v24, s[20:23], s31 offen offset:3072 sc1
    v_accvgpr_read_b32 v48, a80
    v_accvgpr_read_b32 v49, a81
    v_accvgpr_read_b32 v50, a82
    v_accvgpr_read_b32 v51, a83
    v_accvgpr_read_b32 v52, a84
    v_accvgpr_read_b32 v53, a85
    v_accvgpr_read_b32 v54, a86
    v_accvgpr_read_b32 v55, a87
    v_accvgpr_read_b32 v56, a88
    v_accvgpr_read_b32 v57, a89
    v_accvgpr_read_b32 v58, a90
    v_accvgpr_read_b32 v59, a91
    v_accvgpr_read_b32 v60, a92
    v_accvgpr_read_b32 v61, a93
    v_accvgpr_read_b32 v62, a94
    v_accvgpr_read_b32 v63, a95
    v_pk_mul_f32 v[48:49], v[48:49], v[30:31] op_sel_hi:[1,0]
    v_pk_mul_f32 v[50:51], v[50:51], v[30:31] op_sel_hi:[1,0]
    v_pk_mul_f32 v[52:53], v[52:53], v[30:31] op_sel_hi:[1,0]
    v_pk_mul_f32 v[54:55], v[54:55], v[30:31] op_sel_hi:[1,0]
    v_pk_mul_f32 v[56:57], v[56:57], v[30:31] op_sel_hi:[1,0]
    v_pk_mul_f32 v[58:59], v[58:59], v[30:31] op_sel_hi:[1,0]
    v_pk_mul_f32 v[60:61], v[60:61], v[30:31] op_sel_hi:[1,0]
    v_pk_mul_f32 v[62:63], v[62:63], v[30:31] op_sel_hi:[1,0]
    v_cvt_pk_bf16_f32 v96, v48, v49
    v_cvt_pk_bf16_f32 v97, v50, v51
    v_cvt_pk_bf16_f32 v98, v52, v53
    v_cvt_pk_bf16_f32 v99, v54, v55
    buffer_store_dwordx4 v[88:91], v24, s[20:23], s32 offen offset:0 sc1
    v_cvt_pk_bf16_f32 v100, v56, v57
    v_cvt_pk_bf16_f32 v101, v58, v59
    v_cvt_pk_bf16_f32 v102, v60, v61
    v_cvt_pk_bf16_f32 v103, v62, v63
    buffer_store_dwordx4 v[92:95], v24, s[20:23], s32 offen offset:1024 sc1
    v_accvgpr_read_b32 v32, a96
    v_accvgpr_read_b32 v33, a97
    v_accvgpr_read_b32 v34, a98
    v_accvgpr_read_b32 v35, a99
    v_accvgpr_read_b32 v36, a100
    v_accvgpr_read_b32 v37, a101
    v_accvgpr_read_b32 v38, a102
    v_accvgpr_read_b32 v39, a103
    v_accvgpr_read_b32 v40, a104
    v_accvgpr_read_b32 v41, a105
    v_accvgpr_read_b32 v42, a106
    v_accvgpr_read_b32 v43, a107
    v_accvgpr_read_b32 v44, a108
    v_accvgpr_read_b32 v45, a109
    v_accvgpr_read_b32 v46, a110
    v_accvgpr_read_b32 v47, a111
    v_pk_mul_f32 v[32:33], v[32:33], v[16:17] op_sel_hi:[1,0]
    v_pk_mul_f32 v[34:35], v[34:35], v[16:17] op_sel_hi:[1,0]
    v_pk_mul_f32 v[36:37], v[36:37], v[16:17] op_sel_hi:[1,0]
    v_pk_mul_f32 v[38:39], v[38:39], v[16:17] op_sel_hi:[1,0]
    v_pk_mul_f32 v[40:41], v[40:41], v[16:17] op_sel_hi:[1,0]
    v_pk_mul_f32 v[42:43], v[42:43], v[16:17] op_sel_hi:[1,0]
    v_pk_mul_f32 v[44:45], v[44:45], v[16:17] op_sel_hi:[1,0]
    v_pk_mul_f32 v[46:47], v[46:47], v[16:17] op_sel_hi:[1,0]
    v_cvt_pk_bf16_f32 v64, v32, v33
    v_cvt_pk_bf16_f32 v65, v34, v35
    v_cvt_pk_bf16_f32 v66, v36, v37
    v_cvt_pk_bf16_f32 v67, v38, v39
    buffer_store_dwordx4 v[96:99], v24, s[20:23], s32 offen offset:2048 sc1
    v_cvt_pk_bf16_f32 v68, v40, v41
    v_cvt_pk_bf16_f32 v69, v42, v43
    v_cvt_pk_bf16_f32 v70, v44, v45
    v_cvt_pk_bf16_f32 v71, v46, v47
    buffer_store_dwordx4 v[100:103], v24, s[20:23], s32 offen offset:3072 sc1
    v_accvgpr_read_b32 v48, a112
    v_accvgpr_read_b32 v49, a113
    v_accvgpr_read_b32 v50, a114
    v_accvgpr_read_b32 v51, a115
    v_accvgpr_read_b32 v52, a116
    v_accvgpr_read_b32 v53, a117
    v_accvgpr_read_b32 v54, a118
    v_accvgpr_read_b32 v55, a119
    s_waitcnt vmcnt(12)
    s_barrier
    v_accvgpr_read_b32 v56, a120
    v_accvgpr_read_b32 v57, a121
    v_accvgpr_read_b32 v58, a122
    v_accvgpr_read_b32 v59, a123
    v_accvgpr_read_b32 v60, a124
    v_accvgpr_read_b32 v61, a125
    v_accvgpr_read_b32 v62, a126
    ds_read_b128 v[176:179], v27 offset:0
    v_accvgpr_read_b32 v63, a127
    v_pk_mul_f32 v[48:49], v[48:49], v[16:17] op_sel_hi:[1,0]
    v_pk_mul_f32 v[50:51], v[50:51], v[16:17] op_sel_hi:[1,0]
    v_pk_mul_f32 v[52:53], v[52:53], v[16:17] op_sel_hi:[1,0]
    v_pk_mul_f32 v[54:55], v[54:55], v[16:17] op_sel_hi:[1,0]
    v_pk_mul_f32 v[56:57], v[56:57], v[16:17] op_sel_hi:[1,0]
    v_pk_mul_f32 v[58:59], v[58:59], v[16:17] op_sel_hi:[1,0]
    ds_read_b128 v[180:183], v27 offset:2048
    v_pk_mul_f32 v[60:61], v[60:61], v[16:17] op_sel_hi:[1,0]
    v_pk_mul_f32 v[62:63], v[62:63], v[16:17] op_sel_hi:[1,0]
    v_cvt_pk_bf16_f32 v76, v48, v49
    v_cvt_pk_bf16_f32 v77, v50, v51
    v_cvt_pk_bf16_f32 v78, v52, v53
    v_cvt_pk_bf16_f32 v79, v54, v55
    v_cvt_pk_bf16_f32 v80, v56, v57
    ds_read_b128 v[184:187], v27 offset:4096
    v_cvt_pk_bf16_f32 v81, v58, v59
    v_cvt_pk_bf16_f32 v82, v60, v61
    v_cvt_pk_bf16_f32 v83, v62, v63
    v_accvgpr_read_b32 v32, a128
    v_accvgpr_read_b32 v33, a129
    v_accvgpr_read_b32 v34, a130
    v_accvgpr_read_b32 v35, a131
    ds_read_b128 v[188:191], v27 offset:6144
    v_accvgpr_read_b32 v36, a132
    v_accvgpr_read_b32 v37, a133
    v_accvgpr_read_b32 v38, a134
    v_accvgpr_read_b32 v39, a135
    v_accvgpr_read_b32 v40, a136
    v_accvgpr_read_b32 v41, a137
    v_accvgpr_read_b32 v42, a138
    ds_read_b128 v[192:195], v27 offset:8192
    v_accvgpr_read_b32 v43, a139
    v_accvgpr_read_b32 v44, a140
    v_accvgpr_read_b32 v45, a141
    v_accvgpr_read_b32 v46, a142
    v_accvgpr_read_b32 v47, a143
    v_pk_mul_f32 v[32:33], v[32:33], v[18:19] op_sel_hi:[1,0]
    v_pk_mul_f32 v[34:35], v[34:35], v[18:19] op_sel_hi:[1,0]
    ds_read_b128 v[196:199], v27 offset:10240
    v_pk_mul_f32 v[36:37], v[36:37], v[18:19] op_sel_hi:[1,0]
    v_pk_mul_f32 v[38:39], v[38:39], v[18:19] op_sel_hi:[1,0]
    v_pk_mul_f32 v[40:41], v[40:41], v[18:19] op_sel_hi:[1,0]
    v_pk_mul_f32 v[42:43], v[42:43], v[18:19] op_sel_hi:[1,0]
    v_pk_mul_f32 v[44:45], v[44:45], v[18:19] op_sel_hi:[1,0]
    v_pk_mul_f32 v[46:47], v[46:47], v[18:19] op_sel_hi:[1,0]
    v_cvt_pk_bf16_f32 v32, v32, v33
    ds_read_b128 v[200:203], v27 offset:12288
    v_cvt_pk_bf16_f32 v33, v34, v35
    v_cvt_pk_bf16_f32 v34, v36, v37
    v_cvt_pk_bf16_f32 v35, v38, v39
    v_cvt_pk_bf16_f32 v40, v40, v41
    v_cvt_pk_bf16_f32 v41, v42, v43
    v_cvt_pk_bf16_f32 v42, v44, v45
    v_cvt_pk_bf16_f32 v43, v46, v47
    ds_read_b128 v[204:207], v27 offset:14336
    v_accvgpr_read_b32 v48, a144
    v_accvgpr_read_b32 v49, a145
    v_accvgpr_read_b32 v50, a146
    v_accvgpr_read_b32 v51, a147
    v_accvgpr_read_b32 v52, a148
    v_accvgpr_read_b32 v53, a149
    v_accvgpr_read_b32 v54, a150
    ds_read_b128 v[208:211], v27 offset:16384
    v_accvgpr_read_b32 v55, a151
    v_accvgpr_read_b32 v56, a152
    v_accvgpr_read_b32 v57, a153
    v_accvgpr_read_b32 v58, a154
    v_accvgpr_read_b32 v59, a155
    v_accvgpr_read_b32 v60, a156
    v_accvgpr_read_b32 v61, a157
    ds_read_b128 v[212:215], v27 offset:18432
    v_accvgpr_read_b32 v62, a158
    v_accvgpr_read_b32 v63, a159
    v_pk_mul_f32 v[48:49], v[48:49], v[18:19] op_sel_hi:[1,0]
    v_pk_mul_f32 v[50:51], v[50:51], v[18:19] op_sel_hi:[1,0]
    v_pk_mul_f32 v[52:53], v[52:53], v[18:19] op_sel_hi:[1,0]
    v_pk_mul_f32 v[54:55], v[54:55], v[18:19] op_sel_hi:[1,0]
    v_pk_mul_f32 v[56:57], v[56:57], v[18:19] op_sel_hi:[1,0]
    ds_read_b128 v[216:219], v27 offset:1024
    v_pk_mul_f32 v[58:59], v[58:59], v[18:19] op_sel_hi:[1,0]
    v_pk_mul_f32 v[60:61], v[60:61], v[18:19] op_sel_hi:[1,0]
    v_pk_mul_f32 v[62:63], v[62:63], v[18:19] op_sel_hi:[1,0]
    v_cvt_pk_bf16_f32 v48, v48, v49
    v_cvt_pk_bf16_f32 v49, v50, v51
    v_cvt_pk_bf16_f32 v50, v52, v53
    v_cvt_pk_bf16_f32 v51, v54, v55
    ds_read_b128 v[220:223], v27 offset:3072
    v_cvt_pk_bf16_f32 v56, v56, v57
    v_cvt_pk_bf16_f32 v57, v58, v59
    v_cvt_pk_bf16_f32 v58, v60, v61
    v_cvt_pk_bf16_f32 v59, v62, v63
    v_add_u32 v4, 256, v24
    v_add_u32 v5, 131584, v24
    v_add_u32 v6, 262912, v24
    v_add_u32 v7, 394240, v24
    v_add_u32 v8, 525568, v24
    s_lshl_b32 s68, s3, 16
    s_lshl_b32 s49, s3, 14
    s_and_b32 s48, s92, 0x1fff
    v_add_u32 v9, s48, v24
    v_add_u32 v13, s49, v9
    s_and_b32 s48, s93, 0x1fff
    v_add_u32 v10, s48, v24
    v_add_u32 v14, s49, v10
    s_and_b32 s48, s94, 0x1fff
    v_add_u32 v11, s48, v24
    v_add_u32 v15, s49, v11
    s_and_b32 s48, s95, 0x1fff
    v_add_u32 v12, s48, v24
    v_add_u32 v16, s49, v12
    s_waitcnt lgkmcnt(0)
L_op:
    v_mfma_f32_16x16x32_bf16 a[0:3], v[112:115], v[176:179], 0
    s_add_u32 s52, s68, 8192
    buffer_load_dwordx4 v[160:163], v11, s[4:7], s52 offen offset:0 sc1
    v_mfma_f32_16x16x32_bf16 a[0:3], v[144:147], v[216:219], a[0:3]
    ds_read_b128 a[240:243], v13 offset:0
    v_mfma_f32_16x16x32_bf16 a[4:7], v[116:119], v[176:179], 0
    ds_read_b128 v[224:227], v27 offset:5120
    v_mfma_f32_16x16x32_bf16 a[4:7], v[148:151], v[216:219], a[4:7]
    buffer_load_dwordx4 v[164:167], v11, s[4:7], s52 offen offset:1024 sc1
    v_mfma_f32_16x16x32_bf16 a[8:11], v[120:123], v[176:179], 0
    ds_read_b128 a[248:251], v13 offset:1024
    ds_read_b128 a[252:255], v14 offset:0
    v_mfma_f32_16x16x32_bf16 a[8:11], v[152:155], v[216:219], a[8:11]
    buffer_store_dwordx4 v[64:67], v24, s[20:23], s33 offen offset:0 sc1
    v_mfma_f32_16x16x32_bf16 a[12:15], v[124:127], v[176:179], 0
    ds_read_b128 v[228:231], v27 offset:7168
    v_mfma_f32_16x16x32_bf16 a[12:15], v[156:159], v[216:219], a[12:15]
    buffer_load_dwordx4 v[168:171], v12, s[4:7], s52 offen offset:0 sc1
    v_mfma_f32_16x16x32_bf16 a[24:27], v[112:115], v[180:183], 0
    ds_read_b128 v[232:235], v27 offset:9216
    v_mfma_f32_16x16x32_bf16 a[24:27], v[144:147], v[220:223], a[24:27]
    buffer_load_dwordx4 v[172:175], v12, s[4:7], s52 offen offset:1024 sc1
    v_mfma_f32_16x16x32_bf16 a[28:31], v[116:119], v[180:183], 0
    ds_read_b128 v[236:239], v27 offset:11264
    v_mfma_f32_16x16x32_bf16 a[28:31], v[148:151], v[220:223], a[28:31]
    v_mfma_f32_16x16x32_bf16 a[32:35], v[120:123], v[180:183], 0
    buffer_load_dwordx4 a[244:247], v4, s[8:11], s70 offen offset:2048 sc1
    v_mfma_f32_16x16x32_bf16 a[32:35], v[152:155], v[220:223], a[32:35]
    ds_read_b128 v[240:243], v27 offset:13312
    v_mfma_f32_16x16x32_bf16 a[36:39], v[124:127], v[180:183], 0
    v_mfma_f32_16x16x32_bf16 a[36:39], v[156:159], v[220:223], a[36:39]
    ds_read_b128 v[244:247], v27 offset:15360
    v_mfma_f32_16x16x32_bf16 a[48:51], v[112:115], v[184:187], 0
    buffer_store_dwordx4 v[68:71], v24, s[20:23], s33 offen offset:1024 sc1
    s_waitcnt lgkmcnt(7)
    v_mfma_f32_16x16x32_bf16 a[48:51], v[144:147], v[224:227], a[48:51]
    v_mfma_f32_16x16x32_bf16 a[52:55], v[116:119], v[184:187], 0
    ds_read_b128 v[248:251], v27 offset:17408
    v_mfma_f32_16x16x32_bf16 a[52:55], v[148:151], v[224:227], a[52:55]
    v_mfma_f32_16x16x32_bf16 a[56:59], v[120:123], v[184:187], 0
    v_mfma_f32_16x16x32_bf16 a[56:59], v[152:155], v[224:227], a[56:59]
    ds_read_b128 v[252:255], v27 offset:19456
    v_mfma_f32_16x16x32_bf16 a[60:63], v[124:127], v[184:187], 0
    v_mfma_f32_16x16x32_bf16 a[60:63], v[156:159], v[224:227], a[60:63]
    v_mfma_f32_16x16x32_bf16 a[72:75], v[112:115], v[188:191], 0
    s_waitcnt lgkmcnt(6)
    v_mfma_f32_16x16x32_bf16 a[72:75], v[144:147], v[228:231], a[72:75]
    v_mfma_f32_16x16x32_bf16 a[76:79], v[116:119], v[188:191], 0
    v_mfma_f32_16x16x32_bf16 a[76:79], v[148:151], v[228:231], a[76:79]
    v_mfma_f32_16x16x32_bf16 a[80:83], v[120:123], v[188:191], 0
    v_mfma_f32_16x16x32_bf16 a[80:83], v[152:155], v[228:231], a[80:83]
    v_mfma_f32_16x16x32_bf16 a[84:87], v[124:127], v[188:191], 0
    buffer_store_dwordx4 v[76:79], v24, s[20:23], s33 offen offset:2048 sc1
    v_mfma_f32_16x16x32_bf16 a[84:87], v[156:159], v[228:231], a[84:87]
    v_mfma_f32_16x16x32_bf16 a[96:99], v[112:115], v[192:195], 0
    s_waitcnt lgkmcnt(5)
    v_mfma_f32_16x16x32_bf16 a[96:99], v[144:147], v[232:235], a[96:99]
    v_mfma_f32_16x16x32_bf16 a[100:103], v[116:119], v[192:195], 0
    v_mfma_f32_16x16x32_bf16 a[100:103], v[148:151], v[232:235], a[100:103]
    v_mfma_f32_16x16x32_bf16 a[104:107], v[120:123], v[192:195], 0
    v_mfma_f32_16x16x32_bf16 a[104:107], v[152:155], v[232:235], a[104:107]
    v_mfma_f32_16x16x32_bf16 a[108:111], v[124:127], v[192:195], 0
    v_mfma_f32_16x16x32_bf16 a[108:111], v[156:159], v[232:235], a[108:111]
    v_mfma_f32_16x16x32_bf16 a[120:123], v[112:115], v[196:199], 0
    s_waitcnt lgkmcnt(4)
    v_mfma_f32_16x16x32_bf16 a[120:123], v[144:147], v[236:239], a[120:123]
    v_mfma_f32_16x16x32_bf16 a[124:127], v[116:119], v[196:199], 0
    v_mfma_f32_16x16x32_bf16 a[124:127], v[148:151], v[236:239], a[124:127]
    v_mfma_f32_16x16x32_bf16 a[128:131], v[120:123], v[196:199], 0
    buffer_store_dwordx4 v[80:83], v24, s[20:23], s33 offen offset:3072 sc1
    v_mfma_f32_16x16x32_bf16 a[128:131], v[152:155], v[236:239], a[128:131]
    v_mfma_f32_16x16x32_bf16 a[132:135], v[124:127], v[196:199], 0
    v_mfma_f32_16x16x32_bf16 a[132:135], v[156:159], v[236:239], a[132:135]
    v_mfma_f32_16x16x32_bf16 a[144:147], v[112:115], v[200:203], 0
    s_waitcnt lgkmcnt(3)
    v_mfma_f32_16x16x32_bf16 a[144:147], v[144:147], v[240:243], a[144:147]
    v_mfma_f32_16x16x32_bf16 a[148:151], v[116:119], v[200:203], 0
    v_mfma_f32_16x16x32_bf16 a[148:151], v[148:151], v[240:243], a[148:151]
    v_mfma_f32_16x16x32_bf16 a[152:155], v[120:123], v[200:203], 0
    v_mfma_f32_16x16x32_bf16 a[152:155], v[152:155], v[240:243], a[152:155]
    v_mfma_f32_16x16x32_bf16 a[156:159], v[124:127], v[200:203], 0
    v_mfma_f32_16x16x32_bf16 a[156:159], v[156:159], v[240:243], a[156:159]
    v_mfma_f32_16x16x32_bf16 a[168:171], v[112:115], v[204:207], 0
    s_waitcnt lgkmcnt(2)
    v_mfma_f32_16x16x32_bf16 a[168:171], v[144:147], v[244:247], a[168:171]
    v_mfma_f32_16x16x32_bf16 a[172:175], v[116:119], v[204:207], 0
    buffer_store_dwordx4 v[32:35], v24, s[20:23], s34 offen offset:0 sc1
    v_mfma_f32_16x16x32_bf16 a[172:175], v[148:151], v[244:247], a[172:175]
    v_mfma_f32_16x16x32_bf16 a[176:179], v[120:123], v[204:207], 0
    v_mfma_f32_16x16x32_bf16 a[176:179], v[152:155], v[244:247], a[176:179]
    v_mfma_f32_16x16x32_bf16 a[180:183], v[124:127], v[204:207], 0
    v_mfma_f32_16x16x32_bf16 a[180:183], v[156:159], v[244:247], a[180:183]
    v_mfma_f32_16x16x32_bf16 a[192:195], v[112:115], v[208:211], 0
    s_waitcnt lgkmcnt(1)
    v_mfma_f32_16x16x32_bf16 a[192:195], v[144:147], v[248:251], a[192:195]
    v_mfma_f32_16x16x32_bf16 a[196:199], v[116:119], v[208:211], 0
    v_mfma_f32_16x16x32_bf16 a[196:199], v[148:151], v[248:251], a[196:199]
    v_mfma_f32_16x16x32_bf16 a[200:203], v[120:123], v[208:211], 0
    v_mfma_f32_16x16x32_bf16 a[200:203], v[152:155], v[248:251], a[200:203]
    v_mfma_f32_16x16x32_bf16 a[204:207], v[124:127], v[208:211], 0
    v_mfma_f32_16x16x32_bf16 a[204:207], v[156:159], v[248:251], a[204:207]
    buffer_store_dwordx4 v[40:43], v24, s[20:23], s34 offen offset:1024 sc1
    v_mfma_f32_16x16x32_bf16 a[216:219], v[112:115], v[212:215], 0
    s_waitcnt lgkmcnt(0)
    v_mfma_f32_16x16x32_bf16 a[216:219], v[144:147], v[252:255], a[216:219]
    ds_read_b128 v[112:115], v14 offset:1024
    v_mfma_f32_16x16x32_bf16 a[220:223], v[116:119], v[212:215], 0
    v_mfma_f32_16x16x32_bf16 a[220:223], v[148:151], v[252:255], a[220:223]
    ds_read_b128 v[144:147], v15 offset:0
    v_mfma_f32_16x16x32_bf16 a[224:227], v[120:123], v[212:215], 0
    v_mfma_f32_16x16x32_bf16 a[224:227], v[152:155], v[252:255], a[224:227]
    ds_read_b128 v[116:119], v15 offset:1024
    v_mfma_f32_16x16x32_bf16 a[228:231], v[124:127], v[212:215], 0
    buffer_load_dwordx4 v[152:155], v5, s[8:11], s70 offen offset:2048 sc1
    v_mfma_f32_16x16x32_bf16 a[228:231], v[156:159], v[252:255], a[228:231]
    ds_read_b128 v[148:151], v16 offset:0
    s_waitcnt vmcnt(10)
    v_mfma_f32_16x16x32_bf16 a[16:19], v[128:131], v[176:179], 0
    v_mfma_f32_16x16x32_bf16 a[16:19], v[160:163], v[216:219], a[16:19]
    buffer_load_dwordx4 v[124:127], v6, s[8:11], s70 offen offset:2048 sc1
    v_mfma_f32_16x16x32_bf16 a[20:23], v[132:135], v[176:179], 0
    ds_read_b128 v[120:123], v16 offset:1024
    v_mfma_f32_16x16x32_bf16 a[20:23], v[164:167], v[216:219], a[20:23]
    v_mfma_f32_16x16x32_bf16 a[40:43], v[128:131], v[180:183], 0
    buffer_load_dwordx4 v[156:159], v7, s[8:11], s70 offen offset:2048 sc1
    v_mfma_f32_16x16x32_bf16 a[40:43], v[160:163], v[220:223], a[40:43]
    buffer_store_dwordx4 v[48:51], v24, s[20:23], s34 offen offset:2048 sc1
    v_mfma_f32_16x16x32_bf16 a[44:47], v[132:135], v[180:183], 0
    v_mfma_f32_16x16x32_bf16 a[44:47], v[164:167], v[220:223], a[44:47]
    v_mfma_f32_16x16x32_bf16 a[64:67], v[128:131], v[184:187], 0
    v_mfma_f32_16x16x32_bf16 a[64:67], v[160:163], v[224:227], a[64:67]
    v_mfma_f32_16x16x32_bf16 a[68:71], v[132:135], v[184:187], 0
    v_mfma_f32_16x16x32_bf16 a[68:71], v[164:167], v[224:227], a[68:71]
    v_mfma_f32_16x16x32_bf16 a[88:91], v[128:131], v[188:191], 0
    v_mfma_f32_16x16x32_bf16 a[88:91], v[160:163], v[228:231], a[88:91]
    v_mfma_f32_16x16x32_bf16 a[92:95], v[132:135], v[188:191], 0
    v_mfma_f32_16x16x32_bf16 a[92:95], v[164:167], v[228:231], a[92:95]
    v_mfma_f32_16x16x32_bf16 a[112:115], v[128:131], v[192:195], 0
    v_mfma_f32_16x16x32_bf16 a[112:115], v[160:163], v[232:235], a[112:115]
    v_mfma_f32_16x16x32_bf16 a[116:119], v[132:135], v[192:195], 0
    v_mfma_f32_16x16x32_bf16 a[116:119], v[164:167], v[232:235], a[116:119]
    buffer_store_dwordx4 v[56:59], v24, s[20:23], s34 offen offset:3072 sc1
    v_mfma_f32_16x16x32_bf16 a[136:139], v[128:131], v[196:199], 0
    v_mfma_f32_16x16x32_bf16 a[136:139], v[160:163], v[236:239], a[136:139]
    v_mfma_f32_16x16x32_bf16 a[140:143], v[132:135], v[196:199], 0
    v_mfma_f32_16x16x32_bf16 a[140:143], v[164:167], v[236:239], a[140:143]
    v_mfma_f32_16x16x32_bf16 a[160:163], v[128:131], v[200:203], 0
    v_mfma_f32_16x16x32_bf16 a[160:163], v[160:163], v[240:243], a[160:163]
    v_mfma_f32_16x16x32_bf16 a[164:167], v[132:135], v[200:203], 0
    v_mfma_f32_16x16x32_bf16 a[164:167], v[164:167], v[240:243], a[164:167]
    v_mfma_f32_16x16x32_bf16 a[184:187], v[128:131], v[204:207], 0
    v_mfma_f32_16x16x32_bf16 a[184:187], v[160:163], v[244:247], a[184:187]
    v_mfma_f32_16x16x32_bf16 a[188:191], v[132:135], v[204:207], 0
    v_mfma_f32_16x16x32_bf16 a[188:191], v[164:167], v[244:247], a[188:191]
    v_mfma_f32_16x16x32_bf16 a[208:211], v[128:131], v[208:211], 0
    v_mfma_f32_16x16x32_bf16 a[208:211], v[160:163], v[248:251], a[208:211]
    v_mfma_f32_16x16x32_bf16 a[212:215], v[132:135], v[208:211], 0
    v_mfma_f32_16x16x32_bf16 a[212:215], v[164:167], v[248:251], a[212:215]
    v_mfma_f32_16x16x32_bf16 a[232:235], v[128:131], v[212:215], 0
    v_mfma_f32_16x16x32_bf16 a[232:235], v[160:163], v[252:255], a[232:235]
    buffer_load_dwordx4 v[128:131], v8, s[8:11], s70 offen offset:2048 sc1
    v_mfma_f32_16x16x32_bf16 a[236:239], v[132:135], v[212:215], 0
    v_mfma_f32_16x16x32_bf16 a[236:239], v[164:167], v[252:255], a[236:239]
    ds_read_b128 v[132:135], v13 offset:8192
    s_waitcnt vmcnt(12)
    v_mfma_f32_16x16x32_bf16 v[32:35], v[136:139], v[176:179], 0
    buffer_load_dwordx4 v[160:163], v4, s[8:11], s71 offen offset:2048 sc1
    v_mfma_f32_16x16x32_bf16 v[32:35], v[168:171], v[216:219], v[32:35]
    v_mfma_f32_16x16x32_bf16 v[36:39], v[140:143], v[176:179], 0
    v_mfma_f32_16x16x32_bf16 v[36:39], v[172:175], v[216:219], v[36:39]
    buffer_load_dwordx4 v[164:167], v4, s[8:11], s71 offen offset:3072 sc1
    v_mfma_f32_16x16x32_bf16 v[40:43], v[136:139], v[180:183], 0
    ds_read_b128 v[176:179], v13 offset:9216
    v_mfma_f32_16x16x32_bf16 v[40:43], v[168:171], v[220:223], v[40:43]
    ds_read_b128 v[216:219], v14 offset:8192
    v_mfma_f32_16x16x32_bf16 v[44:47], v[140:143], v[180:183], 0
    v_mfma_f32_16x16x32_bf16 v[44:47], v[172:175], v[220:223], v[44:47]
    ds_read_b128 v[180:183], v14 offset:9216
    v_mfma_f32_16x16x32_bf16 v[48:51], v[136:139], v[184:187], 0
    v_mfma_f32_16x16x32_bf16 v[48:51], v[168:171], v[224:227], v[48:51]
    ds_read_b128 v[220:223], v15 offset:8192
    v_mfma_f32_16x16x32_bf16 v[52:55], v[140:143], v[184:187], 0
    v_mfma_f32_16x16x32_bf16 v[52:55], v[172:175], v[224:227], v[52:55]
    ds_read_b128 v[184:187], v15 offset:9216
    v_mfma_f32_16x16x32_bf16 v[56:59], v[136:139], v[188:191], 0
    v_mfma_f32_16x16x32_bf16 v[56:59], v[168:171], v[228:231], v[56:59]
    ds_read_b128 v[224:227], v16 offset:8192
    v_mfma_f32_16x16x32_bf16 v[60:63], v[140:143], v[188:191], 0
    v_mfma_f32_16x16x32_bf16 v[60:63], v[172:175], v[228:231], v[60:63]
    ds_read_b128 v[188:191], v16 offset:9216
    v_mfma_f32_16x16x32_bf16 v[64:67], v[136:139], v[192:195], 0
    buffer_load_dwordx4 v[228:231], v5, s[8:11], s71 offen offset:2048 sc1
    v_mfma_f32_16x16x32_bf16 v[64:67], v[168:171], v[232:235], v[64:67]
    v_mfma_f32_16x16x32_bf16 v[68:71], v[140:143], v[192:195], 0
    v_mfma_f32_16x16x32_bf16 v[68:71], v[172:175], v[232:235], v[68:71]
    buffer_load_dwordx4 v[192:195], v5, s[8:11], s71 offen offset:3072 sc1
    v_mfma_f32_16x16x32_bf16 v[72:75], v[136:139], v[196:199], 0
    v_mfma_f32_16x16x32_bf16 v[72:75], v[168:171], v[236:239], v[72:75]
    v_mfma_f32_16x16x32_bf16 v[76:79], v[140:143], v[196:199], 0
    buffer_load_dwordx4 v[232:235], v6, s[8:11], s71 offen offset:2048 sc1
    v_mfma_f32_16x16x32_bf16 v[76:79], v[172:175], v[236:239], v[76:79]
    v_mfma_f32_16x16x32_bf16 v[80:83], v[136:139], v[200:203], 0
    v_mfma_f32_16x16x32_bf16 v[80:83], v[168:171], v[240:243], v[80:83]
    buffer_load_dwordx4 v[196:199], v6, s[8:11], s71 offen offset:3072 sc1
    v_mfma_f32_16x16x32_bf16 v[84:87], v[140:143], v[200:203], 0
    v_mfma_f32_16x16x32_bf16 v[84:87], v[172:175], v[240:243], v[84:87]
    v_mfma_f32_16x16x32_bf16 v[88:91], v[136:139], v[204:207], 0
    buffer_load_dwordx4 v[236:239], v7, s[8:11], s71 offen offset:2048 sc1
    v_mfma_f32_16x16x32_bf16 v[88:91], v[168:171], v[244:247], v[88:91]
    s_waitcnt vmcnt(8)
    v_mov_b32 v1, 147464
    v_mov_b32 v2, 1
    s_mov_b64 exec, 1
    ds_add_rtn_u32 v3, v1, v2
    s_mov_b64 exec, -1
    s_waitcnt lgkmcnt(0)
    v_readfirstlane_b32 s48, v3
    s_nop 1
    s_cmp_eq_u32 s48, 3
    s_cbranch_scc1 L_sig
L_sigr:
    v_mfma_f32_16x16x32_bf16 v[92:95], v[140:143], v[204:207], 0
    v_mfma_f32_16x16x32_bf16 v[92:95], v[172:175], v[244:247], v[92:95]
    buffer_load_dwordx4 v[200:203], v7, s[8:11], s71 offen offset:3072 sc1
    v_mfma_f32_16x16x32_bf16 v[96:99], v[136:139], v[208:211], 0
    v_mfma_f32_16x16x32_bf16 v[96:99], v[168:171], v[248:251], v[96:99]
    v_mfma_f32_16x16x32_bf16 v[100:103], v[140:143], v[208:211], 0
    buffer_load_dwordx4 v[240:243], v8, s[8:11], s71 offen offset:2048 sc1
    v_mfma_f32_16x16x32_bf16 v[100:103], v[172:175], v[248:251], v[100:103]
    v_mfma_f32_16x16x32_bf16 v[104:107], v[136:139], v[212:215], 0
    v_mfma_f32_16x16x32_bf16 v[104:107], v[168:171], v[252:255], v[104:107]
    buffer_load_dwordx4 v[204:207], v8, s[8:11], s71 offen offset:3072 sc1
    v_mfma_f32_16x16x32_bf16 v[108:111], v[140:143], v[212:215], 0
    v_mfma_f32_16x16x32_bf16 v[108:111], v[172:175], v[252:255], v[108:111]
    v_mfma_f32_16x16x32_bf16 a[0:3], a[240:243], a[244:247], a[0:3]
    buffer_load_dwordx4 v[244:247], v4, s[8:11], s70 offen offset:3072 sc1
    v_mfma_f32_16x16x32_bf16 a[4:7], a[248:251], a[244:247], a[4:7]
    v_mfma_f32_16x16x32_bf16 a[8:11], a[252:255], a[244:247], a[8:11]
    s_waitcnt lgkmcnt(12)
    v_mfma_f32_16x16x32_bf16 a[12:15], v[112:115], a[244:247], a[12:15]
    s_add_u32 s53, s68, 262144
    buffer_load_dwordx4 v[208:211], v9, s[4:7], s53 offen offset:0 sc1
    s_waitcnt lgkmcnt(11)
    v_mfma_f32_16x16x32_bf16 a[16:19], v[144:147], a[244:247], a[16:19]
    s_waitcnt lgkmcnt(10)
    v_mfma_f32_16x16x32_bf16 a[20:23], v[116:119], a[244:247], a[20:23]
    s_waitcnt lgkmcnt(9)
    v_mfma_f32_16x16x32_bf16 v[32:35], v[148:151], a[244:247], v[32:35]
    s_add_u32 s54, s70, 32768
    buffer_load_dwordx4 v[248:251], v4, s[8:11], s54 offen offset:0 sc1
    s_waitcnt lgkmcnt(8)
    v_mfma_f32_16x16x32_bf16 v[36:39], v[120:123], a[244:247], v[36:39]
    v_mfma_f32_16x16x32_bf16 a[24:27], a[240:243], v[152:155], a[24:27]
    v_mfma_f32_16x16x32_bf16 a[28:31], a[248:251], v[152:155], a[28:31]
    buffer_load_dwordx4 v[136:139], v9, s[4:7], s53 offen offset:1024 sc1
    v_mfma_f32_16x16x32_bf16 a[32:35], a[252:255], v[152:155], a[32:35]
    v_mfma_f32_16x16x32_bf16 a[36:39], v[112:115], v[152:155], a[36:39]
    v_mfma_f32_16x16x32_bf16 a[40:43], v[144:147], v[152:155], a[40:43]
    buffer_load_dwordx4 v[168:171], v10, s[4:7], s53 offen offset:0 sc1
    v_mfma_f32_16x16x32_bf16 a[44:47], v[116:119], v[152:155], a[44:47]
    v_mfma_f32_16x16x32_bf16 v[40:43], v[148:151], v[152:155], v[40:43]
    v_mfma_f32_16x16x32_bf16 v[44:47], v[120:123], v[152:155], v[44:47]
    buffer_load_dwordx4 v[140:143], v10, s[4:7], s53 offen offset:1024 sc1
    v_mfma_f32_16x16x32_bf16 a[48:51], a[240:243], v[124:127], a[48:51]
    v_mfma_f32_16x16x32_bf16 a[52:55], a[248:251], v[124:127], a[52:55]
    v_mfma_f32_16x16x32_bf16 a[56:59], a[252:255], v[124:127], a[56:59]
    buffer_load_dwordx4 v[212:215], v11, s[4:7], s53 offen offset:0 sc1
    v_mfma_f32_16x16x32_bf16 a[60:63], v[112:115], v[124:127], a[60:63]
    v_mfma_f32_16x16x32_bf16 a[64:67], v[144:147], v[124:127], a[64:67]
    v_mfma_f32_16x16x32_bf16 a[68:71], v[116:119], v[124:127], a[68:71]
    buffer_load_dwordx4 v[172:175], v11, s[4:7], s53 offen offset:1024 sc1
    v_mfma_f32_16x16x32_bf16 v[48:51], v[148:151], v[124:127], v[48:51]
    v_mfma_f32_16x16x32_bf16 v[52:55], v[120:123], v[124:127], v[52:55]
    v_mfma_f32_16x16x32_bf16 a[72:75], a[240:243], v[156:159], a[72:75]
    buffer_load_dwordx4 v[252:255], v12, s[4:7], s53 offen offset:0 sc1
    v_mfma_f32_16x16x32_bf16 a[76:79], a[248:251], v[156:159], a[76:79]
    v_mfma_f32_16x16x32_bf16 a[80:83], a[252:255], v[156:159], a[80:83]
    v_mfma_f32_16x16x32_bf16 a[84:87], v[112:115], v[156:159], a[84:87]
    buffer_load_dwordx4 a[244:247], v12, s[4:7], s53 offen offset:1024 sc1
    v_mfma_f32_16x16x32_bf16 a[88:91], v[144:147], v[156:159], a[88:91]
    v_mfma_f32_16x16x32_bf16 a[92:95], v[116:119], v[156:159], a[92:95]
    s_waitcnt vmcnt(20)
    v_mfma_f32_16x16x32_bf16 v[56:59], v[148:151], v[156:159], v[56:59]
    buffer_load_dwordx4 v[152:155], v5, s[8:11], s70 offen offset:3072 sc1
    v_mfma_f32_16x16x32_bf16 v[60:63], v[120:123], v[156:159], v[60:63]
    v_mfma_f32_16x16x32_bf16 a[96:99], a[240:243], v[128:131], a[96:99]
    v_mfma_f32_16x16x32_bf16 a[100:103], a[248:251], v[128:131], a[100:103]
    buffer_load_dwordx4 v[124:127], v5, s[8:11], s54 offen offset:0 sc1
    v_mfma_f32_16x16x32_bf16 a[104:107], a[252:255], v[128:131], a[104:107]
    v_mfma_f32_16x16x32_bf16 a[108:111], v[112:115], v[128:131], a[108:111]
    v_mfma_f32_16x16x32_bf16 a[112:115], v[144:147], v[128:131], a[112:115]
    buffer_load_dwordx4 v[156:159], v6, s[8:11], s70 offen offset:3072 sc1
    v_mfma_f32_16x16x32_bf16 a[116:119], v[116:119], v[128:131], a[116:119]
    v_mfma_f32_16x16x32_bf16 v[64:67], v[148:151], v[128:131], v[64:67]
    v_mfma_f32_16x16x32_bf16 v[68:71], v[120:123], v[128:131], v[68:71]
    s_waitcnt vmcnt(21)
    v_mfma_f32_16x16x32_bf16 a[120:123], a[240:243], v[160:163], a[120:123]
    buffer_load_dwordx4 v[128:131], v6, s[8:11], s54 offen offset:0 sc1
    s_waitcnt lgkmcnt(7)
    v_mfma_f32_16x16x32_bf16 a[120:123], v[132:135], v[164:167], a[120:123]
    v_mfma_f32_16x16x32_bf16 a[124:127], a[248:251], v[160:163], a[124:127]
    s_waitcnt lgkmcnt(6)
    v_mfma_f32_16x16x32_bf16 a[124:127], v[176:179], v[164:167], a[124:127]
    v_mfma_f32_16x16x32_bf16 a[128:131], a[252:255], v[160:163], a[128:131]
    s_waitcnt lgkmcnt(5)
    v_mfma_f32_16x16x32_bf16 a[128:131], v[216:219], v[164:167], a[128:131]
    v_mfma_f32_16x16x32_bf16 a[132:135], v[112:115], v[160:163], a[132:135]
    s_waitcnt lgkmcnt(4)
    v_mfma_f32_16x16x32_bf16 a[132:135], v[180:183], v[164:167], a[132:135]
    v_mfma_f32_16x16x32_bf16 a[136:139], v[144:147], v[160:163], a[136:139]
    s_waitcnt lgkmcnt(3)
    v_mfma_f32_16x16x32_bf16 a[136:139], v[220:223], v[164:167], a[136:139]
    v_mfma_f32_16x16x32_bf16 a[140:143], v[116:119], v[160:163], a[140:143]
    s_waitcnt lgkmcnt(2)
    v_mfma_f32_16x16x32_bf16 a[140:143], v[184:187], v[164:167], a[140:143]
    v_mfma_f32_16x16x32_bf16 v[72:75], v[148:151], v[160:163], v[72:75]
    s_waitcnt lgkmcnt(1)
    v_mfma_f32_16x16x32_bf16 v[72:75], v[224:227], v[164:167], v[72:75]
    v_mfma_f32_16x16x32_bf16 v[76:79], v[120:123], v[160:163], v[76:79]
    s_waitcnt vmcnt(20)
    s_waitcnt lgkmcnt(0)
    v_mfma_f32_16x16x32_bf16 v[76:79], v[188:191], v[164:167], v[76:79]
    buffer_load_dwordx4 v[160:163], v7, s[8:11], s70 offen offset:3072 sc1
    v_mfma_f32_16x16x32_bf16 a[144:147], a[240:243], v[228:231], a[144:147]
    v_mfma_f32_16x16x32_bf16 a[144:147], v[132:135], v[192:195], a[144:147]
    v_mfma_f32_16x16x32_bf16 a[148:151], a[248:251], v[228:231], a[148:151]
    buffer_load_dwordx4 v[164:167], v7, s[8:11], s54 offen offset:0 sc1
    v_mfma_f32_16x16x32_bf16 a[148:151], v[176:179], v[192:195], a[148:151]
    v_mfma_f32_16x16x32_bf16 a[152:155], a[252:255], v[228:231], a[152:155]
    v_mfma_f32_16x16x32_bf16 a[152:155], v[216:219], v[192:195], a[152:155]
    v_mfma_f32_16x16x32_bf16 a[156:159], v[112:115], v[228:231], a[156:159]
    v_mfma_f32_16x16x32_bf16 a[156:159], v[180:183], v[192:195], a[156:159]
    v_mfma_f32_16x16x32_bf16 a[160:163], v[144:147], v[228:231], a[160:163]
    v_mfma_f32_16x16x32_bf16 a[160:163], v[220:223], v[192:195], a[160:163]
    v_mfma_f32_16x16x32_bf16 a[164:167], v[116:119], v[228:231], a[164:167]
    v_mfma_f32_16x16x32_bf16 a[164:167], v[184:187], v[192:195], a[164:167]
    v_mfma_f32_16x16x32_bf16 v[80:83], v[148:151], v[228:231], v[80:83]
    v_mfma_f32_16x16x32_bf16 v[80:83], v[224:227], v[192:195], v[80:83]
    s_waitcnt vmcnt(20)
    v_mfma_f32_16x16x32_bf16 v[84:87], v[120:123], v[228:231], v[84:87]
    v_mfma_f32_16x16x32_bf16 v[84:87], v[188:191], v[192:195], v[84:87]
    buffer_load_dwordx4 v[228:231], v8, s[8:11], s70 offen offset:3072 sc1
    v_mfma_f32_16x16x32_bf16 a[168:171], a[240:243], v[232:235], a[168:171]
    v_mfma_f32_16x16x32_bf16 a[168:171], v[132:135], v[196:199], a[168:171]
    v_mfma_f32_16x16x32_bf16 a[172:175], a[248:251], v[232:235], a[172:175]
    buffer_load_dwordx4 v[192:195], v8, s[8:11], s54 offen offset:0 sc1
    v_mfma_f32_16x16x32_bf16 a[172:175], v[176:179], v[196:199], a[172:175]
    v_mfma_f32_16x16x32_bf16 a[176:179], a[252:255], v[232:235], a[176:179]
    v_mfma_f32_16x16x32_bf16 a[176:179], v[216:219], v[196:199], a[176:179]
    v_mfma_f32_16x16x32_bf16 a[180:183], v[112:115], v[232:235], a[180:183]
    v_mfma_f32_16x16x32_bf16 a[180:183], v[180:183], v[196:199], a[180:183]
    v_mfma_f32_16x16x32_bf16 a[184:187], v[144:147], v[232:235], a[184:187]
    v_mfma_f32_16x16x32_bf16 a[184:187], v[220:223], v[196:199], a[184:187]
    v_mfma_f32_16x16x32_bf16 a[188:191], v[116:119], v[232:235], a[188:191]
    v_mfma_f32_16x16x32_bf16 a[188:191], v[184:187], v[196:199], a[188:191]
    v_mfma_f32_16x16x32_bf16 v[88:91], v[148:151], v[232:235], v[88:91]
    s_waitcnt vmcnt(20)
    v_mfma_f32_16x16x32_bf16 v[88:91], v[224:227], v[196:199], v[88:91]
    v_mfma_f32_16x16x32_bf16 v[92:95], v[120:123], v[232:235], v[92:95]
    v_mfma_f32_16x16x32_bf16 v[92:95], v[188:191], v[196:199], v[92:95]
    s_add_u32 s44, s71, 32768
    buffer_load_dwordx4 v[232:235], v4, s[8:11], s44 offen offset:0 sc1
    v_mfma_f32_16x16x32_bf16 a[192:195], a[240:243], v[236:239], a[192:195]
    v_mfma_f32_16x16x32_bf16 a[192:195], v[132:135], v[200:203], a[192:195]
    v_mfma_f32_16x16x32_bf16 a[196:199], a[248:251], v[236:239], a[196:199]
    s_add_u32 s45, s68, 270336
    buffer_load_dwordx4 v[196:199], v9, s[4:7], s45 offen offset:0 sc1
    v_mfma_f32_16x16x32_bf16 a[196:199], v[176:179], v[200:203], a[196:199]
    v_mfma_f32_16x16x32_bf16 a[200:203], a[252:255], v[236:239], a[200:203]
    v_mfma_f32_16x16x32_bf16 a[200:203], v[216:219], v[200:203], a[200:203]
    v_mfma_f32_16x16x32_bf16 a[204:207], v[112:115], v[236:239], a[204:207]
    v_mfma_f32_16x16x32_bf16 a[204:207], v[180:183], v[200:203], a[204:207]
    v_mfma_f32_16x16x32_bf16 a[208:211], v[144:147], v[236:239], a[208:211]
    v_mfma_f32_16x16x32_bf16 a[208:211], v[220:223], v[200:203], a[208:211]
    v_mfma_f32_16x16x32_bf16 a[212:215], v[116:119], v[236:239], a[212:215]
    v_mfma_f32_16x16x32_bf16 a[212:215], v[184:187], v[200:203], a[212:215]
    s_waitcnt vmcnt(21)
    v_mfma_f32_16x16x32_bf16 v[96:99], v[148:151], v[236:239], v[96:99]
    v_mfma_f32_16x16x32_bf16 v[96:99], v[224:227], v[200:203], v[96:99]
    v_mfma_f32_16x16x32_bf16 v[100:103], v[120:123], v[236:239], v[100:103]
    v_mfma_f32_16x16x32_bf16 v[100:103], v[188:191], v[200:203], v[100:103]
    buffer_load_dwordx4 v[236:239], v4, s[8:11], s44 offen offset:1024 sc1
    v_mfma_f32_16x16x32_bf16 a[216:219], a[240:243], v[240:243], a[216:219]
    s_waitcnt vmcnt(21)
    v_mfma_f32_16x16x32_bf16 a[216:219], v[132:135], v[204:207], a[216:219]
    v_mfma_f32_16x16x32_bf16 a[220:223], a[248:251], v[240:243], a[220:223]
    buffer_load_dwordx4 v[200:203], v9, s[4:7], s45 offen offset:1024 sc1
    v_mfma_f32_16x16x32_bf16 a[220:223], v[176:179], v[204:207], a[220:223]
    v_mfma_f32_16x16x32_bf16 a[224:227], a[252:255], v[240:243], a[224:227]
    v_mfma_f32_16x16x32_bf16 a[224:227], v[216:219], v[204:207], a[224:227]
    buffer_load_dwordx4 a[240:243], v10, s[4:7], s45 offen offset:0 sc1
    v_mfma_f32_16x16x32_bf16 a[228:231], v[112:115], v[240:243], a[228:231]
    v_mfma_f32_16x16x32_bf16 a[228:231], v[180:183], v[204:207], a[228:231]
    v_mfma_f32_16x16x32_bf16 a[232:235], v[144:147], v[240:243], a[232:235]
    buffer_load_dwordx4 a[248:251], v10, s[4:7], s45 offen offset:1024 sc1
    v_mfma_f32_16x16x32_bf16 a[232:235], v[220:223], v[204:207], a[232:235]
    v_mfma_f32_16x16x32_bf16 a[236:239], v[116:119], v[240:243], a[236:239]
    v_mfma_f32_16x16x32_bf16 a[236:239], v[184:187], v[204:207], a[236:239]
    buffer_load_dwordx4 a[252:255], v11, s[4:7], s45 offen offset:0 sc1
    v_mfma_f32_16x16x32_bf16 v[104:107], v[148:151], v[240:243], v[104:107]
    v_mfma_f32_16x16x32_bf16 v[104:107], v[224:227], v[204:207], v[104:107]
    v_mfma_f32_16x16x32_bf16 v[108:111], v[120:123], v[240:243], v[108:111]
    buffer_load_dwordx4 v[112:115], v11, s[4:7], s45 offen offset:1024 sc1
    v_mfma_f32_16x16x32_bf16 v[108:111], v[188:191], v[204:207], v[108:111]
    s_waitcnt vmcnt(22)
    v_mfma_f32_16x16x32_bf16 a[0:3], v[132:135], v[244:247], a[0:3]
    v_mfma_f32_16x16x32_bf16 a[0:3], v[208:211], v[248:251], a[0:3]
    buffer_load_dwordx4 v[144:147], v12, s[4:7], s45 offen offset:0 sc1
    v_mfma_f32_16x16x32_bf16 a[4:7], v[176:179], v[244:247], a[4:7]
    v_mfma_f32_16x16x32_bf16 a[4:7], v[136:139], v[248:251], a[4:7]
    v_mfma_f32_16x16x32_bf16 a[8:11], v[216:219], v[244:247], a[8:11]
    s_waitcnt vmcnt(20)
    v_mfma_f32_16x16x32_bf16 a[8:11], v[168:171], v[248:251], a[8:11]
    buffer_load_dwordx4 v[116:119], v12, s[4:7], s45 offen offset:1024 sc1
    v_mfma_f32_16x16x32_bf16 a[12:15], v[180:183], v[244:247], a[12:15]
    v_mfma_f32_16x16x32_bf16 a[12:15], v[140:143], v[248:251], a[12:15]
    buffer_load_dwordx4 v[148:151], v5, s[8:11], s44 offen offset:0 sc1
    v_mfma_f32_16x16x32_bf16 a[16:19], v[220:223], v[244:247], a[16:19]
    v_mfma_f32_16x16x32_bf16 a[16:19], v[212:215], v[248:251], a[16:19]
    s_waitcnt vmcnt(20)
    v_mfma_f32_16x16x32_bf16 a[20:23], v[184:187], v[244:247], a[20:23]
    buffer_load_dwordx4 v[120:123], v5, s[8:11], s44 offen offset:1024 sc1
    v_mfma_f32_16x16x32_bf16 a[20:23], v[172:175], v[248:251], a[20:23]
    v_mfma_f32_16x16x32_bf16 v[32:35], v[224:227], v[244:247], v[32:35]
    v_mfma_f32_16x16x32_bf16 v[32:35], v[252:255], v[248:251], v[32:35]
    buffer_load_dwordx4 v[240:243], v6, s[8:11], s44 offen offset:0 sc1
    v_mfma_f32_16x16x32_bf16 v[36:39], v[188:191], v[244:247], v[36:39]
    s_waitcnt vmcnt(19)
    v_mfma_f32_16x16x32_bf16 v[36:39], a[244:247], v[248:251], v[36:39]
    v_mfma_f32_16x16x32_bf16 a[24:27], v[132:135], v[152:155], a[24:27]
    buffer_load_dwordx4 v[204:207], v6, s[8:11], s44 offen offset:1024 sc1
    v_mfma_f32_16x16x32_bf16 a[24:27], v[208:211], v[124:127], a[24:27]
    v_mfma_f32_16x16x32_bf16 a[28:31], v[176:179], v[152:155], a[28:31]
    v_mfma_f32_16x16x32_bf16 a[28:31], v[136:139], v[124:127], a[28:31]
    buffer_load_dwordx4 v[244:247], v7, s[8:11], s44 offen offset:0 sc1
    v_mfma_f32_16x16x32_bf16 a[32:35], v[216:219], v[152:155], a[32:35]
    v_mfma_f32_16x16x32_bf16 a[32:35], v[168:171], v[124:127], a[32:35]
    v_mfma_f32_16x16x32_bf16 a[36:39], v[180:183], v[152:155], a[36:39]
    buffer_load_dwordx4 v[248:251], v7, s[8:11], s44 offen offset:1024 sc1
    v_mfma_f32_16x16x32_bf16 a[36:39], v[140:143], v[124:127], a[36:39]
    v_mfma_f32_16x16x32_bf16 a[40:43], v[220:223], v[152:155], a[40:43]
    v_mfma_f32_16x16x32_bf16 a[40:43], v[212:215], v[124:127], a[40:43]
    v_mfma_f32_16x16x32_bf16 a[44:47], v[184:187], v[152:155], a[44:47]
    v_mfma_f32_16x16x32_bf16 a[44:47], v[172:175], v[124:127], a[44:47]
    v_mfma_f32_16x16x32_bf16 v[40:43], v[224:227], v[152:155], v[40:43]
    v_mfma_f32_16x16x32_bf16 v[40:43], v[252:255], v[124:127], v[40:43]
    s_waitcnt vmcnt(20)
    v_mfma_f32_16x16x32_bf16 v[44:47], v[188:191], v[152:155], v[44:47]
    v_mfma_f32_16x16x32_bf16 v[44:47], a[244:247], v[124:127], v[44:47]
    buffer_load_dwordx4 v[152:155], v8, s[8:11], s44 offen offset:0 sc1
    v_mfma_f32_16x16x32_bf16 a[48:51], v[132:135], v[156:159], a[48:51]
    v_mfma_f32_16x16x32_bf16 a[48:51], v[208:211], v[128:131], a[48:51]
    v_mfma_f32_16x16x32_bf16 a[52:55], v[176:179], v[156:159], a[52:55]
    buffer_load_dwordx4 v[124:127], v8, s[8:11], s44 offen offset:1024 sc1
    v_mfma_f32_16x16x32_bf16 a[52:55], v[136:139], v[128:131], a[52:55]
    v_mfma_f32_16x16x32_bf16 a[56:59], v[216:219], v[156:159], a[56:59]
    v_mfma_f32_16x16x32_bf16 a[56:59], v[168:171], v[128:131], a[56:59]
    v_mfma_f32_16x16x32_bf16 a[60:63], v[180:183], v[156:159], a[60:63]
    v_mfma_f32_16x16x32_bf16 a[60:63], v[140:143], v[128:131], a[60:63]
    v_mfma_f32_16x16x32_bf16 a[64:67], v[220:223], v[156:159], a[64:67]
    v_mfma_f32_16x16x32_bf16 a[64:67], v[212:215], v[128:131], a[64:67]
    v_mfma_f32_16x16x32_bf16 a[68:71], v[184:187], v[156:159], a[68:71]
    v_mfma_f32_16x16x32_bf16 a[68:71], v[172:175], v[128:131], a[68:71]
    v_mfma_f32_16x16x32_bf16 v[48:51], v[224:227], v[156:159], v[48:51]
    s_waitcnt vmcnt(20)
    v_mfma_f32_16x16x32_bf16 v[48:51], v[252:255], v[128:131], v[48:51]
    v_mfma_f32_16x16x32_bf16 v[52:55], v[188:191], v[156:159], v[52:55]
    v_mfma_f32_16x16x32_bf16 v[52:55], a[244:247], v[128:131], v[52:55]
    buffer_load_dwordx4 v[156:159], v4, s[8:11], s54 offen offset:1024 sc1
    v_mfma_f32_16x16x32_bf16 a[72:75], v[132:135], v[160:163], a[72:75]
    v_mfma_f32_16x16x32_bf16 a[72:75], v[208:211], v[164:167], a[72:75]
    v_mfma_f32_16x16x32_bf16 a[76:79], v[176:179], v[160:163], a[76:79]
    s_add_u32 s69, s68, 278528
    buffer_load_dwordx4 v[128:131], v9, s[4:7], s69 offen offset:0 sc1
    v_mfma_f32_16x16x32_bf16 a[76:79], v[136:139], v[164:167], a[76:79]
    v_mfma_f32_16x16x32_bf16 a[80:83], v[216:219], v[160:163], a[80:83]
    v_mfma_f32_16x16x32_bf16 a[80:83], v[168:171], v[164:167], a[80:83]
    v_mfma_f32_16x16x32_bf16 a[84:87], v[180:183], v[160:163], a[84:87]
    v_mfma_f32_16x16x32_bf16 a[84:87], v[140:143], v[164:167], a[84:87]
    v_mfma_f32_16x16x32_bf16 a[88:91], v[220:223], v[160:163], a[88:91]
    v_mfma_f32_16x16x32_bf16 a[88:91], v[212:215], v[164:167], a[88:91]
    v_mfma_f32_16x16x32_bf16 a[92:95], v[184:187], v[160:163], a[92:95]
    v_mfma_f32_16x16x32_bf16 a[92:95], v[172:175], v[164:167], a[92:95]
    s_waitcnt vmcnt(21)
    v_mfma_f32_16x16x32_bf16 v[56:59], v[224:227], v[160:163], v[56:59]
    v_mfma_f32_16x16x32_bf16 v[56:59], v[252:255], v[164:167], v[56:59]
    v_mfma_f32_16x16x32_bf16 v[60:63], v[188:191], v[160:163], v[60:63]
    v_mfma_f32_16x16x32_bf16 v[60:63], a[244:247], v[164:167], v[60:63]
    buffer_load_dwordx4 v[160:163], v4, s[8:11], s54 offen offset:2048 sc1
    v_mfma_f32_16x16x32_bf16 a[96:99], v[132:135], v[228:231], a[96:99]
    s_waitcnt vmcnt(21)
    v_mfma_f32_16x16x32_bf16 a[96:99], v[208:211], v[192:195], a[96:99]
    v_mfma_f32_16x16x32_bf16 a[100:103], v[176:179], v[228:231], a[100:103]
    buffer_load_dwordx4 v[164:167], v9, s[4:7], s69 offen offset:1024 sc1
    v_mfma_f32_16x16x32_bf16 a[100:103], v[136:139], v[192:195], a[100:103]
    v_mfma_f32_16x16x32_bf16 a[104:107], v[216:219], v[228:231], a[104:107]
    v_mfma_f32_16x16x32_bf16 a[104:107], v[168:171], v[192:195], a[104:107]
    buffer_load_dwordx4 v[132:135], v10, s[4:7], s69 offen offset:0 sc1
    v_mfma_f32_16x16x32_bf16 a[108:111], v[180:183], v[228:231], a[108:111]
    v_mfma_f32_16x16x32_bf16 a[108:111], v[140:143], v[192:195], a[108:111]
    v_mfma_f32_16x16x32_bf16 a[112:115], v[220:223], v[228:231], a[112:115]
    buffer_load_dwordx4 v[176:179], v10, s[4:7], s69 offen offset:1024 sc1
    v_mfma_f32_16x16x32_bf16 a[112:115], v[212:215], v[192:195], a[112:115]
    v_mfma_f32_16x16x32_bf16 a[116:119], v[184:187], v[228:231], a[116:119]
    v_mfma_f32_16x16x32_bf16 a[116:119], v[172:175], v[192:195], a[116:119]
    buffer_load_dwordx4 v[216:219], v11, s[4:7], s69 offen offset:0 sc1
    v_mfma_f32_16x16x32_bf16 v[64:67], v[224:227], v[228:231], v[64:67]
    v_mfma_f32_16x16x32_bf16 v[64:67], v[252:255], v[192:195], v[64:67]
    v_mfma_f32_16x16x32_bf16 v[68:71], v[188:191], v[228:231], v[68:71]
    buffer_load_dwordx4 v[180:183], v11, s[4:7], s69 offen offset:1024 sc1
    v_mfma_f32_16x16x32_bf16 v[68:71], a[244:247], v[192:195], v[68:71]
    s_waitcnt vmcnt(22)
    v_mfma_f32_16x16x32_bf16 a[120:123], v[208:211], v[232:235], a[120:123]
    v_mfma_f32_16x16x32_bf16 a[120:123], v[196:199], v[236:239], a[120:123]
    buffer_load_dwordx4 v[220:223], v12, s[4:7], s69 offen offset:0 sc1
    v_mfma_f32_16x16x32_bf16 a[124:127], v[136:139], v[232:235], a[124:127]
    v_mfma_f32_16x16x32_bf16 a[124:127], v[200:203], v[236:239], a[124:127]
    v_mfma_f32_16x16x32_bf16 a[128:131], v[168:171], v[232:235], a[128:131]
    s_waitcnt vmcnt(20)
    v_mfma_f32_16x16x32_bf16 a[128:131], a[240:243], v[236:239], a[128:131]
    buffer_load_dwordx4 v[184:187], v12, s[4:7], s69 offen offset:1024 sc1
    v_mfma_f32_16x16x32_bf16 a[132:135], v[140:143], v[232:235], a[132:135]
    v_mfma_f32_16x16x32_bf16 a[132:135], a[248:251], v[236:239], a[132:135]
    buffer_load_dwordx4 v[224:227], v5, s[8:11], s54 offen offset:1024 sc1
    v_mfma_f32_16x16x32_bf16 a[136:139], v[212:215], v[232:235], a[136:139]
    v_mfma_f32_16x16x32_bf16 a[136:139], a[252:255], v[236:239], a[136:139]
    s_waitcnt vmcnt(20)
    v_mfma_f32_16x16x32_bf16 a[140:143], v[172:175], v[232:235], a[140:143]
    buffer_load_dwordx4 v[188:191], v5, s[8:11], s54 offen offset:2048 sc1
    v_mfma_f32_16x16x32_bf16 a[140:143], v[112:115], v[236:239], a[140:143]
    v_mfma_f32_16x16x32_bf16 v[72:75], v[252:255], v[232:235], v[72:75]
    v_mfma_f32_16x16x32_bf16 v[72:75], v[144:147], v[236:239], v[72:75]
    buffer_load_dwordx4 v[228:231], v6, s[8:11], s54 offen offset:1024 sc1
    v_mfma_f32_16x16x32_bf16 v[76:79], a[244:247], v[232:235], v[76:79]
    s_waitcnt vmcnt(19)
    v_mfma_f32_16x16x32_bf16 v[76:79], v[116:119], v[236:239], v[76:79]
    v_mfma_f32_16x16x32_bf16 a[144:147], v[208:211], v[148:151], a[144:147]
    buffer_load_dwordx4 v[192:195], v6, s[8:11], s54 offen offset:2048 sc1
    v_mfma_f32_16x16x32_bf16 a[144:147], v[196:199], v[120:123], a[144:147]
    v_mfma_f32_16x16x32_bf16 a[148:151], v[136:139], v[148:151], a[148:151]
    v_mfma_f32_16x16x32_bf16 a[148:151], v[200:203], v[120:123], a[148:151]
    buffer_load_dwordx4 v[232:235], v7, s[8:11], s54 offen offset:1024 sc1
    v_mfma_f32_16x16x32_bf16 a[152:155], v[168:171], v[148:151], a[152:155]
    v_mfma_f32_16x16x32_bf16 a[152:155], a[240:243], v[120:123], a[152:155]
    v_mfma_f32_16x16x32_bf16 a[156:159], v[140:143], v[148:151], a[156:159]
    buffer_load_dwordx4 v[236:239], v7, s[8:11], s54 offen offset:2048 sc1
    v_mfma_f32_16x16x32_bf16 a[156:159], a[248:251], v[120:123], a[156:159]
    v_mfma_f32_16x16x32_bf16 a[160:163], v[212:215], v[148:151], a[160:163]
    v_mfma_f32_16x16x32_bf16 a[160:163], a[252:255], v[120:123], a[160:163]
    v_mfma_f32_16x16x32_bf16 a[164:167], v[172:175], v[148:151], a[164:167]
    v_mfma_f32_16x16x32_bf16 a[164:167], v[112:115], v[120:123], a[164:167]
    v_mfma_f32_16x16x32_bf16 v[80:83], v[252:255], v[148:151], v[80:83]
    v_mfma_f32_16x16x32_bf16 v[80:83], v[144:147], v[120:123], v[80:83]
    s_waitcnt vmcnt(20)
    v_mfma_f32_16x16x32_bf16 v[84:87], a[244:247], v[148:151], v[84:87]
    v_mfma_f32_16x16x32_bf16 v[84:87], v[116:119], v[120:123], v[84:87]
    buffer_load_dwordx4 v[148:151], v8, s[8:11], s54 offen offset:1024 sc1
    v_mfma_f32_16x16x32_bf16 a[168:171], v[208:211], v[240:243], a[168:171]
    v_mfma_f32_16x16x32_bf16 a[168:171], v[196:199], v[204:207], a[168:171]
    v_mfma_f32_16x16x32_bf16 a[172:175], v[136:139], v[240:243], a[172:175]
    buffer_load_dwordx4 v[120:123], v8, s[8:11], s54 offen offset:2048 sc1
    v_mfma_f32_16x16x32_bf16 a[172:175], v[200:203], v[204:207], a[172:175]
    v_mfma_f32_16x16x32_bf16 a[176:179], v[168:171], v[240:243], a[176:179]
    v_mfma_f32_16x16x32_bf16 a[176:179], a[240:243], v[204:207], a[176:179]
    v_mfma_f32_16x16x32_bf16 a[180:183], v[140:143], v[240:243], a[180:183]
    v_mfma_f32_16x16x32_bf16 a[180:183], a[248:251], v[204:207], a[180:183]
    v_mfma_f32_16x16x32_bf16 a[184:187], v[212:215], v[240:243], a[184:187]
    v_mfma_f32_16x16x32_bf16 a[184:187], a[252:255], v[204:207], a[184:187]
    v_mfma_f32_16x16x32_bf16 a[188:191], v[172:175], v[240:243], a[188:191]
    v_mfma_f32_16x16x32_bf16 a[188:191], v[112:115], v[204:207], a[188:191]
    s_lshl_b32 s48, s62, 3
    v_mfma_f32_16x16x32_bf16 v[88:91], v[252:255], v[240:243], v[88:91]
    s_waitcnt vmcnt(20)
    v_mfma_f32_16x16x32_bf16 v[88:91], v[144:147], v[204:207], v[88:91]
    s_add_u32 s48, s48, s65
    v_mfma_f32_16x16x32_bf16 v[92:95], a[244:247], v[240:243], v[92:95]
    v_mfma_f32_16x16x32_bf16 v[92:95], v[116:119], v[204:207], v[92:95]
    s_lshl_b32 s48, s48, 7
    v_mfma_f32_16x16x32_bf16 a[192:195], v[208:211], v[244:247], a[192:195]
    buffer_load_dwordx4 v[240:243], v4, s[8:11], s44 offen offset:2048 sc1
    v_mfma_f32_16x16x32_bf16 a[192:195], v[196:199], v[248:251], a[192:195]
    s_add_u32 s48, s48, 53820224
    v_mfma_f32_16x16x32_bf16 a[196:199], v[136:139], v[244:247], a[196:199]
    s_add_u32 s52, s68, 286720
    buffer_load_dwordx4 v[204:207], v9, s[4:7], s52 offen offset:0 sc1
    v_mfma_f32_16x16x32_bf16 a[196:199], v[200:203], v[248:251], a[196:199]
    s_and_b32 s49, s66, 1
    v_mfma_f32_16x16x32_bf16 a[200:203], v[168:171], v[244:247], a[200:203]
    v_mfma_f32_16x16x32_bf16 a[200:203], a[240:243], v[248:251], a[200:203]
    s_lshl_b32 s49, s49, 5
    v_mfma_f32_16x16x32_bf16 a[204:207], v[140:143], v[244:247], a[204:207]
    v_mfma_f32_16x16x32_bf16 a[204:207], a[248:251], v[248:251], a[204:207]
    s_add_u32 s48, s48, s49
    v_mfma_f32_16x16x32_bf16 a[208:211], v[212:215], v[244:247], a[208:211]
    v_mfma_f32_16x16x32_bf16 a[208:211], a[252:255], v[248:251], a[208:211]
    v_and_b32 v29, 7, v0
    v_mfma_f32_16x16x32_bf16 a[212:215], v[172:175], v[244:247], a[212:215]
    v_mfma_f32_16x16x32_bf16 a[212:215], v[112:115], v[248:251], a[212:215]
    v_lshl_add_u32 v29, v29, 2, s48
    s_waitcnt vmcnt(21)
    v_mfma_f32_16x16x32_bf16 v[96:99], v[252:255], v[244:247], v[96:99]
    v_mfma_f32_16x16x32_bf16 v[96:99], v[144:147], v[248:251], v[96:99]
    global_load_dword v31, v29, s[60:61] sc0 sc1
    v_mfma_f32_16x16x32_bf16 v[100:103], a[244:247], v[244:247], v[100:103]
    v_mfma_f32_16x16x32_bf16 v[100:103], v[116:119], v[248:251], v[100:103]
    buffer_load_dwordx4 v[244:247], v4, s[8:11], s44 offen offset:3072 sc1
    v_mfma_f32_16x16x32_bf16 a[216:219], v[208:211], v[152:155], a[216:219]
    s_waitcnt vmcnt(22)
    v_mfma_f32_16x16x32_bf16 a[216:219], v[196:199], v[124:127], a[216:219]
    v_mfma_f32_16x16x32_bf16 a[220:223], v[136:139], v[152:155], a[220:223]
    buffer_load_dwordx4 v[248:251], v9, s[4:7], s52 offen offset:1024 sc1
    v_mfma_f32_16x16x32_bf16 a[220:223], v[200:203], v[124:127], a[220:223]
    v_mfma_f32_16x16x32_bf16 a[224:227], v[168:171], v[152:155], a[224:227]
    v_mfma_f32_16x16x32_bf16 a[224:227], a[240:243], v[124:127], a[224:227]
    buffer_load_dwordx4 v[208:211], v10, s[4:7], s52 offen offset:0 sc1
    v_mfma_f32_16x16x32_bf16 a[228:231], v[140:143], v[152:155], a[228:231]
    v_mfma_f32_16x16x32_bf16 a[228:231], a[248:251], v[124:127], a[228:231]
    v_mfma_f32_16x16x32_bf16 a[232:235], v[212:215], v[152:155], a[232:235]
    buffer_load_dwordx4 v[136:139], v10, s[4:7], s52 offen offset:1024 sc1
    v_mfma_f32_16x16x32_bf16 a[232:235], a[252:255], v[124:127], a[232:235]
    v_mfma_f32_16x16x32_bf16 a[236:239], v[172:175], v[152:155], a[236:239]
    v_mfma_f32_16x16x32_bf16 a[236:239], v[112:115], v[124:127], a[236:239]
    buffer_load_dwordx4 v[168:171], v11, s[4:7], s52 offen offset:0 sc1
    v_mfma_f32_16x16x32_bf16 v[104:107], v[252:255], v[152:155], v[104:107]
    v_mfma_f32_16x16x32_bf16 v[104:107], v[144:147], v[124:127], v[104:107]
    v_mfma_f32_16x16x32_bf16 v[108:111], a[244:247], v[152:155], v[108:111]
    buffer_load_dwordx4 v[140:143], v11, s[4:7], s52 offen offset:1024 sc1
    v_mfma_f32_16x16x32_bf16 v[108:111], v[116:119], v[124:127], v[108:111]
    s_waitcnt vmcnt(23)
    v_mfma_f32_16x16x32_bf16 a[0:3], v[196:199], v[156:159], a[0:3]
    v_mfma_f32_16x16x32_bf16 a[0:3], v[128:131], v[160:163], a[0:3]
    buffer_load_dwordx4 v[212:215], v12, s[4:7], s52 offen offset:0 sc1
    v_mfma_f32_16x16x32_bf16 a[4:7], v[200:203], v[156:159], a[4:7]
    v_mfma_f32_16x16x32_bf16 a[4:7], v[164:167], v[160:163], a[4:7]
    v_mfma_f32_16x16x32_bf16 a[8:11], a[240:243], v[156:159], a[8:11]
    s_waitcnt vmcnt(21)
    v_mfma_f32_16x16x32_bf16 a[8:11], v[132:135], v[160:163], a[8:11]
    buffer_load_dwordx4 v[172:175], v12, s[4:7], s52 offen offset:1024 sc1
    v_mfma_f32_16x16x32_bf16 a[12:15], a[248:251], v[156:159], a[12:15]
    v_mfma_f32_16x16x32_bf16 a[12:15], v[176:179], v[160:163], a[12:15]
    buffer_load_dwordx4 v[252:255], v5, s[8:11], s44 offen offset:2048 sc1
    v_mfma_f32_16x16x32_bf16 a[16:19], a[252:255], v[156:159], a[16:19]
    v_mfma_f32_16x16x32_bf16 a[16:19], v[216:219], v[160:163], a[16:19]
    s_waitcnt vmcnt(21)
    v_mfma_f32_16x16x32_bf16 a[20:23], v[112:115], v[156:159], a[20:23]
    buffer_load_dwordx4 a[244:247], v5, s[8:11], s44 offen offset:3072 sc1
    v_mfma_f32_16x16x32_bf16 a[20:23], v[180:183], v[160:163], a[20:23]
    v_mfma_f32_16x16x32_bf16 v[32:35], v[144:147], v[156:159], v[32:35]
    v_mfma_f32_16x16x32_bf16 v[32:35], v[220:223], v[160:163], v[32:35]
    buffer_load_dwordx4 v[152:155], v6, s[8:11], s44 offen offset:2048 sc1
    v_mfma_f32_16x16x32_bf16 v[36:39], v[116:119], v[156:159], v[36:39]
    s_waitcnt vmcnt(20)
    v_mfma_f32_16x16x32_bf16 v[36:39], v[184:187], v[160:163], v[36:39]
    v_mfma_f32_16x16x32_bf16 a[24:27], v[196:199], v[224:227], a[24:27]
    buffer_load_dwordx4 v[124:127], v6, s[8:11], s44 offen offset:3072 sc1
    v_mfma_f32_16x16x32_bf16 a[24:27], v[128:131], v[188:191], a[24:27]
    v_mfma_f32_16x16x32_bf16 a[28:31], v[200:203], v[224:227], a[28:31]
    v_mfma_f32_16x16x32_bf16 a[28:31], v[164:167], v[188:191], a[28:31]
    buffer_load_dwordx4 v[156:159], v7, s[8:11], s44 offen offset:2048 sc1
    v_mfma_f32_16x16x32_bf16 a[32:35], a[240:243], v[224:227], a[32:35]
    v_mfma_f32_16x16x32_bf16 a[32:35], v[132:135], v[188:191], a[32:35]
    v_mfma_f32_16x16x32_bf16 a[36:39], a[248:251], v[224:227], a[36:39]
    buffer_load_dwordx4 v[160:163], v7, s[8:11], s44 offen offset:3072 sc1
    v_mfma_f32_16x16x32_bf16 a[36:39], v[176:179], v[188:191], a[36:39]
    v_mfma_f32_16x16x32_bf16 a[40:43], a[252:255], v[224:227], a[40:43]
    v_mfma_f32_16x16x32_bf16 a[40:43], v[216:219], v[188:191], a[40:43]
    v_mfma_f32_16x16x32_bf16 a[44:47], v[112:115], v[224:227], a[44:47]
    v_mfma_f32_16x16x32_bf16 a[44:47], v[180:183], v[188:191], a[44:47]
    v_mfma_f32_16x16x32_bf16 v[40:43], v[144:147], v[224:227], v[40:43]
    v_mfma_f32_16x16x32_bf16 v[40:43], v[220:223], v[188:191], v[40:43]
    s_waitcnt vmcnt(21)
    v_mfma_f32_16x16x32_bf16 v[44:47], v[116:119], v[224:227], v[44:47]
    v_mfma_f32_16x16x32_bf16 v[44:47], v[184:187], v[188:191], v[44:47]
    buffer_load_dwordx4 v[224:227], v8, s[8:11], s44 offen offset:2048 sc1
    v_mfma_f32_16x16x32_bf16 a[48:51], v[196:199], v[228:231], a[48:51]
    v_mfma_f32_16x16x32_bf16 a[48:51], v[128:131], v[192:195], a[48:51]
    v_mfma_f32_16x16x32_bf16 a[52:55], v[200:203], v[228:231], a[52:55]
    buffer_load_dwordx4 v[188:191], v8, s[8:11], s44 offen offset:3072 sc1
    v_mfma_f32_16x16x32_bf16 a[52:55], v[164:167], v[192:195], a[52:55]
    v_mfma_f32_16x16x32_bf16 a[56:59], a[240:243], v[228:231], a[56:59]
    v_mfma_f32_16x16x32_bf16 a[56:59], v[132:135], v[192:195], a[56:59]
    v_mfma_f32_16x16x32_bf16 a[60:63], a[248:251], v[228:231], a[60:63]
    v_mfma_f32_16x16x32_bf16 a[60:63], v[176:179], v[192:195], a[60:63]
    v_mfma_f32_16x16x32_bf16 a[64:67], a[252:255], v[228:231], a[64:67]
    v_mfma_f32_16x16x32_bf16 a[64:67], v[216:219], v[192:195], a[64:67]
    v_mfma_f32_16x16x32_bf16 a[68:71], v[112:115], v[228:231], a[68:71]
    v_mfma_f32_16x16x32_bf16 a[68:71], v[180:183], v[192:195], a[68:71]
    v_mfma_f32_16x16x32_bf16 v[48:51], v[144:147], v[228:231], v[48:51]
    s_waitcnt vmcnt(21)
    v_mfma_f32_16x16x32_bf16 v[48:51], v[220:223], v[192:195], v[48:51]
    v_mfma_f32_16x16x32_bf16 v[52:55], v[116:119], v[228:231], v[52:55]
    v_mfma_f32_16x16x32_bf16 v[52:55], v[184:187], v[192:195], v[52:55]
    buffer_load_dwordx4 v[228:231], v4, s[8:11], s54 offen offset:3072 sc1
    v_mfma_f32_16x16x32_bf16 a[72:75], v[196:199], v[232:235], a[72:75]
    v_mfma_f32_16x16x32_bf16 a[72:75], v[128:131], v[236:239], a[72:75]
    v_mfma_f32_16x16x32_bf16 a[76:79], v[200:203], v[232:235], a[76:79]
    s_add_u32 s53, s68, 32768
    buffer_load_dwordx4 v[192:195], v9, s[4:7], s53 offen offset:0 sc1
    v_mfma_f32_16x16x32_bf16 a[76:79], v[164:167], v[236:239], a[76:79]
    v_mfma_f32_16x16x32_bf16 a[80:83], a[240:243], v[232:235], a[80:83]
    v_mfma_f32_16x16x32_bf16 a[80:83], v[132:135], v[236:239], a[80:83]
    v_mfma_f32_16x16x32_bf16 a[84:87], a[248:251], v[232:235], a[84:87]
    v_mfma_f32_16x16x32_bf16 a[84:87], v[176:179], v[236:239], a[84:87]
    v_mfma_f32_16x16x32_bf16 a[88:91], a[252:255], v[232:235], a[88:91]
    v_mfma_f32_16x16x32_bf16 a[88:91], v[216:219], v[236:239], a[88:91]
    v_mfma_f32_16x16x32_bf16 a[92:95], v[112:115], v[232:235], a[92:95]
    v_mfma_f32_16x16x32_bf16 a[92:95], v[180:183], v[236:239], a[92:95]
    s_waitcnt vmcnt(22)
    v_mfma_f32_16x16x32_bf16 v[56:59], v[144:147], v[232:235], v[56:59]
    v_mfma_f32_16x16x32_bf16 v[56:59], v[220:223], v[236:239], v[56:59]
    v_mfma_f32_16x16x32_bf16 v[60:63], v[116:119], v[232:235], v[60:63]
    v_mfma_f32_16x16x32_bf16 v[60:63], v[184:187], v[236:239], v[60:63]
    s_waitcnt vmcnt(18)
    v_cmp_gt_u32 vcc, 16, v31
    s_nop 1
    s_nop 1
    s_cbranch_vccnz L_pw
L_pwr:
    s_add_u32 s45, s70, 4096
    buffer_load_dwordx4 v[232:235], v4, s[8:11], s45 offen offset:0 sc1
    v_mfma_f32_16x16x32_bf16 a[96:99], v[196:199], v[148:151], a[96:99]
    v_mfma_f32_16x16x32_bf16 a[96:99], v[128:131], v[120:123], a[96:99]
    v_mfma_f32_16x16x32_bf16 a[100:103], v[200:203], v[148:151], a[100:103]
    buffer_load_dwordx4 v[236:239], v9, s[4:7], s53 offen offset:1024 sc1
    v_mfma_f32_16x16x32_bf16 a[100:103], v[164:167], v[120:123], a[100:103]
    v_mfma_f32_16x16x32_bf16 a[104:107], a[240:243], v[148:151], a[104:107]
    v_mfma_f32_16x16x32_bf16 a[104:107], v[132:135], v[120:123], a[104:107]
    buffer_load_dwordx4 v[196:199], v10, s[4:7], s53 offen offset:0 sc1
    v_mfma_f32_16x16x32_bf16 a[108:111], a[248:251], v[148:151], a[108:111]
    v_mfma_f32_16x16x32_bf16 a[108:111], v[176:179], v[120:123], a[108:111]
    v_mfma_f32_16x16x32_bf16 a[112:115], a[252:255], v[148:151], a[112:115]
    buffer_load_dwordx4 v[200:203], v10, s[4:7], s53 offen offset:1024 sc1
    v_mfma_f32_16x16x32_bf16 a[112:115], v[216:219], v[120:123], a[112:115]
    v_mfma_f32_16x16x32_bf16 a[116:119], v[112:115], v[148:151], a[116:119]
    v_mfma_f32_16x16x32_bf16 a[116:119], v[180:183], v[120:123], a[116:119]
    buffer_load_dwordx4 a[240:243], v11, s[4:7], s53 offen offset:0 sc1
    v_mfma_f32_16x16x32_bf16 v[64:67], v[144:147], v[148:151], v[64:67]
    v_mfma_f32_16x16x32_bf16 v[64:67], v[220:223], v[120:123], v[64:67]
    v_mfma_f32_16x16x32_bf16 v[68:71], v[116:119], v[148:151], v[68:71]
    buffer_load_dwordx4 a[248:251], v11, s[4:7], s53 offen offset:1024 sc1
    v_mfma_f32_16x16x32_bf16 v[68:71], v[184:187], v[120:123], v[68:71]
    s_waitcnt vmcnt(22)
    v_mfma_f32_16x16x32_bf16 a[120:123], v[128:131], v[240:243], a[120:123]
    v_mfma_f32_16x16x32_bf16 a[120:123], v[204:207], v[244:247], a[120:123]
    buffer_load_dwordx4 a[252:255], v12, s[4:7], s53 offen offset:0 sc1
    v_mfma_f32_16x16x32_bf16 a[124:127], v[164:167], v[240:243], a[124:127]
    v_mfma_f32_16x16x32_bf16 a[124:127], v[248:251], v[244:247], a[124:127]
    v_mfma_f32_16x16x32_bf16 a[128:131], v[132:135], v[240:243], a[128:131]
    s_waitcnt vmcnt(20)
    v_mfma_f32_16x16x32_bf16 a[128:131], v[208:211], v[244:247], a[128:131]
    buffer_load_dwordx4 v[112:115], v12, s[4:7], s53 offen offset:1024 sc1
    v_mfma_f32_16x16x32_bf16 a[132:135], v[176:179], v[240:243], a[132:135]
    v_mfma_f32_16x16x32_bf16 a[132:135], v[136:139], v[244:247], a[132:135]
    buffer_load_dwordx4 v[144:147], v5, s[8:11], s54 offen offset:3072 sc1
    v_mfma_f32_16x16x32_bf16 a[136:139], v[216:219], v[240:243], a[136:139]
    v_mfma_f32_16x16x32_bf16 a[136:139], v[168:171], v[244:247], a[136:139]
    s_waitcnt vmcnt(20)
    v_mfma_f32_16x16x32_bf16 a[140:143], v[180:183], v[240:243], a[140:143]
    buffer_load_dwordx4 v[116:119], v5, s[8:11], s45 offen offset:0 sc1
    v_mfma_f32_16x16x32_bf16 a[140:143], v[140:143], v[244:247], a[140:143]
    v_mfma_f32_16x16x32_bf16 v[72:75], v[220:223], v[240:243], v[72:75]
    v_mfma_f32_16x16x32_bf16 v[72:75], v[212:215], v[244:247], v[72:75]
    buffer_load_dwordx4 v[148:151], v6, s[8:11], s54 offen offset:3072 sc1
    v_mfma_f32_16x16x32_bf16 v[76:79], v[184:187], v[240:243], v[76:79]
    s_waitcnt vmcnt(19)
    v_mfma_f32_16x16x32_bf16 v[76:79], v[172:175], v[244:247], v[76:79]
    v_mfma_f32_16x16x32_bf16 a[144:147], v[128:131], v[252:255], a[144:147]
    buffer_load_dwordx4 v[120:123], v6, s[8:11], s45 offen offset:0 sc1
    v_mfma_f32_16x16x32_bf16 a[144:147], v[204:207], a[244:247], a[144:147]
    v_mfma_f32_16x16x32_bf16 a[148:151], v[164:167], v[252:255], a[148:151]
    v_mfma_f32_16x16x32_bf16 a[148:151], v[248:251], a[244:247], a[148:151]
    buffer_load_dwordx4 v[240:243], v7, s[8:11], s54 offen offset:3072 sc1
    v_mfma_f32_16x16x32_bf16 a[152:155], v[132:135], v[252:255], a[152:155]
    v_mfma_f32_16x16x32_bf16 a[152:155], v[208:211], a[244:247], a[152:155]
    v_mfma_f32_16x16x32_bf16 a[156:159], v[176:179], v[252:255], a[156:159]
    buffer_load_dwordx4 v[244:247], v7, s[8:11], s45 offen offset:0 sc1
    v_mfma_f32_16x16x32_bf16 a[156:159], v[136:139], a[244:247], a[156:159]
    v_mfma_f32_16x16x32_bf16 a[160:163], v[216:219], v[252:255], a[160:163]
    v_mfma_f32_16x16x32_bf16 a[160:163], v[168:171], a[244:247], a[160:163]
    v_mfma_f32_16x16x32_bf16 a[164:167], v[180:183], v[252:255], a[164:167]
    v_mfma_f32_16x16x32_bf16 a[164:167], v[140:143], a[244:247], a[164:167]
    v_mfma_f32_16x16x32_bf16 v[80:83], v[220:223], v[252:255], v[80:83]
    v_mfma_f32_16x16x32_bf16 v[80:83], v[212:215], a[244:247], v[80:83]
    s_waitcnt vmcnt(20)
    v_mfma_f32_16x16x32_bf16 v[84:87], v[184:187], v[252:255], v[84:87]
    v_mfma_f32_16x16x32_bf16 v[84:87], v[172:175], a[244:247], v[84:87]
    buffer_load_dwordx4 v[252:255], v8, s[8:11], s54 offen offset:3072 sc1
    v_mfma_f32_16x16x32_bf16 a[168:171], v[128:131], v[152:155], a[168:171]
    v_mfma_f32_16x16x32_bf16 a[168:171], v[204:207], v[124:127], a[168:171]
    v_mfma_f32_16x16x32_bf16 a[172:175], v[164:167], v[152:155], a[172:175]
    buffer_load_dwordx4 a[244:247], v8, s[8:11], s45 offen offset:0 sc1
    v_mfma_f32_16x16x32_bf16 a[172:175], v[248:251], v[124:127], a[172:175]
    v_mfma_f32_16x16x32_bf16 a[176:179], v[132:135], v[152:155], a[176:179]
    v_mfma_f32_16x16x32_bf16 a[176:179], v[208:211], v[124:127], a[176:179]
    v_mfma_f32_16x16x32_bf16 a[180:183], v[176:179], v[152:155], a[180:183]
    v_mfma_f32_16x16x32_bf16 a[180:183], v[136:139], v[124:127], a[180:183]
    v_mfma_f32_16x16x32_bf16 a[184:187], v[216:219], v[152:155], a[184:187]
    v_mfma_f32_16x16x32_bf16 a[184:187], v[168:171], v[124:127], a[184:187]
    v_mfma_f32_16x16x32_bf16 a[188:191], v[180:183], v[152:155], a[188:191]
    v_mfma_f32_16x16x32_bf16 a[188:191], v[140:143], v[124:127], a[188:191]
    v_mfma_f32_16x16x32_bf16 v[88:91], v[220:223], v[152:155], v[88:91]
    s_waitcnt vmcnt(20)
    v_mfma_f32_16x16x32_bf16 v[88:91], v[212:215], v[124:127], v[88:91]
    v_mfma_f32_16x16x32_bf16 v[92:95], v[184:187], v[152:155], v[92:95]
    v_mfma_f32_16x16x32_bf16 v[92:95], v[172:175], v[124:127], v[92:95]
    s_add_u32 s69, s71, 4096
    buffer_load_dwordx4 v[152:155], v4, s[8:11], s69 offen offset:0 sc1
    v_mfma_f32_16x16x32_bf16 a[192:195], v[128:131], v[156:159], a[192:195]
    v_mfma_f32_16x16x32_bf16 a[192:195], v[204:207], v[160:163], a[192:195]
    v_mfma_f32_16x16x32_bf16 a[196:199], v[164:167], v[156:159], a[196:199]
    s_add_u32 s52, s68, 40960
    buffer_load_dwordx4 v[124:127], v9, s[4:7], s52 offen offset:0 sc1
    v_mfma_f32_16x16x32_bf16 a[196:199], v[248:251], v[160:163], a[196:199]
    v_mfma_f32_16x16x32_bf16 a[200:203], v[132:135], v[156:159], a[200:203]
    v_mfma_f32_16x16x32_bf16 a[200:203], v[208:211], v[160:163], a[200:203]
    v_mfma_f32_16x16x32_bf16 a[204:207], v[176:179], v[156:159], a[204:207]
    v_mfma_f32_16x16x32_bf16 a[204:207], v[136:139], v[160:163], a[204:207]
    v_mfma_f32_16x16x32_bf16 a[208:211], v[216:219], v[156:159], a[208:211]
    v_mfma_f32_16x16x32_bf16 a[208:211], v[168:171], v[160:163], a[208:211]
    v_mfma_f32_16x16x32_bf16 a[212:215], v[180:183], v[156:159], a[212:215]
    v_mfma_f32_16x16x32_bf16 a[212:215], v[140:143], v[160:163], a[212:215]
    s_waitcnt vmcnt(21)
    v_mfma_f32_16x16x32_bf16 v[96:99], v[220:223], v[156:159], v[96:99]
    v_mfma_f32_16x16x32_bf16 v[96:99], v[212:215], v[160:163], v[96:99]
    v_mfma_f32_16x16x32_bf16 v[100:103], v[184:187], v[156:159], v[100:103]
    v_mfma_f32_16x16x32_bf16 v[100:103], v[172:175], v[160:163], v[100:103]
    buffer_load_dwordx4 v[156:159], v4, s[8:11], s69 offen offset:1024 sc1
    v_mfma_f32_16x16x32_bf16 a[216:219], v[128:131], v[224:227], a[216:219]
    s_waitcnt vmcnt(21)
    v_mfma_f32_16x16x32_bf16 a[216:219], v[204:207], v[188:191], a[216:219]
    v_mfma_f32_16x16x32_bf16 a[220:223], v[164:167], v[224:227], a[220:223]
    buffer_load_dwordx4 v[160:163], v9, s[4:7], s52 offen offset:1024 sc1
    v_mfma_f32_16x16x32_bf16 a[220:223], v[248:251], v[188:191], a[220:223]
    v_mfma_f32_16x16x32_bf16 a[224:227], v[132:135], v[224:227], a[224:227]
    v_mfma_f32_16x16x32_bf16 a[224:227], v[208:211], v[188:191], a[224:227]
    buffer_load_dwordx4 v[128:131], v10, s[4:7], s52 offen offset:0 sc1
    v_mfma_f32_16x16x32_bf16 a[228:231], v[176:179], v[224:227], a[228:231]
    v_mfma_f32_16x16x32_bf16 a[228:231], v[136:139], v[188:191], a[228:231]
    v_mfma_f32_16x16x32_bf16 a[232:235], v[216:219], v[224:227], a[232:235]
    buffer_load_dwordx4 v[164:167], v10, s[4:7], s52 offen offset:1024 sc1
    v_mfma_f32_16x16x32_bf16 a[232:235], v[168:171], v[188:191], a[232:235]
    v_mfma_f32_16x16x32_bf16 a[236:239], v[180:183], v[224:227], a[236:239]
    v_mfma_f32_16x16x32_bf16 a[236:239], v[140:143], v[188:191], a[236:239]
    buffer_load_dwordx4 v[132:135], v11, s[4:7], s52 offen offset:0 sc1
    v_mfma_f32_16x16x32_bf16 v[104:107], v[220:223], v[224:227], v[104:107]
    v_mfma_f32_16x16x32_bf16 v[104:107], v[212:215], v[188:191], v[104:107]
    v_mfma_f32_16x16x32_bf16 v[108:111], v[184:187], v[224:227], v[108:111]
    buffer_load_dwordx4 v[176:179], v11, s[4:7], s52 offen offset:1024 sc1
    v_mfma_f32_16x16x32_bf16 v[108:111], v[172:175], v[188:191], v[108:111]
    s_waitcnt vmcnt(22)
    v_mfma_f32_16x16x32_bf16 a[0:3], v[204:207], v[228:231], a[0:3]
    v_mfma_f32_16x16x32_bf16 a[0:3], v[192:195], v[232:235], a[0:3]
    buffer_load_dwordx4 v[216:219], v12, s[4:7], s52 offen offset:0 sc1
    v_mfma_f32_16x16x32_bf16 a[4:7], v[248:251], v[228:231], a[4:7]
    v_mfma_f32_16x16x32_bf16 a[4:7], v[236:239], v[232:235], a[4:7]
    v_mfma_f32_16x16x32_bf16 a[8:11], v[208:211], v[228:231], a[8:11]
    s_waitcnt vmcnt(20)
    v_mfma_f32_16x16x32_bf16 a[8:11], v[196:199], v[232:235], a[8:11]
    buffer_load_dwordx4 v[180:183], v12, s[4:7], s52 offen offset:1024 sc1
    v_mfma_f32_16x16x32_bf16 a[12:15], v[136:139], v[228:231], a[12:15]
    v_mfma_f32_16x16x32_bf16 a[12:15], v[200:203], v[232:235], a[12:15]
    buffer_load_dwordx4 v[220:223], v5, s[8:11], s69 offen offset:0 sc1
    v_mfma_f32_16x16x32_bf16 a[16:19], v[168:171], v[228:231], a[16:19]
    v_mfma_f32_16x16x32_bf16 a[16:19], a[240:243], v[232:235], a[16:19]
    s_waitcnt vmcnt(20)
    v_mfma_f32_16x16x32_bf16 a[20:23], v[140:143], v[228:231], a[20:23]
    buffer_load_dwordx4 v[184:187], v5, s[8:11], s69 offen offset:1024 sc1
    v_mfma_f32_16x16x32_bf16 a[20:23], a[248:251], v[232:235], a[20:23]
    v_mfma_f32_16x16x32_bf16 v[32:35], v[212:215], v[228:231], v[32:35]
    v_mfma_f32_16x16x32_bf16 v[32:35], a[252:255], v[232:235], v[32:35]
    buffer_load_dwordx4 v[224:227], v6, s[8:11], s69 offen offset:0 sc1
    v_mfma_f32_16x16x32_bf16 v[36:39], v[172:175], v[228:231], v[36:39]
    s_waitcnt vmcnt(19)
    v_mfma_f32_16x16x32_bf16 v[36:39], v[112:115], v[232:235], v[36:39]
    v_mfma_f32_16x16x32_bf16 a[24:27], v[204:207], v[144:147], a[24:27]
    buffer_load_dwordx4 v[188:191], v6, s[8:11], s69 offen offset:1024 sc1
    v_mfma_f32_16x16x32_bf16 a[24:27], v[192:195], v[116:119], a[24:27]
    v_mfma_f32_16x16x32_bf16 a[28:31], v[248:251], v[144:147], a[28:31]
    v_mfma_f32_16x16x32_bf16 a[28:31], v[236:239], v[116:119], a[28:31]
    buffer_load_dwordx4 v[228:231], v7, s[8:11], s69 offen offset:0 sc1
    v_mfma_f32_16x16x32_bf16 a[32:35], v[208:211], v[144:147], a[32:35]
    v_mfma_f32_16x16x32_bf16 a[32:35], v[196:199], v[116:119], a[32:35]
    v_mfma_f32_16x16x32_bf16 a[36:39], v[136:139], v[144:147], a[36:39]
    buffer_load_dwordx4 v[232:235], v7, s[8:11], s69 offen offset:1024 sc1
    v_mfma_f32_16x16x32_bf16 a[36:39], v[200:203], v[116:119], a[36:39]
    v_mfma_f32_16x16x32_bf16 a[40:43], v[168:171], v[144:147], a[40:43]
    v_mfma_f32_16x16x32_bf16 a[40:43], a[240:243], v[116:119], a[40:43]
    v_mfma_f32_16x16x32_bf16 a[44:47], v[140:143], v[144:147], a[44:47]
    v_mfma_f32_16x16x32_bf16 a[44:47], a[248:251], v[116:119], a[44:47]
    v_mfma_f32_16x16x32_bf16 v[40:43], v[212:215], v[144:147], v[40:43]
    v_mfma_f32_16x16x32_bf16 v[40:43], a[252:255], v[116:119], v[40:43]
    s_waitcnt vmcnt(20)
    v_mfma_f32_16x16x32_bf16 v[44:47], v[172:175], v[144:147], v[44:47]
    v_mfma_f32_16x16x32_bf16 v[44:47], v[112:115], v[116:119], v[44:47]
    buffer_load_dwordx4 v[144:147], v8, s[8:11], s69 offen offset:0 sc1
    v_mfma_f32_16x16x32_bf16 a[48:51], v[204:207], v[148:151], a[48:51]
    v_mfma_f32_16x16x32_bf16 a[48:51], v[192:195], v[120:123], a[48:51]
    v_mfma_f32_16x16x32_bf16 a[52:55], v[248:251], v[148:151], a[52:55]
    buffer_load_dwordx4 v[116:119], v8, s[8:11], s69 offen offset:1024 sc1
    v_mfma_f32_16x16x32_bf16 a[52:55], v[236:239], v[120:123], a[52:55]
    v_mfma_f32_16x16x32_bf16 a[56:59], v[208:211], v[148:151], a[56:59]
    v_mfma_f32_16x16x32_bf16 a[56:59], v[196:199], v[120:123], a[56:59]
    v_mfma_f32_16x16x32_bf16 a[60:63], v[136:139], v[148:151], a[60:63]
    v_mfma_f32_16x16x32_bf16 a[60:63], v[200:203], v[120:123], a[60:63]
    s_barrier
    v_mfma_f32_16x16x32_bf16 a[64:67], v[168:171], v[148:151], a[64:67]
    v_mfma_f32_16x16x32_bf16 a[64:67], a[240:243], v[120:123], a[64:67]
    v_mfma_f32_16x16x32_bf16 a[68:71], v[140:143], v[148:151], a[68:71]
    v_mfma_f32_16x16x32_bf16 a[68:71], a[248:251], v[120:123], a[68:71]
    v_mfma_f32_16x16x32_bf16 v[48:51], v[212:215], v[148:151], v[48:51]
    s_waitcnt vmcnt(20)
    v_mfma_f32_16x16x32_bf16 v[48:51], a[252:255], v[120:123], v[48:51]
    v_mfma_f32_16x16x32_bf16 v[52:55], v[172:175], v[148:151], v[52:55]
    v_mfma_f32_16x16x32_bf16 v[52:55], v[112:115], v[120:123], v[52:55]
    buffer_load_dwordx4 v[148:151], v4, s[8:11], s45 offen offset:1024 sc1
    v_mfma_f32_16x16x32_bf16 a[72:75], v[204:207], v[240:243], a[72:75]
    v_mfma_f32_16x16x32_bf16 a[72:75], v[192:195], v[244:247], a[72:75]
    v_mfma_f32_16x16x32_bf16 a[76:79], v[248:251], v[240:243], a[76:79]
    s_add_u32 s44, s68, 49152
    buffer_load_dwordx4 v[120:123], v9, s[4:7], s44 offen offset:0 sc1
    v_mfma_f32_16x16x32_bf16 a[76:79], v[236:239], v[244:247], a[76:79]
    v_mfma_f32_16x16x32_bf16 a[80:83], v[208:211], v[240:243], a[80:83]
    v_mfma_f32_16x16x32_bf16 a[80:83], v[196:199], v[244:247], a[80:83]
    v_mfma_f32_16x16x32_bf16 a[84:87], v[136:139], v[240:243], a[84:87]
    v_mfma_f32_16x16x32_bf16 a[84:87], v[200:203], v[244:247], a[84:87]
    v_mfma_f32_16x16x32_bf16 a[88:91], v[168:171], v[240:243], a[88:91]
    v_mfma_f32_16x16x32_bf16 a[88:91], a[240:243], v[244:247], a[88:91]
    v_mfma_f32_16x16x32_bf16 a[92:95], v[140:143], v[240:243], a[92:95]
    v_mfma_f32_16x16x32_bf16 a[92:95], a[248:251], v[244:247], a[92:95]
    s_waitcnt vmcnt(21)
    v_mfma_f32_16x16x32_bf16 v[56:59], v[212:215], v[240:243], v[56:59]
    s_add_u32 s48, s3, 1
    v_mfma_f32_16x16x32_bf16 v[56:59], a[252:255], v[244:247], v[56:59]
    v_mfma_f32_16x16x32_bf16 v[60:63], v[172:175], v[240:243], v[60:63]
    v_mfma_f32_16x16x32_bf16 v[60:63], v[112:115], v[244:247], v[60:63]
    buffer_load_dwordx4 v[240:243], v4, s[8:11], s45 offen offset:2048 sc1
    v_mfma_f32_16x16x32_bf16 a[96:99], v[204:207], v[252:255], a[96:99]
    s_and_b32 s48, s48, 3
    s_waitcnt vmcnt(21)
    v_mfma_f32_16x16x32_bf16 a[96:99], v[192:195], a[244:247], a[96:99]
    v_mfma_f32_16x16x32_bf16 a[100:103], v[248:251], v[252:255], a[100:103]
    buffer_load_dwordx4 v[244:247], v9, s[4:7], s44 offen offset:1024 sc1
    v_mfma_f32_16x16x32_bf16 a[100:103], v[236:239], a[244:247], a[100:103]
    v_mfma_f32_16x16x32_bf16 a[104:107], v[208:211], v[252:255], a[104:107]
    s_mul_i32 s49, s48, 30720
    v_mfma_f32_16x16x32_bf16 a[104:107], v[196:199], a[244:247], a[104:107]
    buffer_load_dwordx4 v[204:207], v10, s[4:7], s44 offen offset:0 sc1
    v_mfma_f32_16x16x32_bf16 a[108:111], v[136:139], v[252:255], a[108:111]
    v_mfma_f32_16x16x32_bf16 a[108:111], v[200:203], a[244:247], a[108:111]
    v_mfma_f32_16x16x32_bf16 a[112:115], v[168:171], v[252:255], a[112:115]
    buffer_load_dwordx4 v[248:251], v10, s[4:7], s44 offen offset:1024 sc1
    v_mfma_f32_16x16x32_bf16 a[112:115], a[240:243], a[244:247], a[112:115]
    s_add_u32 s49, s49, 0
    v_mfma_f32_16x16x32_bf16 a[116:119], v[140:143], v[252:255], a[116:119]
    v_mfma_f32_16x16x32_bf16 a[116:119], a[248:251], a[244:247], a[116:119]
    buffer_load_dwordx4 v[208:211], v11, s[4:7], s44 offen offset:0 sc1
    v_mfma_f32_16x16x32_bf16 v[64:67], v[212:215], v[252:255], v[64:67]
    v_add_u32 v13, s49, v24
    v_mfma_f32_16x16x32_bf16 v[64:67], a[252:255], a[244:247], v[64:67]
    v_mfma_f32_16x16x32_bf16 v[68:71], v[172:175], v[252:255], v[68:71]
    buffer_load_dwordx4 v[136:139], v11, s[4:7], s44 offen offset:1024 sc1
    v_mfma_f32_16x16x32_bf16 v[68:71], v[112:115], a[244:247], v[68:71]
    s_waitcnt vmcnt(22)
    v_mfma_f32_16x16x32_bf16 a[120:123], v[192:195], v[152:155], a[120:123]
    s_add_u32 s48, s3, 2
    v_mfma_f32_16x16x32_bf16 a[120:123], v[124:127], v[156:159], a[120:123]
    buffer_load_dwordx4 v[168:171], v12, s[4:7], s44 offen offset:0 sc1
    v_mfma_f32_16x16x32_bf16 a[124:127], v[236:239], v[152:155], a[124:127]
    v_mfma_f32_16x16x32_bf16 a[124:127], v[160:163], v[156:159], a[124:127]
    v_mfma_f32_16x16x32_bf16 a[128:131], v[196:199], v[152:155], a[128:131]
    s_and_b32 s48, s48, 3
    s_waitcnt vmcnt(20)
    v_mfma_f32_16x16x32_bf16 a[128:131], v[128:131], v[156:159], a[128:131]
    buffer_load_dwordx4 v[140:143], v12, s[4:7], s44 offen offset:1024 sc1
    v_mfma_f32_16x16x32_bf16 a[132:135], v[200:203], v[152:155], a[132:135]
    v_mfma_f32_16x16x32_bf16 a[132:135], v[164:167], v[156:159], a[132:135]
    buffer_load_dwordx4 v[212:215], v5, s[8:11], s45 offen offset:1024 sc1
    v_mfma_f32_16x16x32_bf16 a[136:139], a[240:243], v[152:155], a[136:139]
    s_mul_i32 s49, s48, 30720
    v_mfma_f32_16x16x32_bf16 a[136:139], v[132:135], v[156:159], a[136:139]
    s_waitcnt vmcnt(20)
    v_mfma_f32_16x16x32_bf16 a[140:143], a[248:251], v[152:155], a[140:143]
    buffer_load_dwordx4 v[172:175], v5, s[8:11], s45 offen offset:2048 sc1
    v_mfma_f32_16x16x32_bf16 a[140:143], v[176:179], v[156:159], a[140:143]
    v_mfma_f32_16x16x32_bf16 v[72:75], a[252:255], v[152:155], v[72:75]
    s_add_u32 s49, s49, 10240
    v_mfma_f32_16x16x32_bf16 v[72:75], v[216:219], v[156:159], v[72:75]
    buffer_load_dwordx4 v[252:255], v6, s[8:11], s45 offen offset:1024 sc1
    v_mfma_f32_16x16x32_bf16 v[76:79], v[112:115], v[152:155], v[76:79]
    s_waitcnt vmcnt(19)
    v_mfma_f32_16x16x32_bf16 v[76:79], v[180:183], v[156:159], v[76:79]
    v_mfma_f32_16x16x32_bf16 a[144:147], v[192:195], v[220:223], a[144:147]
    buffer_load_dwordx4 a[244:247], v6, s[8:11], s45 offen offset:2048 sc1
    v_mfma_f32_16x16x32_bf16 a[144:147], v[124:127], v[184:187], a[144:147]
    v_add_u32 v14, s49, v24
    v_mfma_f32_16x16x32_bf16 a[148:151], v[236:239], v[220:223], a[148:151]
    v_mfma_f32_16x16x32_bf16 a[148:151], v[160:163], v[184:187], a[148:151]
    buffer_load_dwordx4 v[152:155], v7, s[8:11], s45 offen offset:1024 sc1
    v_mfma_f32_16x16x32_bf16 a[152:155], v[196:199], v[220:223], a[152:155]
    s_add_u32 s48, s3, 3
    v_mfma_f32_16x16x32_bf16 a[152:155], v[128:131], v[184:187], a[152:155]
    v_mfma_f32_16x16x32_bf16 a[156:159], v[200:203], v[220:223], a[156:159]
    buffer_load_dwordx4 v[156:159], v7, s[8:11], s45 offen offset:2048 sc1
    v_mfma_f32_16x16x32_bf16 a[156:159], v[164:167], v[184:187], a[156:159]
    v_mfma_f32_16x16x32_bf16 a[160:163], a[240:243], v[220:223], a[160:163]
    s_and_b32 s48, s48, 3
    v_mfma_f32_16x16x32_bf16 a[160:163], v[132:135], v[184:187], a[160:163]
    v_mfma_f32_16x16x32_bf16 a[164:167], a[248:251], v[220:223], a[164:167]
    v_mfma_f32_16x16x32_bf16 a[164:167], v[176:179], v[184:187], a[164:167]
    v_mfma_f32_16x16x32_bf16 v[80:83], a[252:255], v[220:223], v[80:83]
    s_mul_i32 s49, s48, 30720
    v_mfma_f32_16x16x32_bf16 v[80:83], v[216:219], v[184:187], v[80:83]
    s_waitcnt vmcnt(20)
    v_mfma_f32_16x16x32_bf16 v[84:87], v[112:115], v[220:223], v[84:87]
    v_mfma_f32_16x16x32_bf16 v[84:87], v[180:183], v[184:187], v[84:87]
    buffer_load_dwordx4 v[220:223], v8, s[8:11], s45 offen offset:1024 sc1
    v_mfma_f32_16x16x32_bf16 a[168:171], v[192:195], v[224:227], a[168:171]
    s_add_u32 s49, s49, 20480
    v_mfma_f32_16x16x32_bf16 a[168:171], v[124:127], v[188:191], a[168:171]
    v_mfma_f32_16x16x32_bf16 a[172:175], v[236:239], v[224:227], a[172:175]
    buffer_load_dwordx4 v[184:187], v8, s[8:11], s45 offen offset:2048 sc1
    v_mfma_f32_16x16x32_bf16 a[172:175], v[160:163], v[188:191], a[172:175]
    v_mfma_f32_16x16x32_bf16 a[176:179], v[196:199], v[224:227], a[176:179]
    v_add_u32 v15, s49, v24
    v_mfma_f32_16x16x32_bf16 a[176:179], v[128:131], v[188:191], a[176:179]
    v_mfma_f32_16x16x32_bf16 a[180:183], v[200:203], v[224:227], a[180:183]
    v_mfma_f32_16x16x32_bf16 a[180:183], v[164:167], v[188:191], a[180:183]
    v_mfma_f32_16x16x32_bf16 a[184:187], a[240:243], v[224:227], a[184:187]
    s_mul_i32 s48, s3, 30720
    v_mfma_f32_16x16x32_bf16 a[184:187], v[132:135], v[188:191], a[184:187]
    v_mfma_f32_16x16x32_bf16 a[188:191], a[248:251], v[224:227], a[188:191]
    v_mfma_f32_16x16x32_bf16 a[188:191], v[176:179], v[188:191], a[188:191]
    v_mfma_f32_16x16x32_bf16 v[88:91], a[252:255], v[224:227], v[88:91]
    s_waitcnt vmcnt(20)
    v_mfma_f32_16x16x32_bf16 v[88:91], v[216:219], v[188:191], v[88:91]
    v_add_u32 v17, s48, v24
    v_mfma_f32_16x16x32_bf16 v[92:95], v[112:115], v[224:227], v[92:95]
    v_mfma_f32_16x16x32_bf16 v[92:95], v[180:183], v[188:191], v[92:95]
    buffer_load_dwordx4 v[224:227], v4, s[8:11], s69 offen offset:2048 sc1
    v_mfma_f32_16x16x32_bf16 a[192:195], v[192:195], v[228:231], a[192:195]
    v_and_b32 v3, 15, v0
    v_mfma_f32_16x16x32_bf16 a[192:195], v[124:127], v[232:235], a[192:195]
    v_mfma_f32_16x16x32_bf16 a[196:199], v[236:239], v[228:231], a[196:199]
    s_add_u32 s53, s68, 57344
    buffer_load_dwordx4 v[188:191], v9, s[4:7], s53 offen offset:0 sc1
    v_mfma_f32_16x16x32_bf16 a[196:199], v[160:163], v[232:235], a[196:199]
    v_mfma_f32_16x16x32_bf16 a[200:203], v[196:199], v[228:231], a[200:203]
    v_and_b32 v1, 48, v0
    v_mfma_f32_16x16x32_bf16 a[200:203], v[128:131], v[232:235], a[200:203]
    v_mfma_f32_16x16x32_bf16 a[204:207], v[200:203], v[228:231], a[204:207]
    v_mfma_f32_16x16x32_bf16 a[204:207], v[164:167], v[232:235], a[204:207]
    v_mfma_f32_16x16x32_bf16 a[208:211], a[240:243], v[228:231], a[208:211]
    s_mul_i32 s48, s65, 304
    v_mfma_f32_16x16x32_bf16 a[208:211], v[132:135], v[232:235], a[208:211]
    v_mfma_f32_16x16x32_bf16 a[212:215], a[248:251], v[228:231], a[212:215]
    v_mfma_f32_16x16x32_bf16 a[212:215], v[176:179], v[232:235], a[212:215]
    s_waitcnt vmcnt(21)
    v_mfma_f32_16x16x32_bf16 v[96:99], a[252:255], v[228:231], v[96:99]
    s_mul_i32 s49, s66, 80
    v_mfma_f32_16x16x32_bf16 v[96:99], v[216:219], v[232:235], v[96:99]
    v_mfma_f32_16x16x32_bf16 v[100:103], v[112:115], v[228:231], v[100:103]
    v_mfma_f32_16x16x32_bf16 v[100:103], v[180:183], v[232:235], v[100:103]
    buffer_load_dwordx4 v[228:231], v4, s[8:11], s69 offen offset:3072 sc1
    v_mfma_f32_16x16x32_bf16 a[216:219], v[192:195], v[144:147], a[216:219]
    s_add_u32 s48, s48, s49
    s_waitcnt vmcnt(21)
    v_mfma_f32_16x16x32_bf16 a[216:219], v[124:127], v[116:119], a[216:219]
    v_mfma_f32_16x16x32_bf16 a[220:223], v[236:239], v[144:147], a[220:223]
    buffer_load_dwordx4 v[232:235], v9, s[4:7], s53 offen offset:1024 sc1
    v_mfma_f32_16x16x32_bf16 a[220:223], v[160:163], v[116:119], a[220:223]
    v_mfma_f32_16x16x32_bf16 a[224:227], v[196:199], v[144:147], a[224:227]
    s_lshl_b32 s48, s48, 11
    v_mfma_f32_16x16x32_bf16 a[224:227], v[128:131], v[116:119], a[224:227]
    buffer_load_dwordx4 v[192:195], v10, s[4:7], s53 offen offset:0 sc1
    v_mfma_f32_16x16x32_bf16 a[228:231], v[200:203], v[144:147], a[228:231]
    v_mfma_f32_16x16x32_bf16 a[228:231], v[164:167], v[116:119], a[228:231]
    v_mfma_f32_16x16x32_bf16 a[232:235], a[240:243], v[144:147], a[232:235]
    buffer_load_dwordx4 v[236:239], v10, s[4:7], s53 offen offset:1024 sc1
    v_mfma_f32_16x16x32_bf16 a[232:235], v[132:135], v[116:119], a[232:235]
    s_lshl_b32 s49, s62, 10
    v_mfma_f32_16x16x32_bf16 a[236:239], a[248:251], v[144:147], a[236:239]
    v_mfma_f32_16x16x32_bf16 a[236:239], v[176:179], v[116:119], a[236:239]
    buffer_load_dwordx4 v[196:199], v11, s[4:7], s53 offen offset:0 sc1
    v_mfma_f32_16x16x32_bf16 v[104:107], a[252:255], v[144:147], v[104:107]
    s_add_u32 s48, s48, s49
    v_mfma_f32_16x16x32_bf16 v[104:107], v[216:219], v[116:119], v[104:107]
    v_mfma_f32_16x16x32_bf16 v[108:111], v[112:115], v[144:147], v[108:111]
    buffer_load_dwordx4 v[200:203], v11, s[4:7], s53 offen offset:1024 sc1
    v_mfma_f32_16x16x32_bf16 v[108:111], v[180:183], v[116:119], v[108:111]
    s_waitcnt vmcnt(22)
    v_mfma_f32_16x16x32_bf16 a[0:3], v[124:127], v[148:151], a[0:3]
    s_lshl_b32 s49, s67, 8
    v_mfma_f32_16x16x32_bf16 a[0:3], v[120:123], v[240:243], a[0:3]
    buffer_load_dwordx4 a[240:243], v12, s[4:7], s53 offen offset:0 sc1
    v_mfma_f32_16x16x32_bf16 a[4:7], v[160:163], v[148:151], a[4:7]
    v_mfma_f32_16x16x32_bf16 a[4:7], v[244:247], v[240:243], a[4:7]
    v_mfma_f32_16x16x32_bf16 a[8:11], v[128:131], v[148:151], a[8:11]
    s_add_u32 s48, s48, s49
    s_waitcnt vmcnt(20)
    v_mfma_f32_16x16x32_bf16 a[8:11], v[204:207], v[240:243], a[8:11]
    buffer_load_dwordx4 a[248:251], v12, s[4:7], s53 offen offset:1024 sc1
    v_mfma_f32_16x16x32_bf16 a[12:15], v[164:167], v[148:151], a[12:15]
    v_mfma_f32_16x16x32_bf16 a[12:15], v[248:251], v[240:243], a[12:15]
    buffer_load_dwordx4 a[252:255], v5, s[8:11], s69 offen offset:2048 sc1
    v_mfma_f32_16x16x32_bf16 a[16:19], v[132:135], v[148:151], a[16:19]
    s_lshl_b32 s49, s3, 6
    v_mfma_f32_16x16x32_bf16 a[16:19], v[208:211], v[240:243], a[16:19]
    s_waitcnt vmcnt(20)
    v_mfma_f32_16x16x32_bf16 a[20:23], v[176:179], v[148:151], a[20:23]
    buffer_load_dwordx4 v[112:115], v5, s[8:11], s69 offen offset:3072 sc1
    v_mfma_f32_16x16x32_bf16 a[20:23], v[136:139], v[240:243], a[20:23]
    v_mfma_f32_16x16x32_bf16 v[32:35], v[216:219], v[148:151], v[32:35]
    s_add_u32 s48, s48, s49
    v_mfma_f32_16x16x32_bf16 v[32:35], v[168:171], v[240:243], v[32:35]
    buffer_load_dwordx4 v[144:147], v6, s[8:11], s69 offen offset:2048 sc1
    v_mfma_f32_16x16x32_bf16 v[36:39], v[180:183], v[148:151], v[36:39]
    s_waitcnt vmcnt(19)
    v_mfma_f32_16x16x32_bf16 v[36:39], v[140:143], v[240:243], v[36:39]
    v_mfma_f32_16x16x32_bf16 a[24:27], v[124:127], v[212:215], a[24:27]
    buffer_load_dwordx4 v[116:119], v6, s[8:11], s69 offen offset:3072 sc1
    v_mfma_f32_16x16x32_bf16 a[24:27], v[120:123], v[172:175], a[24:27]
    v_lshl_add_u32 v2, v3, 11, v1
    v_mfma_f32_16x16x32_bf16 a[28:31], v[160:163], v[212:215], a[28:31]
    v_mfma_f32_16x16x32_bf16 a[28:31], v[244:247], v[172:175], a[28:31]
    buffer_load_dwordx4 v[148:151], v7, s[8:11], s69 offen offset:2048 sc1
    v_mfma_f32_16x16x32_bf16 a[32:35], v[128:131], v[212:215], a[32:35]
    v_add_u32 v2, s48, v2
    v_mfma_f32_16x16x32_bf16 a[32:35], v[204:207], v[172:175], a[32:35]
    v_mfma_f32_16x16x32_bf16 a[36:39], v[164:167], v[212:215], a[36:39]
    buffer_load_dwordx4 v[240:243], v7, s[8:11], s69 offen offset:3072 sc1
    v_mfma_f32_16x16x32_bf16 a[36:39], v[248:251], v[172:175], a[36:39]
    v_mfma_f32_16x16x32_bf16 a[40:43], v[132:135], v[212:215], a[40:43]
    s_mov_b32 s16, s58
    v_mfma_f32_16x16x32_bf16 a[40:43], v[208:211], v[172:175], a[40:43]
    v_mfma_f32_16x16x32_bf16 a[44:47], v[176:179], v[212:215], a[44:47]
    v_mfma_f32_16x16x32_bf16 a[44:47], v[136:139], v[172:175], a[44:47]
    v_mfma_f32_16x16x32_bf16 v[40:43], v[216:219], v[212:215], v[40:43]
    s_mov_b32 s17, s59
    v_mfma_f32_16x16x32_bf16 v[40:43], v[168:171], v[172:175], v[40:43]
    s_waitcnt vmcnt(20)
    v_mfma_f32_16x16x32_bf16 v[44:47], v[180:183], v[212:215], v[44:47]
    v_mfma_f32_16x16x32_bf16 v[44:47], v[140:143], v[172:175], v[44:47]
    buffer_load_dwordx4 v[212:215], v8, s[8:11], s69 offen offset:2048 sc1
    v_mfma_f32_16x16x32_bf16 a[48:51], v[124:127], v[252:255], a[48:51]
    s_mov_b32 s18, 4980736
    v_mfma_f32_16x16x32_bf16 a[48:51], v[120:123], a[244:247], a[48:51]
    v_mfma_f32_16x16x32_bf16 a[52:55], v[160:163], v[252:255], a[52:55]
    buffer_load_dwordx4 v[172:175], v8, s[8:11], s69 offen offset:3072 sc1
    v_mfma_f32_16x16x32_bf16 a[52:55], v[244:247], a[244:247], a[52:55]
    v_mfma_f32_16x16x32_bf16 a[56:59], v[128:131], v[252:255], a[56:59]
    s_mul_i32 s30, s2, 20480
    v_mfma_f32_16x16x32_bf16 a[56:59], v[204:207], a[244:247], a[56:59]
    v_mfma_f32_16x16x32_bf16 a[60:63], v[164:167], v[252:255], a[60:63]
    v_mfma_f32_16x16x32_bf16 a[60:63], v[248:251], a[244:247], a[60:63]
    v_mfma_f32_16x16x32_bf16 a[64:67], v[132:135], v[252:255], a[64:67]
    s_mul_i32 s31, s3, 5120
    v_mfma_f32_16x16x32_bf16 a[64:67], v[208:211], a[244:247], a[64:67]
    v_mfma_f32_16x16x32_bf16 a[68:71], v[176:179], v[252:255], a[68:71]
    v_mfma_f32_16x16x32_bf16 a[68:71], v[136:139], a[244:247], a[68:71]
    v_mfma_f32_16x16x32_bf16 v[48:51], v[216:219], v[252:255], v[48:51]
    s_waitcnt vmcnt(20)
    v_mfma_f32_16x16x32_bf16 v[48:51], v[168:171], a[244:247], v[48:51]
    s_add_u32 s30, s30, s31
    v_mfma_f32_16x16x32_bf16 v[52:55], v[180:183], v[252:255], v[52:55]
    v_mfma_f32_16x16x32_bf16 v[52:55], v[140:143], a[244:247], v[52:55]
    buffer_load_dwordx4 v[252:255], v4, s[8:11], s45 offen offset:3072 sc1
    v_mfma_f32_16x16x32_bf16 a[72:75], v[124:127], v[152:155], a[72:75]
    s_add_u32 s30, s30, 48577280
    v_mfma_f32_16x16x32_bf16 a[72:75], v[120:123], v[156:159], a[72:75]
    v_mfma_f32_16x16x32_bf16 a[76:79], v[160:163], v[152:155], a[76:79]
    s_add_u32 s54, s68, 294912
    buffer_load_dwordx4 a[244:247], v9, s[4:7], s54 offen offset:0 sc1
    v_mfma_f32_16x16x32_bf16 a[76:79], v[244:247], v[156:159], a[76:79]
    v_mfma_f32_16x16x32_bf16 a[80:83], v[128:131], v[152:155], a[80:83]
    s_add_u32 s31, s30, 4096
    v_mfma_f32_16x16x32_bf16 a[80:83], v[204:207], v[156:159], a[80:83]
    v_mfma_f32_16x16x32_bf16 a[84:87], v[164:167], v[152:155], a[84:87]
    v_mfma_f32_16x16x32_bf16 a[84:87], v[248:251], v[156:159], a[84:87]
    v_mfma_f32_16x16x32_bf16 a[88:91], v[132:135], v[152:155], a[88:91]
    s_xor_b32 s34, s2, 1
    v_mfma_f32_16x16x32_bf16 a[88:91], v[208:211], v[156:159], a[88:91]
    v_mfma_f32_16x16x32_bf16 a[92:95], v[176:179], v[152:155], a[92:95]
    v_mfma_f32_16x16x32_bf16 a[92:95], v[136:139], v[156:159], a[92:95]
    s_waitcnt vmcnt(21)
    v_mfma_f32_16x16x32_bf16 v[56:59], v[216:219], v[152:155], v[56:59]
    s_mul_i32 s32, s34, 20480
    v_mfma_f32_16x16x32_bf16 v[56:59], v[168:171], v[156:159], v[56:59]
    v_mfma_f32_16x16x32_bf16 v[60:63], v[180:183], v[152:155], v[60:63]
    v_mfma_f32_16x16x32_bf16 v[60:63], v[140:143], v[156:159], v[60:63]
    s_add_u32 s52, s70, 36864
    buffer_load_dwordx4 v[152:155], v4, s[8:11], s52 offen offset:0 sc1
    v_mfma_f32_16x16x32_bf16 a[96:99], v[124:127], v[220:223], a[96:99]
    s_mul_i32 s33, s3, 5120
    s_waitcnt vmcnt(21)
    v_mfma_f32_16x16x32_bf16 a[96:99], v[120:123], v[184:187], a[96:99]
    v_mfma_f32_16x16x32_bf16 a[100:103], v[160:163], v[220:223], a[100:103]
    buffer_load_dwordx4 v[156:159], v9, s[4:7], s54 offen offset:1024 sc1
    v_mfma_f32_16x16x32_bf16 a[100:103], v[244:247], v[184:187], a[100:103]
    v_mfma_f32_16x16x32_bf16 a[104:107], v[128:131], v[220:223], a[104:107]
    s_add_u32 s32, s32, s33
    v_mfma_f32_16x16x32_bf16 a[104:107], v[204:207], v[184:187], a[104:107]
    buffer_load_dwordx4 v[124:127], v10, s[4:7], s54 offen offset:0 sc1
    v_mfma_f32_16x16x32_bf16 a[108:111], v[164:167], v[220:223], a[108:111]
    v_mfma_f32_16x16x32_bf16 a[108:111], v[248:251], v[184:187], a[108:111]
    v_mfma_f32_16x16x32_bf16 a[112:115], v[132:135], v[220:223], a[112:115]
    buffer_load_dwordx4 v[160:163], v10, s[4:7], s54 offen offset:1024 sc1
    v_mfma_f32_16x16x32_bf16 a[112:115], v[208:211], v[184:187], a[112:115]
    s_add_u32 s32, s32, 48577280
    v_mfma_f32_16x16x32_bf16 a[116:119], v[176:179], v[220:223], a[116:119]
    v_mfma_f32_16x16x32_bf16 a[116:119], v[136:139], v[184:187], a[116:119]
    buffer_load_dwordx4 v[128:131], v11, s[4:7], s54 offen offset:0 sc1
    v_mfma_f32_16x16x32_bf16 v[64:67], v[216:219], v[220:223], v[64:67]
    s_add_u32 s33, s32, 4096
    v_mfma_f32_16x16x32_bf16 v[64:67], v[168:171], v[184:187], v[64:67]
    v_mfma_f32_16x16x32_bf16 v[68:71], v[180:183], v[220:223], v[68:71]
    buffer_load_dwordx4 v[164:167], v11, s[4:7], s54 offen offset:1024 sc1
    v_mfma_f32_16x16x32_bf16 v[68:71], v[140:143], v[184:187], v[68:71]
    s_waitcnt vmcnt(22)
    v_mfma_f32_16x16x32_bf16 a[120:123], v[120:123], v[224:227], a[120:123]
    s_lshl_b32 s48, s3, 2
    v_mfma_f32_16x16x32_bf16 a[120:123], v[188:191], v[228:231], a[120:123]
    buffer_load_dwordx4 v[132:135], v12, s[4:7], s54 offen offset:0 sc1
    v_mfma_f32_16x16x32_bf16 a[124:127], v[244:247], v[224:227], a[124:127]
    v_mfma_f32_16x16x32_bf16 a[124:127], v[232:235], v[228:231], a[124:127]
    v_mfma_f32_16x16x32_bf16 a[128:131], v[204:207], v[224:227], a[128:131]
    s_add_u32 s48, s48, 53824256
    s_waitcnt vmcnt(20)
    v_mfma_f32_16x16x32_bf16 a[128:131], v[192:195], v[228:231], a[128:131]
    buffer_load_dwordx4 v[176:179], v12, s[4:7], s54 offen offset:1024 sc1
    v_mfma_f32_16x16x32_bf16 a[132:135], v[248:251], v[224:227], a[132:135]
    v_mfma_f32_16x16x32_bf16 a[132:135], v[236:239], v[228:231], a[132:135]
    buffer_load_dwordx4 v[216:219], v5, s[8:11], s45 offen offset:3072 sc1
    v_mfma_f32_16x16x32_bf16 a[136:139], v[208:211], v[224:227], a[136:139]
    s_lshl_b32 s49, s2, 7
    v_mfma_f32_16x16x32_bf16 a[136:139], v[196:199], v[228:231], a[136:139]
    s_waitcnt vmcnt(20)
    v_mfma_f32_16x16x32_bf16 a[140:143], v[136:139], v[224:227], a[140:143]
    buffer_load_dwordx4 v[180:183], v5, s[8:11], s52 offen offset:0 sc1
    v_mfma_f32_16x16x32_bf16 a[140:143], v[200:203], v[228:231], a[140:143]
    v_mfma_f32_16x16x32_bf16 v[72:75], v[168:171], v[224:227], v[72:75]
    s_add_u32 s49, s49, s48
    v_mfma_f32_16x16x32_bf16 v[72:75], a[240:243], v[228:231], v[72:75]
    buffer_load_dwordx4 v[220:223], v6, s[8:11], s45 offen offset:3072 sc1
    v_mfma_f32_16x16x32_bf16 v[76:79], v[140:143], v[224:227], v[76:79]
    s_waitcnt vmcnt(19)
    v_mfma_f32_16x16x32_bf16 v[76:79], a[248:251], v[228:231], v[76:79]
    v_mfma_f32_16x16x32_bf16 a[144:147], v[120:123], a[252:255], a[144:147]
    buffer_load_dwordx4 v[184:187], v6, s[8:11], s52 offen offset:0 sc1
    v_mfma_f32_16x16x32_bf16 a[144:147], v[188:191], v[112:115], a[144:147]
    v_mov_b32 v25, s49
    v_mfma_f32_16x16x32_bf16 a[148:151], v[244:247], a[252:255], a[148:151]
    v_mfma_f32_16x16x32_bf16 a[148:151], v[232:235], v[112:115], a[148:151]
    buffer_load_dwordx4 v[224:227], v7, s[8:11], s45 offen offset:3072 sc1
    v_mfma_f32_16x16x32_bf16 a[152:155], v[204:207], a[252:255], a[152:155]
    s_lshl_b32 s34, s34, 7
    v_mfma_f32_16x16x32_bf16 a[152:155], v[192:195], v[112:115], a[152:155]
    v_mfma_f32_16x16x32_bf16 a[156:159], v[248:251], a[252:255], a[156:159]
    buffer_load_dwordx4 v[228:231], v7, s[8:11], s52 offen offset:0 sc1
    v_mfma_f32_16x16x32_bf16 a[156:159], v[236:239], v[112:115], a[156:159]
    v_mfma_f32_16x16x32_bf16 a[160:163], v[208:211], a[252:255], a[160:163]
    s_add_u32 s34, s34, s48
    v_mfma_f32_16x16x32_bf16 a[160:163], v[196:199], v[112:115], a[160:163]
    v_mfma_f32_16x16x32_bf16 a[164:167], v[136:139], a[252:255], a[164:167]
    v_mfma_f32_16x16x32_bf16 a[164:167], v[200:203], v[112:115], a[164:167]
    v_mfma_f32_16x16x32_bf16 v[80:83], v[168:171], a[252:255], v[80:83]
    v_mov_b32 v29, s34
    v_mfma_f32_16x16x32_bf16 v[80:83], a[240:243], v[112:115], v[80:83]
    s_waitcnt vmcnt(20)
    v_mfma_f32_16x16x32_bf16 v[84:87], v[140:143], a[252:255], v[84:87]
    v_mfma_f32_16x16x32_bf16 v[84:87], a[248:251], v[112:115], v[84:87]
    buffer_load_dwordx4 a[252:255], v8, s[8:11], s45 offen offset:3072 sc1
    v_mfma_f32_16x16x32_bf16 a[168:171], v[120:123], v[144:147], a[168:171]
    v_mov_b32 v26, 16
    v_mfma_f32_16x16x32_bf16 a[168:171], v[188:191], v[116:119], a[168:171]
    v_mfma_f32_16x16x32_bf16 a[172:175], v[244:247], v[144:147], a[172:175]
    buffer_load_dwordx4 v[112:115], v8, s[8:11], s52 offen offset:0 sc1
    v_mfma_f32_16x16x32_bf16 a[172:175], v[232:235], v[116:119], a[172:175]
    v_mfma_f32_16x16x32_bf16 a[176:179], v[204:207], v[144:147], a[176:179]
    v_mfma_f32_16x16x32_bf16 a[176:179], v[192:195], v[116:119], a[176:179]
    v_mfma_f32_16x16x32_bf16 a[180:183], v[248:251], v[144:147], a[180:183]
    v_mfma_f32_16x16x32_bf16 a[180:183], v[236:239], v[116:119], a[180:183]
    v_mfma_f32_16x16x32_bf16 a[184:187], v[208:211], v[144:147], a[184:187]
    v_mfma_f32_16x16x32_bf16 a[184:187], v[196:199], v[116:119], a[184:187]
    v_mfma_f32_16x16x32_bf16 a[188:191], v[136:139], v[144:147], a[188:191]
    v_mfma_f32_16x16x32_bf16 a[188:191], v[200:203], v[116:119], a[188:191]
    v_mfma_f32_16x16x32_bf16 v[88:91], v[168:171], v[144:147], v[88:91]
    s_waitcnt vmcnt(20)
    v_mfma_f32_16x16x32_bf16 v[88:91], a[240:243], v[116:119], v[88:91]
    v_mfma_f32_16x16x32_bf16 v[92:95], v[140:143], v[144:147], v[92:95]
    v_mfma_f32_16x16x32_bf16 v[92:95], a[248:251], v[116:119], v[92:95]
    s_add_u32 s44, s68, 303104
    buffer_load_dwordx4 v[144:147], v9, s[4:7], s44 offen offset:0 sc1
    v_mfma_f32_16x16x32_bf16 a[192:195], v[120:123], v[148:151], a[192:195]
    v_mfma_f32_16x16x32_bf16 a[192:195], v[188:191], v[240:243], a[192:195]
    v_mfma_f32_16x16x32_bf16 a[196:199], v[244:247], v[148:151], a[196:199]
    buffer_load_dwordx4 v[116:119], v4, s[8:11], s52 offen offset:1024 sc1
    v_mfma_f32_16x16x32_bf16 a[196:199], v[232:235], v[240:243], a[196:199]
    v_mfma_f32_16x16x32_bf16 a[200:203], v[204:207], v[148:151], a[200:203]
    v_mfma_f32_16x16x32_bf16 a[200:203], v[192:195], v[240:243], a[200:203]
    v_mfma_f32_16x16x32_bf16 a[204:207], v[248:251], v[148:151], a[204:207]
    v_mfma_f32_16x16x32_bf16 a[204:207], v[236:239], v[240:243], a[204:207]
    v_mfma_f32_16x16x32_bf16 a[208:211], v[208:211], v[148:151], a[208:211]
    v_mfma_f32_16x16x32_bf16 a[208:211], v[196:199], v[240:243], a[208:211]
    v_mfma_f32_16x16x32_bf16 a[212:215], v[136:139], v[148:151], a[212:215]
    v_mfma_f32_16x16x32_bf16 a[212:215], v[200:203], v[240:243], a[212:215]
    s_waitcnt vmcnt(21)
    v_mfma_f32_16x16x32_bf16 v[96:99], v[168:171], v[148:151], v[96:99]
    v_mfma_f32_16x16x32_bf16 v[96:99], a[240:243], v[240:243], v[96:99]
    v_mfma_f32_16x16x32_bf16 v[100:103], v[140:143], v[148:151], v[100:103]
    v_mfma_f32_16x16x32_bf16 v[100:103], a[248:251], v[240:243], v[100:103]
    s_add_u32 s53, s68, 311296
    buffer_load_dwordx4 v[148:151], v9, s[4:7], s53 offen offset:0 sc1
    v_mfma_f32_16x16x32_bf16 a[216:219], v[120:123], v[212:215], a[216:219]
    s_waitcnt vmcnt(21)
    v_mfma_f32_16x16x32_bf16 a[216:219], v[188:191], v[172:175], a[216:219]
    v_mfma_f32_16x16x32_bf16 a[220:223], v[244:247], v[212:215], a[220:223]
    buffer_load_dwordx4 v[240:243], v4, s[8:11], s52 offen offset:2048 sc1
    v_mfma_f32_16x16x32_bf16 a[220:223], v[232:235], v[172:175], a[220:223]
    v_mfma_f32_16x16x32_bf16 a[224:227], v[204:207], v[212:215], a[224:227]
    v_mfma_f32_16x16x32_bf16 a[224:227], v[192:195], v[172:175], a[224:227]
    s_add_u32 s69, s68, 319488
    buffer_load_dwordx4 v[120:123], v9, s[4:7], s69 offen offset:0 sc1
    v_mfma_f32_16x16x32_bf16 a[228:231], v[248:251], v[212:215], a[228:231]
    v_mfma_f32_16x16x32_bf16 a[228:231], v[236:239], v[172:175], a[228:231]
    v_mfma_f32_16x16x32_bf16 a[232:235], v[208:211], v[212:215], a[232:235]
    buffer_load_dwordx4 v[244:247], v4, s[8:11], s52 offen offset:3072 sc1
    v_mfma_f32_16x16x32_bf16 a[232:235], v[196:199], v[172:175], a[232:235]
    v_mfma_f32_16x16x32_bf16 a[236:239], v[136:139], v[212:215], a[236:239]
    v_mfma_f32_16x16x32_bf16 a[236:239], v[200:203], v[172:175], a[236:239]
    buffer_load_dwordx4 v[204:207], v9, s[4:7], s44 offen offset:1024 sc1
    v_mfma_f32_16x16x32_bf16 v[104:107], v[168:171], v[212:215], v[104:107]
    v_mfma_f32_16x16x32_bf16 v[104:107], a[240:243], v[172:175], v[104:107]
    v_mfma_f32_16x16x32_bf16 v[108:111], v[140:143], v[212:215], v[108:111]
    buffer_load_dwordx4 v[248:251], v9, s[4:7], s53 offen offset:1024 sc1
    v_mfma_f32_16x16x32_bf16 v[108:111], a[248:251], v[172:175], v[108:111]
    s_waitcnt vmcnt(22)
    v_mfma_f32_16x16x32_bf16 a[0:3], v[188:191], v[252:255], a[0:3]
    v_mfma_f32_16x16x32_bf16 a[0:3], a[244:247], v[152:155], a[0:3]
    buffer_load_dwordx4 v[208:211], v9, s[4:7], s69 offen offset:1024 sc1
    v_mfma_f32_16x16x32_bf16 a[4:7], v[232:235], v[252:255], a[4:7]
    v_mfma_f32_16x16x32_bf16 a[4:7], v[156:159], v[152:155], a[4:7]
    v_mfma_f32_16x16x32_bf16 a[8:11], v[192:195], v[252:255], a[8:11]
    s_waitcnt vmcnt(20)
    v_mfma_f32_16x16x32_bf16 a[8:11], v[124:127], v[152:155], a[8:11]
    buffer_load_dwordx4 v[136:139], v5, s[8:11], s52 offen offset:1024 sc1
    v_mfma_f32_16x16x32_bf16 a[12:15], v[236:239], v[252:255], a[12:15]
    v_mfma_f32_16x16x32_bf16 a[12:15], v[160:163], v[152:155], a[12:15]
    buffer_load_dwordx4 v[168:171], v5, s[8:11], s52 offen offset:2048 sc1
    v_mfma_f32_16x16x32_bf16 a[16:19], v[196:199], v[252:255], a[16:19]
    v_mfma_f32_16x16x32_bf16 a[16:19], v[128:131], v[152:155], a[16:19]
    s_waitcnt vmcnt(20)
    v_mfma_f32_16x16x32_bf16 a[20:23], v[200:203], v[252:255], a[20:23]
    buffer_load_dwordx4 v[140:143], v5, s[8:11], s52 offen offset:3072 sc1
    v_mfma_f32_16x16x32_bf16 a[20:23], v[164:167], v[152:155], a[20:23]
    v_mfma_f32_16x16x32_bf16 v[32:35], a[240:243], v[252:255], v[32:35]
    v_mfma_f32_16x16x32_bf16 v[32:35], v[132:135], v[152:155], v[32:35]
    buffer_load_dwordx4 v[212:215], v6, s[8:11], s52 offen offset:1024 sc1
    v_mfma_f32_16x16x32_bf16 v[36:39], a[248:251], v[252:255], v[36:39]
    s_waitcnt vmcnt(19)
    v_mfma_f32_16x16x32_bf16 v[36:39], v[176:179], v[152:155], v[36:39]
    v_mfma_f32_16x16x32_bf16 a[24:27], v[188:191], v[216:219], a[24:27]
    buffer_load_dwordx4 v[172:175], v6, s[8:11], s52 offen offset:2048 sc1
    v_mfma_f32_16x16x32_bf16 a[24:27], a[244:247], v[180:183], a[24:27]
    v_mfma_f32_16x16x32_bf16 a[28:31], v[232:235], v[216:219], a[28:31]
    v_mfma_f32_16x16x32_bf16 a[28:31], v[156:159], v[180:183], a[28:31]
    buffer_load_dwordx4 v[252:255], v6, s[8:11], s52 offen offset:3072 sc1
    v_mfma_f32_16x16x32_bf16 a[32:35], v[192:195], v[216:219], a[32:35]
    v_mfma_f32_16x16x32_bf16 a[32:35], v[124:127], v[180:183], a[32:35]
    v_mfma_f32_16x16x32_bf16 a[36:39], v[236:239], v[216:219], a[36:39]
    buffer_load_dwordx4 v[152:155], v7, s[8:11], s52 offen offset:1024 sc1
    v_mfma_f32_16x16x32_bf16 a[36:39], v[160:163], v[180:183], a[36:39]
    v_mfma_f32_16x16x32_bf16 a[40:43], v[196:199], v[216:219], a[40:43]
    v_mfma_f32_16x16x32_bf16 a[40:43], v[128:131], v[180:183], a[40:43]
    v_mfma_f32_16x16x32_bf16 a[44:47], v[200:203], v[216:219], a[44:47]
    v_mfma_f32_16x16x32_bf16 a[44:47], v[164:167], v[180:183], a[44:47]
    v_mfma_f32_16x16x32_bf16 v[40:43], a[240:243], v[216:219], v[40:43]
    v_mfma_f32_16x16x32_bf16 v[40:43], v[132:135], v[180:183], v[40:43]
    s_waitcnt vmcnt(20)
    v_mfma_f32_16x16x32_bf16 v[44:47], a[248:251], v[216:219], v[44:47]
    v_mfma_f32_16x16x32_bf16 v[44:47], v[176:179], v[180:183], v[44:47]
    buffer_load_dwordx4 v[216:219], v7, s[8:11], s52 offen offset:2048 sc1
    v_mfma_f32_16x16x32_bf16 a[48:51], v[188:191], v[220:223], a[48:51]
    v_mfma_f32_16x16x32_bf16 a[48:51], a[244:247], v[184:187], a[48:51]
    v_mfma_f32_16x16x32_bf16 a[52:55], v[232:235], v[220:223], a[52:55]
    buffer_load_dwordx4 v[180:183], v7, s[8:11], s52 offen offset:3072 sc1
    v_mfma_f32_16x16x32_bf16 a[52:55], v[156:159], v[184:187], a[52:55]
    v_mfma_f32_16x16x32_bf16 a[56:59], v[192:195], v[220:223], a[56:59]
    v_mfma_f32_16x16x32_bf16 a[56:59], v[124:127], v[184:187], a[56:59]
    v_mfma_f32_16x16x32_bf16 a[60:63], v[236:239], v[220:223], a[60:63]
    v_mfma_f32_16x16x32_bf16 a[60:63], v[160:163], v[184:187], a[60:63]
    v_mfma_f32_16x16x32_bf16 a[64:67], v[196:199], v[220:223], a[64:67]
    v_mfma_f32_16x16x32_bf16 a[64:67], v[128:131], v[184:187], a[64:67]
    v_mfma_f32_16x16x32_bf16 a[68:71], v[200:203], v[220:223], a[68:71]
    v_mfma_f32_16x16x32_bf16 a[68:71], v[164:167], v[184:187], a[68:71]
    v_mfma_f32_16x16x32_bf16 v[48:51], a[240:243], v[220:223], v[48:51]
    s_waitcnt vmcnt(20)
    v_mfma_f32_16x16x32_bf16 v[48:51], v[132:135], v[184:187], v[48:51]
    v_mfma_f32_16x16x32_bf16 v[52:55], a[248:251], v[220:223], v[52:55]
    v_mfma_f32_16x16x32_bf16 v[52:55], v[176:179], v[184:187], v[52:55]
    buffer_load_dwordx4 v[220:223], v8, s[8:11], s52 offen offset:1024 sc1
    v_mfma_f32_16x16x32_bf16 a[72:75], v[188:191], v[224:227], a[72:75]
    v_mfma_f32_16x16x32_bf16 a[72:75], a[244:247], v[228:231], a[72:75]
    v_mfma_f32_16x16x32_bf16 a[76:79], v[232:235], v[224:227], a[76:79]
    buffer_load_dwordx4 v[184:187], v8, s[8:11], s52 offen offset:2048 sc1
    v_mfma_f32_16x16x32_bf16 a[76:79], v[156:159], v[228:231], a[76:79]
    v_mfma_f32_16x16x32_bf16 a[80:83], v[192:195], v[224:227], a[80:83]
    v_mfma_f32_16x16x32_bf16 a[80:83], v[124:127], v[228:231], a[80:83]
    v_mfma_f32_16x16x32_bf16 a[84:87], v[236:239], v[224:227], a[84:87]
    v_mfma_f32_16x16x32_bf16 a[84:87], v[160:163], v[228:231], a[84:87]
    v_mfma_f32_16x16x32_bf16 a[88:91], v[196:199], v[224:227], a[88:91]
    v_mfma_f32_16x16x32_bf16 a[88:91], v[128:131], v[228:231], a[88:91]
    v_mfma_f32_16x16x32_bf16 a[92:95], v[200:203], v[224:227], a[92:95]
    v_mfma_f32_16x16x32_bf16 a[92:95], v[164:167], v[228:231], a[92:95]
    s_waitcnt vmcnt(21)
    v_mfma_f32_16x16x32_bf16 v[56:59], a[240:243], v[224:227], v[56:59]
    v_mfma_f32_16x16x32_bf16 v[56:59], v[132:135], v[228:231], v[56:59]
    v_mfma_f32_16x16x32_bf16 v[60:63], a[248:251], v[224:227], v[60:63]
    v_mfma_f32_16x16x32_bf16 v[60:63], v[176:179], v[228:231], v[60:63]
    buffer_load_dwordx4 v[224:227], v8, s[8:11], s52 offen offset:3072 sc1
    v_mfma_f32_16x16x32_bf16 a[96:99], v[188:191], a[252:255], a[96:99]
    s_waitcnt vmcnt(21)
    v_mfma_f32_16x16x32_bf16 a[96:99], a[244:247], v[112:115], a[96:99]
    v_mfma_f32_16x16x32_bf16 a[100:103], v[232:235], a[252:255], a[100:103]
    buffer_load_dwordx4 v[228:231], v10, s[4:7], s44 offen offset:0 sc1
    v_mfma_f32_16x16x32_bf16 a[100:103], v[156:159], v[112:115], a[100:103]
    v_mfma_f32_16x16x32_bf16 a[104:107], v[192:195], a[252:255], a[104:107]
    v_mfma_f32_16x16x32_bf16 a[104:107], v[124:127], v[112:115], a[104:107]
    buffer_load_dwordx4 v[188:191], v10, s[4:7], s53 offen offset:0 sc1
    v_mfma_f32_16x16x32_bf16 a[108:111], v[236:239], a[252:255], a[108:111]
    v_mfma_f32_16x16x32_bf16 a[108:111], v[160:163], v[112:115], a[108:111]
    v_mfma_f32_16x16x32_bf16 a[112:115], v[196:199], a[252:255], a[112:115]
    buffer_load_dwordx4 a[244:247], v10, s[4:7], s69 offen offset:0 sc1
    v_mfma_f32_16x16x32_bf16 a[112:115], v[128:131], v[112:115], a[112:115]
    v_mfma_f32_16x16x32_bf16 a[116:119], v[200:203], a[252:255], a[116:119]
    v_mfma_f32_16x16x32_bf16 a[116:119], v[164:167], v[112:115], a[116:119]
    buffer_load_dwordx4 v[232:235], v10, s[4:7], s44 offen offset:1024 sc1
    v_mfma_f32_16x16x32_bf16 v[64:67], a[240:243], a[252:255], v[64:67]
    v_mfma_f32_16x16x32_bf16 v[64:67], v[132:135], v[112:115], v[64:67]
    v_mfma_f32_16x16x32_bf16 v[68:71], a[248:251], a[252:255], v[68:71]
    buffer_load_dwordx4 v[156:159], v10, s[4:7], s53 offen offset:1024 sc1
    v_mfma_f32_16x16x32_bf16 v[68:71], v[176:179], v[112:115], v[68:71]
    s_waitcnt vmcnt(18)
    v_mfma_f32_16x16x32_bf16 a[0:3], v[144:147], v[116:119], a[0:3]
    v_mfma_f32_16x16x32_bf16 a[0:3], v[148:151], v[240:243], a[0:3]
    buffer_load_dwordx4 v[192:195], v10, s[4:7], s69 offen offset:1024 sc1
    v_mfma_f32_16x16x32_bf16 a[0:3], v[120:123], v[244:247], a[0:3]
    v_mfma_f32_16x16x32_bf16 a[4:7], v[204:207], v[116:119], a[4:7]
    v_mfma_f32_16x16x32_bf16 a[4:7], v[248:251], v[240:243], a[4:7]
    s_waitcnt vmcnt(15)
    v_mfma_f32_16x16x32_bf16 a[4:7], v[208:211], v[244:247], a[4:7]
    buffer_load_dwordx4 v[124:127], v11, s[4:7], s44 offen offset:0 sc1
    v_mfma_f32_16x16x32_bf16 a[24:27], v[144:147], v[136:139], a[24:27]
    v_mfma_f32_16x16x32_bf16 a[24:27], v[148:151], v[168:171], a[24:27]
    buffer_load_dwordx4 v[236:239], v11, s[4:7], s53 offen offset:0 sc1
    v_mfma_f32_16x16x32_bf16 a[24:27], v[120:123], v[140:143], a[24:27]
    v_mfma_f32_16x16x32_bf16 a[28:31], v[204:207], v[136:139], a[28:31]
    s_waitcnt vmcnt(14)
    v_mfma_f32_16x16x32_bf16 a[28:31], v[248:251], v[168:171], a[28:31]
    ds_write_b128 v13, a[0:3] offset:0
    v_mfma_f32_16x16x32_bf16 a[28:31], v[208:211], v[140:143], a[28:31]
    buffer_load_dwordx4 v[160:163], v11, s[4:7], s69 offen offset:0 sc1
    v_mfma_f32_16x16x32_bf16 a[48:51], v[144:147], v[212:215], a[48:51]
    v_mfma_f32_16x16x32_bf16 a[48:51], v[148:151], v[172:175], a[48:51]
    ds_write_b128 v13, a[4:7] offset:1024
    v_mfma_f32_16x16x32_bf16 a[48:51], v[120:123], v[252:255], a[48:51]
    s_waitcnt vmcnt(13)
    v_mfma_f32_16x16x32_bf16 a[52:55], v[204:207], v[212:215], a[52:55]
    buffer_load_dwordx4 v[196:199], v11, s[4:7], s44 offen offset:1024 sc1
    v_mfma_f32_16x16x32_bf16 a[52:55], v[248:251], v[172:175], a[52:55]
    ds_write_b128 v13, a[24:27] offset:2048
    v_mfma_f32_16x16x32_bf16 a[52:55], v[208:211], v[252:255], a[52:55]
    buffer_load_dwordx4 v[128:131], v11, s[4:7], s53 offen offset:1024 sc1
    v_mfma_f32_16x16x32_bf16 a[72:75], v[144:147], v[152:155], a[72:75]
    v_mfma_f32_16x16x32_bf16 a[72:75], v[148:151], v[216:219], a[72:75]
    s_waitcnt vmcnt(13)
    v_mfma_f32_16x16x32_bf16 a[72:75], v[120:123], v[180:183], a[72:75]
    ds_write_b128 v13, a[28:31] offset:3072
    v_mfma_f32_16x16x32_bf16 a[76:79], v[204:207], v[152:155], a[76:79]
    buffer_load_dwordx4 v[200:203], v11, s[4:7], s69 offen offset:1024 sc1
    v_mfma_f32_16x16x32_bf16 a[76:79], v[248:251], v[216:219], a[76:79]
    buffer_load_dwordx4 a[240:243], v12, s[4:7], s44 offen offset:0 sc1
    v_mfma_f32_16x16x32_bf16 a[76:79], v[208:211], v[180:183], a[76:79]
    ds_write_b128 v13, a[48:51] offset:4096
    v_mfma_f32_16x16x32_bf16 a[96:99], v[144:147], v[220:223], a[96:99]
    s_waitcnt vmcnt(13)
    v_mfma_f32_16x16x32_bf16 a[96:99], v[148:151], v[184:187], a[96:99]
    buffer_load_dwordx4 a[248:251], v12, s[4:7], s53 offen offset:0 sc1
    v_mfma_f32_16x16x32_bf16 a[96:99], v[120:123], v[224:227], a[96:99]
    ds_write_b128 v13, a[52:55] offset:5120
    v_mfma_f32_16x16x32_bf16 a[100:103], v[204:207], v[220:223], a[100:103]
    v_mfma_f32_16x16x32_bf16 a[100:103], v[248:251], v[184:187], a[100:103]
    buffer_load_dwordx4 a[252:255], v12, s[4:7], s69 offen offset:0 sc1
    v_mfma_f32_16x16x32_bf16 a[100:103], v[208:211], v[224:227], a[100:103]
    s_waitcnt vmcnt(10)
    v_mfma_f32_16x16x32_bf16 a[8:11], v[228:231], v[116:119], a[8:11]
    ds_write_b128 v13, a[72:75] offset:6144
    v_mfma_f32_16x16x32_bf16 a[8:11], v[188:191], v[240:243], a[8:11]
    buffer_load_dwordx4 a[0:3], v12, s[4:7], s44 offen offset:1024 sc1
    v_mfma_f32_16x16x32_bf16 a[8:11], a[244:247], v[244:247], a[8:11]
    ds_write_b128 v13, a[76:79] offset:7168
    v_mfma_f32_16x16x32_bf16 a[12:15], v[232:235], v[116:119], a[12:15]
    v_mfma_f32_16x16x32_bf16 a[12:15], v[156:159], v[240:243], a[12:15]
    s_waitcnt vmcnt(10)
    v_mfma_f32_16x16x32_bf16 a[12:15], v[192:195], v[244:247], a[12:15]
    buffer_load_dwordx4 a[4:7], v12, s[4:7], s53 offen offset:1024 sc1
    v_mfma_f32_16x16x32_bf16 a[32:35], v[228:231], v[136:139], a[32:35]
    ds_write_b128 v13, a[96:99] offset:8192
    v_mfma_f32_16x16x32_bf16 a[32:35], v[188:191], v[168:171], a[32:35]
    buffer_load_dwordx4 a[24:27], v12, s[4:7], s69 offen offset:1024 sc1
    v_mfma_f32_16x16x32_bf16 a[32:35], a[244:247], v[140:143], a[32:35]
    v_mfma_f32_16x16x32_bf16 a[36:39], v[232:235], v[136:139], a[36:39]
    ds_write_b128 v13, a[100:103] offset:9216
    v_mfma_f32_16x16x32_bf16 a[36:39], v[156:159], v[168:171], a[36:39]
    buffer_load_dwordx4 a[28:31], v9, s[4:7], s54 offen offset:0 sc1
    v_mfma_f32_16x16x32_bf16 a[36:39], v[192:195], v[140:143], a[36:39]
    v_mfma_f32_16x16x32_bf16 a[56:59], v[228:231], v[212:215], a[56:59]
    ds_write_b128 v14, a[8:11] offset:0
    v_mfma_f32_16x16x32_bf16 a[56:59], v[188:191], v[172:175], a[56:59]
    s_add_u32 s45, s71, 36864
    buffer_load_dwordx4 a[48:51], v4, s[8:11], s45 offen offset:0 sc1
    v_mfma_f32_16x16x32_bf16 a[56:59], a[244:247], v[252:255], a[56:59]
    v_mfma_f32_16x16x32_bf16 a[60:63], v[232:235], v[212:215], a[60:63]
    ds_write_b128 v14, a[12:15] offset:1024
    v_mfma_f32_16x16x32_bf16 a[60:63], v[156:159], v[172:175], a[60:63]
    buffer_load_dwordx4 a[52:55], v5, s[8:11], s45 offen offset:0 sc1
    v_mfma_f32_16x16x32_bf16 a[60:63], v[192:195], v[252:255], a[60:63]
    v_mfma_f32_16x16x32_bf16 a[80:83], v[228:231], v[152:155], a[80:83]
    v_mfma_f32_16x16x32_bf16 a[80:83], v[188:191], v[216:219], a[80:83]
    ds_write_b128 v14, a[32:35] offset:2048
    v_mfma_f32_16x16x32_bf16 a[80:83], a[244:247], v[180:183], a[80:83]
    buffer_load_dwordx4 a[72:75], v6, s[8:11], s45 offen offset:0 sc1
    v_mfma_f32_16x16x32_bf16 a[84:87], v[232:235], v[152:155], a[84:87]
    v_mfma_f32_16x16x32_bf16 a[84:87], v[156:159], v[216:219], a[84:87]
    ds_write_b128 v14, a[36:39] offset:3072
    v_mfma_f32_16x16x32_bf16 a[84:87], v[192:195], v[180:183], a[84:87]
    buffer_load_dwordx4 a[76:79], v7, s[8:11], s45 offen offset:0 sc1
    v_mfma_f32_16x16x32_bf16 a[104:107], v[228:231], v[220:223], a[104:107]
    v_mfma_f32_16x16x32_bf16 a[104:107], v[188:191], v[184:187], a[104:107]
    ds_write_b128 v14, a[56:59] offset:4096
    v_mfma_f32_16x16x32_bf16 a[104:107], a[244:247], v[224:227], a[104:107]
    buffer_load_dwordx4 a[96:99], v8, s[8:11], s45 offen offset:0 sc1
    v_mfma_f32_16x16x32_bf16 a[108:111], v[232:235], v[220:223], a[108:111]
    v_mfma_f32_16x16x32_bf16 a[108:111], v[156:159], v[184:187], a[108:111]
    ds_write_b128 v14, a[60:63] offset:5120
    v_mfma_f32_16x16x32_bf16 a[108:111], v[192:195], v[224:227], a[108:111]
    s_waitcnt vmcnt(13)
    v_mfma_f32_16x16x32_bf16 a[16:19], v[124:127], v[116:119], a[16:19]
    buffer_load_dwordx4 a[100:103], v9, s[4:7], s54 offen offset:1024 sc1
    v_mfma_f32_16x16x32_bf16 a[16:19], v[236:239], v[240:243], a[16:19]
    buffer_load_dwordx4 a[8:11], v10, s[4:7], s54 offen offset:0 sc1
    v_mfma_f32_16x16x32_bf16 a[16:19], v[160:163], v[244:247], a[16:19]
    ds_write_b128 v14, a[80:83] offset:6144
    v_mfma_f32_16x16x32_bf16 a[20:23], v[196:199], v[116:119], a[20:23]
    v_mfma_f32_16x16x32_bf16 a[20:23], v[128:131], v[240:243], a[20:23]
    s_waitcnt vmcnt(14)
    v_mfma_f32_16x16x32_bf16 a[20:23], v[200:203], v[244:247], a[20:23]
    ds_write_b128 v14, a[84:87] offset:7168
    v_mfma_f32_16x16x32_bf16 a[40:43], v[124:127], v[136:139], a[40:43]
    buffer_load_dwordx4 a[12:15], v10, s[4:7], s54 offen offset:1024 sc1
    v_mfma_f32_16x16x32_bf16 a[40:43], v[236:239], v[168:171], a[40:43]
    buffer_load_dwordx4 a[32:35], v11, s[4:7], s54 offen offset:0 sc1
    v_mfma_f32_16x16x32_bf16 a[40:43], v[160:163], v[140:143], a[40:43]
    ds_write_b128 v14, a[104:107] offset:8192
    v_mfma_f32_16x16x32_bf16 a[44:47], v[196:199], v[136:139], a[44:47]
    v_mfma_f32_16x16x32_bf16 a[44:47], v[128:131], v[168:171], a[44:47]
    buffer_load_dwordx4 a[36:39], v11, s[4:7], s54 offen offset:1024 sc1
    v_mfma_f32_16x16x32_bf16 a[44:47], v[200:203], v[140:143], a[44:47]
    ds_write_b128 v14, a[108:111] offset:9216
    v_mfma_f32_16x16x32_bf16 a[64:67], v[124:127], v[212:215], a[64:67]
    v_mfma_f32_16x16x32_bf16 a[64:67], v[236:239], v[172:175], a[64:67]
    buffer_load_dwordx4 a[56:59], v12, s[4:7], s54 offen offset:0 sc1
    v_mfma_f32_16x16x32_bf16 a[64:67], v[160:163], v[252:255], a[64:67]
    v_mfma_f32_16x16x32_bf16 a[68:71], v[196:199], v[212:215], a[68:71]
    ds_write_b128 v15, a[16:19] offset:0
    v_mfma_f32_16x16x32_bf16 a[68:71], v[128:131], v[172:175], a[68:71]
    buffer_load_dwordx4 a[60:63], v12, s[4:7], s54 offen offset:1024 sc1
    v_mfma_f32_16x16x32_bf16 a[68:71], v[200:203], v[252:255], a[68:71]
    v_mfma_f32_16x16x32_bf16 a[88:91], v[124:127], v[152:155], a[88:91]
    ds_write_b128 v15, a[20:23] offset:1024
    v_mfma_f32_16x16x32_bf16 a[88:91], v[236:239], v[216:219], a[88:91]
    buffer_load_dwordx4 a[80:83], v4, s[8:11], s45 offen offset:1024 sc1
    v_mfma_f32_16x16x32_bf16 a[88:91], v[160:163], v[180:183], a[88:91]
    v_mfma_f32_16x16x32_bf16 a[92:95], v[196:199], v[152:155], a[92:95]
    ds_write_b128 v15, a[40:43] offset:2048
    v_mfma_f32_16x16x32_bf16 a[92:95], v[128:131], v[216:219], a[92:95]
    buffer_load_dwordx4 a[84:87], v4, s[8:11], s45 offen offset:2048 sc1
    v_mfma_f32_16x16x32_bf16 a[92:95], v[200:203], v[180:183], a[92:95]
    v_mfma_f32_16x16x32_bf16 a[112:115], v[124:127], v[220:223], a[112:115]
    ds_write_b128 v15, a[44:47] offset:3072
    v_mfma_f32_16x16x32_bf16 a[112:115], v[236:239], v[184:187], a[112:115]
    buffer_load_dwordx4 a[104:107], v4, s[8:11], s45 offen offset:3072 sc1
    v_mfma_f32_16x16x32_bf16 a[112:115], v[160:163], v[224:227], a[112:115]
    v_mfma_f32_16x16x32_bf16 a[116:119], v[196:199], v[220:223], a[116:119]
    v_mfma_f32_16x16x32_bf16 a[116:119], v[128:131], v[184:187], a[116:119]
    ds_write_b128 v15, a[64:67] offset:4096
    v_mfma_f32_16x16x32_bf16 a[116:119], v[200:203], v[224:227], a[116:119]
    s_waitcnt vmcnt(17)
    v_mfma_f32_16x16x32_bf16 v[32:35], a[240:243], v[116:119], v[32:35]
    buffer_load_dwordx4 a[108:111], v5, s[8:11], s45 offen offset:1024 sc1
    v_mfma_f32_16x16x32_bf16 v[32:35], a[248:251], v[240:243], v[32:35]
    ds_write_b128 v15, a[68:71] offset:5120
    v_mfma_f32_16x16x32_bf16 v[32:35], a[252:255], v[244:247], v[32:35]
    buffer_load_dwordx4 a[16:19], v5, s[8:11], s45 offen offset:2048 sc1
    v_mfma_f32_16x16x32_bf16 v[36:39], a[0:3], v[116:119], v[36:39]
    v_mfma_f32_16x16x32_bf16 v[36:39], a[4:7], v[240:243], v[36:39]
    s_waitcnt vmcnt(18)
    v_mfma_f32_16x16x32_bf16 v[36:39], a[24:27], v[244:247], v[36:39]
    ds_write_b128 v15, a[88:91] offset:6144
    v_mfma_f32_16x16x32_bf16 v[40:43], a[240:243], v[136:139], v[40:43]
    buffer_load_dwordx4 a[20:23], v5, s[8:11], s45 offen offset:3072 sc1
    v_mfma_f32_16x16x32_bf16 v[40:43], a[248:251], v[168:171], v[40:43]
    ds_write_b128 v15, a[92:95] offset:7168
    v_mfma_f32_16x16x32_bf16 v[40:43], a[252:255], v[140:143], v[40:43]
    buffer_load_dwordx4 a[40:43], v6, s[8:11], s45 offen offset:1024 sc1
    v_mfma_f32_16x16x32_bf16 v[44:47], a[0:3], v[136:139], v[44:47]
    v_mfma_f32_16x16x32_bf16 v[44:47], a[4:7], v[168:171], v[44:47]
    buffer_load_dwordx4 a[44:47], v6, s[8:11], s45 offen offset:2048 sc1
    v_mfma_f32_16x16x32_bf16 v[44:47], a[24:27], v[140:143], v[44:47]
    ds_write_b128 v15, a[112:115] offset:8192
    v_mfma_f32_16x16x32_bf16 v[48:51], a[240:243], v[212:215], v[48:51]
    v_mfma_f32_16x16x32_bf16 v[48:51], a[248:251], v[172:175], v[48:51]
    buffer_load_dwordx4 a[64:67], v6, s[8:11], s45 offen offset:3072 sc1
    v_mfma_f32_16x16x32_bf16 v[48:51], a[252:255], v[252:255], v[48:51]
    ds_write_b128 v15, a[116:119] offset:9216
    v_mfma_f32_16x16x32_bf16 v[52:55], a[0:3], v[212:215], v[52:55]
    v_mfma_f32_16x16x32_bf16 v[52:55], a[4:7], v[172:175], v[52:55]
    buffer_load_dwordx4 a[68:71], v7, s[8:11], s45 offen offset:1024 sc1
    v_mfma_f32_16x16x32_bf16 v[52:55], a[24:27], v[252:255], v[52:55]
    v_mfma_f32_16x16x32_bf16 v[56:59], a[240:243], v[152:155], v[56:59]
    v_mfma_f32_16x16x32_bf16 v[56:59], a[248:251], v[216:219], v[56:59]
    s_waitcnt lgkmcnt(0)
    s_barrier
    v_mfma_f32_16x16x32_bf16 v[56:59], a[252:255], v[180:183], v[56:59]
    buffer_load_dwordx4 a[88:91], v7, s[8:11], s45 offen offset:2048 sc1
    v_mfma_f32_16x16x32_bf16 v[60:63], a[0:3], v[152:155], v[60:63]
    ds_read_b128 v[116:119], v17 offset:0
    ds_read_b128 v[240:243], v17 offset:1024
    v_mfma_f32_16x16x32_bf16 v[60:63], a[4:7], v[216:219], v[60:63]
    buffer_load_dwordx4 a[92:95], v7, s[8:11], s45 offen offset:3072 sc1
    v_mfma_f32_16x16x32_bf16 v[60:63], a[24:27], v[180:183], v[60:63]
    ds_read_b128 v[244:247], v17 offset:10240
    ds_read_b128 v[136:139], v17 offset:11264
    v_mfma_f32_16x16x32_bf16 v[64:67], a[240:243], v[220:223], v[64:67]
    ds_read_b128 v[168:171], v17 offset:20480
    ds_read_b128 v[140:143], v17 offset:21504
    v_mfma_f32_16x16x32_bf16 v[64:67], a[248:251], v[184:187], v[64:67]
    buffer_load_dwordx4 a[112:115], v8, s[8:11], s45 offen offset:1024 sc1
    v_mfma_f32_16x16x32_bf16 v[64:67], a[252:255], v[224:227], v[64:67]
    ds_read_b128 v[212:215], v17 offset:2048
    ds_read_b128 v[172:175], v17 offset:3072
    v_mfma_f32_16x16x32_bf16 v[68:71], a[0:3], v[220:223], v[68:71]
    ds_read_b128 v[252:255], v17 offset:12288
    ds_read_b128 v[152:155], v17 offset:13312
    v_mfma_f32_16x16x32_bf16 v[68:71], a[4:7], v[184:187], v[68:71]
    ds_read_b128 v[216:219], v17 offset:22528
    ds_read_b128 v[180:183], v17 offset:23552
    v_mfma_f32_16x16x32_bf16 v[68:71], a[24:27], v[224:227], v[68:71]
    ds_read_b128 v[220:223], v17 offset:4096
    ds_read_b128 v[184:187], v17 offset:5120
    s_nop 0
    ds_read_b128 v[224:227], v17 offset:14336
    s_waitcnt lgkmcnt(3)
    s_nop 0
    v_pk_add_f32 v[32:33], v[32:33], v[116:117]
    v_pk_add_f32 v[34:35], v[34:35], v[118:119]
    ds_read_b128 v[116:119], v17 offset:15360
    v_pk_add_f32 v[36:37], v[36:37], v[240:241]
    v_pk_add_f32 v[38:39], v[38:39], v[242:243]
    ds_read_b128 v[240:243], v17 offset:24576
    v_pk_add_f32 v[32:33], v[32:33], v[244:245]
    v_pk_add_f32 v[34:35], v[34:35], v[246:247]
    ds_read_b128 v[244:247], v17 offset:25600
    v_pk_add_f32 v[36:37], v[36:37], v[136:137]
    v_pk_add_f32 v[38:39], v[38:39], v[138:139]
    ds_read_b128 v[136:139], v17 offset:6144
    v_pk_add_f32 v[32:33], v[32:33], v[168:169]
    v_pk_add_f32 v[34:35], v[34:35], v[170:171]
    ds_read_b128 v[168:171], v17 offset:7168
    v_pk_add_f32 v[36:37], v[36:37], v[140:141]
    v_pk_add_f32 v[38:39], v[38:39], v[142:143]
    ds_read_b128 v[140:143], v17 offset:16384
    v_cvt_pk_bf16_f32 v32, v32, v33
    v_cvt_pk_bf16_f32 v33, v34, v35
    v_cvt_pk_bf16_f32 v34, v36, v37
    v_cvt_pk_bf16_f32 v35, v38, v39
    buffer_store_dwordx4 v[32:35], v24, s[20:23], s30 offen offset:0 sc1
    v_pk_add_f32 v[40:41], v[40:41], v[212:213]
    v_pk_add_f32 v[42:43], v[42:43], v[214:215]
    ds_read_b128 v[212:215], v17 offset:17408
    v_pk_add_f32 v[44:45], v[44:45], v[172:173]
    v_pk_add_f32 v[46:47], v[46:47], v[174:175]
    ds_read_b128 v[172:175], v17 offset:26624
    v_pk_add_f32 v[40:41], v[40:41], v[252:253]
    v_pk_add_f32 v[42:43], v[42:43], v[254:255]
    ds_read_b128 v[252:255], v17 offset:27648
    v_pk_add_f32 v[44:45], v[44:45], v[152:153]
    v_pk_add_f32 v[46:47], v[46:47], v[154:155]
    ds_read_b128 v[152:155], v17 offset:8192
    v_pk_add_f32 v[40:41], v[40:41], v[216:217]
    v_pk_add_f32 v[42:43], v[42:43], v[218:219]
    ds_read_b128 v[216:219], v17 offset:9216
    v_pk_add_f32 v[44:45], v[44:45], v[180:181]
    v_pk_add_f32 v[46:47], v[46:47], v[182:183]
    ds_read_b128 v[180:183], v17 offset:18432
    v_cvt_pk_bf16_f32 v40, v40, v41
    v_cvt_pk_bf16_f32 v41, v42, v43
    v_cvt_pk_bf16_f32 v42, v44, v45
    v_cvt_pk_bf16_f32 v43, v46, v47
    buffer_store_dwordx4 v[40:43], v24, s[20:23], s30 offen offset:1024 sc1
    s_waitcnt lgkmcnt(9)
    s_nop 0
    v_pk_add_f32 v[48:49], v[48:49], v[220:221]
    v_pk_add_f32 v[50:51], v[50:51], v[222:223]
    ds_read_b128 v[220:223], v17 offset:19456
    v_pk_add_f32 v[52:53], v[52:53], v[184:185]
    v_pk_add_f32 v[54:55], v[54:55], v[186:187]
    ds_read_b128 v[184:187], v17 offset:28672
    v_pk_add_f32 v[48:49], v[48:49], v[224:225]
    v_pk_add_f32 v[50:51], v[50:51], v[226:227]
    ds_read_b128 v[224:227], v17 offset:29696
    v_pk_add_f32 v[52:53], v[52:53], v[116:117]
    v_pk_add_f32 v[54:55], v[54:55], v[118:119]
    v_pk_add_f32 v[48:49], v[48:49], v[240:241]
    v_pk_add_f32 v[50:51], v[50:51], v[242:243]
    v_pk_add_f32 v[52:53], v[52:53], v[244:245]
    v_pk_add_f32 v[54:55], v[54:55], v[246:247]
    v_cvt_pk_bf16_f32 v48, v48, v49
    v_cvt_pk_bf16_f32 v49, v50, v51
    v_cvt_pk_bf16_f32 v50, v52, v53
    v_cvt_pk_bf16_f32 v51, v54, v55
    buffer_store_dwordx4 v[48:51], v24, s[20:23], s30 offen offset:2048 sc1
    s_waitcnt lgkmcnt(6)
    s_nop 0
    v_pk_add_f32 v[56:57], v[56:57], v[136:137]
    v_pk_add_f32 v[58:59], v[58:59], v[138:139]
    v_pk_add_f32 v[60:61], v[60:61], v[168:169]
    v_pk_add_f32 v[62:63], v[62:63], v[170:171]
    v_pk_add_f32 v[56:57], v[56:57], v[140:141]
    v_pk_add_f32 v[58:59], v[58:59], v[142:143]
    v_pk_add_f32 v[60:61], v[60:61], v[212:213]
    v_pk_add_f32 v[62:63], v[62:63], v[214:215]
    v_pk_add_f32 v[56:57], v[56:57], v[172:173]
    v_pk_add_f32 v[58:59], v[58:59], v[174:175]
    v_pk_add_f32 v[60:61], v[60:61], v[252:253]
    v_pk_add_f32 v[62:63], v[62:63], v[254:255]
    s_waitcnt lgkmcnt(0)
    s_barrier
    v_cvt_pk_bf16_f32 v56, v56, v57
    v_cvt_pk_bf16_f32 v57, v58, v59
    v_cvt_pk_bf16_f32 v58, v60, v61
    v_cvt_pk_bf16_f32 v59, v62, v63
    buffer_store_dwordx4 v[56:59], v24, s[20:23], s30 offen offset:3072 sc1
    v_pk_add_f32 v[64:65], v[64:65], v[152:153]
    v_pk_add_f32 v[66:67], v[66:67], v[154:155]
    v_pk_add_f32 v[68:69], v[68:69], v[216:217]
    v_pk_add_f32 v[70:71], v[70:71], v[218:219]
    v_pk_add_f32 v[64:65], v[64:65], v[180:181]
    v_pk_add_f32 v[66:67], v[66:67], v[182:183]
    v_pk_add_f32 v[68:69], v[68:69], v[220:221]
    v_pk_add_f32 v[70:71], v[70:71], v[222:223]
    v_pk_add_f32 v[64:65], v[64:65], v[184:185]
    v_pk_add_f32 v[66:67], v[66:67], v[186:187]
    v_pk_add_f32 v[68:69], v[68:69], v[224:225]
    v_pk_add_f32 v[70:71], v[70:71], v[226:227]
    v_cvt_pk_bf16_f32 v64, v64, v65
    v_cvt_pk_bf16_f32 v65, v66, v67
    v_cvt_pk_bf16_f32 v66, v68, v69
    v_cvt_pk_bf16_f32 v67, v70, v71
    buffer_store_dwordx4 v[64:67], v24, s[20:23], s31 offen offset:0 sc1
    s_waitcnt vmcnt(25)
    v_mfma_f32_16x16x32_bf16 a[120:123], a[28:31], a[48:51], a[120:123]
    buffer_load_dwordx4 a[116:119], v8, s[8:11], s45 offen offset:2048 sc1
    v_mfma_f32_16x16x32_bf16 a[144:147], a[28:31], a[52:55], a[144:147]
    buffer_load_dwordx4 v[164:167], v8, s[8:11], s45 offen offset:3072 sc1
    v_mfma_f32_16x16x32_bf16 a[168:171], a[28:31], a[72:75], a[168:171]
    v_mfma_f32_16x16x32_bf16 a[192:195], a[28:31], a[76:79], a[192:195]
    v_mfma_f32_16x16x32_bf16 a[216:219], a[28:31], a[96:99], a[216:219]
    s_waitcnt vmcnt(26)
    v_mfma_f32_16x16x32_bf16 a[124:127], a[100:103], a[48:51], a[124:127]
    v_mfma_f32_16x16x32_bf16 a[148:151], a[100:103], a[52:55], a[148:151]
    v_mfma_f32_16x16x32_bf16 a[172:175], a[100:103], a[72:75], a[172:175]
    v_mfma_f32_16x16x32_bf16 a[196:199], a[100:103], a[76:79], a[196:199]
    v_mfma_f32_16x16x32_bf16 a[220:223], a[100:103], a[96:99], a[220:223]
    s_waitcnt vmcnt(25)
    v_mfma_f32_16x16x32_bf16 a[128:131], a[8:11], a[48:51], a[128:131]
    v_mfma_f32_16x16x32_bf16 a[152:155], a[8:11], a[52:55], a[152:155]
    v_mfma_f32_16x16x32_bf16 a[176:179], a[8:11], a[72:75], a[176:179]
    v_mfma_f32_16x16x32_bf16 a[200:203], a[8:11], a[76:79], a[200:203]
    v_mfma_f32_16x16x32_bf16 a[224:227], a[8:11], a[96:99], a[224:227]
    s_waitcnt vmcnt(24)
    v_mfma_f32_16x16x32_bf16 a[132:135], a[12:15], a[48:51], a[132:135]
    v_mfma_f32_16x16x32_bf16 a[156:159], a[12:15], a[52:55], a[156:159]
    v_mfma_f32_16x16x32_bf16 a[180:183], a[12:15], a[72:75], a[180:183]
    v_mfma_f32_16x16x32_bf16 a[204:207], a[12:15], a[76:79], a[204:207]
    v_mfma_f32_16x16x32_bf16 a[228:231], a[12:15], a[96:99], a[228:231]
    s_waitcnt vmcnt(23)
    v_mfma_f32_16x16x32_bf16 a[136:139], a[32:35], a[48:51], a[136:139]
    v_mfma_f32_16x16x32_bf16 a[160:163], a[32:35], a[52:55], a[160:163]
    v_mfma_f32_16x16x32_bf16 a[184:187], a[32:35], a[72:75], a[184:187]
    v_mfma_f32_16x16x32_bf16 a[208:211], a[32:35], a[76:79], a[208:211]
    v_mfma_f32_16x16x32_bf16 a[232:235], a[32:35], a[96:99], a[232:235]
    s_waitcnt vmcnt(22)
    v_mfma_f32_16x16x32_bf16 a[140:143], a[36:39], a[48:51], a[140:143]
    v_mfma_f32_16x16x32_bf16 a[164:167], a[36:39], a[52:55], a[164:167]
    v_mfma_f32_16x16x32_bf16 a[188:191], a[36:39], a[72:75], a[188:191]
    v_mfma_f32_16x16x32_bf16 a[212:215], a[36:39], a[76:79], a[212:215]
    v_mfma_f32_16x16x32_bf16 a[236:239], a[36:39], a[96:99], a[236:239]
    s_waitcnt vmcnt(21)
    v_mfma_f32_16x16x32_bf16 v[72:75], a[56:59], a[48:51], v[72:75]
    v_mfma_f32_16x16x32_bf16 v[80:83], a[56:59], a[52:55], v[80:83]
    v_mfma_f32_16x16x32_bf16 v[88:91], a[56:59], a[72:75], v[88:91]
    v_mfma_f32_16x16x32_bf16 v[96:99], a[56:59], a[76:79], v[96:99]
    v_mfma_f32_16x16x32_bf16 v[104:107], a[56:59], a[96:99], v[104:107]
    s_waitcnt vmcnt(20)
    v_mfma_f32_16x16x32_bf16 v[76:79], a[60:63], a[48:51], v[76:79]
    v_mfma_f32_16x16x32_bf16 v[84:87], a[60:63], a[52:55], v[84:87]
    v_mfma_f32_16x16x32_bf16 v[92:95], a[60:63], a[72:75], v[92:95]
    v_mfma_f32_16x16x32_bf16 v[100:103], a[60:63], a[76:79], v[100:103]
    v_mfma_f32_16x16x32_bf16 v[108:111], a[60:63], a[96:99], v[108:111]
    s_waitcnt vmcnt(17)
    v_mfma_f32_16x16x32_bf16 a[120:123], v[144:147], a[80:83], a[120:123]
    v_mfma_f32_16x16x32_bf16 a[120:123], v[148:151], a[84:87], a[120:123]
    v_mfma_f32_16x16x32_bf16 a[120:123], v[120:123], a[104:107], a[120:123]
    v_mfma_f32_16x16x32_bf16 a[124:127], v[204:207], a[80:83], a[124:127]
    v_mfma_f32_16x16x32_bf16 a[124:127], v[248:251], a[84:87], a[124:127]
    s_waitcnt vmcnt(14)
    v_mfma_f32_16x16x32_bf16 a[124:127], v[208:211], a[104:107], a[124:127]
    v_mfma_f32_16x16x32_bf16 a[144:147], v[144:147], a[108:111], a[144:147]
    v_mfma_f32_16x16x32_bf16 a[144:147], v[148:151], a[16:19], a[144:147]
    v_mfma_f32_16x16x32_bf16 a[144:147], v[120:123], a[20:23], a[144:147]
    v_mfma_f32_16x16x32_bf16 a[148:151], v[204:207], a[108:111], a[148:151]
    s_waitcnt vmcnt(11)
    v_mfma_f32_16x16x32_bf16 a[148:151], v[248:251], a[16:19], a[148:151]
    ds_write_b128 v13, a[120:123] offset:0
    v_mfma_f32_16x16x32_bf16 a[148:151], v[208:211], a[20:23], a[148:151]
    v_mfma_f32_16x16x32_bf16 a[168:171], v[144:147], a[40:43], a[168:171]
    v_mfma_f32_16x16x32_bf16 a[168:171], v[148:151], a[44:47], a[168:171]
    ds_write_b128 v13, a[124:127] offset:1024
    v_mfma_f32_16x16x32_bf16 a[168:171], v[120:123], a[64:67], a[168:171]
    s_waitcnt vmcnt(9)
    v_mfma_f32_16x16x32_bf16 a[172:175], v[204:207], a[40:43], a[172:175]
    v_mfma_f32_16x16x32_bf16 a[172:175], v[248:251], a[44:47], a[172:175]
    ds_write_b128 v13, a[144:147] offset:2048
    v_mfma_f32_16x16x32_bf16 a[172:175], v[208:211], a[64:67], a[172:175]
    v_mfma_f32_16x16x32_bf16 a[192:195], v[144:147], a[68:71], a[192:195]
    v_mfma_f32_16x16x32_bf16 a[192:195], v[148:151], a[88:91], a[192:195]
    s_waitcnt vmcnt(7)
    v_mfma_f32_16x16x32_bf16 a[192:195], v[120:123], a[92:95], a[192:195]
    ds_write_b128 v13, a[148:151] offset:3072
    v_mfma_f32_16x16x32_bf16 a[196:199], v[204:207], a[68:71], a[196:199]
    v_mfma_f32_16x16x32_bf16 a[196:199], v[248:251], a[88:91], a[196:199]
    v_mfma_f32_16x16x32_bf16 a[196:199], v[208:211], a[92:95], a[196:199]
    ds_write_b128 v13, a[168:171] offset:4096
    v_mfma_f32_16x16x32_bf16 a[216:219], v[144:147], a[112:115], a[216:219]
    s_waitcnt vmcnt(0)
    v_mfma_f32_16x16x32_bf16 a[216:219], v[148:151], a[116:119], a[216:219]
    v_mfma_f32_16x16x32_bf16 a[216:219], v[120:123], v[164:167], a[216:219]
    ds_write_b128 v13, a[172:175] offset:5120
    v_mfma_f32_16x16x32_bf16 a[220:223], v[204:207], a[112:115], a[220:223]
    v_mfma_f32_16x16x32_bf16 a[220:223], v[248:251], a[116:119], a[220:223]
    v_mfma_f32_16x16x32_bf16 a[220:223], v[208:211], v[164:167], a[220:223]
    ds_write_b128 v13, a[192:195] offset:6144
    v_mfma_f32_16x16x32_bf16 a[128:131], v[228:231], a[80:83], a[128:131]
    s_mov_b64 exec, 1
    global_store_dword v25, v26, s[60:61] sc0 sc1
    s_mov_b64 exec, -1
    v_mfma_f32_16x16x32_bf16 a[128:131], v[188:191], a[84:87], a[128:131]
    v_mfma_f32_16x16x32_bf16 a[128:131], a[244:247], a[104:107], a[128:131]
    ds_write_b128 v13, a[196:199] offset:7168
    v_mfma_f32_16x16x32_bf16 a[132:135], v[232:235], a[80:83], a[132:135]
    v_mfma_f32_16x16x32_bf16 a[132:135], v[156:159], a[84:87], a[132:135]
    v_mfma_f32_16x16x32_bf16 a[132:135], v[192:195], a[104:107], a[132:135]
    v_mfma_f32_16x16x32_bf16 a[152:155], v[228:231], a[108:111], a[152:155]
    ds_write_b128 v13, a[216:219] offset:8192
    v_mfma_f32_16x16x32_bf16 a[152:155], v[188:191], a[16:19], a[152:155]
    v_mfma_f32_16x16x32_bf16 a[152:155], a[244:247], a[20:23], a[152:155]
    v_mfma_f32_16x16x32_bf16 a[156:159], v[232:235], a[108:111], a[156:159]
    ds_write_b128 v13, a[220:223] offset:9216
    v_mfma_f32_16x16x32_bf16 a[156:159], v[156:159], a[16:19], a[156:159]
    v_mfma_f32_16x16x32_bf16 a[156:159], v[192:195], a[20:23], a[156:159]
    v_mfma_f32_16x16x32_bf16 a[176:179], v[228:231], a[40:43], a[176:179]
    ds_write_b128 v14, a[128:131] offset:0
    v_mfma_f32_16x16x32_bf16 a[176:179], v[188:191], a[44:47], a[176:179]
    v_mfma_f32_16x16x32_bf16 a[176:179], a[244:247], a[64:67], a[176:179]
    v_mfma_f32_16x16x32_bf16 a[180:183], v[232:235], a[40:43], a[180:183]
    ds_write_b128 v14, a[132:135] offset:1024
    v_mfma_f32_16x16x32_bf16 a[180:183], v[156:159], a[44:47], a[180:183]
    v_mfma_f32_16x16x32_bf16 a[180:183], v[192:195], a[64:67], a[180:183]
    v_mfma_f32_16x16x32_bf16 a[200:203], v[228:231], a[68:71], a[200:203]
    v_mfma_f32_16x16x32_bf16 a[200:203], v[188:191], a[88:91], a[200:203]
    ds_write_b128 v14, a[152:155] offset:2048
    v_mfma_f32_16x16x32_bf16 a[200:203], a[244:247], a[92:95], a[200:203]
    v_mfma_f32_16x16x32_bf16 a[204:207], v[232:235], a[68:71], a[204:207]
    v_mfma_f32_16x16x32_bf16 a[204:207], v[156:159], a[88:91], a[204:207]
    ds_write_b128 v14, a[156:159] offset:3072
    v_mfma_f32_16x16x32_bf16 a[204:207], v[192:195], a[92:95], a[204:207]
    v_mfma_f32_16x16x32_bf16 a[224:227], v[228:231], a[112:115], a[224:227]
    v_mfma_f32_16x16x32_bf16 a[224:227], v[188:191], a[116:119], a[224:227]
    ds_write_b128 v14, a[176:179] offset:4096
    v_mfma_f32_16x16x32_bf16 a[224:227], a[244:247], v[164:167], a[224:227]
    v_mfma_f32_16x16x32_bf16 a[228:231], v[232:235], a[112:115], a[228:231]
    v_mfma_f32_16x16x32_bf16 a[228:231], v[156:159], a[116:119], a[228:231]
    ds_write_b128 v14, a[180:183] offset:5120
    v_mfma_f32_16x16x32_bf16 a[228:231], v[192:195], v[164:167], a[228:231]
    v_mfma_f32_16x16x32_bf16 a[136:139], v[124:127], a[80:83], a[136:139]
    v_mfma_f32_16x16x32_bf16 a[136:139], v[236:239], a[84:87], a[136:139]
    v_mfma_f32_16x16x32_bf16 a[136:139], v[160:163], a[104:107], a[136:139]
    ds_write_b128 v14, a[200:203] offset:6144
    v_mfma_f32_16x16x32_bf16 a[140:143], v[196:199], a[80:83], a[140:143]
    v_mfma_f32_16x16x32_bf16 a[140:143], v[128:131], a[84:87], a[140:143]
    v_mfma_f32_16x16x32_bf16 a[140:143], v[200:203], a[104:107], a[140:143]
    ds_write_b128 v14, a[204:207] offset:7168
    v_mfma_f32_16x16x32_bf16 a[160:163], v[124:127], a[108:111], a[160:163]
    global_load_dword v31, v29, s[60:61] sc0 sc1
    v_mfma_f32_16x16x32_bf16 a[160:163], v[236:239], a[16:19], a[160:163]
    v_mfma_f32_16x16x32_bf16 a[160:163], v[160:163], a[20:23], a[160:163]
    ds_write_b128 v14, a[224:227] offset:8192
    v_mfma_f32_16x16x32_bf16 a[164:167], v[196:199], a[108:111], a[164:167]
    v_mfma_f32_16x16x32_bf16 a[164:167], v[128:131], a[16:19], a[164:167]
    v_mfma_f32_16x16x32_bf16 a[164:167], v[200:203], a[20:23], a[164:167]
    ds_write_b128 v14, a[228:231] offset:9216
    v_mfma_f32_16x16x32_bf16 a[184:187], v[124:127], a[40:43], a[184:187]
    v_mfma_f32_16x16x32_bf16 a[184:187], v[236:239], a[44:47], a[184:187]
    v_mfma_f32_16x16x32_bf16 a[184:187], v[160:163], a[64:67], a[184:187]
    v_mfma_f32_16x16x32_bf16 a[188:191], v[196:199], a[40:43], a[188:191]
    ds_write_b128 v15, a[136:139] offset:0
    v_mfma_f32_16x16x32_bf16 a[188:191], v[128:131], a[44:47], a[188:191]
    v_mfma_f32_16x16x32_bf16 a[188:191], v[200:203], a[64:67], a[188:191]
    v_mfma_f32_16x16x32_bf16 a[208:211], v[124:127], a[68:71], a[208:211]
    ds_write_b128 v15, a[140:143] offset:1024
    v_mfma_f32_16x16x32_bf16 a[208:211], v[236:239], a[88:91], a[208:211]
    v_mfma_f32_16x16x32_bf16 a[208:211], v[160:163], a[92:95], a[208:211]
    v_mfma_f32_16x16x32_bf16 a[212:215], v[196:199], a[68:71], a[212:215]
    ds_write_b128 v15, a[160:163] offset:2048
    v_mfma_f32_16x16x32_bf16 a[212:215], v[128:131], a[88:91], a[212:215]
    v_mfma_f32_16x16x32_bf16 a[212:215], v[200:203], a[92:95], a[212:215]
    v_mfma_f32_16x16x32_bf16 a[232:235], v[124:127], a[112:115], a[232:235]
    ds_write_b128 v15, a[164:167] offset:3072
    v_mfma_f32_16x16x32_bf16 a[232:235], v[236:239], a[116:119], a[232:235]
    v_mfma_f32_16x16x32_bf16 a[232:235], v[160:163], v[164:167], a[232:235]
    v_mfma_f32_16x16x32_bf16 a[236:239], v[196:199], a[112:115], a[236:239]
    v_mfma_f32_16x16x32_bf16 a[236:239], v[128:131], a[116:119], a[236:239]
    ds_write_b128 v15, a[184:187] offset:4096
    v_mfma_f32_16x16x32_bf16 a[236:239], v[200:203], v[164:167], a[236:239]
    v_mfma_f32_16x16x32_bf16 v[72:75], a[240:243], a[80:83], v[72:75]
    v_mfma_f32_16x16x32_bf16 v[72:75], a[248:251], a[84:87], v[72:75]
    ds_write_b128 v15, a[188:191] offset:5120
    v_mfma_f32_16x16x32_bf16 v[72:75], a[252:255], a[104:107], v[72:75]
    v_mfma_f32_16x16x32_bf16 v[76:79], a[0:3], a[80:83], v[76:79]
    v_mfma_f32_16x16x32_bf16 v[76:79], a[4:7], a[84:87], v[76:79]
    ds_write_b128 v15, a[208:211] offset:6144
    v_mfma_f32_16x16x32_bf16 v[76:79], a[24:27], a[104:107], v[76:79]
    v_mfma_f32_16x16x32_bf16 v[80:83], a[240:243], a[108:111], v[80:83]
    v_mfma_f32_16x16x32_bf16 v[80:83], a[248:251], a[16:19], v[80:83]
    ds_write_b128 v15, a[212:215] offset:7168
    v_mfma_f32_16x16x32_bf16 v[80:83], a[252:255], a[20:23], v[80:83]
    v_mfma_f32_16x16x32_bf16 v[84:87], a[0:3], a[108:111], v[84:87]
    v_mfma_f32_16x16x32_bf16 v[84:87], a[4:7], a[16:19], v[84:87]
    v_mfma_f32_16x16x32_bf16 v[84:87], a[24:27], a[20:23], v[84:87]
    ds_write_b128 v15, a[232:235] offset:8192
    v_mfma_f32_16x16x32_bf16 v[88:91], a[240:243], a[40:43], v[88:91]
    v_mfma_f32_16x16x32_bf16 v[88:91], a[248:251], a[44:47], v[88:91]
    v_mfma_f32_16x16x32_bf16 v[88:91], a[252:255], a[64:67], v[88:91]
    ds_write_b128 v15, a[236:239] offset:9216
    v_mfma_f32_16x16x32_bf16 v[92:95], a[0:3], a[40:43], v[92:95]
    v_mfma_f32_16x16x32_bf16 v[92:95], a[4:7], a[44:47], v[92:95]
    v_mfma_f32_16x16x32_bf16 v[92:95], a[24:27], a[64:67], v[92:95]
    s_waitcnt lgkmcnt(0)
    s_barrier
    v_mfma_f32_16x16x32_bf16 v[96:99], a[240:243], a[68:71], v[96:99]
    s_waitcnt vmcnt(0)
    v_cmp_gt_u32 vcc, 16, v31
    ds_read_b128 v[140:143], v17 offset:0
    v_mfma_f32_16x16x32_bf16 v[96:99], a[248:251], a[88:91], v[96:99]
    ds_read_b128 v[212:215], v17 offset:1024
    s_cbranch_vccnz L_xs
    buffer_load_dwordx4 v[116:119], v24, s[20:23], s32 offen offset:0 sc1
    buffer_load_dwordx4 v[240:243], v24, s[20:23], s32 offen offset:1024 sc1
    buffer_load_dwordx4 v[244:247], v24, s[20:23], s32 offen offset:2048 sc1
    buffer_load_dwordx4 v[136:139], v24, s[20:23], s32 offen offset:3072 sc1
    buffer_load_dwordx4 v[168:171], v24, s[20:23], s33 offen offset:0 sc1
L_xs:
    v_mfma_f32_16x16x32_bf16 v[96:99], a[252:255], a[92:95], v[96:99]
    ds_read_b128 v[172:175], v17 offset:10240
    v_mfma_f32_16x16x32_bf16 v[100:103], a[0:3], a[68:71], v[100:103]
    ds_read_b128 v[252:255], v17 offset:11264
    v_mfma_f32_16x16x32_bf16 v[100:103], a[4:7], a[88:91], v[100:103]
    ds_read_b128 v[152:155], v17 offset:20480
    v_mfma_f32_16x16x32_bf16 v[100:103], a[24:27], a[92:95], v[100:103]
    ds_read_b128 v[216:219], v17 offset:21504
    v_mfma_f32_16x16x32_bf16 v[104:107], a[240:243], a[112:115], v[104:107]
    ds_read_b128 v[180:183], v17 offset:2048
    v_mfma_f32_16x16x32_bf16 v[104:107], a[248:251], a[116:119], v[104:107]
    ds_read_b128 v[220:223], v17 offset:3072
    v_mfma_f32_16x16x32_bf16 v[104:107], a[252:255], v[164:167], v[104:107]
    ds_read_b128 v[184:187], v17 offset:12288
    v_mfma_f32_16x16x32_bf16 v[108:111], a[0:3], a[112:115], v[108:111]
    ds_read_b128 v[224:227], v17 offset:13312
    v_mfma_f32_16x16x32_bf16 v[108:111], a[4:7], a[116:119], v[108:111]
    ds_read_b128 v[32:35], v17 offset:22528
    v_mfma_f32_16x16x32_bf16 v[108:111], a[24:27], v[164:167], v[108:111]
    ds_read_b128 v[36:39], v17 offset:23552
    s_nop 0
    ds_read_b128 v[40:43], v17 offset:4096
    ds_read_b128 v[44:47], v17 offset:5120
    ds_read_b128 v[48:51], v17 offset:14336
    ds_read_b128 v[52:55], v17 offset:15360
    ds_read_b128 v[56:59], v17 offset:24576
    ds_read_b128 v[60:63], v17 offset:25600
    ds_read_b128 v[64:67], v17 offset:6144
    ds_read_b128 v[68:71], v17 offset:7168
    ds_read_b128 v[112:115], v17 offset:16384
    ds_read_b128 v[120:123], v17 offset:17408
    ds_read_b128 v[124:127], v17 offset:26624
    ds_read_b128 v[128:131], v17 offset:27648
    ds_read_b128 v[132:135], v17 offset:8192
    ds_read_b128 v[144:147], v17 offset:9216
    ds_read_b128 v[148:151], v17 offset:18432
    ds_read_b128 v[156:159], v17 offset:19456
    ds_read_b128 v[160:163], v17 offset:28672
    ds_read_b128 v[164:167], v17 offset:29696
    s_waitcnt lgkmcnt(14)
    s_nop 0
    v_pk_add_f32 v[72:73], v[72:73], v[140:141]
    v_pk_add_f32 v[74:75], v[74:75], v[142:143]
    v_pk_add_f32 v[76:77], v[76:77], v[212:213]
    v_pk_add_f32 v[78:79], v[78:79], v[214:215]
    v_pk_add_f32 v[72:73], v[72:73], v[172:173]
    v_pk_add_f32 v[74:75], v[74:75], v[174:175]
    v_pk_add_f32 v[76:77], v[76:77], v[252:253]
    v_pk_add_f32 v[78:79], v[78:79], v[254:255]
    v_pk_add_f32 v[72:73], v[72:73], v[152:153]
    v_pk_add_f32 v[74:75], v[74:75], v[154:155]
    v_pk_add_f32 v[76:77], v[76:77], v[216:217]
    v_pk_add_f32 v[78:79], v[78:79], v[218:219]
    v_pk_add_f32 v[80:81], v[80:81], v[180:181]
    v_pk_add_f32 v[82:83], v[82:83], v[182:183]
    v_pk_add_f32 v[84:85], v[84:85], v[220:221]
    v_pk_add_f32 v[86:87], v[86:87], v[222:223]
    v_pk_add_f32 v[80:81], v[80:81], v[184:185]
    v_pk_add_f32 v[82:83], v[82:83], v[186:187]
    v_pk_add_f32 v[84:85], v[84:85], v[224:225]
    v_pk_add_f32 v[86:87], v[86:87], v[226:227]
    v_pk_add_f32 v[80:81], v[80:81], v[32:33]
    v_pk_add_f32 v[82:83], v[82:83], v[34:35]
    v_pk_add_f32 v[84:85], v[84:85], v[36:37]
    v_pk_add_f32 v[86:87], v[86:87], v[38:39]
    s_waitcnt lgkmcnt(12)
    s_nop 0
    v_pk_add_f32 v[88:89], v[88:89], v[40:41]
    v_pk_add_f32 v[90:91], v[90:91], v[42:43]
    v_pk_add_f32 v[92:93], v[92:93], v[44:45]
    v_pk_add_f32 v[94:95], v[94:95], v[46:47]
    v_pk_add_f32 v[88:89], v[88:89], v[48:49]
    v_pk_add_f32 v[90:91], v[90:91], v[50:51]
    v_pk_add_f32 v[92:93], v[92:93], v[52:53]
    v_pk_add_f32 v[94:95], v[94:95], v[54:55]
    v_pk_add_f32 v[88:89], v[88:89], v[56:57]
    v_pk_add_f32 v[90:91], v[90:91], v[58:59]
    v_pk_add_f32 v[92:93], v[92:93], v[60:61]
    v_pk_add_f32 v[94:95], v[94:95], v[62:63]
    s_waitcnt lgkmcnt(6)
    s_nop 0
    v_pk_add_f32 v[96:97], v[96:97], v[64:65]
    v_pk_add_f32 v[98:99], v[98:99], v[66:67]
    v_pk_add_f32 v[100:101], v[100:101], v[68:69]
    v_pk_add_f32 v[102:103], v[102:103], v[70:71]
    v_pk_add_f32 v[96:97], v[96:97], v[112:113]
    v_pk_add_f32 v[98:99], v[98:99], v[114:115]
    v_pk_add_f32 v[100:101], v[100:101], v[120:121]
    v_pk_add_f32 v[102:103], v[102:103], v[122:123]
    v_pk_add_f32 v[96:97], v[96:97], v[124:125]
    v_pk_add_f32 v[98:99], v[98:99], v[126:127]
    v_pk_add_f32 v[100:101], v[100:101], v[128:129]
    v_pk_add_f32 v[102:103], v[102:103], v[130:131]
    s_waitcnt lgkmcnt(0)
    s_nop 0
    v_pk_add_f32 v[104:105], v[104:105], v[132:133]
    v_pk_add_f32 v[106:107], v[106:107], v[134:135]
    v_pk_add_f32 v[108:109], v[108:109], v[144:145]
    v_pk_add_f32 v[110:111], v[110:111], v[146:147]
    v_pk_add_f32 v[104:105], v[104:105], v[148:149]
    v_pk_add_f32 v[106:107], v[106:107], v[150:151]
    v_pk_add_f32 v[108:109], v[108:109], v[156:157]
    v_pk_add_f32 v[110:111], v[110:111], v[158:159]
    v_pk_add_f32 v[104:105], v[104:105], v[160:161]
    v_pk_add_f32 v[106:107], v[106:107], v[162:163]
    v_pk_add_f32 v[108:109], v[108:109], v[164:165]
    v_pk_add_f32 v[110:111], v[110:111], v[166:167]
    s_cbranch_vccnz L_xw
L_xr:
    s_waitcnt vmcnt(0)
    s_mov_b32 s48, 0
    v_lshlrev_b32 v40, 16, v116
    v_and_b32 v41, 0xffff0000, v116
    v_lshlrev_b32_e64 v42, 16, v117
    v_and_b32 v43, 0xffff0000, v117
    v_lshlrev_b32_e64 v44, 16, v118
    v_and_b32 v45, 0xffff0000, v118
    v_lshlrev_b32_e64 v46, 16, v119
    v_and_b32 v47, 0xffff0000, v119
    v_pk_add_f32 v[72:73], v[72:73], v[40:41]
    v_pk_add_f32 v[74:75], v[74:75], v[42:43]
    v_pk_add_f32 v[76:77], v[76:77], v[44:45]
    v_pk_add_f32 v[78:79], v[78:79], v[46:47]
    v_cvt_pk_bf16_f32 v72, v72, v73
    v_cvt_pk_bf16_f32 v73, v74, v75
    v_cvt_pk_bf16_f32 v74, v76, v77
    v_cvt_pk_bf16_f32 v75, v78, v79
    buffer_store_dwordx4 v[72:75], v2, s[16:19], s48 offen sc0 nt sc1
    v_lshlrev_b32_e64 v40, 16, v240
    v_and_b32 v41, 0xffff0000, v240
    v_lshlrev_b32_e64 v42, 16, v241
    v_and_b32 v43, 0xffff0000, v241
    v_lshlrev_b32_e64 v44, 16, v242
    v_and_b32 v45, 0xffff0000, v242
    v_lshlrev_b32_e64 v46, 16, v243
    v_and_b32 v47, 0xffff0000, v243
    v_pk_add_f32 v[80:81], v[80:81], v[40:41]
    v_pk_add_f32 v[82:83], v[82:83], v[42:43]
    v_pk_add_f32 v[84:85], v[84:85], v[44:45]
    v_pk_add_f32 v[86:87], v[86:87], v[46:47]
    s_mov_b32 s48, 32768
    v_cvt_pk_bf16_f32 v80, v80, v81
    v_cvt_pk_bf16_f32 v81, v82, v83
    v_cvt_pk_bf16_f32 v82, v84, v85
    v_cvt_pk_bf16_f32 v83, v86, v87
    buffer_store_dwordx4 v[80:83], v2, s[16:19], s48 offen sc0 nt sc1
    v_lshlrev_b32_e64 v40, 16, v244
    v_and_b32 v41, 0xffff0000, v244
    v_lshlrev_b32_e64 v42, 16, v245
    v_and_b32 v43, 0xffff0000, v245
    v_lshlrev_b32_e64 v44, 16, v246
    v_and_b32 v45, 0xffff0000, v246
    v_lshlrev_b32_e64 v46, 16, v247
    v_and_b32 v47, 0xffff0000, v247
    v_pk_add_f32 v[88:89], v[88:89], v[40:41]
    v_pk_add_f32 v[90:91], v[90:91], v[42:43]
    v_pk_add_f32 v[92:93], v[92:93], v[44:45]
    v_pk_add_f32 v[94:95], v[94:95], v[46:47]
    s_mov_b32 s48, 65536
    v_cvt_pk_bf16_f32 v88, v88, v89
    v_cvt_pk_bf16_f32 v89, v90, v91
    v_cvt_pk_bf16_f32 v90, v92, v93
    v_cvt_pk_bf16_f32 v91, v94, v95
    buffer_store_dwordx4 v[88:91], v2, s[16:19], s48 offen sc0 nt sc1
    v_lshlrev_b32_e64 v40, 16, v136
    v_and_b32 v41, 0xffff0000, v136
    v_lshlrev_b32_e64 v42, 16, v137
    v_and_b32 v43, 0xffff0000, v137
    v_lshlrev_b32_e64 v44, 16, v138
    v_and_b32 v45, 0xffff0000, v138
    v_lshlrev_b32_e64 v46, 16, v139
    v_and_b32 v47, 0xffff0000, v139
    v_pk_add_f32 v[96:97], v[96:97], v[40:41]
    v_pk_add_f32 v[98:99], v[98:99], v[42:43]
    v_pk_add_f32 v[100:101], v[100:101], v[44:45]
    v_pk_add_f32 v[102:103], v[102:103], v[46:47]
    s_mov_b32 s48, 98304
    v_cvt_pk_bf16_f32 v96, v96, v97
    v_cvt_pk_bf16_f32 v97, v98, v99
    v_cvt_pk_bf16_f32 v98, v100, v101
    v_cvt_pk_bf16_f32 v99, v102, v103
    buffer_store_dwordx4 v[96:99], v2, s[16:19], s48 offen sc0 nt sc1
    s_cmp_eq_u32 s66, 3
    s_cbranch_scc1 L_fin
    v_lshlrev_b32_e64 v40, 16, v168
    v_and_b32 v41, 0xffff0000, v168
    v_lshlrev_b32_e64 v42, 16, v169
    v_and_b32 v43, 0xffff0000, v169
    v_lshlrev_b32_e64 v44, 16, v170
    v_and_b32 v45, 0xffff0000, v170
    v_lshlrev_b32_e64 v46, 16, v171
    v_and_b32 v47, 0xffff0000, v171
    v_pk_add_f32 v[104:105], v[104:105], v[40:41]
    v_pk_add_f32 v[106:107], v[106:107], v[42:43]
    v_pk_add_f32 v[108:109], v[108:109], v[44:45]
    v_pk_add_f32 v[110:111], v[110:111], v[46:47]
    s_mov_b32 s48, 131072
    v_cvt_pk_bf16_f32 v104, v104, v105
    v_cvt_pk_bf16_f32 v105, v106, v107
    v_cvt_pk_bf16_f32 v106, v108, v109
    v_cvt_pk_bf16_f32 v107, v110, v111
    buffer_store_dwordx4 v[104:107], v2, s[16:19], s48 offen sc0 nt sc1
L_fin:
L_end:
    s_endpgm
L_sig:
    s_lshl_b32 s48, s62, 3
    s_add_u32 s48, s48, s63
    s_lshl_b32 s48, s48, 7
    s_lshl_b32 s49, s64, 1
    s_add_u32 s48, s48, s49
    s_add_u32 s48, s48, 53820224
    v_lshl_add_u32 v1, v24, 2, s48
    v_mov_b32 v2, 16
    s_mov_b64 exec, 1
    global_store_dword v1, v2, s[60:61] sc0 sc1
    s_mov_b64 exec, -1
    s_branch L_sigr
L_pw:
    s_mov_b32 s49, 0x20000
    s_waitcnt vmcnt(0)
L_pw2:
    v_cmp_gt_u32 vcc, 16, v31
    s_sub_u32 s49, s49, 1
    s_cmp_eq_u32 s49, 0
    s_cbranch_scc1 L_pwr
    s_nop 2
    s_cbranch_vccz L_pwr
    s_nop 0
    global_load_dword v31, v29, s[60:61] sc0 sc1
    s_sleep 4
    s_waitcnt vmcnt(0)
    s_branch L_pw2
L_xw:
    s_nop 0
    s_mov_b32 s49, 0x20000
    s_waitcnt vmcnt(0)
L_xw2:
    v_cmp_gt_u32 vcc, 16, v31
    s_sub_u32 s49, s49, 1
    s_cmp_eq_u32 s49, 0
    s_cbranch_scc1 L_xw3
    s_nop 2
    s_cbranch_vccz L_xw3
    s_nop 0
    global_load_dword v31, v29, s[60:61] sc0 sc1
    s_sleep 4
    s_waitcnt vmcnt(0)
    s_branch L_xw2
L_xw3:
    s_nop 0
    buffer_load_dwordx4 v[116:119], v24, s[20:23], s32 offen offset:0 sc1
    buffer_load_dwordx4 v[240:243], v24, s[20:23], s32 offen offset:1024 sc1
    buffer_load_dwordx4 v[244:247], v24, s[20:23], s32 offen offset:2048 sc1
    buffer_load_dwordx4 v[136:139], v24, s[20:23], s32 offen offset:3072 sc1
    buffer_load_dwordx4 v[168:171], v24, s[20:23], s33 offen offset:0 sc1
    s_branch L_xr
L_var4:
    v_lshrrev_b32 v2, 2, v30
    v_and_b32_e64 v3, 1, v31
    v_lshl_add_u32 v3, v3, 2, v2
    v_bfe_u32 v1, v30, 1, 1
    v_xor_b32_e64 v3, v3, v1
    v_lshl_add_u32 v2, v31, 3, v2
    v_lshlrev_b32 v2, 8, v2
    v_and_b32 v1, 1, v30
    v_lshl_add_u32 v2, v1, 4, v2
    v_xor_b32_e64 v1, 0, v3
    v_lshl_add_u32 v248, v1, 5, v2
    v_xor_b32_e64 v1, 2, v3
    v_lshl_add_u32 v249, v1, 5, v2
    v_xor_b32_e64 v1, 4, v3
    v_lshl_add_u32 v250, v1, 5, v2
    v_xor_b32_e64 v1, 6, v3
    v_lshl_add_u32 v251, v1, 5, v2
    v_bfe_u32 v1, v0, 2, 4
    v_lshrrev_b32 v2, 1, v1
    v_and_b32 v3, 3, v0
    v_xor_b32 v2, v2, v3
    v_lshlrev_b32 v2, 4, v2
    v_lshl_add_u32 v2, v1, 7, v2
    v_add_u32 v252, s34, v2
    v_xor_b32 v253, 64, v252
    v_xor_b32 v1, v30, v31
    v_xor_b32 v2, 0, v1
    v_lshlrev_b32_e64 v2, 4, v2
    v_lshl_add_u32 v240, v31, 8, v2
    v_mov_b32 v20, v16
    v_xor_b32 v2, 4, v1
    v_lshlrev_b32_e64 v2, 4, v2
    v_lshl_add_u32 v241, v31, 8, v2
    v_mov_b32 v21, v17
    v_xor_b32 v2, 8, v1
    v_lshlrev_b32_e64 v2, 4, v2
    v_lshl_add_u32 v242, v31, 8, v2
    v_mov_b32 v22, v18
    v_xor_b32 v2, 12, v1
    v_lshlrev_b32_e64 v2, 4, v2
    v_lshl_add_u32 v243, v31, 8, v2
    v_mov_b32 v23, v19
    v_lshrrev_b32 v2, 1, v30
    v_xor_b32 v2, v2, v31
    v_and_b32 v3, 1, v30
    v_lshlrev_b32 v3, 4, v3
    v_xor_b32 v1, 0, v2
    v_lshl_add_u32 v1, v1, 5, v3
    v_lshl_add_u32 v244, v31, 8, v1
    v_xor_b32_e64 v1, 4, v2
    v_lshl_add_u32 v1, v1, 5, v3
    v_lshl_add_u32 v245, v31, 8, v1
    v_xor_b32_e64 v1, 0, v2
    v_lshl_add_u32 v1, v1, 5, v3
    v_lshl_add_u32 v246, v31, 8, v1
    v_xor_b32_e64 v1, 4, v2
    v_lshl_add_u32 v1, v1, 5, v3
    v_lshl_add_u32 v247, v31, 8, v1
    v_mov_b32 v1, 147456
    ds_write_b64 v1, v[32:33]
    ds_write_b64 v1, v[32:33] offset:8
    s_waitcnt vmcnt(12) lgkmcnt(0)
    s_barrier
    ds_read_b128 a[96:99], v28 offset:0
    ds_read_b128 a[100:103], v29 offset:0
    ds_read_b128 a[104:107], v28 offset:2048
    ds_read_b128 a[108:111], v29 offset:2048
    ds_read_b128 a[112:115], v28 offset:4096
    ds_read_b128 a[116:119], v29 offset:4096
    ds_read_b128 a[120:123], v28 offset:6144
    ds_read_b128 a[124:127], v29 offset:6144
    ds_read_b64_tr_b16 a[176:177], v248 offset:0
    ds_read_b64_tr_b16 a[178:179], v248 offset:1024
    ds_read_b64_tr_b16 a[180:181], v248 offset:8192
    ds_read_b64_tr_b16 a[182:183], v248 offset:9216
    ds_read_b64_tr_b16 a[184:185], v248 offset:8
    ds_read_b64_tr_b16 a[186:187], v248 offset:1032
    ds_read_b64_tr_b16 a[188:189], v248 offset:8200
    ds_read_b64_tr_b16 a[190:191], v248 offset:9224
    s_add_u32 m0, s34, 45056
    s_add_u32 s98, s33, 32768
    buffer_load_dwordx4 v24, s[8:11], s98 offen offset:0 nt lds
    buffer_load_dwordx4 v25, s[8:11], s98 offen offset:1024 nt lds
    buffer_load_dwordx4 v26, s[8:11], s98 offen offset:2048 nt lds
    buffer_load_dwordx4 v27, s[8:11], s98 offen offset:3072 nt lds
    s_add_u32 m0, s34, 49152
    s_add_u32 s98, s33, 65536
    buffer_load_dwordx4 v24, s[8:11], s98 offen offset:0 nt lds
    buffer_load_dwordx4 v25, s[8:11], s98 offen offset:1024 nt lds
    s_add_u32 s33, s33, 128
    s_lshl_b32 s48, s3, 13
    s_and_b32 s49, s66, 1
    s_lshl_b32 s49, s49, 16
    s_add_u32 s48, s48, s49
    s_mul_i32 s99, s66, 656640
    s_add_u32 s99, s99, s48
    s_xor_b32 s98, s66, 1
    s_mul_i32 s98, s98, 656640
    s_add_u32 s98, s98, s48
    s_mov_b32 s35, 3
    s_waitcnt lgkmcnt(0)
    s_nop 0
    s_nop 0
    s_nop 0
    s_nop 0
    s_nop 0
    s_nop 0
L_q4:
    s_cmp_eq_u32 s35, 0
    s_cselect_b32 s8, s4, s8
    s_cselect_b32 s9, s5, s9
    s_cselect_b32 s10, s6, s10
    s_cselect_b32 s33, s70, s33
    s_waitcnt lgkmcnt(10)
    v_mfma_f32_16x16x32_bf16 v[96:99], a[176:179], a[96:99], v[96:99]
    s_add_u32 m0, s34, 0
    s_add_u32 s48, s33, 0
    s_waitcnt lgkmcnt(8)
    v_mfma_f32_16x16x32_bf16 v[96:99], a[180:183], a[100:103], v[96:99]
    ds_read_b64_tr_b16 a[192:193], v249 offset:0
    v_mfma_f32_16x16x32_bf16 v[128:131], a[176:179], a[104:107], v[128:131]
    buffer_load_dwordx4 v24, s[8:11], s48 offen offset:0 nt lds
    v_mfma_f32_16x16x32_bf16 v[128:131], a[180:183], a[108:111], v[128:131]
    ds_read_b64_tr_b16 a[194:195], v249 offset:1024
    s_waitcnt lgkmcnt(9)
    v_mfma_f32_16x16x32_bf16 v[160:163], a[176:179], a[112:115], v[160:163]
    ds_read_b64_tr_b16 a[196:197], v249 offset:8192
    s_waitcnt lgkmcnt(9)
    v_mfma_f32_16x16x32_bf16 v[160:163], a[180:183], a[116:119], v[160:163]
    ds_read_b64_tr_b16 a[198:199], v249 offset:9216
    s_waitcnt lgkmcnt(9)
    v_mfma_f32_16x16x32_bf16 v[192:195], a[176:179], a[120:123], v[192:195]
    buffer_load_dwordx4 v25, s[8:11], s48 offen offset:1024 nt lds
    s_waitcnt lgkmcnt(8)
    v_mfma_f32_16x16x32_bf16 v[192:195], a[180:183], a[124:127], v[192:195]
    buffer_load_dwordx4 v26, s[8:11], s48 offen offset:2048 nt lds
    s_waitcnt lgkmcnt(6)
    v_mfma_f32_16x16x32_bf16 v[100:103], a[184:187], a[96:99], v[100:103]
    s_waitcnt lgkmcnt(4)
    v_mfma_f32_16x16x32_bf16 v[100:103], a[188:191], a[100:103], v[100:103]
    buffer_load_dwordx4 v27, s[8:11], s48 offen offset:3072 nt lds
    v_mfma_f32_16x16x32_bf16 v[132:135], a[184:187], a[104:107], v[132:135]
    ds_read_b64_tr_b16 a[200:201], v249 offset:8
    v_mfma_f32_16x16x32_bf16 v[132:135], a[188:191], a[108:111], v[132:135]
    s_mov_b32 m0, 49152
    s_add_u32 s0, s0, s32
    v_mfma_f32_16x16x32_bf16 v[164:167], a[184:187], a[112:115], v[164:167]
    ds_read_b64_tr_b16 a[202:203], v249 offset:1032
    v_mfma_f32_16x16x32_bf16 v[164:167], a[188:191], a[116:119], v[164:167]
    ds_read_b64_tr_b16 a[204:205], v249 offset:8200
    v_mfma_f32_16x16x32_bf16 v[196:199], a[184:187], a[120:123], v[196:199]
    ds_read_b64_tr_b16 a[206:207], v249 offset:9224
    v_mfma_f32_16x16x32_bf16 v[196:199], a[188:191], a[124:127], v[196:199]
    buffer_load_dwordx4 v16, s[12:15], s30 offen offset:0 nt lds
    s_waitcnt lgkmcnt(6)
    v_mfma_f32_16x16x32_bf16 v[104:107], a[192:195], a[96:99], v[104:107]
    buffer_load_dwordx4 v17, s[12:15], s30 offen offset:1024 nt lds
    s_waitcnt lgkmcnt(4)
    v_mfma_f32_16x16x32_bf16 v[104:107], a[196:199], a[100:103], v[104:107]
    ds_read_b64_tr_b16 a[176:177], v250 offset:0
    v_mfma_f32_16x16x32_bf16 v[136:139], a[192:195], a[104:107], v[136:139]
    buffer_load_dwordx4 v18, s[12:15], s30 offen offset:2048 nt lds
    v_mfma_f32_16x16x32_bf16 v[136:139], a[196:199], a[108:111], v[136:139]
    ds_read_b64_tr_b16 a[178:179], v250 offset:1024
    v_mfma_f32_16x16x32_bf16 v[168:171], a[192:195], a[112:115], v[168:171]
    ds_read_b64_tr_b16 a[180:181], v250 offset:8192
    v_mfma_f32_16x16x32_bf16 v[168:171], a[196:199], a[116:119], v[168:171]
    ds_read_b64_tr_b16 a[182:183], v250 offset:9216
    v_mfma_f32_16x16x32_bf16 v[200:203], a[192:195], a[120:123], v[200:203]
    buffer_load_dwordx4 v19, s[12:15], s30 offen offset:3072 nt lds
    v_mfma_f32_16x16x32_bf16 v[200:203], a[196:199], a[124:127], v[200:203]
    s_mov_b32 m0, 53248
    s_add_u32 s49, s30, s52
    s_waitcnt lgkmcnt(6)
    v_mfma_f32_16x16x32_bf16 v[108:111], a[200:203], a[96:99], v[108:111]
    s_waitcnt lgkmcnt(4)
    v_mfma_f32_16x16x32_bf16 v[108:111], a[204:207], a[100:103], v[108:111]
    ds_read_b64_tr_b16 a[184:185], v250 offset:8
    v_mfma_f32_16x16x32_bf16 v[140:143], a[200:203], a[104:107], v[140:143]
    buffer_load_dwordx4 v16, s[12:15], s49 offen offset:0 nt lds
    v_mfma_f32_16x16x32_bf16 v[140:143], a[204:207], a[108:111], v[140:143]
    ds_read_b64_tr_b16 a[186:187], v250 offset:1032
    v_mfma_f32_16x16x32_bf16 v[172:175], a[200:203], a[112:115], v[172:175]
    buffer_load_dwordx4 v17, s[12:15], s49 offen offset:1024 nt lds
    v_mfma_f32_16x16x32_bf16 v[172:175], a[204:207], a[116:119], v[172:175]
    ds_read_b64_tr_b16 a[188:189], v250 offset:8200
    v_mfma_f32_16x16x32_bf16 v[204:207], a[200:203], a[120:123], v[204:207]
    ds_read_b64_tr_b16 a[190:191], v250 offset:9224
    v_mfma_f32_16x16x32_bf16 v[204:207], a[204:207], a[124:127], v[204:207]
    buffer_load_dwordx4 v18, s[12:15], s49 offen offset:2048 nt lds
    s_waitcnt lgkmcnt(6)
    v_mfma_f32_16x16x32_bf16 v[112:115], a[176:179], a[96:99], v[112:115]
    s_waitcnt lgkmcnt(4)
    v_mfma_f32_16x16x32_bf16 v[112:115], a[180:183], a[100:103], v[112:115]
    buffer_load_dwordx4 v19, s[12:15], s49 offen offset:3072 nt lds
    v_mfma_f32_16x16x32_bf16 v[144:147], a[176:179], a[104:107], v[144:147]
    ds_read_b64_tr_b16 a[192:193], v251 offset:0
    v_mfma_f32_16x16x32_bf16 v[144:147], a[180:183], a[108:111], v[144:147]
    s_mov_b32 m0, 57344
    s_add_u32 s49, s30, s53
    v_mfma_f32_16x16x32_bf16 v[176:179], a[176:179], a[112:115], v[176:179]
    ds_read_b64_tr_b16 a[194:195], v251 offset:1024
    v_mfma_f32_16x16x32_bf16 v[176:179], a[180:183], a[116:119], v[176:179]
    ds_read_b64_tr_b16 a[196:197], v251 offset:8192
    v_mfma_f32_16x16x32_bf16 v[208:211], a[176:179], a[120:123], v[208:211]
    ds_read_b64_tr_b16 a[198:199], v251 offset:9216
    v_mfma_f32_16x16x32_bf16 v[208:211], a[180:183], a[124:127], v[208:211]
    buffer_load_dwordx4 v20, s[16:19], s49 offen offset:0 nt lds
    s_waitcnt lgkmcnt(6)
    v_mfma_f32_16x16x32_bf16 v[116:119], a[184:187], a[96:99], v[116:119]
    buffer_load_dwordx4 v21, s[16:19], s49 offen offset:1024 nt lds
    s_waitcnt lgkmcnt(4)
    v_mfma_f32_16x16x32_bf16 v[116:119], a[188:191], a[100:103], v[116:119]
    ds_read_b64_tr_b16 a[200:201], v251 offset:8
    v_mfma_f32_16x16x32_bf16 v[148:151], a[184:187], a[104:107], v[148:151]
    buffer_load_dwordx4 v22, s[16:19], s49 offen offset:2048 nt lds
    v_mfma_f32_16x16x32_bf16 v[148:151], a[188:191], a[108:111], v[148:151]
    ds_read_b64_tr_b16 a[202:203], v251 offset:1032
    v_mfma_f32_16x16x32_bf16 v[180:183], a[184:187], a[112:115], v[180:183]
    ds_read_b64_tr_b16 a[204:205], v251 offset:8200
    v_mfma_f32_16x16x32_bf16 v[180:183], a[188:191], a[116:119], v[180:183]
    ds_read_b64_tr_b16 a[206:207], v251 offset:9224
    v_mfma_f32_16x16x32_bf16 v[212:215], a[184:187], a[120:123], v[212:215]
    buffer_load_dwordx4 v23, s[16:19], s49 offen offset:3072 nt lds
    v_mfma_f32_16x16x32_bf16 v[212:215], a[188:191], a[124:127], v[212:215]
    s_waitcnt vmcnt(30) lgkmcnt(0)
    s_barrier
    v_mfma_f32_16x16x32_bf16 v[120:123], a[192:195], a[96:99], v[120:123]
    s_mov_b32 m0, 61440
    s_add_u32 s49, s30, s54
    v_mfma_f32_16x16x32_bf16 v[120:123], a[196:199], a[100:103], v[120:123]
    buffer_load_dwordx4 v20, s[16:19], s49 offen offset:0 nt lds
    v_mfma_f32_16x16x32_bf16 v[152:155], a[192:195], a[104:107], v[152:155]
    ds_read_b64_tr_b16 a[176:177], v248 offset:16384
    v_mfma_f32_16x16x32_bf16 v[152:155], a[196:199], a[108:111], v[152:155]
    ds_read_b64_tr_b16 a[178:179], v248 offset:17408
    v_mfma_f32_16x16x32_bf16 v[184:187], a[192:195], a[112:115], v[184:187]
    buffer_load_dwordx4 v21, s[16:19], s49 offen offset:1024 nt lds
    v_mfma_f32_16x16x32_bf16 v[184:187], a[196:199], a[116:119], v[184:187]
    ds_read_b64_tr_b16 a[180:181], v248 offset:24576
    v_mfma_f32_16x16x32_bf16 v[216:219], a[192:195], a[120:123], v[216:219]
    ds_read_b64_tr_b16 a[182:183], v248 offset:25600
    v_mfma_f32_16x16x32_bf16 v[216:219], a[196:199], a[124:127], v[216:219]
    buffer_load_dwordx4 v22, s[16:19], s49 offen offset:2048 nt lds
    v_mfma_f32_16x16x32_bf16 v[124:127], a[200:203], a[96:99], v[124:127]
    buffer_load_dwordx4 v23, s[16:19], s49 offen offset:3072 nt lds
    v_mfma_f32_16x16x32_bf16 v[124:127], a[204:207], a[100:103], v[124:127]
    ds_read_b64_tr_b16 a[184:185], v248 offset:16392
    v_mfma_f32_16x16x32_bf16 v[156:159], a[200:203], a[104:107], v[156:159]
    ds_read_b64_tr_b16 a[186:187], v248 offset:17416
    v_mfma_f32_16x16x32_bf16 v[156:159], a[204:207], a[108:111], v[156:159]
    s_add_u32 s49, s0, s1
    s_and_b32 s49, s49, s45
    v_mfma_f32_16x16x32_bf16 v[188:191], a[200:203], a[112:115], v[188:191]
    ds_read_b64_tr_b16 a[188:189], v248 offset:24584
    v_mfma_f32_16x16x32_bf16 v[188:191], a[204:207], a[116:119], v[188:191]
    ds_read_b64_tr_b16 a[190:191], v248 offset:25608
    v_mfma_f32_16x16x32_bf16 v[220:223], a[200:203], a[120:123], v[220:223]
    s_and_b32 s30, s0, s44
    s_or_b32 s30, s30, s49
    v_mfma_f32_16x16x32_bf16 v[220:223], a[204:207], a[124:127], v[220:223]
    s_cmp_eq_u32 s35, 0
    s_cbranch_scc1 L_qs4
L_qn4:
    s_waitcnt lgkmcnt(6)
    v_mfma_f32_16x16x32_bf16 a[0:3], a[176:179], a[96:99], a[0:3]
    s_add_u32 m0, s34, 4096
    s_add_u32 s48, s33, 32768
    s_waitcnt lgkmcnt(4)
    v_mfma_f32_16x16x32_bf16 a[0:3], a[180:183], a[100:103], a[0:3]
    ds_read_b64_tr_b16 a[192:193], v249 offset:16384
    v_mfma_f32_16x16x32_bf16 a[32:35], a[176:179], a[104:107], a[32:35]
    buffer_load_dwordx4 v24, s[8:11], s48 offen offset:0 nt lds
    v_mfma_f32_16x16x32_bf16 a[32:35], a[180:183], a[108:111], a[32:35]
    ds_read_b64_tr_b16 a[194:195], v249 offset:17408
    v_mfma_f32_16x16x32_bf16 a[64:67], a[176:179], a[112:115], a[64:67]
    ds_read_b64_tr_b16 a[196:197], v249 offset:24576
    v_mfma_f32_16x16x32_bf16 a[64:67], a[180:183], a[116:119], a[64:67]
    ds_read_b64_tr_b16 a[198:199], v249 offset:25600
    v_mfma_f32_16x16x32_bf16 v[32:35], a[176:179], a[120:123], v[32:35]
    buffer_load_dwordx4 v25, s[8:11], s48 offen offset:1024 nt lds
    v_mfma_f32_16x16x32_bf16 v[32:35], a[180:183], a[124:127], v[32:35]
    buffer_load_dwordx4 v26, s[8:11], s48 offen offset:2048 nt lds
    s_waitcnt lgkmcnt(6)
    v_mfma_f32_16x16x32_bf16 a[4:7], a[184:187], a[96:99], a[4:7]
    s_waitcnt lgkmcnt(4)
    v_mfma_f32_16x16x32_bf16 a[4:7], a[188:191], a[100:103], a[4:7]
    buffer_load_dwordx4 v27, s[8:11], s48 offen offset:3072 nt lds
    s_add_u32 s33, s33, 128
    v_mfma_f32_16x16x32_bf16 a[36:39], a[184:187], a[104:107], a[36:39]
    ds_read_b64_tr_b16 a[200:201], v249 offset:16392
    v_mfma_f32_16x16x32_bf16 a[36:39], a[188:191], a[108:111], a[36:39]
    s_mov_b32 m0, 0
    s_add_u32 s0, s0, s31
    v_mfma_f32_16x16x32_bf16 a[68:71], a[184:187], a[112:115], a[68:71]
    ds_read_b64_tr_b16 a[202:203], v249 offset:17416
    v_mfma_f32_16x16x32_bf16 a[68:71], a[188:191], a[116:119], a[68:71]
    ds_read_b64_tr_b16 a[204:205], v249 offset:24584
    v_mfma_f32_16x16x32_bf16 v[36:39], a[184:187], a[120:123], v[36:39]
    ds_read_b64_tr_b16 a[206:207], v249 offset:25608
    v_mfma_f32_16x16x32_bf16 v[36:39], a[188:191], a[124:127], v[36:39]
    buffer_load_dwordx4 v16, s[12:15], s30 offen offset:0 nt lds
    s_waitcnt lgkmcnt(6)
    v_mfma_f32_16x16x32_bf16 a[8:11], a[192:195], a[96:99], a[8:11]
    buffer_load_dwordx4 v17, s[12:15], s30 offen offset:1024 nt lds
    s_waitcnt lgkmcnt(4)
    v_mfma_f32_16x16x32_bf16 a[8:11], a[196:199], a[100:103], a[8:11]
    ds_read_b64_tr_b16 a[176:177], v250 offset:16384
    v_mfma_f32_16x16x32_bf16 a[40:43], a[192:195], a[104:107], a[40:43]
    buffer_load_dwordx4 v18, s[12:15], s30 offen offset:2048 nt lds
    v_mfma_f32_16x16x32_bf16 a[40:43], a[196:199], a[108:111], a[40:43]
    ds_read_b64_tr_b16 a[178:179], v250 offset:17408
    v_mfma_f32_16x16x32_bf16 a[72:75], a[192:195], a[112:115], a[72:75]
    ds_read_b64_tr_b16 a[180:181], v250 offset:24576
    v_mfma_f32_16x16x32_bf16 a[72:75], a[196:199], a[116:119], a[72:75]
    ds_read_b64_tr_b16 a[182:183], v250 offset:25600
    v_mfma_f32_16x16x32_bf16 v[40:43], a[192:195], a[120:123], v[40:43]
    buffer_load_dwordx4 v19, s[12:15], s30 offen offset:3072 nt lds
    v_mfma_f32_16x16x32_bf16 v[40:43], a[196:199], a[124:127], v[40:43]
    s_waitcnt vmcnt(28)
    s_waitcnt lgkmcnt(6)
    v_mfma_f32_16x16x32_bf16 a[12:15], a[200:203], a[96:99], a[12:15]
    s_mov_b32 m0, 4096
    s_add_u32 s49, s30, s52
    s_waitcnt lgkmcnt(4)
    v_mfma_f32_16x16x32_bf16 a[12:15], a[204:207], a[100:103], a[12:15]
    ds_read_b64_tr_b16 a[184:185], v250 offset:16392
    v_mfma_f32_16x16x32_bf16 a[44:47], a[200:203], a[104:107], a[44:47]
    buffer_load_dwordx4 v16, s[12:15], s49 offen offset:0 nt lds
    v_mfma_f32_16x16x32_bf16 a[44:47], a[204:207], a[108:111], a[44:47]
    ds_read_b64_tr_b16 a[186:187], v250 offset:17416
    v_mfma_f32_16x16x32_bf16 a[76:79], a[200:203], a[112:115], a[76:79]
    buffer_load_dwordx4 v17, s[12:15], s49 offen offset:1024 nt lds
    v_mfma_f32_16x16x32_bf16 a[76:79], a[204:207], a[116:119], a[76:79]
    ds_read_b64_tr_b16 a[188:189], v250 offset:24584
    v_mfma_f32_16x16x32_bf16 v[44:47], a[200:203], a[120:123], v[44:47]
    ds_read_b64_tr_b16 a[190:191], v250 offset:25608
    v_mfma_f32_16x16x32_bf16 v[44:47], a[204:207], a[124:127], v[44:47]
    buffer_load_dwordx4 v18, s[12:15], s49 offen offset:2048 nt lds
    s_waitcnt lgkmcnt(6)
    v_mfma_f32_16x16x32_bf16 a[16:19], a[176:179], a[96:99], a[16:19]
    ds_read_b128 a[136:139], v28 offset:40960
    s_waitcnt lgkmcnt(5)
    v_mfma_f32_16x16x32_bf16 a[16:19], a[180:183], a[100:103], a[16:19]
    buffer_load_dwordx4 v19, s[12:15], s49 offen offset:3072 nt lds
    v_mfma_f32_16x16x32_bf16 a[48:51], a[176:179], a[104:107], a[48:51]
    ds_read_b64_tr_b16 a[192:193], v251 offset:16384
    v_mfma_f32_16x16x32_bf16 a[48:51], a[180:183], a[108:111], a[48:51]
    s_mov_b32 m0, 8192
    s_add_u32 s49, s30, s53
    v_mfma_f32_16x16x32_bf16 a[80:83], a[176:179], a[112:115], a[80:83]
    ds_read_b64_tr_b16 a[194:195], v251 offset:17408
    v_mfma_f32_16x16x32_bf16 a[80:83], a[180:183], a[116:119], a[80:83]
    ds_read_b64_tr_b16 a[196:197], v251 offset:24576
    v_mfma_f32_16x16x32_bf16 v[48:51], a[176:179], a[120:123], v[48:51]
    ds_read_b64_tr_b16 a[198:199], v251 offset:25600
    v_mfma_f32_16x16x32_bf16 v[48:51], a[180:183], a[124:127], v[48:51]
    buffer_load_dwordx4 v20, s[16:19], s49 offen offset:0 nt lds
    s_waitcnt lgkmcnt(7)
    v_mfma_f32_16x16x32_bf16 a[20:23], a[184:187], a[96:99], a[20:23]
    buffer_load_dwordx4 v21, s[16:19], s49 offen offset:1024 nt lds
    s_waitcnt lgkmcnt(5)
    v_mfma_f32_16x16x32_bf16 a[20:23], a[188:191], a[100:103], a[20:23]
    ds_read_b64_tr_b16 a[200:201], v251 offset:16392
    v_mfma_f32_16x16x32_bf16 a[52:55], a[184:187], a[104:107], a[52:55]
    buffer_load_dwordx4 v22, s[16:19], s49 offen offset:2048 nt lds
    v_mfma_f32_16x16x32_bf16 a[52:55], a[188:191], a[108:111], a[52:55]
    ds_read_b64_tr_b16 a[202:203], v251 offset:17416
    v_mfma_f32_16x16x32_bf16 a[84:87], a[184:187], a[112:115], a[84:87]
    ds_read_b64_tr_b16 a[204:205], v251 offset:24584
    v_mfma_f32_16x16x32_bf16 a[84:87], a[188:191], a[116:119], a[84:87]
    ds_read_b64_tr_b16 a[206:207], v251 offset:25608
    ds_read_b128 a[140:143], v29 offset:40960
    ds_read_b128 a[144:147], v28 offset:43008
    ds_read_b128 a[148:151], v29 offset:43008
    v_mfma_f32_16x16x32_bf16 v[52:55], a[184:187], a[120:123], v[52:55]
    buffer_load_dwordx4 v23, s[16:19], s49 offen offset:3072 nt lds
    v_mfma_f32_16x16x32_bf16 v[52:55], a[188:191], a[124:127], v[52:55]
    s_waitcnt vmcnt(36) lgkmcnt(0)
    s_barrier
    v_mfma_f32_16x16x32_bf16 a[24:27], a[192:195], a[96:99], a[24:27]
    s_mov_b32 m0, 12288
    s_add_u32 s49, s30, s54
    v_mfma_f32_16x16x32_bf16 a[24:27], a[196:199], a[100:103], a[24:27]
    buffer_load_dwordx4 v20, s[16:19], s49 offen offset:0 nt lds
    v_mfma_f32_16x16x32_bf16 a[56:59], a[192:195], a[104:107], a[56:59]
    ds_read_b64_tr_b16 a[176:177], v248 offset:32768
    v_mfma_f32_16x16x32_bf16 a[56:59], a[196:199], a[108:111], a[56:59]
    ds_read_b64_tr_b16 a[178:179], v248 offset:33792
    v_mfma_f32_16x16x32_bf16 a[88:91], a[192:195], a[112:115], a[88:91]
    buffer_load_dwordx4 v21, s[16:19], s49 offen offset:1024 nt lds
    v_mfma_f32_16x16x32_bf16 a[88:91], a[196:199], a[116:119], a[88:91]
    ds_read_b64_tr_b16 a[180:181], v248 offset:40960
    v_mfma_f32_16x16x32_bf16 v[56:59], a[192:195], a[120:123], v[56:59]
    ds_read_b64_tr_b16 a[182:183], v248 offset:41984
    v_mfma_f32_16x16x32_bf16 v[56:59], a[196:199], a[124:127], v[56:59]
    buffer_load_dwordx4 v22, s[16:19], s49 offen offset:2048 nt lds
    v_mfma_f32_16x16x32_bf16 a[28:31], a[200:203], a[96:99], a[28:31]
    buffer_load_dwordx4 v23, s[16:19], s49 offen offset:3072 nt lds
    v_mfma_f32_16x16x32_bf16 a[28:31], a[204:207], a[100:103], a[28:31]
    ds_read_b128 a[152:155], v28 offset:45056
    v_mfma_f32_16x16x32_bf16 a[60:63], a[200:203], a[104:107], a[60:63]
    ds_read_b128 a[156:159], v29 offset:45056
    v_mfma_f32_16x16x32_bf16 a[60:63], a[204:207], a[108:111], a[60:63]
    ds_read_b128 a[160:163], v28 offset:47104
    v_mfma_f32_16x16x32_bf16 a[92:95], a[200:203], a[112:115], a[92:95]
    ds_read_b128 a[164:167], v29 offset:47104
    s_add_u32 s49, s0, s1
    s_and_b32 s49, s49, s45
    v_mfma_f32_16x16x32_bf16 a[92:95], a[204:207], a[116:119], a[92:95]
    ds_read_b64_tr_b16 a[184:185], v248 offset:32776
    v_mfma_f32_16x16x32_bf16 v[60:63], a[200:203], a[120:123], v[60:63]
    ds_read_b64_tr_b16 a[186:187], v248 offset:33800
    ds_read_b64_tr_b16 a[188:189], v248 offset:40968
    ds_read_b64_tr_b16 a[190:191], v248 offset:41992
    v_mfma_f32_16x16x32_bf16 v[60:63], a[204:207], a[124:127], v[60:63]
    s_and_b32 s30, s0, s44
    s_or_b32 s30, s30, s49
    s_sub_u32 s35, s35, 1
    s_cbranch_scc1 L_ql4
    s_waitcnt lgkmcnt(10)
    v_mfma_f32_16x16x32_bf16 v[96:99], a[176:179], a[136:139], v[96:99]
    s_add_u32 m0, s34, 40960
    s_add_u32 s48, s33, 0
    s_waitcnt lgkmcnt(8)
    v_mfma_f32_16x16x32_bf16 v[96:99], a[180:183], a[140:143], v[96:99]
    ds_read_b64_tr_b16 a[192:193], v249 offset:32768
    v_mfma_f32_16x16x32_bf16 v[128:131], a[176:179], a[144:147], v[128:131]
    buffer_load_dwordx4 v24, s[8:11], s48 offen offset:0 nt lds
    v_mfma_f32_16x16x32_bf16 v[128:131], a[180:183], a[148:151], v[128:131]
    ds_read_b64_tr_b16 a[194:195], v249 offset:33792
    s_waitcnt lgkmcnt(9)
    v_mfma_f32_16x16x32_bf16 v[160:163], a[176:179], a[152:155], v[160:163]
    ds_read_b64_tr_b16 a[196:197], v249 offset:40960
    s_waitcnt lgkmcnt(9)
    v_mfma_f32_16x16x32_bf16 v[160:163], a[180:183], a[156:159], v[160:163]
    ds_read_b64_tr_b16 a[198:199], v249 offset:41984
    s_waitcnt lgkmcnt(9)
    v_mfma_f32_16x16x32_bf16 v[192:195], a[176:179], a[160:163], v[192:195]
    buffer_load_dwordx4 v25, s[8:11], s48 offen offset:1024 nt lds
    s_waitcnt lgkmcnt(8)
    v_mfma_f32_16x16x32_bf16 v[192:195], a[180:183], a[164:167], v[192:195]
    buffer_load_dwordx4 v26, s[8:11], s48 offen offset:2048 nt lds
    s_waitcnt lgkmcnt(6)
    v_mfma_f32_16x16x32_bf16 v[100:103], a[184:187], a[136:139], v[100:103]
    s_waitcnt lgkmcnt(4)
    v_mfma_f32_16x16x32_bf16 v[100:103], a[188:191], a[140:143], v[100:103]
    buffer_load_dwordx4 v27, s[8:11], s48 offen offset:3072 nt lds
    v_mfma_f32_16x16x32_bf16 v[132:135], a[184:187], a[144:147], v[132:135]
    ds_read_b64_tr_b16 a[200:201], v249 offset:32776
    v_mfma_f32_16x16x32_bf16 v[132:135], a[188:191], a[148:151], v[132:135]
    s_mov_b32 m0, 16384
    s_add_u32 s0, s0, s32
    v_mfma_f32_16x16x32_bf16 v[164:167], a[184:187], a[152:155], v[164:167]
    ds_read_b64_tr_b16 a[202:203], v249 offset:33800
    v_mfma_f32_16x16x32_bf16 v[164:167], a[188:191], a[156:159], v[164:167]
    ds_read_b64_tr_b16 a[204:205], v249 offset:40968
    v_mfma_f32_16x16x32_bf16 v[196:199], a[184:187], a[160:163], v[196:199]
    ds_read_b64_tr_b16 a[206:207], v249 offset:41992
    v_mfma_f32_16x16x32_bf16 v[196:199], a[188:191], a[164:167], v[196:199]
    buffer_load_dwordx4 v16, s[12:15], s30 offen offset:0 nt lds
    s_waitcnt lgkmcnt(6)
    v_mfma_f32_16x16x32_bf16 v[104:107], a[192:195], a[136:139], v[104:107]
    buffer_load_dwordx4 v17, s[12:15], s30 offen offset:1024 nt lds
    s_waitcnt lgkmcnt(4)
    v_mfma_f32_16x16x32_bf16 v[104:107], a[196:199], a[140:143], v[104:107]
    ds_read_b64_tr_b16 a[176:177], v250 offset:32768
    v_mfma_f32_16x16x32_bf16 v[136:139], a[192:195], a[144:147], v[136:139]
    buffer_load_dwordx4 v18, s[12:15], s30 offen offset:2048 nt lds
    v_mfma_f32_16x16x32_bf16 v[136:139], a[196:199], a[148:151], v[136:139]
    ds_read_b64_tr_b16 a[178:179], v250 offset:33792
    v_mfma_f32_16x16x32_bf16 v[168:171], a[192:195], a[152:155], v[168:171]
    ds_read_b64_tr_b16 a[180:181], v250 offset:40960
    v_mfma_f32_16x16x32_bf16 v[168:171], a[196:199], a[156:159], v[168:171]
    ds_read_b64_tr_b16 a[182:183], v250 offset:41984
    v_mfma_f32_16x16x32_bf16 v[200:203], a[192:195], a[160:163], v[200:203]
    buffer_load_dwordx4 v19, s[12:15], s30 offen offset:3072 nt lds
    v_mfma_f32_16x16x32_bf16 v[200:203], a[196:199], a[164:167], v[200:203]
    s_mov_b32 m0, 20480
    s_add_u32 s49, s30, s52
    s_waitcnt lgkmcnt(6)
    v_mfma_f32_16x16x32_bf16 v[108:111], a[200:203], a[136:139], v[108:111]
    s_waitcnt lgkmcnt(4)
    v_mfma_f32_16x16x32_bf16 v[108:111], a[204:207], a[140:143], v[108:111]
    ds_read_b64_tr_b16 a[184:185], v250 offset:32776
    v_mfma_f32_16x16x32_bf16 v[140:143], a[200:203], a[144:147], v[140:143]
    buffer_load_dwordx4 v16, s[12:15], s49 offen offset:0 nt lds
    v_mfma_f32_16x16x32_bf16 v[140:143], a[204:207], a[148:151], v[140:143]
    ds_read_b64_tr_b16 a[186:187], v250 offset:33800
    v_mfma_f32_16x16x32_bf16 v[172:175], a[200:203], a[152:155], v[172:175]
    buffer_load_dwordx4 v17, s[12:15], s49 offen offset:1024 nt lds
    v_mfma_f32_16x16x32_bf16 v[172:175], a[204:207], a[156:159], v[172:175]
    ds_read_b64_tr_b16 a[188:189], v250 offset:40968
    v_mfma_f32_16x16x32_bf16 v[204:207], a[200:203], a[160:163], v[204:207]
    ds_read_b64_tr_b16 a[190:191], v250 offset:41992
    v_mfma_f32_16x16x32_bf16 v[204:207], a[204:207], a[164:167], v[204:207]
    buffer_load_dwordx4 v18, s[12:15], s49 offen offset:2048 nt lds
    s_waitcnt lgkmcnt(6)
    v_mfma_f32_16x16x32_bf16 v[112:115], a[176:179], a[136:139], v[112:115]
    s_waitcnt lgkmcnt(4)
    v_mfma_f32_16x16x32_bf16 v[112:115], a[180:183], a[140:143], v[112:115]
    buffer_load_dwordx4 v19, s[12:15], s49 offen offset:3072 nt lds
    v_mfma_f32_16x16x32_bf16 v[144:147], a[176:179], a[144:147], v[144:147]
    ds_read_b64_tr_b16 a[192:193], v251 offset:32768
    v_mfma_f32_16x16x32_bf16 v[144:147], a[180:183], a[148:151], v[144:147]
    s_mov_b32 m0, 24576
    s_add_u32 s49, s30, s53
    v_mfma_f32_16x16x32_bf16 v[176:179], a[176:179], a[152:155], v[176:179]
    ds_read_b64_tr_b16 a[194:195], v251 offset:33792
    v_mfma_f32_16x16x32_bf16 v[176:179], a[180:183], a[156:159], v[176:179]
    ds_read_b64_tr_b16 a[196:197], v251 offset:40960
    v_mfma_f32_16x16x32_bf16 v[208:211], a[176:179], a[160:163], v[208:211]
    ds_read_b64_tr_b16 a[198:199], v251 offset:41984
    v_mfma_f32_16x16x32_bf16 v[208:211], a[180:183], a[164:167], v[208:211]
    buffer_load_dwordx4 v20, s[16:19], s49 offen offset:0 nt lds
    s_waitcnt lgkmcnt(6)
    v_mfma_f32_16x16x32_bf16 v[116:119], a[184:187], a[136:139], v[116:119]
    buffer_load_dwordx4 v21, s[16:19], s49 offen offset:1024 nt lds
    s_waitcnt lgkmcnt(4)
    v_mfma_f32_16x16x32_bf16 v[116:119], a[188:191], a[140:143], v[116:119]
    ds_read_b64_tr_b16 a[200:201], v251 offset:32776
    v_mfma_f32_16x16x32_bf16 v[148:151], a[184:187], a[144:147], v[148:151]
    buffer_load_dwordx4 v22, s[16:19], s49 offen offset:2048 nt lds
    v_mfma_f32_16x16x32_bf16 v[148:151], a[188:191], a[148:151], v[148:151]
    ds_read_b64_tr_b16 a[202:203], v251 offset:33800
    v_mfma_f32_16x16x32_bf16 v[180:183], a[184:187], a[152:155], v[180:183]
    ds_read_b64_tr_b16 a[204:205], v251 offset:40968
    v_mfma_f32_16x16x32_bf16 v[180:183], a[188:191], a[156:159], v[180:183]
    ds_read_b64_tr_b16 a[206:207], v251 offset:41992
    v_mfma_f32_16x16x32_bf16 v[212:215], a[184:187], a[160:163], v[212:215]
    buffer_load_dwordx4 v23, s[16:19], s49 offen offset:3072 nt lds
    v_mfma_f32_16x16x32_bf16 v[212:215], a[188:191], a[164:167], v[212:215]
    s_waitcnt vmcnt(36) lgkmcnt(0)
    s_barrier
    v_mfma_f32_16x16x32_bf16 v[120:123], a[192:195], a[136:139], v[120:123]
    s_mov_b32 m0, 28672
    s_add_u32 s49, s30, s54
    v_mfma_f32_16x16x32_bf16 v[120:123], a[196:199], a[140:143], v[120:123]
    buffer_load_dwordx4 v20, s[16:19], s49 offen offset:0 nt lds
    v_mfma_f32_16x16x32_bf16 v[152:155], a[192:195], a[144:147], v[152:155]
    ds_read_b64_tr_b16 a[176:177], v248 offset:49152
    v_mfma_f32_16x16x32_bf16 v[152:155], a[196:199], a[148:151], v[152:155]
    ds_read_b64_tr_b16 a[178:179], v248 offset:50176
    v_mfma_f32_16x16x32_bf16 v[184:187], a[192:195], a[152:155], v[184:187]
    buffer_load_dwordx4 v21, s[16:19], s49 offen offset:1024 nt lds
    v_mfma_f32_16x16x32_bf16 v[184:187], a[196:199], a[156:159], v[184:187]
    ds_read_b64_tr_b16 a[180:181], v248 offset:57344
    v_mfma_f32_16x16x32_bf16 v[216:219], a[192:195], a[160:163], v[216:219]
    ds_read_b64_tr_b16 a[182:183], v248 offset:58368
    v_mfma_f32_16x16x32_bf16 v[216:219], a[196:199], a[164:167], v[216:219]
    buffer_load_dwordx4 v22, s[16:19], s49 offen offset:2048 nt lds
    v_mfma_f32_16x16x32_bf16 v[124:127], a[200:203], a[136:139], v[124:127]
    buffer_load_dwordx4 v23, s[16:19], s49 offen offset:3072 nt lds
    v_mfma_f32_16x16x32_bf16 v[124:127], a[204:207], a[140:143], v[124:127]
    ds_read_b64_tr_b16 a[184:185], v248 offset:49160
    v_mfma_f32_16x16x32_bf16 v[156:159], a[200:203], a[144:147], v[156:159]
    ds_read_b64_tr_b16 a[186:187], v248 offset:50184
    v_mfma_f32_16x16x32_bf16 v[156:159], a[204:207], a[148:151], v[156:159]
    s_add_u32 s49, s0, s1
    s_and_b32 s49, s49, s45
    v_mfma_f32_16x16x32_bf16 v[188:191], a[200:203], a[152:155], v[188:191]
    ds_read_b64_tr_b16 a[188:189], v248 offset:57352
    v_mfma_f32_16x16x32_bf16 v[188:191], a[204:207], a[156:159], v[188:191]
    ds_read_b64_tr_b16 a[190:191], v248 offset:58376
    v_mfma_f32_16x16x32_bf16 v[220:223], a[200:203], a[160:163], v[220:223]
    s_and_b32 s30, s0, s44
    s_or_b32 s30, s30, s49
    v_mfma_f32_16x16x32_bf16 v[220:223], a[204:207], a[164:167], v[220:223]
    s_waitcnt lgkmcnt(6)
    v_mfma_f32_16x16x32_bf16 a[0:3], a[176:179], a[136:139], a[0:3]
    s_add_u32 m0, s34, 45056
    s_add_u32 s48, s33, 32768
    s_waitcnt lgkmcnt(4)
    v_mfma_f32_16x16x32_bf16 a[0:3], a[180:183], a[140:143], a[0:3]
    ds_read_b64_tr_b16 a[192:193], v249 offset:49152
    v_mfma_f32_16x16x32_bf16 a[32:35], a[176:179], a[144:147], a[32:35]
    buffer_load_dwordx4 v24, s[8:11], s48 offen offset:0 nt lds
    v_mfma_f32_16x16x32_bf16 a[32:35], a[180:183], a[148:151], a[32:35]
    ds_read_b64_tr_b16 a[194:195], v249 offset:50176
    v_mfma_f32_16x16x32_bf16 a[64:67], a[176:179], a[152:155], a[64:67]
    ds_read_b64_tr_b16 a[196:197], v249 offset:57344
    v_mfma_f32_16x16x32_bf16 a[64:67], a[180:183], a[156:159], a[64:67]
    ds_read_b64_tr_b16 a[198:199], v249 offset:58368
    v_mfma_f32_16x16x32_bf16 v[32:35], a[176:179], a[160:163], v[32:35]
    buffer_load_dwordx4 v25, s[8:11], s48 offen offset:1024 nt lds
    v_mfma_f32_16x16x32_bf16 v[32:35], a[180:183], a[164:167], v[32:35]
    buffer_load_dwordx4 v26, s[8:11], s48 offen offset:2048 nt lds
    s_waitcnt lgkmcnt(6)
    v_mfma_f32_16x16x32_bf16 a[4:7], a[184:187], a[136:139], a[4:7]
    s_waitcnt lgkmcnt(4)
    v_mfma_f32_16x16x32_bf16 a[4:7], a[188:191], a[140:143], a[4:7]
    buffer_load_dwordx4 v27, s[8:11], s48 offen offset:3072 nt lds
    s_add_u32 s33, s33, 128
    v_mfma_f32_16x16x32_bf16 a[36:39], a[184:187], a[144:147], a[36:39]
    ds_read_b64_tr_b16 a[200:201], v249 offset:49160
    v_mfma_f32_16x16x32_bf16 a[36:39], a[188:191], a[148:151], a[36:39]
    s_mov_b32 m0, 32768
    s_add_u32 s0, s0, s31
    v_mfma_f32_16x16x32_bf16 a[68:71], a[184:187], a[152:155], a[68:71]
    ds_read_b64_tr_b16 a[202:203], v249 offset:50184
    v_mfma_f32_16x16x32_bf16 a[68:71], a[188:191], a[156:159], a[68:71]
    ds_read_b64_tr_b16 a[204:205], v249 offset:57352
    v_mfma_f32_16x16x32_bf16 v[36:39], a[184:187], a[160:163], v[36:39]
    ds_read_b64_tr_b16 a[206:207], v249 offset:58376
    v_mfma_f32_16x16x32_bf16 v[36:39], a[188:191], a[164:167], v[36:39]
    buffer_load_dwordx4 v16, s[12:15], s30 offen offset:0 nt lds
    s_waitcnt lgkmcnt(6)
    v_mfma_f32_16x16x32_bf16 a[8:11], a[192:195], a[136:139], a[8:11]
    buffer_load_dwordx4 v17, s[12:15], s30 offen offset:1024 nt lds
    s_waitcnt lgkmcnt(4)
    v_mfma_f32_16x16x32_bf16 a[8:11], a[196:199], a[140:143], a[8:11]
    ds_read_b64_tr_b16 a[176:177], v250 offset:49152
    v_mfma_f32_16x16x32_bf16 a[40:43], a[192:195], a[144:147], a[40:43]
    buffer_load_dwordx4 v18, s[12:15], s30 offen offset:2048 nt lds
    v_mfma_f32_16x16x32_bf16 a[40:43], a[196:199], a[148:151], a[40:43]
    ds_read_b64_tr_b16 a[178:179], v250 offset:50176
    v_mfma_f32_16x16x32_bf16 a[72:75], a[192:195], a[152:155], a[72:75]
    ds_read_b64_tr_b16 a[180:181], v250 offset:57344
    v_mfma_f32_16x16x32_bf16 a[72:75], a[196:199], a[156:159], a[72:75]
    ds_read_b64_tr_b16 a[182:183], v250 offset:58368
    v_mfma_f32_16x16x32_bf16 v[40:43], a[192:195], a[160:163], v[40:43]
    buffer_load_dwordx4 v19, s[12:15], s30 offen offset:3072 nt lds
    v_mfma_f32_16x16x32_bf16 v[40:43], a[196:199], a[164:167], v[40:43]
    s_waitcnt vmcnt(44)
    s_waitcnt lgkmcnt(6)
    v_mfma_f32_16x16x32_bf16 a[12:15], a[200:203], a[136:139], a[12:15]
    s_mov_b32 m0, 36864
    s_add_u32 s49, s30, s52
    s_waitcnt lgkmcnt(4)
    v_mfma_f32_16x16x32_bf16 a[12:15], a[204:207], a[140:143], a[12:15]
    ds_read_b64_tr_b16 a[184:185], v250 offset:49160
    v_mfma_f32_16x16x32_bf16 a[44:47], a[200:203], a[144:147], a[44:47]
    buffer_load_dwordx4 v16, s[12:15], s49 offen offset:0 nt lds
    v_mfma_f32_16x16x32_bf16 a[44:47], a[204:207], a[148:151], a[44:47]
    ds_read_b64_tr_b16 a[186:187], v250 offset:50184
    v_mfma_f32_16x16x32_bf16 a[76:79], a[200:203], a[152:155], a[76:79]
    buffer_load_dwordx4 v17, s[12:15], s49 offen offset:1024 nt lds
    v_mfma_f32_16x16x32_bf16 a[76:79], a[204:207], a[156:159], a[76:79]
    ds_read_b64_tr_b16 a[188:189], v250 offset:57352
    v_mfma_f32_16x16x32_bf16 v[44:47], a[200:203], a[160:163], v[44:47]
    ds_read_b64_tr_b16 a[190:191], v250 offset:58376
    v_mfma_f32_16x16x32_bf16 v[44:47], a[204:207], a[164:167], v[44:47]
    buffer_load_dwordx4 v18, s[12:15], s49 offen offset:2048 nt lds
    s_waitcnt lgkmcnt(6)
    v_mfma_f32_16x16x32_bf16 a[16:19], a[176:179], a[136:139], a[16:19]
    ds_read_b128 a[96:99], v28 offset:0
    s_waitcnt lgkmcnt(5)
    v_mfma_f32_16x16x32_bf16 a[16:19], a[180:183], a[140:143], a[16:19]
    buffer_load_dwordx4 v19, s[12:15], s49 offen offset:3072 nt lds
    v_mfma_f32_16x16x32_bf16 a[48:51], a[176:179], a[144:147], a[48:51]
    ds_read_b64_tr_b16 a[192:193], v251 offset:49152
    v_mfma_f32_16x16x32_bf16 a[48:51], a[180:183], a[148:151], a[48:51]
    s_mov_b32 m0, 40960
    s_add_u32 s49, s30, s53
    v_mfma_f32_16x16x32_bf16 a[80:83], a[176:179], a[152:155], a[80:83]
    ds_read_b64_tr_b16 a[194:195], v251 offset:50176
    v_mfma_f32_16x16x32_bf16 a[80:83], a[180:183], a[156:159], a[80:83]
    ds_read_b64_tr_b16 a[196:197], v251 offset:57344
    v_mfma_f32_16x16x32_bf16 v[48:51], a[176:179], a[160:163], v[48:51]
    ds_read_b64_tr_b16 a[198:199], v251 offset:58368
    v_mfma_f32_16x16x32_bf16 v[48:51], a[180:183], a[164:167], v[48:51]
    buffer_load_dwordx4 v20, s[16:19], s49 offen offset:0 nt lds
    s_waitcnt lgkmcnt(7)
    v_mfma_f32_16x16x32_bf16 a[20:23], a[184:187], a[136:139], a[20:23]
    buffer_load_dwordx4 v21, s[16:19], s49 offen offset:1024 nt lds
    s_waitcnt lgkmcnt(5)
    v_mfma_f32_16x16x32_bf16 a[20:23], a[188:191], a[140:143], a[20:23]
    ds_read_b64_tr_b16 a[200:201], v251 offset:49160
    v_mfma_f32_16x16x32_bf16 a[52:55], a[184:187], a[144:147], a[52:55]
    buffer_load_dwordx4 v22, s[16:19], s49 offen offset:2048 nt lds
    v_mfma_f32_16x16x32_bf16 a[52:55], a[188:191], a[148:151], a[52:55]
    ds_read_b64_tr_b16 a[202:203], v251 offset:50184
    v_mfma_f32_16x16x32_bf16 a[84:87], a[184:187], a[152:155], a[84:87]
    ds_read_b64_tr_b16 a[204:205], v251 offset:57352
    v_mfma_f32_16x16x32_bf16 a[84:87], a[188:191], a[156:159], a[84:87]
    ds_read_b64_tr_b16 a[206:207], v251 offset:58376
    ds_read_b128 a[100:103], v29 offset:0
    ds_read_b128 a[104:107], v28 offset:2048
    ds_read_b128 a[108:111], v29 offset:2048
    v_mfma_f32_16x16x32_bf16 v[52:55], a[184:187], a[160:163], v[52:55]
    buffer_load_dwordx4 v23, s[16:19], s49 offen offset:3072 nt lds
    v_mfma_f32_16x16x32_bf16 v[52:55], a[188:191], a[164:167], v[52:55]
    s_waitcnt vmcnt(36) lgkmcnt(0)
    s_barrier
    v_mfma_f32_16x16x32_bf16 a[24:27], a[192:195], a[136:139], a[24:27]
    s_mov_b32 m0, 45056
    s_add_u32 s49, s30, s54
    v_mfma_f32_16x16x32_bf16 a[24:27], a[196:199], a[140:143], a[24:27]
    buffer_load_dwordx4 v20, s[16:19], s49 offen offset:0 nt lds
    v_mfma_f32_16x16x32_bf16 a[56:59], a[192:195], a[144:147], a[56:59]
    ds_read_b64_tr_b16 a[176:177], v248 offset:0
    v_mfma_f32_16x16x32_bf16 a[56:59], a[196:199], a[148:151], a[56:59]
    ds_read_b64_tr_b16 a[178:179], v248 offset:1024
    v_mfma_f32_16x16x32_bf16 a[88:91], a[192:195], a[152:155], a[88:91]
    buffer_load_dwordx4 v21, s[16:19], s49 offen offset:1024 nt lds
    v_mfma_f32_16x16x32_bf16 a[88:91], a[196:199], a[156:159], a[88:91]
    ds_read_b64_tr_b16 a[180:181], v248 offset:8192
    v_mfma_f32_16x16x32_bf16 v[56:59], a[192:195], a[160:163], v[56:59]
    ds_read_b64_tr_b16 a[182:183], v248 offset:9216
    v_mfma_f32_16x16x32_bf16 v[56:59], a[196:199], a[164:167], v[56:59]
    buffer_load_dwordx4 v22, s[16:19], s49 offen offset:2048 nt lds
    v_mfma_f32_16x16x32_bf16 a[28:31], a[200:203], a[136:139], a[28:31]
    buffer_load_dwordx4 v23, s[16:19], s49 offen offset:3072 nt lds
    v_mfma_f32_16x16x32_bf16 a[28:31], a[204:207], a[140:143], a[28:31]
    ds_read_b128 a[112:115], v28 offset:4096
    v_mfma_f32_16x16x32_bf16 a[60:63], a[200:203], a[144:147], a[60:63]
    ds_read_b128 a[116:119], v29 offset:4096
    v_mfma_f32_16x16x32_bf16 a[60:63], a[204:207], a[148:151], a[60:63]
    ds_read_b128 a[120:123], v28 offset:6144
    v_mfma_f32_16x16x32_bf16 a[92:95], a[200:203], a[152:155], a[92:95]
    ds_read_b128 a[124:127], v29 offset:6144
    s_add_u32 s49, s0, s1
    s_and_b32 s49, s49, s45
    v_mfma_f32_16x16x32_bf16 a[92:95], a[204:207], a[156:159], a[92:95]
    ds_read_b64_tr_b16 a[184:185], v248 offset:8
    v_mfma_f32_16x16x32_bf16 v[60:63], a[200:203], a[160:163], v[60:63]
    ds_read_b64_tr_b16 a[186:187], v248 offset:1032
    ds_read_b64_tr_b16 a[188:189], v248 offset:8200
    ds_read_b64_tr_b16 a[190:191], v248 offset:9224
    v_mfma_f32_16x16x32_bf16 v[60:63], a[204:207], a[164:167], v[60:63]
    s_and_b32 s30, s0, s44
    s_or_b32 s30, s30, s49
    s_branch L_q4
L_ql4:
    s_waitcnt lgkmcnt(10)
    v_mfma_f32_16x16x32_bf16 v[96:99], a[176:179], a[136:139], v[96:99]
    s_mov_b32 m0, 16384
    s_add_u32 s0, s0, s32
    s_waitcnt lgkmcnt(8)
    v_mfma_f32_16x16x32_bf16 v[96:99], a[180:183], a[140:143], v[96:99]
    ds_read_b64_tr_b16 a[192:193], v249 offset:32768
    v_mfma_f32_16x16x32_bf16 v[128:131], a[176:179], a[144:147], v[128:131]
    ds_read_b64_tr_b16 a[194:195], v249 offset:33792
    v_mfma_f32_16x16x32_bf16 v[128:131], a[180:183], a[148:151], v[128:131]
    ds_read_b64_tr_b16 a[196:197], v249 offset:40960
    v_and_b32 v1, 63, v0
    v_lshlrev_b32 v24, 4, v1
    s_waitcnt lgkmcnt(10)
    v_mfma_f32_16x16x32_bf16 v[160:163], a[176:179], a[152:155], v[160:163]
    ds_read_b64_tr_b16 a[198:199], v249 offset:41984
    buffer_load_dwordx4 v16, s[12:15], s30 offen offset:0 nt lds
    s_waitcnt lgkmcnt(10)
    v_mfma_f32_16x16x32_bf16 v[160:163], a[180:183], a[156:159], v[160:163]
    s_add_u32 s70, s71, 8192
    s_add_u32 s68, s50, 393984
    s_waitcnt lgkmcnt(9)
    v_mfma_f32_16x16x32_bf16 v[192:195], a[176:179], a[160:163], v[192:195]
    buffer_load_dwordx4 v17, s[12:15], s30 offen offset:1024 nt lds
    s_waitcnt lgkmcnt(8)
    v_mfma_f32_16x16x32_bf16 v[192:195], a[180:183], a[164:167], v[192:195]
    v_add_u32 v27, s96, v24
    v_add_u32 v25, 8192, v27
    s_waitcnt lgkmcnt(4)
    v_mfma_f32_16x16x32_bf16 v[100:103], a[184:187], a[136:139], v[100:103]
    s_add_u32 s4, s60, s46
    s_addc_u32 s5, s61, 0
    v_mfma_f32_16x16x32_bf16 v[100:103], a[188:191], a[140:143], v[100:103]
    ds_read_b64_tr_b16 a[200:201], v249 offset:32776
    v_mfma_f32_16x16x32_bf16 v[132:135], a[184:187], a[144:147], v[132:135]
    ds_read_b64_tr_b16 a[202:203], v249 offset:33800
    buffer_load_dwordx4 v18, s[12:15], s30 offen offset:2048 nt lds
    v_mfma_f32_16x16x32_bf16 v[132:135], a[188:191], a[148:151], v[132:135]
    ds_read_b64_tr_b16 a[204:205], v249 offset:40968
    s_add_u32 s8, s60, s55
    s_addc_u32 s9, s61, 0
    v_mfma_f32_16x16x32_bf16 v[164:167], a[184:187], a[152:155], v[164:167]
    ds_read_b64_tr_b16 a[206:207], v249 offset:41992
    v_mul_f32 v160, s38, v160
    v_mfma_f32_16x16x32_bf16 v[164:167], a[188:191], a[156:159], v[164:167]
    buffer_load_dwordx4 v19, s[12:15], s30 offen offset:3072 nt lds
    s_mov_b32 s6, 0x80000
    s_mov_b32 s10, 2495232
    v_mfma_f32_16x16x32_bf16 v[196:199], a[184:187], a[160:163], v[196:199]
    s_mov_b32 m0, 20480
    s_add_u32 s49, s30, s52
    v_mfma_f32_16x16x32_bf16 v[196:199], a[188:191], a[164:167], v[196:199]
    v_mul_f32 v192, s38, v192
    s_waitcnt lgkmcnt(4)
    v_mfma_f32_16x16x32_bf16 v[104:107], a[192:195], a[136:139], v[104:107]
    s_mov_b32 s35, 8
    v_mfma_f32_16x16x32_bf16 v[104:107], a[196:199], a[140:143], v[104:107]
    ds_read_b64_tr_b16 a[176:177], v250 offset:32768
    v_mul_f32 v193, s38, v193
    v_mfma_f32_16x16x32_bf16 v[136:139], a[192:195], a[144:147], v[136:139]
    ds_read_b64_tr_b16 a[178:179], v250 offset:33792
    v_mul_f32 v194, s38, v194
    v_mfma_f32_16x16x32_bf16 v[136:139], a[196:199], a[148:151], v[136:139]
    ds_read_b64_tr_b16 a[180:181], v250 offset:40960
    buffer_load_dwordx4 v16, s[12:15], s49 offen offset:0 nt lds
    v_mfma_f32_16x16x32_bf16 v[168:171], a[192:195], a[152:155], v[168:171]
    ds_read_b64_tr_b16 a[182:183], v250 offset:41984
    v_mul_f32 v195, s38, v195
    v_mfma_f32_16x16x32_bf16 v[168:171], a[196:199], a[156:159], v[168:171]
    buffer_load_dwordx4 v17, s[12:15], s49 offen offset:1024 nt lds
    v_mfma_f32_16x16x32_bf16 v[200:203], a[192:195], a[160:163], v[200:203]
    v_mul_f32 v196, s38, v196
    v_mul_f32 v197, s38, v197
    v_mfma_f32_16x16x32_bf16 v[200:203], a[196:199], a[164:167], v[200:203]
    v_mul_f32 v198, s38, v198
    s_waitcnt vmcnt(22) lgkmcnt(4)
    v_mfma_f32_16x16x32_bf16 v[108:111], a[200:203], a[136:139], v[108:111]
    buffer_load_dwordx4 v18, s[12:15], s49 offen offset:2048 nt lds
    v_mfma_f32_16x16x32_bf16 v[108:111], a[204:207], a[140:143], v[108:111]
    ds_read_b64_tr_b16 a[184:185], v250 offset:32776
    v_mul_f32 v199, s38, v199
    v_mfma_f32_16x16x32_bf16 v[140:143], a[200:203], a[144:147], v[140:143]
    ds_read_b64_tr_b16 a[186:187], v250 offset:33800
    v_mul_f32 v161, s38, v161
    v_mfma_f32_16x16x32_bf16 v[140:143], a[204:207], a[148:151], v[140:143]
    ds_read_b64_tr_b16 a[188:189], v250 offset:40968
    v_mul_f32 v168, s38, v168
    v_mfma_f32_16x16x32_bf16 v[172:175], a[200:203], a[152:155], v[172:175]
    ds_read_b64_tr_b16 a[190:191], v250 offset:41992
    buffer_load_dwordx4 v19, s[12:15], s49 offen offset:3072 nt lds
    v_mfma_f32_16x16x32_bf16 v[172:175], a[204:207], a[156:159], v[172:175]
    ds_read_b64_tr_b16 a[96:97], v252 offset:0
    v_mul_f32 v200, s38, v200
    v_mfma_f32_16x16x32_bf16 v[204:207], a[200:203], a[160:163], v[204:207]
    ds_read_b64_tr_b16 a[98:99], v252 offset:2048
    v_mul_f32 v201, s38, v201
    v_mfma_f32_16x16x32_bf16 v[204:207], a[204:207], a[164:167], v[204:207]
    s_mov_b32 m0, 24576
    s_add_u32 s49, s30, s53
    s_waitcnt lgkmcnt(4)
    v_mfma_f32_16x16x32_bf16 v[112:115], a[176:179], a[136:139], v[112:115]
    buffer_load_dwordx4 v20, s[16:19], s49 offen offset:0 nt lds
    v_mfma_f32_16x16x32_bf16 v[112:115], a[180:183], a[140:143], v[112:115]
    ds_read_b64_tr_b16 a[192:193], v251 offset:32768
    v_mul_f32 v202, s38, v202
    v_mfma_f32_16x16x32_bf16 v[144:147], a[176:179], a[144:147], v[144:147]
    ds_read_b64_tr_b16 a[194:195], v251 offset:33792
    v_mul_f32 v203, s38, v203
    v_mfma_f32_16x16x32_bf16 v[144:147], a[180:183], a[148:151], v[144:147]
    ds_read_b64_tr_b16 a[196:197], v251 offset:40960
    v_mul_f32 v169, s38, v169
    v_mfma_f32_16x16x32_bf16 v[176:179], a[176:179], a[152:155], v[176:179]
    ds_read_b64_tr_b16 a[198:199], v251 offset:41984
    buffer_load_dwordx4 v21, s[16:19], s49 offen offset:1024 nt lds
    v_mfma_f32_16x16x32_bf16 v[176:179], a[180:183], a[156:159], v[176:179]
    ds_read_b64_tr_b16 a[100:101], v252 offset:8
    v_mul_f32 v204, s38, v204
    v_mfma_f32_16x16x32_bf16 v[208:211], a[176:179], a[160:163], v[208:211]
    ds_read_b64_tr_b16 a[102:103], v252 offset:2056
    v_mul_f32 v205, s38, v205
    v_mfma_f32_16x16x32_bf16 v[208:211], a[180:183], a[164:167], v[208:211]
    buffer_load_dwordx4 v22, s[16:19], s49 offen offset:2048 nt lds
    s_waitcnt lgkmcnt(4)
    v_mfma_f32_16x16x32_bf16 v[116:119], a[184:187], a[136:139], v[116:119]
    buffer_load_dwordx4 v23, s[16:19], s49 offen offset:3072 nt lds
    v_mfma_f32_16x16x32_bf16 v[116:119], a[188:191], a[140:143], v[116:119]
    ds_read_b64_tr_b16 a[200:201], v251 offset:32776
    v_mul_f32 v206, s38, v206
    v_mfma_f32_16x16x32_bf16 v[148:151], a[184:187], a[144:147], v[148:151]
    ds_read_b64_tr_b16 a[202:203], v251 offset:33800
    v_mul_f32 v207, s38, v207
    v_mfma_f32_16x16x32_bf16 v[148:151], a[188:191], a[148:151], v[148:151]
    ds_read_b64_tr_b16 a[204:205], v251 offset:40968
    v_mul_f32 v176, s38, v176
    v_mfma_f32_16x16x32_bf16 v[180:183], a[184:187], a[152:155], v[180:183]
    ds_read_b64_tr_b16 a[206:207], v251 offset:41992
    buffer_store_dwordx4 a[96:99], v24, s[20:23], s71 offen offset:0 sc1
    v_mfma_f32_16x16x32_bf16 v[180:183], a[188:191], a[156:159], v[180:183]
    s_mov_b32 m0, 28672
    s_add_u32 s49, s30, s54
    v_mfma_f32_16x16x32_bf16 v[212:215], a[184:187], a[160:163], v[212:215]
    buffer_load_dwordx4 v20, s[16:19], s49 offen offset:0 nt lds
    v_mfma_f32_16x16x32_bf16 v[212:215], a[188:191], a[164:167], v[212:215]
    s_waitcnt vmcnt(34) lgkmcnt(0)
    s_barrier
    v_mfma_f32_16x16x32_bf16 v[120:123], a[192:195], a[136:139], v[120:123]
    v_mul_f32 v208, s38, v208
    v_mul_f32 v209, s38, v209
    v_mfma_f32_16x16x32_bf16 v[120:123], a[196:199], a[140:143], v[120:123]
    ds_read_b64_tr_b16 a[176:177], v248 offset:49152
    v_mul_f32 v210, s38, v210
    v_mfma_f32_16x16x32_bf16 v[152:155], a[192:195], a[144:147], v[152:155]
    ds_read_b64_tr_b16 a[178:179], v248 offset:50176
    v_mul_f32 v211, s38, v211
    v_mfma_f32_16x16x32_bf16 v[152:155], a[196:199], a[148:151], v[152:155]
    ds_read_b64_tr_b16 a[180:181], v248 offset:57344
    buffer_load_dwordx4 v21, s[16:19], s49 offen offset:1024 nt lds
    v_mfma_f32_16x16x32_bf16 v[184:187], a[192:195], a[152:155], v[184:187]
    ds_read_b64_tr_b16 a[182:183], v248 offset:58368
    v_mul_f32 v177, s38, v177
    v_mfma_f32_16x16x32_bf16 v[184:187], a[196:199], a[156:159], v[184:187]
    ds_read_b64_tr_b16 a[104:105], v253 offset:0
    v_mul_f32 v212, s38, v212
    v_mfma_f32_16x16x32_bf16 v[216:219], a[192:195], a[160:163], v[216:219]
    ds_read_b64_tr_b16 a[106:107], v253 offset:2048
    buffer_load_dwordx4 v22, s[16:19], s49 offen offset:2048 nt lds
    v_mfma_f32_16x16x32_bf16 v[216:219], a[196:199], a[164:167], v[216:219]
    buffer_load_dwordx4 v23, s[16:19], s49 offen offset:3072 nt lds
    v_mfma_f32_16x16x32_bf16 v[124:127], a[200:203], a[136:139], v[124:127]
    v_mul_f32 v213, s38, v213
    v_mul_f32 v214, s38, v214
    v_mfma_f32_16x16x32_bf16 v[124:127], a[204:207], a[140:143], v[124:127]
    ds_read_b64_tr_b16 a[184:185], v248 offset:49160
    v_mul_f32 v215, s38, v215
    v_mfma_f32_16x16x32_bf16 v[156:159], a[200:203], a[144:147], v[156:159]
    ds_read_b64_tr_b16 a[186:187], v248 offset:50184
    v_mul_f32 v178, s38, v178
    v_mfma_f32_16x16x32_bf16 v[156:159], a[204:207], a[148:151], v[156:159]
    ds_read_b64_tr_b16 a[188:189], v248 offset:57352
    v_mul_f32 v184, s38, v184
    v_mfma_f32_16x16x32_bf16 v[188:191], a[200:203], a[152:155], v[188:191]
    ds_read_b64_tr_b16 a[190:191], v248 offset:58376
    s_add_u32 s49, s0, s1
    s_and_b32 s49, s49, s45
    v_mfma_f32_16x16x32_bf16 v[188:191], a[204:207], a[156:159], v[188:191]
    ds_read_b64_tr_b16 a[108:109], v253 offset:8
    buffer_store_dwordx4 a[100:103], v24, s[20:23], s71 offen offset:1024 sc1
    v_mfma_f32_16x16x32_bf16 v[220:223], a[200:203], a[160:163], v[220:223]
    ds_read_b64_tr_b16 a[110:111], v253 offset:2056
    v_mul_f32 v216, s38, v216
    v_mfma_f32_16x16x32_bf16 v[220:223], a[204:207], a[164:167], v[220:223]
    s_and_b32 s30, s0, s44
    s_or_b32 s30, s30, s49
    s_waitcnt lgkmcnt(4)
    v_mfma_f32_16x16x32_bf16 a[0:3], a[176:179], a[136:139], a[0:3]
    s_mov_b32 m0, 32768
    s_add_u32 s0, s0, s31
    v_mfma_f32_16x16x32_bf16 a[0:3], a[180:183], a[140:143], a[0:3]
    ds_read_b64_tr_b16 a[192:193], v249 offset:49152
    v_mul_f32 v217, s38, v217
    v_mfma_f32_16x16x32_bf16 a[32:35], a[176:179], a[144:147], a[32:35]
    ds_read_b64_tr_b16 a[194:195], v249 offset:50176
    v_mul_f32 v218, s38, v218
    v_mfma_f32_16x16x32_bf16 a[32:35], a[180:183], a[148:151], a[32:35]
    ds_read_b64_tr_b16 a[196:197], v249 offset:57344
    v_mul_f32 v219, s38, v219
    v_mfma_f32_16x16x32_bf16 a[64:67], a[176:179], a[152:155], a[64:67]
    ds_read_b64_tr_b16 a[198:199], v249 offset:58368
    buffer_load_dwordx4 v16, s[12:15], s30 offen offset:0 nt lds
    v_mfma_f32_16x16x32_bf16 a[64:67], a[180:183], a[156:159], a[64:67]
    ds_read_b64_tr_b16 a[208:209], v252 offset:4096
    v_mul_f32 v220, s38, v220
    v_mfma_f32_16x16x32_bf16 v[32:35], a[176:179], a[160:163], v[32:35]
    ds_read_b64_tr_b16 a[210:211], v252 offset:6144
    v_mul_f32 v221, s38, v221
    v_mfma_f32_16x16x32_bf16 v[32:35], a[180:183], a[164:167], v[32:35]
    buffer_load_dwordx4 v17, s[12:15], s30 offen offset:1024 nt lds
    s_waitcnt lgkmcnt(4)
    v_mfma_f32_16x16x32_bf16 a[4:7], a[184:187], a[136:139], a[4:7]
    buffer_load_dwordx4 v18, s[12:15], s30 offen offset:2048 nt lds
    v_mfma_f32_16x16x32_bf16 a[4:7], a[188:191], a[140:143], a[4:7]
    ds_read_b64_tr_b16 a[200:201], v249 offset:49160
    v_mul_f32 v222, s38, v222
    v_mfma_f32_16x16x32_bf16 a[36:39], a[184:187], a[144:147], a[36:39]
    ds_read_b64_tr_b16 a[202:203], v249 offset:50184
    v_mul_f32 v223, s38, v223
    v_mfma_f32_16x16x32_bf16 a[36:39], a[188:191], a[148:151], a[36:39]
    ds_read_b64_tr_b16 a[204:205], v249 offset:57352
    v_cvt_pk_bf16_f32 v239, v222, v223
    v_mfma_f32_16x16x32_bf16 a[68:71], a[184:187], a[152:155], a[68:71]
    ds_read_b64_tr_b16 a[206:207], v249 offset:58376
    v_cvt_pk_bf16_f32 v238, v220, v221
    v_mfma_f32_16x16x32_bf16 a[68:71], a[188:191], a[156:159], a[68:71]
    ds_read_b64_tr_b16 a[212:213], v252 offset:4104
    buffer_load_dwordx4 v19, s[12:15], s30 offen offset:3072 nt lds
    v_mfma_f32_16x16x32_bf16 v[36:39], a[184:187], a[160:163], v[36:39]
    ds_read_b64_tr_b16 a[214:215], v252 offset:6152
    v_cvt_pk_bf16_f32 v237, v218, v219
    v_mfma_f32_16x16x32_bf16 v[36:39], a[188:191], a[164:167], v[36:39]
    buffer_store_dwordx4 a[104:107], v24, s[20:23], s71 offen offset:2048 sc1
    s_waitcnt lgkmcnt(4)
    v_mfma_f32_16x16x32_bf16 a[8:11], a[192:195], a[136:139], a[8:11]
    s_mov_b32 m0, 36864
    s_add_u32 s49, s30, s52
    v_cvt_pk_bf16_f32 v236, v216, v217
    v_mfma_f32_16x16x32_bf16 a[8:11], a[196:199], a[140:143], a[8:11]
    ds_read_b64_tr_b16 a[176:177], v250 offset:49152
    v_cvt_pk_bf16_f32 v235, v214, v215
    v_mfma_f32_16x16x32_bf16 a[40:43], a[192:195], a[144:147], a[40:43]
    ds_read_b64_tr_b16 a[178:179], v250 offset:50176
    v_cvt_pk_bf16_f32 v234, v212, v213
    v_mfma_f32_16x16x32_bf16 a[40:43], a[196:199], a[148:151], a[40:43]
    ds_read_b64_tr_b16 a[180:181], v250 offset:57344
    buffer_load_dwordx4 v16, s[12:15], s49 offen offset:0 nt lds
    v_mfma_f32_16x16x32_bf16 a[72:75], a[192:195], a[152:155], a[72:75]
    ds_read_b64_tr_b16 a[182:183], v250 offset:58368
    v_cvt_pk_bf16_f32 v233, v210, v211
    v_mfma_f32_16x16x32_bf16 a[72:75], a[196:199], a[156:159], a[72:75]
    ds_read_b64_tr_b16 a[216:217], v253 offset:4096
    v_cvt_pk_bf16_f32 v232, v208, v209
    v_mfma_f32_16x16x32_bf16 v[40:43], a[192:195], a[160:163], v[40:43]
    ds_read_b64_tr_b16 a[218:219], v253 offset:6144
    buffer_load_dwordx4 v17, s[12:15], s49 offen offset:1024 nt lds
    v_mfma_f32_16x16x32_bf16 v[40:43], a[196:199], a[164:167], v[40:43]
    v_cvt_pk_bf16_f32 v231, v206, v207
    s_waitcnt lgkmcnt(4)
    v_mfma_f32_16x16x32_bf16 a[12:15], a[200:203], a[136:139], a[12:15]
    buffer_load_dwordx4 v18, s[12:15], s49 offen offset:2048 nt lds
    v_mfma_f32_16x16x32_bf16 a[12:15], a[204:207], a[140:143], a[12:15]
    ds_read_b64_tr_b16 a[184:185], v250 offset:49160
    v_cvt_pk_bf16_f32 v230, v204, v205
    v_mfma_f32_16x16x32_bf16 a[44:47], a[200:203], a[144:147], a[44:47]
    ds_read_b64_tr_b16 a[186:187], v250 offset:50184
    v_cvt_pk_bf16_f32 v229, v202, v203
    v_mfma_f32_16x16x32_bf16 a[44:47], a[204:207], a[148:151], a[44:47]
    ds_read_b64_tr_b16 a[188:189], v250 offset:57352
    v_cvt_pk_bf16_f32 v228, v200, v201
    v_mfma_f32_16x16x32_bf16 a[76:79], a[200:203], a[152:155], a[76:79]
    ds_read_b64_tr_b16 a[190:191], v250 offset:58376
    buffer_load_dwordx4 v19, s[12:15], s49 offen offset:3072 nt lds
    v_mfma_f32_16x16x32_bf16 a[76:79], a[204:207], a[156:159], a[76:79]
    ds_read_b64_tr_b16 a[220:221], v253 offset:4104
    v_cvt_pk_bf16_f32 v227, v198, v199
    v_mfma_f32_16x16x32_bf16 v[44:47], a[200:203], a[160:163], v[44:47]
    ds_read_b64_tr_b16 a[222:223], v253 offset:6152
    v_cvt_pk_bf16_f32 v226, v196, v197
    v_mfma_f32_16x16x32_bf16 v[44:47], a[204:207], a[164:167], v[44:47]
    s_mov_b32 m0, 40960
    s_add_u32 s49, s30, s53
    s_waitcnt lgkmcnt(4)
    v_mfma_f32_16x16x32_bf16 a[16:19], a[176:179], a[136:139], a[16:19]
    buffer_store_dwordx4 a[108:111], v24, s[20:23], s71 offen offset:3072 sc1
    v_mfma_f32_16x16x32_bf16 a[16:19], a[180:183], a[140:143], a[16:19]
    ds_read_b64_tr_b16 a[192:193], v251 offset:49152
    buffer_load_dwordx4 v20, s[16:19], s49 offen offset:0 nt lds
    v_mfma_f32_16x16x32_bf16 a[48:51], a[176:179], a[144:147], a[48:51]
    ds_read_b64_tr_b16 a[194:195], v251 offset:50176
    v_cvt_pk_bf16_f32 v225, v194, v195
    v_mfma_f32_16x16x32_bf16 a[48:51], a[180:183], a[148:151], a[48:51]
    ds_read_b64_tr_b16 a[196:197], v251 offset:57344
    v_cvt_pk_bf16_f32 v224, v192, v193
    v_mfma_f32_16x16x32_bf16 a[80:83], a[176:179], a[152:155], a[80:83]
    ds_read_b64_tr_b16 a[198:199], v251 offset:58368
    buffer_load_dwordx4 v21, s[16:19], s49 offen offset:1024 nt lds
    v_mfma_f32_16x16x32_bf16 a[80:83], a[180:183], a[156:159], a[80:83]
    v_mul_f32 v185, s38, v185
    v_mul_f32 v186, s38, v186
    v_mfma_f32_16x16x32_bf16 v[48:51], a[176:179], a[160:163], v[48:51]
    v_mul_f32 v187, s38, v187
    v_mul_f32 v188, s38, v188
    v_mul_f32 v189, s38, v189
    v_mul_f32 v190, s38, v190
    v_mul_f32 v191, s38, v191
    v_mfma_f32_16x16x32_bf16 v[48:51], a[180:183], a[164:167], v[48:51]
    buffer_load_dwordx4 v22, s[16:19], s49 offen offset:2048 nt lds
    s_waitcnt lgkmcnt(4)
    v_mfma_f32_16x16x32_bf16 a[20:23], a[184:187], a[136:139], a[20:23]
    v_cvt_pk_bf16_f32 v223, v190, v191
    v_cvt_pk_bf16_f32 v222, v188, v189
    v_mfma_f32_16x16x32_bf16 a[20:23], a[188:191], a[140:143], a[20:23]
    ds_read_b64_tr_b16 a[200:201], v251 offset:49160
    v_cvt_pk_bf16_f32 v221, v186, v187
    v_cvt_pk_bf16_f32 v220, v184, v185
    v_mfma_f32_16x16x32_bf16 a[52:55], a[184:187], a[144:147], a[52:55]
    ds_read_b64_tr_b16 a[202:203], v251 offset:50184
    buffer_load_dwordx4 v23, s[16:19], s49 offen offset:3072 nt lds
    v_mfma_f32_16x16x32_bf16 a[52:55], a[188:191], a[148:151], a[52:55]
    ds_read_b64_tr_b16 a[204:205], v251 offset:57352
    v_mul_f32 v179, s38, v179
    v_mfma_f32_16x16x32_bf16 a[84:87], a[184:187], a[152:155], a[84:87]
    ds_read_b64_tr_b16 a[206:207], v251 offset:58376
    v_mul_f32 v180, s38, v180
    v_mul_f32 v181, s38, v181
    v_mul_f32 v182, s38, v182
    v_mul_f32 v183, s38, v183
    v_mfma_f32_16x16x32_bf16 a[84:87], a[188:191], a[156:159], a[84:87]
    s_mov_b32 m0, 45056
    s_add_u32 s49, s30, s54
    v_mfma_f32_16x16x32_bf16 v[52:55], a[184:187], a[160:163], v[52:55]
    v_cvt_pk_bf16_f32 v219, v182, v183
    v_cvt_pk_bf16_f32 v218, v180, v181
    v_mfma_f32_16x16x32_bf16 v[52:55], a[188:191], a[164:167], v[52:55]
    v_cvt_pk_bf16_f32 v217, v178, v179
    v_cvt_pk_bf16_f32 v216, v176, v177
    s_waitcnt vmcnt(32) lgkmcnt(0)
    s_barrier
    v_mfma_f32_16x16x32_bf16 a[24:27], a[192:195], a[136:139], a[24:27]
    buffer_load_dwordx4 v20, s[16:19], s49 offen offset:0 nt lds
    v_mfma_f32_16x16x32_bf16 a[24:27], a[196:199], a[140:143], a[24:27]
    buffer_store_dwordx4 a[208:211], v24, s[20:23], s70 offen offset:0 sc1
    v_mfma_f32_16x16x32_bf16 a[56:59], a[192:195], a[144:147], a[56:59]
    v_mul_f32 v170, s38, v170
    v_mul_f32 v171, s38, v171
    v_mul_f32 v172, s38, v172
    v_mul_f32 v173, s38, v173
    v_mul_f32 v174, s38, v174
    v_mul_f32 v175, s38, v175
    v_mfma_f32_16x16x32_bf16 a[56:59], a[196:199], a[148:151], a[56:59]
    buffer_load_dwordx4 v21, s[16:19], s49 offen offset:1024 nt lds
    v_mfma_f32_16x16x32_bf16 a[88:91], a[192:195], a[152:155], a[88:91]
    v_cvt_pk_bf16_f32 v215, v174, v175
    v_cvt_pk_bf16_f32 v214, v172, v173
    v_mfma_f32_16x16x32_bf16 a[88:91], a[196:199], a[156:159], a[88:91]
    v_cvt_pk_bf16_f32 v213, v170, v171
    v_cvt_pk_bf16_f32 v212, v168, v169
    v_mfma_f32_16x16x32_bf16 v[56:59], a[192:195], a[160:163], v[56:59]
    buffer_load_dwordx4 v22, s[16:19], s49 offen offset:2048 nt lds
    v_mfma_f32_16x16x32_bf16 v[56:59], a[196:199], a[164:167], v[56:59]
    buffer_load_dwordx4 v23, s[16:19], s49 offen offset:3072 nt lds
    v_mfma_f32_16x16x32_bf16 a[28:31], a[200:203], a[136:139], a[28:31]
    v_mul_f32 v162, s38, v162
    v_mul_f32 v163, s38, v163
    v_mfma_f32_16x16x32_bf16 a[28:31], a[204:207], a[140:143], a[28:31]
    v_mul_f32 v164, s38, v164
    v_mul_f32 v165, s38, v165
    v_mul_f32 v166, s38, v166
    v_mul_f32 v167, s38, v167
    v_mfma_f32_16x16x32_bf16 a[60:63], a[200:203], a[144:147], a[60:63]
    s_add_u32 s49, s0, s1
    s_and_b32 s49, s49, s45
    v_mfma_f32_16x16x32_bf16 a[60:63], a[204:207], a[148:151], a[60:63]
    v_cvt_pk_bf16_f32 v211, v166, v167
    v_cvt_pk_bf16_f32 v210, v164, v165
    v_mfma_f32_16x16x32_bf16 a[92:95], a[200:203], a[152:155], a[92:95]
    v_cvt_pk_bf16_f32 v209, v162, v163
    v_cvt_pk_bf16_f32 v208, v160, v161
    v_mfma_f32_16x16x32_bf16 a[92:95], a[204:207], a[156:159], a[92:95]
    s_and_b32 s30, s0, s44
    s_or_b32 s30, s30, s49
    v_mfma_f32_16x16x32_bf16 v[60:63], a[200:203], a[160:163], v[60:63]
    v_mfma_f32_16x16x32_bf16 v[60:63], a[204:207], a[164:167], v[60:63]
    v_pk_mul_f32 v[152:153], v[152:153], s[38:39]
    v_pk_mul_f32 v[154:155], v[154:155], s[38:39]
    v_pk_mul_f32 v[156:157], v[156:157], s[38:39]
    v_pk_mul_f32 v[158:159], v[158:159], s[38:39]
    v_pk_mul_f32 v[144:145], v[144:145], s[38:39]
    v_pk_mul_f32 v[146:147], v[146:147], s[38:39]
    v_pk_mul_f32 v[148:149], v[148:149], s[38:39]
    v_pk_mul_f32 v[150:151], v[150:151], s[38:39]
    v_pk_mul_f32 v[136:137], v[136:137], s[38:39]
    v_pk_mul_f32 v[138:139], v[138:139], s[38:39]
    v_pk_mul_f32 v[140:141], v[140:141], s[38:39]
    v_pk_mul_f32 v[142:143], v[142:143], s[38:39]
    v_pk_mul_f32 v[128:129], v[128:129], s[38:39]
    v_pk_mul_f32 v[130:131], v[130:131], s[38:39]
    v_pk_mul_f32 v[132:133], v[132:133], s[38:39]
    v_pk_mul_f32 v[134:135], v[134:135], s[38:39]
    v_cvt_pk_bf16_f32 v207, v158, v159
    v_cvt_pk_bf16_f32 v206, v156, v157
    s_mov_b32 m0, 49152
    s_add_u32 s0, s0, 0x2000
    buffer_load_dwordx4 v16, s[12:15], s30 offen offset:0 nt lds
    v_cvt_pk_bf16_f32 v205, v154, v155
    v_cvt_pk_bf16_f32 v204, v152, v153
    buffer_load_dwordx4 v17, s[12:15], s30 offen offset:1024 nt lds
    v_cvt_pk_bf16_f32 v203, v150, v151
    v_cvt_pk_bf16_f32 v202, v148, v149
    buffer_load_dwordx4 v18, s[12:15], s30 offen offset:2048 nt lds
    v_cvt_pk_bf16_f32 v201, v146, v147
    v_cvt_pk_bf16_f32 v200, v144, v145
    buffer_load_dwordx4 v19, s[12:15], s30 offen offset:3072 nt lds
    v_cvt_pk_bf16_f32 v199, v142, v143
    v_cvt_pk_bf16_f32 v198, v140, v141
    s_mov_b32 m0, 53248
    s_add_u32 s49, s30, s52
    s_nop 0
    buffer_load_dwordx4 v16, s[12:15], s49 offen offset:0 nt lds
    v_cvt_pk_bf16_f32 v197, v138, v139
    v_cvt_pk_bf16_f32 v196, v136, v137
    buffer_load_dwordx4 v17, s[12:15], s49 offen offset:1024 nt lds
    v_cvt_pk_bf16_f32 v195, v134, v135
    v_cvt_pk_bf16_f32 v194, v132, v133
    buffer_load_dwordx4 v18, s[12:15], s49 offen offset:2048 nt lds
    v_cvt_pk_bf16_f32 v193, v130, v131
    v_cvt_pk_bf16_f32 v192, v128, v129
    buffer_load_dwordx4 v19, s[12:15], s49 offen offset:3072 nt lds
    s_mov_b32 m0, 57344
    s_add_u32 s49, s30, s53
    s_nop 0
    buffer_load_dwordx4 v20, s[16:19], s49 offen offset:0 nt lds
    v_pk_mul_f32 v[120:121], v[120:121], s[38:39]
    v_pk_mul_f32 v[122:123], v[122:123], s[38:39]
    v_pk_mul_f32 v[124:125], v[124:125], s[38:39]
    v_pk_mul_f32 v[126:127], v[126:127], s[38:39]
    v_pk_mul_f32 v[112:113], v[112:113], s[38:39]
    v_pk_mul_f32 v[114:115], v[114:115], s[38:39]
    v_pk_mul_f32 v[116:117], v[116:117], s[38:39]
    v_pk_mul_f32 v[118:119], v[118:119], s[38:39]
    v_pk_mul_f32 v[104:105], v[104:105], s[38:39]
    v_pk_mul_f32 v[106:107], v[106:107], s[38:39]
    v_pk_mul_f32 v[108:109], v[108:109], s[38:39]
    v_pk_mul_f32 v[110:111], v[110:111], s[38:39]
    v_pk_mul_f32 v[96:97], v[96:97], s[38:39]
    v_pk_mul_f32 v[98:99], v[98:99], s[38:39]
    v_pk_mul_f32 v[100:101], v[100:101], s[38:39]
    v_pk_mul_f32 v[102:103], v[102:103], s[38:39]
    v_mfma_f32_32x32x16_bf16 a[96:111], a[248:251], a[248:251], 0
    v_cvt_pk_bf16_f32 v191, v126, v127
    v_cvt_pk_bf16_f32 v190, v124, v125
    buffer_load_dwordx4 v21, s[16:19], s49 offen offset:1024 nt lds
    v_cvt_pk_bf16_f32 v189, v122, v123
    v_cvt_pk_bf16_f32 v188, v120, v121
    buffer_load_dwordx4 v22, s[16:19], s49 offen offset:2048 nt lds
    v_cvt_pk_bf16_f32 v187, v118, v119
    v_cvt_pk_bf16_f32 v186, v116, v117
    buffer_load_dwordx4 v23, s[16:19], s49 offen offset:3072 nt lds
    v_cvt_pk_bf16_f32 v185, v114, v115
    v_cvt_pk_bf16_f32 v184, v112, v113
    s_mov_b32 m0, 61440
    s_add_u32 s49, s30, s54
    s_nop 0
    buffer_load_dwordx4 v20, s[16:19], s49 offen offset:0 nt lds
    v_cvt_pk_bf16_f32 v183, v110, v111
    v_cvt_pk_bf16_f32 v182, v108, v109
    buffer_load_dwordx4 v21, s[16:19], s49 offen offset:1024 nt lds
    v_cvt_pk_bf16_f32 v181, v106, v107
    v_cvt_pk_bf16_f32 v180, v104, v105
    buffer_load_dwordx4 v22, s[16:19], s49 offen offset:2048 nt lds
    v_cvt_pk_bf16_f32 v179, v102, v103
    v_cvt_pk_bf16_f32 v178, v100, v101
    buffer_load_dwordx4 v23, s[16:19], s49 offen offset:3072 nt lds
    v_cvt_pk_bf16_f32 v177, v98, v99
    v_cvt_pk_bf16_f32 v176, v96, v97
    s_add_u32 s49, s0, s1
    s_and_b32 s49, s49, s45
    s_and_b32 s30, s0, s44
    s_or_b32 s30, s30, s49
    ds_read_b128 a[160:163], v4 offset:0
    v_pk_mul_f32 v[56:57], v[56:57], s[38:39]
    v_pk_mul_f32 v[58:59], v[58:59], s[38:39]
    v_pk_mul_f32 v[60:61], v[60:61], s[38:39]
    v_pk_mul_f32 v[62:63], v[62:63], s[38:39]
    v_pk_mul_f32 v[48:49], v[48:49], s[38:39]
    v_pk_mul_f32 v[50:51], v[50:51], s[38:39]
    v_pk_mul_f32 v[52:53], v[52:53], s[38:39]
    v_pk_mul_f32 v[54:55], v[54:55], s[38:39]
    v_pk_mul_f32 v[40:41], v[40:41], s[38:39]
    v_pk_mul_f32 v[42:43], v[42:43], s[38:39]
    v_pk_mul_f32 v[44:45], v[44:45], s[38:39]
    v_pk_mul_f32 v[46:47], v[46:47], s[38:39]
    v_pk_mul_f32 v[32:33], v[32:33], s[38:39]
    v_pk_mul_f32 v[34:35], v[34:35], s[38:39]
    v_pk_mul_f32 v[36:37], v[36:37], s[38:39]
    v_pk_mul_f32 v[38:39], v[38:39], s[38:39]
    v_mfma_f32_32x32x16_bf16 a[112:127], a[248:251], a[248:251], 0
    v_cvt_pk_bf16_f32 v159, v62, v63
    v_cvt_pk_bf16_f32 v158, v60, v61
    ds_read_b128 a[164:167], v5 offset:0
    v_cvt_pk_bf16_f32 v157, v58, v59
    v_cvt_pk_bf16_f32 v156, v56, v57
    ds_read_b128 a[168:171], v6 offset:0
    v_cvt_pk_bf16_f32 v155, v54, v55
    v_cvt_pk_bf16_f32 v154, v52, v53
    ds_read_b128 a[172:175], v7 offset:0
    v_cvt_pk_bf16_f32 v153, v50, v51
    v_cvt_pk_bf16_f32 v152, v48, v49
    ds_read_b128 a[176:179], v4 offset:4096
    v_cvt_pk_bf16_f32 v151, v46, v47
    v_cvt_pk_bf16_f32 v150, v44, v45
    ds_read_b128 a[180:183], v5 offset:4096
    v_cvt_pk_bf16_f32 v149, v42, v43
    v_cvt_pk_bf16_f32 v148, v40, v41
    ds_read_b128 a[184:187], v6 offset:4096
    v_cvt_pk_bf16_f32 v147, v38, v39
    v_cvt_pk_bf16_f32 v146, v36, v37
    ds_read_b128 a[188:191], v7 offset:4096
    v_cvt_pk_bf16_f32 v145, v34, v35
    v_cvt_pk_bf16_f32 v144, v32, v33
    s_lshl_b32 s48, s62, 3
    s_add_u32 s48, s48, s63
    s_lshl_b32 s48, s48, 7
    s_lshl_b32 s49, s64, 1
    s_add_u32 s48, s48, s49
    s_nop 0
    s_add_u32 s48, s48, 53820160
    v_lshl_add_u32 v1, v24, 2, s48
    v_mov_b32 v2, 0
    s_mov_b64 exec, 3
    global_store_dword v1, v2, s[60:61] sc0 sc1
    s_mov_b64 exec, -1
    s_lshl_b32 s48, s2, 7
    s_add_u32 s48, s48, 53824256
    v_lshrrev_b32 v1, 2, v24
    v_add_u32 v1, s48, v1
    s_mov_b64 exec, 15
    s_nop 0
    global_store_dword v1, v2, s[60:61] sc0 sc1
    s_mov_b64 exec, -1
    v_and_b32 v1, 3, v0
    v_xor_b32 v2, v31, v1
    v_lshlrev_b32 v2, 4, v2
    v_lshl_add_u32 v92, v1, 8, v2
    ds_read_b128 v[48:51], v92 offset:0
    ds_read_b128 v[52:55], v92 offset:64
    ds_read_b128 v[56:59], v92 offset:128
    ds_read_b128 v[60:63], v92 offset:192
    v_bfe_i32 v74, v0, 0, 1
    v_and_b32 v74, 0xaaaaaaaa, v74
    v_or_b32 v74, 0x44444444, v74
    v_accvgpr_read_b32 v32, a0
    v_accvgpr_read_b32 v33, a1
    v_accvgpr_read_b32 v34, a2
    v_accvgpr_read_b32 v35, a3
    v_accvgpr_read_b32 v36, a4
    v_accvgpr_read_b32 v37, a5
    v_accvgpr_read_b32 v38, a6
    v_accvgpr_read_b32 v39, a7
    v_accvgpr_read_b32 v40, a8
    v_accvgpr_read_b32 v41, a9
    v_accvgpr_read_b32 v42, a10
    v_accvgpr_read_b32 v43, a11
    v_accvgpr_read_b32 v44, a12
    v_accvgpr_read_b32 v45, a13
    v_accvgpr_read_b32 v46, a14
    v_accvgpr_read_b32 v47, a15
    v_pk_mul_f32 v[32:33], v[32:33], s[38:39]
    v_pk_mul_f32 v[34:35], v[34:35], s[38:39]
    v_pk_mul_f32 v[36:37], v[36:37], s[38:39]
    v_pk_mul_f32 v[38:39], v[38:39], s[38:39]
    v_pk_mul_f32 v[40:41], v[40:41], s[38:39]
    v_pk_mul_f32 v[42:43], v[42:43], s[38:39]
    v_pk_mul_f32 v[44:45], v[44:45], s[38:39]
    v_pk_mul_f32 v[46:47], v[46:47], s[38:39]
    s_waitcnt lgkmcnt(0)
    s_nop 0
    v_mfma_f32_16x16x32_bf16 v[76:79], v[48:51], v[176:179], 0
    v_cvt_pk_bf16_f32 v99, v38, v39
    v_cvt_pk_bf16_f32 v98, v36, v37
    v_mfma_f32_16x16x32_bf16 v[76:79], v[52:55], v[180:183], v[76:79]
    v_cvt_pk_bf16_f32 v97, v34, v35
    v_cvt_pk_bf16_f32 v96, v32, v33
    v_mfma_f32_16x16x32_bf16 v[76:79], v[56:59], v[184:187], v[76:79]
    v_cvt_pk_bf16_f32 v103, v46, v47
    v_cvt_pk_bf16_f32 v102, v44, v45
    v_mfma_f32_16x16x32_bf16 v[76:79], v[60:63], v[188:191], v[76:79]
    v_cvt_pk_bf16_f32 v101, v42, v43
    v_cvt_pk_bf16_f32 v100, v40, v41
    v_mfma_f32_32x32x16_bf16 a[0:15], a[248:251], a[248:251], 0
    v_accvgpr_read_b32 v32, a16
    v_accvgpr_read_b32 v33, a17
    v_accvgpr_read_b32 v34, a18
    v_accvgpr_read_b32 v35, a19
    v_accvgpr_read_b32 v36, a20
    v_accvgpr_read_b32 v37, a21
    v_accvgpr_read_b32 v38, a22
    v_accvgpr_read_b32 v39, a23
    v_accvgpr_read_b32 v40, a24
    v_accvgpr_read_b32 v41, a25
    v_accvgpr_read_b32 v42, a26
    v_accvgpr_read_b32 v43, a27
    v_accvgpr_read_b32 v44, a28
    v_accvgpr_read_b32 v45, a29
    v_accvgpr_read_b32 v46, a30
    v_accvgpr_read_b32 v47, a31
    v_pk_mul_f32 v[32:33], v[32:33], s[38:39]
    v_pk_mul_f32 v[34:35], v[34:35], s[38:39]
    v_pk_mul_f32 v[36:37], v[36:37], s[38:39]
    v_pk_mul_f32 v[38:39], v[38:39], s[38:39]
    v_pk_mul_f32 v[40:41], v[40:41], s[38:39]
    v_pk_mul_f32 v[42:43], v[42:43], s[38:39]
    v_pk_mul_f32 v[44:45], v[44:45], s[38:39]
    v_pk_mul_f32 v[46:47], v[46:47], s[38:39]
    v_mfma_f32_16x16x32_bf16 v[80:83], v[48:51], v[192:195], 0
    buffer_store_dwordx4 a[212:215], v24, s[20:23], s70 offen offset:1024 sc1
    v_mfma_f32_16x16x32_bf16 v[80:83], v[52:55], v[196:199], v[80:83]
    ds_write_b128 v27, v[96:99] offset:0
    v_mfma_f32_16x16x32_bf16 v[80:83], v[56:59], v[200:203], v[80:83]
    v_cvt_pk_bf16_f32 v107, v38, v39
    v_cvt_pk_bf16_f32 v106, v36, v37
    v_mfma_f32_16x16x32_bf16 v[80:83], v[60:63], v[204:207], v[80:83]
    v_cvt_pk_bf16_f32 v105, v34, v35
    v_cvt_pk_bf16_f32 v104, v32, v33
    v_mfma_f32_32x32x16_bf16 a[16:31], a[248:251], a[248:251], 0
    ds_write_b128 v27, v[100:103] offset:1024
    v_cvt_pk_bf16_f32 v111, v46, v47
    v_cvt_pk_bf16_f32 v110, v44, v45
    v_cvt_pk_bf16_f32 v109, v42, v43
    v_cvt_pk_bf16_f32 v108, v40, v41
    v_accvgpr_read_b32 v32, a32
    v_accvgpr_read_b32 v33, a33
    v_accvgpr_read_b32 v34, a34
    v_accvgpr_read_b32 v35, a35
    v_accvgpr_read_b32 v36, a36
    v_accvgpr_read_b32 v37, a37
    v_accvgpr_read_b32 v38, a38
    v_accvgpr_read_b32 v39, a39
    v_accvgpr_read_b32 v40, a40
    v_accvgpr_read_b32 v41, a41
    v_accvgpr_read_b32 v42, a42
    v_accvgpr_read_b32 v43, a43
    v_accvgpr_read_b32 v44, a44
    v_accvgpr_read_b32 v45, a45
    v_accvgpr_read_b32 v46, a46
    v_accvgpr_read_b32 v47, a47
    v_pk_mul_f32 v[32:33], v[32:33], s[38:39]
    v_pk_mul_f32 v[34:35], v[34:35], s[38:39]
    v_pk_mul_f32 v[36:37], v[36:37], s[38:39]
    v_pk_mul_f32 v[38:39], v[38:39], s[38:39]
    v_pk_mul_f32 v[40:41], v[40:41], s[38:39]
    v_pk_mul_f32 v[42:43], v[42:43], s[38:39]
    v_pk_mul_f32 v[44:45], v[44:45], s[38:39]
    v_pk_mul_f32 v[46:47], v[46:47], s[38:39]
    v_mfma_f32_16x16x32_bf16 v[84:87], v[48:51], v[208:211], 0
    ds_write_b128 v27, v[104:107] offset:2048
    v_mfma_f32_16x16x32_bf16 v[84:87], v[52:55], v[212:215], v[84:87]
    v_cvt_pk_bf16_f32 v115, v38, v39
    v_cvt_pk_bf16_f32 v114, v36, v37
    v_mfma_f32_16x16x32_bf16 v[84:87], v[56:59], v[216:219], v[84:87]
    v_cvt_pk_bf16_f32 v113, v34, v35
    v_cvt_pk_bf16_f32 v112, v32, v33
    v_mfma_f32_16x16x32_bf16 v[84:87], v[60:63], v[220:223], v[84:87]
    ds_write_b128 v27, v[108:111] offset:3072
    v_mfma_f32_32x32x16_bf16 a[32:47], a[248:251], a[248:251], 0
    v_cvt_pk_bf16_f32 v119, v46, v47
    v_cvt_pk_bf16_f32 v118, v44, v45
    v_cvt_pk_bf16_f32 v117, v42, v43
    v_cvt_pk_bf16_f32 v116, v40, v41
    v_accvgpr_read_b32 v32, a48
    v_accvgpr_read_b32 v33, a49
    v_accvgpr_read_b32 v34, a50
    v_accvgpr_read_b32 v35, a51
    v_accvgpr_read_b32 v36, a52
    v_accvgpr_read_b32 v37, a53
    v_accvgpr_read_b32 v38, a54
    v_accvgpr_read_b32 v39, a55
    v_accvgpr_read_b32 v40, a56
    v_accvgpr_read_b32 v41, a57
    v_accvgpr_read_b32 v42, a58
    v_accvgpr_read_b32 v43, a59
    v_accvgpr_read_b32 v44, a60
    v_accvgpr_read_b32 v45, a61
    v_accvgpr_read_b32 v46, a62
    v_accvgpr_read_b32 v47, a63
    v_pk_mul_f32 v[32:33], v[32:33], s[38:39]
    v_pk_mul_f32 v[34:35], v[34:35], s[38:39]
    v_pk_mul_f32 v[36:37], v[36:37], s[38:39]
    v_pk_mul_f32 v[38:39], v[38:39], s[38:39]
    v_pk_mul_f32 v[40:41], v[40:41], s[38:39]
    v_pk_mul_f32 v[42:43], v[42:43], s[38:39]
    v_pk_mul_f32 v[44:45], v[44:45], s[38:39]
    v_pk_mul_f32 v[46:47], v[46:47], s[38:39]
    v_mfma_f32_16x16x32_bf16 v[88:91], v[48:51], v[224:227], 0
    buffer_store_dwordx4 a[216:219], v24, s[20:23], s70 offen offset:2048 sc1
    v_mfma_f32_16x16x32_bf16 v[88:91], v[52:55], v[228:231], v[88:91]
    v_cvt_pk_bf16_f32 v123, v38, v39
    v_cvt_pk_bf16_f32 v122, v36, v37
    v_mfma_f32_16x16x32_bf16 v[88:91], v[56:59], v[232:235], v[88:91]
    v_cvt_pk_bf16_f32 v121, v34, v35
    v_cvt_pk_bf16_f32 v120, v32, v33
    v_mfma_f32_16x16x32_bf16 v[88:91], v[60:63], v[236:239], v[88:91]
    v_cvt_pk_bf16_f32 v127, v46, v47
    v_cvt_pk_bf16_f32 v126, v44, v45
    v_mfma_f32_32x32x16_bf16 a[48:63], a[248:251], a[248:251], 0
    v_cvt_pk_bf16_f32 v125, v42, v43
    v_cvt_pk_bf16_f32 v124, v40, v41
    v_accvgpr_read_b32 v32, a64
    v_accvgpr_read_b32 v33, a65
    v_accvgpr_read_b32 v34, a66
    v_accvgpr_read_b32 v35, a67
    v_accvgpr_read_b32 v36, a68
    v_accvgpr_read_b32 v37, a69
    v_accvgpr_read_b32 v38, a70
    v_accvgpr_read_b32 v39, a71
    v_accvgpr_read_b32 v40, a72
    v_accvgpr_read_b32 v41, a73
    v_accvgpr_read_b32 v42, a74
    v_accvgpr_read_b32 v43, a75
    v_accvgpr_read_b32 v44, a76
    v_accvgpr_read_b32 v45, a77
    v_accvgpr_read_b32 v46, a78
    v_accvgpr_read_b32 v47, a79
    v_pk_mul_f32 v[32:33], v[32:33], s[38:39]
    v_pk_mul_f32 v[34:35], v[34:35], s[38:39]
    v_pk_mul_f32 v[36:37], v[36:37], s[38:39]
    v_pk_mul_f32 v[38:39], v[38:39], s[38:39]
    v_pk_mul_f32 v[40:41], v[40:41], s[38:39]
    v_pk_mul_f32 v[42:43], v[42:43], s[38:39]
    v_pk_mul_f32 v[44:45], v[44:45], s[38:39]
    v_pk_mul_f32 v[46:47], v[46:47], s[38:39]
    v_mfma_f32_32x32x16_bf16 a[64:79], a[248:251], a[248:251], 0
    v_mov_b64_e64 v[96:97], 0
    v_cvt_pk_bf16_f32 v131, v38, v39
    v_cvt_pk_bf16_f32 v130, v36, v37
    v_cvt_pk_bf16_f32 v129, v34, v35
    v_cvt_pk_bf16_f32 v128, v32, v33
    v_mov_b64 v[98:99], 0
    v_mov_b64 v[100:101], 0
    v_mov_b64 v[102:103], 0
    v_mov_b64 v[104:105], 0
    v_mov_b64 v[106:107], 0
    v_mov_b64 v[108:109], 0
    v_mov_b64_e64 v[110:111], 0
    v_cvt_pk_bf16_f32 v135, v46, v47
    v_cvt_pk_bf16_f32 v134, v44, v45
    v_cvt_pk_bf16_f32 v133, v42, v43
    v_cvt_pk_bf16_f32 v132, v40, v41
    v_accvgpr_read_b32 v32, a80
    v_accvgpr_read_b32 v33, a81
    v_accvgpr_read_b32 v34, a82
    v_accvgpr_read_b32 v35, a83
    v_accvgpr_read_b32 v36, a84
    v_accvgpr_read_b32 v37, a85
    v_accvgpr_read_b32 v38, a86
    v_accvgpr_read_b32 v39, a87
    v_accvgpr_read_b32 v40, a88
    v_accvgpr_read_b32 v41, a89
    v_accvgpr_read_b32 v42, a90
    v_accvgpr_read_b32 v43, a91
    v_accvgpr_read_b32 v44, a92
    v_accvgpr_read_b32 v45, a93
    v_accvgpr_read_b32 v46, a94
    v_accvgpr_read_b32 v47, a95
    v_pk_mul_f32 v[32:33], v[32:33], s[38:39]
    v_pk_mul_f32 v[34:35], v[34:35], s[38:39]
    v_pk_mul_f32 v[36:37], v[36:37], s[38:39]
    v_pk_mul_f32 v[38:39], v[38:39], s[38:39]
    v_pk_mul_f32 v[40:41], v[40:41], s[38:39]
    v_pk_mul_f32 v[42:43], v[42:43], s[38:39]
    v_pk_mul_f32 v[44:45], v[44:45], s[38:39]
    v_pk_mul_f32 v[46:47], v[46:47], s[38:39]
    v_mfma_f32_32x32x16_bf16 a[80:95], a[248:251], a[248:251], 0
    buffer_store_dwordx4 a[220:223], v24, s[20:23], s70 offen offset:3072 sc1
    v_cvt_pk_bf16_f32 v139, v38, v39
    v_cvt_pk_bf16_f32 v138, v36, v37
    v_cvt_pk_bf16_f32 v137, v34, v35
    v_cvt_pk_bf16_f32 v136, v32, v33
    v_cvt_pk_bf16_f32 v143, v46, v47
    v_cvt_pk_bf16_f32 v142, v44, v45
    v_cvt_pk_bf16_f32 v141, v42, v43
    v_cvt_pk_bf16_f32 v140, v40, v41
    ds_read_b64_tr_b16 a[192:193], v8 offset:8192
    ds_read_b64_tr_b16 a[194:195], v8 offset:12288
    ds_read_b64_tr_b16 a[196:197], v9 offset:8192
    ds_read_b64_tr_b16 a[198:199], v9 offset:12288
    ds_read_b64_tr_b16 a[200:201], v10 offset:8192
    ds_read_b64_tr_b16 a[202:203], v10 offset:12288
    ds_read_b64_tr_b16 a[204:205], v11 offset:8192
    ds_read_b64_tr_b16 a[206:207], v11 offset:12288
    v_max3_f32 v76, v76, v77, v78
    v_max3_f32 v80, v80, v81, v82
    v_max3_f32 v84, v84, v85, v86
    v_max3_f32 v88, v88, v89, v90
    v_max_f32 v76, v76, v79
    v_max_f32 v80, v80, v83
    v_max_f32 v84, v84, v87
    v_max_f32 v88, v88, v91
    v_pk_mul_f32 v[78:79], v[76:77], -1.0 op_sel_hi:[0,0]
    v_pk_mul_f32 v[82:83], v[80:81], -1.0 op_sel_hi:[0,0]
    v_pk_mul_f32 v[86:87], v[84:85], -1.0 op_sel_hi:[0,0]
    v_pk_mul_f32 v[90:91], v[88:89], -1.0 op_sel_hi:[0,0]
    v_pk_mul_f32 v[76:77], v[76:77], -1.0 op_sel_hi:[0,0]
    v_pk_mul_f32 v[80:81], v[80:81], -1.0 op_sel_hi:[0,0]
    v_pk_mul_f32 v[84:85], v[84:85], -1.0 op_sel_hi:[0,0]
    v_pk_mul_f32 v[88:89], v[88:89], -1.0 op_sel_hi:[0,0]
    s_mov_b32 s70, s98
    s_mov_b32 s71, s99
    s_nop 0
    s_nop 0
    s_nop 0
L_loop4:
    s_waitcnt lgkmcnt(8)
    v_mfma_f32_16x16x32_bf16 v[32:35], a[160:163], v[176:179], v[76:79]
    ds_read_b64_tr_b16 a[236:237], v12 offset:8192
    v_mfma_f32_16x16x32_bf16 v[32:35], a[164:167], v[180:183], v[32:35]
    ds_read_b64_tr_b16 a[238:239], v12 offset:12288
    v_mfma_f32_16x16x32_bf16 v[32:35], a[168:171], v[184:187], v[32:35]
    ds_read_b64_tr_b16 a[240:241], v13 offset:8192
    v_mfma_f32_16x16x32_bf16 v[32:35], a[172:175], v[188:191], v[32:35]
    ds_read_b64_tr_b16 a[242:243], v13 offset:12288
    v_mfma_f32_16x16x32_bf16 v[36:39], a[176:179], v[176:179], v[76:79]
    ds_read_b64_tr_b16 a[248:249], v14 offset:8192
    v_mfma_f32_16x16x32_bf16 v[36:39], a[180:183], v[180:183], v[36:39]
    ds_read_b64_tr_b16 a[250:251], v14 offset:12288
    v_mfma_f32_16x16x32_bf16 v[36:39], a[184:187], v[184:187], v[36:39]
    ds_read_b64_tr_b16 a[252:253], v15 offset:8192
    v_mfma_f32_16x16x32_bf16 v[36:39], a[188:191], v[188:191], v[36:39]
    ds_read_b64_tr_b16 a[254:255], v15 offset:12288
    v_mfma_f32_16x16x32_bf16 v[40:43], a[160:163], v[192:195], v[80:83]
    v_exp_f32 v32, v32
    v_mfma_f32_16x16x32_bf16 v[40:43], a[164:167], v[196:199], v[40:43]
    v_exp_f32 v33, v33
    v_mfma_f32_16x16x32_bf16 v[40:43], a[168:171], v[200:203], v[40:43]
    v_exp_f32 v34, v34
    v_mfma_f32_16x16x32_bf16 v[40:43], a[172:175], v[204:207], v[40:43]
    v_exp_f32 v35, v35
    v_mfma_f32_16x16x32_bf16 v[44:47], a[176:179], v[192:195], v[80:83]
    v_cvt_pk_bf16_f32 v56, v32, v33
    v_cvt_pk_bf16_f32 v57, v34, v35
    v_mfma_f32_16x16x32_bf16 v[44:47], a[180:183], v[196:199], v[44:47]
    v_exp_f32 v36, v36
    v_mfma_f32_16x16x32_bf16 v[44:47], a[184:187], v[200:203], v[44:47]
    v_exp_f32 v37, v37
    v_mfma_f32_16x16x32_bf16 v[44:47], a[188:191], v[204:207], v[44:47]
    v_exp_f32 v38, v38
    v_mfma_f32_16x16x32_bf16 v[48:51], a[160:163], v[208:211], v[84:87]
    v_exp_f32 v39, v39
    v_mfma_f32_16x16x32_bf16 v[48:51], a[164:167], v[212:215], v[48:51]
    v_cvt_pk_bf16_f32 v58, v36, v37
    v_cvt_pk_bf16_f32 v59, v38, v39
    v_mfma_f32_16x16x32_bf16 v[48:51], a[168:171], v[216:219], v[48:51]
    v_exp_f32 v40, v40
    v_mfma_f32_16x16x32_bf16 v[48:51], a[172:175], v[220:223], v[48:51]
    v_exp_f32 v41, v41
    v_mfma_f32_16x16x32_bf16 v[52:55], a[176:179], v[208:211], v[84:87]
    v_exp_f32 v42, v42
    v_mfma_f32_16x16x32_bf16 v[52:55], a[180:183], v[212:215], v[52:55]
    v_exp_f32 v43, v43
    v_mfma_f32_16x16x32_bf16 v[52:55], a[184:187], v[216:219], v[52:55]
    v_exp_f32 v44, v44
    v_mfma_f32_16x16x32_bf16 v[52:55], a[188:191], v[220:223], v[52:55]
    v_exp_f32 v45, v45
    v_mfma_f32_16x16x32_bf16 v[32:35], a[160:163], v[224:227], v[88:91]
    v_exp_f32 v46, v46
    v_mfma_f32_16x16x32_bf16 v[32:35], a[164:167], v[228:231], v[32:35]
    v_exp_f32 v47, v47
    v_mfma_f32_16x16x32_bf16 v[32:35], a[168:171], v[232:235], v[32:35]
    v_cvt_pk_bf16_f32 v60, v40, v41
    v_cvt_pk_bf16_f32 v61, v42, v43
    v_mfma_f32_16x16x32_bf16 v[32:35], a[172:175], v[236:239], v[32:35]
    v_cvt_pk_bf16_f32 v62, v44, v45
    v_cvt_pk_bf16_f32 v63, v46, v47
    v_mfma_f32_16x16x32_bf16 v[36:39], a[176:179], v[224:227], v[88:91]
    v_exp_f32 v48, v48
    v_mfma_f32_16x16x32_bf16 v[36:39], a[180:183], v[228:231], v[36:39]
    v_exp_f32 v49, v49
    v_mfma_f32_16x16x32_bf16 v[36:39], a[184:187], v[232:235], v[36:39]
    v_exp_f32 v50, v50
    v_mfma_f32_16x16x32_bf16 v[36:39], a[188:191], v[236:239], v[36:39]
    s_waitcnt vmcnt(32) lgkmcnt(0)
    s_barrier
    v_mfma_f32_16x16x32_bf16 a[0:3], a[208:211], v[96:99], a[0:3]
    s_mov_b32 m0, 0
    s_add_u32 s0, s0, 0x2000
    buffer_load_dwordx4 v16, s[12:15], s30 offen offset:0 nt lds
    v_mfma_f32_16x16x32_bf16 a[0:3], a[192:195], v[56:59], a[0:3]
    v_exp_f32 v51, v51
    v_mfma_f32_16x16x32_bf16 a[4:7], a[212:215], v[96:99], a[4:7]
    buffer_load_dwordx4 v17, s[12:15], s30 offen offset:1024 nt lds
    v_cvt_pk_bf16_f32 v64, v48, v49
    v_mfma_f32_16x16x32_bf16 a[4:7], a[196:199], v[56:59], a[4:7]
    v_exp_f32 v52, v52
    v_mfma_f32_16x16x32_bf16 a[8:11], a[216:219], v[96:99], a[8:11]
    buffer_load_dwordx4 v18, s[12:15], s30 offen offset:2048 nt lds
    v_cvt_pk_bf16_f32 v65, v50, v51
    v_mfma_f32_16x16x32_bf16 a[8:11], a[200:203], v[56:59], a[8:11]
    v_exp_f32 v53, v53
    v_mfma_f32_16x16x32_bf16 a[12:15], a[220:223], v[96:99], a[12:15]
    buffer_load_dwordx4 v19, s[12:15], s30 offen offset:3072 nt lds
    v_cvt_pk_bf16_f32 v66, v52, v53
    v_mfma_f32_16x16x32_bf16 a[12:15], a[204:207], v[56:59], a[12:15]
    v_exp_f32 v54, v54
    v_mfma_f32_16x16x32_bf16 a[32:35], a[208:211], v[100:103], a[32:35]
    s_mov_b32 m0, 4096
    s_add_u32 s49, s30, s52
    buffer_load_dwordx4 v16, s[12:15], s49 offen offset:0 nt lds
    v_mfma_f32_16x16x32_bf16 a[32:35], a[192:195], v[60:63], a[32:35]
    v_exp_f32 v55, v55
    v_mfma_f32_16x16x32_bf16 a[36:39], a[212:215], v[100:103], a[36:39]
    buffer_load_dwordx4 v17, s[12:15], s49 offen offset:1024 nt lds
    v_cvt_pk_bf16_f32 v67, v54, v55
    v_mfma_f32_16x16x32_bf16 a[36:39], a[196:199], v[60:63], a[36:39]
    v_exp_f32 v32, v32
    v_mfma_f32_16x16x32_bf16 a[40:43], a[216:219], v[100:103], a[40:43]
    buffer_load_dwordx4 v18, s[12:15], s49 offen offset:2048 nt lds
    ds_read_b128 a[160:163], v4 offset:16384
    v_mfma_f32_16x16x32_bf16 a[40:43], a[200:203], v[60:63], a[40:43]
    v_exp_f32 v33, v33
    v_mfma_f32_16x16x32_bf16 a[44:47], a[220:223], v[100:103], a[44:47]
    buffer_load_dwordx4 v19, s[12:15], s49 offen offset:3072 nt lds
    v_cvt_pk_bf16_f32 v68, v32, v33
    v_mfma_f32_16x16x32_bf16 a[44:47], a[204:207], v[60:63], a[44:47]
    v_exp_f32 v34, v34
    v_smfmac_f32_16x16x64_bf16 a[224:227], a[244:247], v[56:63], v74
    ds_read_b128 a[164:167], v5 offset:16384
    v_mfma_f32_16x16x32_bf16 a[64:67], a[208:211], v[104:107], a[64:67]
    s_mov_b32 m0, 8192
    s_add_u32 s49, s30, s53
    buffer_load_dwordx4 v20, s[16:19], s49 offen offset:0 nt lds
    v_mfma_f32_16x16x32_bf16 a[64:67], a[192:195], v[64:67], a[64:67]
    buffer_load_dwordx4 v21, s[16:19], s49 offen offset:1024 nt lds
    ds_read_b128 a[168:171], v6 offset:16384
    v_mfma_f32_16x16x32_bf16 a[68:71], a[212:215], v[104:107], a[68:71]
    v_exp_f32 v35, v35
    v_mfma_f32_16x16x32_bf16 a[68:71], a[196:199], v[64:67], a[68:71]
    buffer_load_dwordx4 v22, s[16:19], s49 offen offset:2048 nt lds
    v_cvt_pk_bf16_f32 v69, v34, v35
    v_mfma_f32_16x16x32_bf16 a[72:75], a[216:219], v[104:107], a[72:75]
    v_exp_f32 v36, v36
    v_mfma_f32_16x16x32_bf16 a[72:75], a[200:203], v[64:67], a[72:75]
    v_exp_f32 v37, v37
    v_exp_f32 v38, v38
    v_exp_f32 v39, v39
    v_mfma_f32_16x16x32_bf16 a[76:79], a[220:223], v[104:107], a[76:79]
    buffer_load_dwordx4 v23, s[16:19], s49 offen offset:3072 nt lds
    v_cvt_pk_bf16_f32 v70, v36, v37
    v_cvt_pk_bf16_f32 v71, v38, v39
    v_mfma_f32_16x16x32_bf16 a[76:79], a[204:207], v[64:67], a[76:79]
    ds_read_b128 a[172:175], v7 offset:16384
    ds_read_b128 a[176:179], v4 offset:20480
    v_mfma_f32_16x16x32_bf16 a[96:99], a[208:211], v[108:111], a[96:99]
    ds_read_b128 a[180:183], v5 offset:20480
    ds_read_b128 a[184:187], v6 offset:20480
    ds_read_b128 a[188:191], v7 offset:20480
    s_mov_b32 m0, 12288
    s_add_u32 s49, s30, s54
    buffer_load_dwordx4 v20, s[16:19], s49 offen offset:0 nt lds
    v_mfma_f32_16x16x32_bf16 a[96:99], a[192:195], v[68:71], a[96:99]
    ds_read_b64_tr_b16 a[192:193], v12 offset:24576
    buffer_load_dwordx4 v21, s[16:19], s49 offen offset:1024 nt lds
    v_mfma_f32_16x16x32_bf16 a[100:103], a[212:215], v[108:111], a[100:103]
    ds_read_b64_tr_b16 a[194:195], v12 offset:28672
    v_mfma_f32_16x16x32_bf16 a[100:103], a[196:199], v[68:71], a[100:103]
    ds_read_b64_tr_b16 a[196:197], v13 offset:24576
    buffer_load_dwordx4 v22, s[16:19], s49 offen offset:2048 nt lds
    v_mfma_f32_16x16x32_bf16 a[104:107], a[216:219], v[108:111], a[104:107]
    ds_read_b64_tr_b16 a[198:199], v13 offset:28672
    v_mfma_f32_16x16x32_bf16 a[104:107], a[200:203], v[68:71], a[104:107]
    ds_read_b64_tr_b16 a[200:201], v14 offset:24576
    buffer_load_dwordx4 v23, s[16:19], s49 offen offset:3072 nt lds
    v_mfma_f32_16x16x32_bf16 a[108:111], a[220:223], v[108:111], a[108:111]
    ds_read_b64_tr_b16 a[202:203], v14 offset:28672
    v_mfma_f32_16x16x32_bf16 a[108:111], a[204:207], v[68:71], a[108:111]
    ds_read_b64_tr_b16 a[204:205], v15 offset:24576
    v_smfmac_f32_16x16x64_bf16 a[228:231], a[244:247], v[64:71], v74
    ds_read_b64_tr_b16 a[206:207], v15 offset:28672
    s_add_u32 s49, s0, s1
    s_and_b32 s49, s49, s45
    s_and_b32 s30, s0, s44
    s_or_b32 s30, s30, s49
    s_waitcnt lgkmcnt(8)
    v_mfma_f32_16x16x32_bf16 v[32:35], a[160:163], v[176:179], v[76:79]
    ds_read_b64_tr_b16 a[208:209], v8 offset:24576
    v_mfma_f32_16x16x32_bf16 v[32:35], a[164:167], v[180:183], v[32:35]
    ds_read_b64_tr_b16 a[210:211], v8 offset:28672
    v_mfma_f32_16x16x32_bf16 v[32:35], a[168:171], v[184:187], v[32:35]
    ds_read_b64_tr_b16 a[212:213], v9 offset:24576
    v_mfma_f32_16x16x32_bf16 v[32:35], a[172:175], v[188:191], v[32:35]
    ds_read_b64_tr_b16 a[214:215], v9 offset:28672
    v_mfma_f32_16x16x32_bf16 v[36:39], a[176:179], v[176:179], v[76:79]
    ds_read_b64_tr_b16 a[216:217], v10 offset:24576
    v_mfma_f32_16x16x32_bf16 v[36:39], a[180:183], v[180:183], v[36:39]
    ds_read_b64_tr_b16 a[218:219], v10 offset:28672
    v_mfma_f32_16x16x32_bf16 v[36:39], a[184:187], v[184:187], v[36:39]
    ds_read_b64_tr_b16 a[220:221], v11 offset:24576
    v_mfma_f32_16x16x32_bf16 v[36:39], a[188:191], v[188:191], v[36:39]
    ds_read_b64_tr_b16 a[222:223], v11 offset:28672
    v_mfma_f32_16x16x32_bf16 v[40:43], a[160:163], v[192:195], v[80:83]
    v_exp_f32 v32, v32
    v_mfma_f32_16x16x32_bf16 v[40:43], a[164:167], v[196:199], v[40:43]
    v_exp_f32 v33, v33
    v_mfma_f32_16x16x32_bf16 v[40:43], a[168:171], v[200:203], v[40:43]
    v_exp_f32 v34, v34
    v_mfma_f32_16x16x32_bf16 v[40:43], a[172:175], v[204:207], v[40:43]
    v_exp_f32 v35, v35
    v_mfma_f32_16x16x32_bf16 v[44:47], a[176:179], v[192:195], v[80:83]
    v_cvt_pk_bf16_f32 v96, v32, v33
    v_cvt_pk_bf16_f32 v97, v34, v35
    v_mfma_f32_16x16x32_bf16 v[44:47], a[180:183], v[196:199], v[44:47]
    v_exp_f32 v36, v36
    v_mfma_f32_16x16x32_bf16 v[44:47], a[184:187], v[200:203], v[44:47]
    v_exp_f32 v37, v37
    v_mfma_f32_16x16x32_bf16 v[44:47], a[188:191], v[204:207], v[44:47]
    v_exp_f32 v38, v38
    v_mfma_f32_16x16x32_bf16 v[48:51], a[160:163], v[208:211], v[84:87]
    v_exp_f32 v39, v39
    v_mfma_f32_16x16x32_bf16 v[48:51], a[164:167], v[212:215], v[48:51]
    v_cvt_pk_bf16_f32 v98, v36, v37
    v_cvt_pk_bf16_f32 v99, v38, v39
    v_mfma_f32_16x16x32_bf16 v[48:51], a[168:171], v[216:219], v[48:51]
    v_exp_f32 v40, v40
    v_mfma_f32_16x16x32_bf16 v[48:51], a[172:175], v[220:223], v[48:51]
    v_exp_f32 v41, v41
    v_mfma_f32_16x16x32_bf16 v[52:55], a[176:179], v[208:211], v[84:87]
    v_exp_f32 v42, v42
    v_mfma_f32_16x16x32_bf16 v[52:55], a[180:183], v[212:215], v[52:55]
    v_exp_f32 v43, v43
    v_mfma_f32_16x16x32_bf16 v[52:55], a[184:187], v[216:219], v[52:55]
    v_exp_f32 v44, v44
    v_mfma_f32_16x16x32_bf16 v[52:55], a[188:191], v[220:223], v[52:55]
    v_exp_f32 v45, v45
    v_mfma_f32_16x16x32_bf16 v[32:35], a[160:163], v[224:227], v[88:91]
    v_exp_f32 v46, v46
    v_mfma_f32_16x16x32_bf16 v[32:35], a[164:167], v[228:231], v[32:35]
    v_exp_f32 v47, v47
    v_mfma_f32_16x16x32_bf16 v[32:35], a[168:171], v[232:235], v[32:35]
    v_cvt_pk_bf16_f32 v100, v40, v41
    v_cvt_pk_bf16_f32 v101, v42, v43
    v_mfma_f32_16x16x32_bf16 v[32:35], a[172:175], v[236:239], v[32:35]
    v_cvt_pk_bf16_f32 v102, v44, v45
    v_cvt_pk_bf16_f32 v103, v46, v47
    v_mfma_f32_16x16x32_bf16 v[36:39], a[176:179], v[224:227], v[88:91]
    v_exp_f32 v48, v48
    v_mfma_f32_16x16x32_bf16 v[36:39], a[180:183], v[228:231], v[36:39]
    v_exp_f32 v49, v49
    v_mfma_f32_16x16x32_bf16 v[36:39], a[184:187], v[232:235], v[36:39]
    v_exp_f32 v50, v50
    v_mfma_f32_16x16x32_bf16 v[36:39], a[188:191], v[236:239], v[36:39]
    s_waitcnt vmcnt(32) lgkmcnt(0)
    s_barrier
    v_mfma_f32_16x16x32_bf16 a[16:19], a[236:239], v[56:59], a[16:19]
    s_mov_b32 m0, 16384
    s_add_u32 s0, s0, 0x2000
    buffer_load_dwordx4 v16, s[12:15], s30 offen offset:0 nt lds
    v_mfma_f32_16x16x32_bf16 a[16:19], a[192:195], v[96:99], a[16:19]
    v_exp_f32 v51, v51
    v_mfma_f32_16x16x32_bf16 a[20:23], a[240:243], v[56:59], a[20:23]
    buffer_load_dwordx4 v17, s[12:15], s30 offen offset:1024 nt lds
    v_cvt_pk_bf16_f32 v104, v48, v49
    v_mfma_f32_16x16x32_bf16 a[20:23], a[196:199], v[96:99], a[20:23]
    v_exp_f32 v52, v52
    v_mfma_f32_16x16x32_bf16 a[24:27], a[248:251], v[56:59], a[24:27]
    buffer_load_dwordx4 v18, s[12:15], s30 offen offset:2048 nt lds
    v_cvt_pk_bf16_f32 v105, v50, v51
    v_mfma_f32_16x16x32_bf16 a[24:27], a[200:203], v[96:99], a[24:27]
    v_exp_f32 v53, v53
    v_mfma_f32_16x16x32_bf16 a[28:31], a[252:255], v[56:59], a[28:31]
    buffer_load_dwordx4 v19, s[12:15], s30 offen offset:3072 nt lds
    v_cvt_pk_bf16_f32 v106, v52, v53
    v_mfma_f32_16x16x32_bf16 a[28:31], a[204:207], v[96:99], a[28:31]
    v_exp_f32 v54, v54
    v_mfma_f32_16x16x32_bf16 a[48:51], a[236:239], v[60:63], a[48:51]
    s_mov_b32 m0, 20480
    s_add_u32 s49, s30, s52
    buffer_load_dwordx4 v16, s[12:15], s49 offen offset:0 nt lds
    v_mfma_f32_16x16x32_bf16 a[48:51], a[192:195], v[100:103], a[48:51]
    v_exp_f32 v55, v55
    v_mfma_f32_16x16x32_bf16 a[52:55], a[240:243], v[60:63], a[52:55]
    buffer_load_dwordx4 v17, s[12:15], s49 offen offset:1024 nt lds
    v_cvt_pk_bf16_f32 v107, v54, v55
    v_mfma_f32_16x16x32_bf16 a[52:55], a[196:199], v[100:103], a[52:55]
    v_exp_f32 v32, v32
    v_mfma_f32_16x16x32_bf16 a[56:59], a[248:251], v[60:63], a[56:59]
    buffer_load_dwordx4 v18, s[12:15], s49 offen offset:2048 nt lds
    ds_read_b128 a[160:163], v4 offset:32768
    v_mfma_f32_16x16x32_bf16 a[56:59], a[200:203], v[100:103], a[56:59]
    v_exp_f32 v33, v33
    v_mfma_f32_16x16x32_bf16 a[60:63], a[252:255], v[60:63], a[60:63]
    buffer_load_dwordx4 v19, s[12:15], s49 offen offset:3072 nt lds
    v_cvt_pk_bf16_f32 v108, v32, v33
    v_mfma_f32_16x16x32_bf16 a[60:63], a[204:207], v[100:103], a[60:63]
    v_exp_f32 v34, v34
    v_smfmac_f32_16x16x64_bf16 a[224:227], a[244:247], v[96:103], v74
    ds_read_b128 a[164:167], v5 offset:32768
    v_mfma_f32_16x16x32_bf16 a[80:83], a[236:239], v[64:67], a[80:83]
    s_mov_b32 m0, 24576
    s_add_u32 s49, s30, s53
    buffer_load_dwordx4 v20, s[16:19], s49 offen offset:0 nt lds
    v_mfma_f32_16x16x32_bf16 a[80:83], a[192:195], v[104:107], a[80:83]
    buffer_load_dwordx4 v21, s[16:19], s49 offen offset:1024 nt lds
    ds_read_b128 a[168:171], v6 offset:32768
    v_mfma_f32_16x16x32_bf16 a[84:87], a[240:243], v[64:67], a[84:87]
    v_exp_f32 v35, v35
    v_mfma_f32_16x16x32_bf16 a[84:87], a[196:199], v[104:107], a[84:87]
    buffer_load_dwordx4 v22, s[16:19], s49 offen offset:2048 nt lds
    v_cvt_pk_bf16_f32 v109, v34, v35
    v_mfma_f32_16x16x32_bf16 a[88:91], a[248:251], v[64:67], a[88:91]
    v_exp_f32 v36, v36
    v_mfma_f32_16x16x32_bf16 a[88:91], a[200:203], v[104:107], a[88:91]
    v_exp_f32 v37, v37
    v_exp_f32 v38, v38
    v_exp_f32 v39, v39
    v_mfma_f32_16x16x32_bf16 a[92:95], a[252:255], v[64:67], a[92:95]
    buffer_load_dwordx4 v23, s[16:19], s49 offen offset:3072 nt lds
    v_cvt_pk_bf16_f32 v110, v36, v37
    v_cvt_pk_bf16_f32 v111, v38, v39
    v_mfma_f32_16x16x32_bf16 a[92:95], a[204:207], v[104:107], a[92:95]
    ds_read_b128 a[172:175], v7 offset:32768
    ds_read_b128 a[176:179], v4 offset:36864
    v_mfma_f32_16x16x32_bf16 a[112:115], a[236:239], v[68:71], a[112:115]
    ds_read_b128 a[180:183], v5 offset:36864
    ds_read_b128 a[184:187], v6 offset:36864
    ds_read_b128 a[188:191], v7 offset:36864
    s_mov_b32 m0, 28672
    s_add_u32 s49, s30, s54
    buffer_load_dwordx4 v20, s[16:19], s49 offen offset:0 nt lds
    v_mfma_f32_16x16x32_bf16 a[112:115], a[192:195], v[108:111], a[112:115]
    ds_read_b64_tr_b16 a[192:193], v8 offset:40960
    buffer_load_dwordx4 v21, s[16:19], s49 offen offset:1024 nt lds
    v_mfma_f32_16x16x32_bf16 a[116:119], a[240:243], v[68:71], a[116:119]
    ds_read_b64_tr_b16 a[194:195], v8 offset:45056
    v_mfma_f32_16x16x32_bf16 a[116:119], a[196:199], v[108:111], a[116:119]
    ds_read_b64_tr_b16 a[196:197], v9 offset:40960
    buffer_load_dwordx4 v22, s[16:19], s49 offen offset:2048 nt lds
    v_mfma_f32_16x16x32_bf16 a[120:123], a[248:251], v[68:71], a[120:123]
    ds_read_b64_tr_b16 a[198:199], v9 offset:45056
    v_mfma_f32_16x16x32_bf16 a[120:123], a[200:203], v[108:111], a[120:123]
    ds_read_b64_tr_b16 a[200:201], v10 offset:40960
    buffer_load_dwordx4 v23, s[16:19], s49 offen offset:3072 nt lds
    v_mfma_f32_16x16x32_bf16 a[124:127], a[252:255], v[68:71], a[124:127]
    ds_read_b64_tr_b16 a[202:203], v10 offset:45056
    v_mfma_f32_16x16x32_bf16 a[124:127], a[204:207], v[108:111], a[124:127]
    ds_read_b64_tr_b16 a[204:205], v11 offset:40960
    v_smfmac_f32_16x16x64_bf16 a[228:231], a[244:247], v[104:111], v74
    ds_read_b64_tr_b16 a[206:207], v11 offset:45056
    s_add_u32 s49, s0, s1
    s_and_b32 s49, s49, s45
    s_and_b32 s30, s0, s44
    s_or_b32 s30, s30, s49
    s_waitcnt lgkmcnt(8)
    v_mfma_f32_16x16x32_bf16 v[32:35], a[160:163], v[176:179], v[76:79]
    ds_read_b64_tr_b16 a[236:237], v12 offset:40960
    v_mfma_f32_16x16x32_bf16 v[32:35], a[164:167], v[180:183], v[32:35]
    ds_read_b64_tr_b16 a[238:239], v12 offset:45056
    v_mfma_f32_16x16x32_bf16 v[32:35], a[168:171], v[184:187], v[32:35]
    ds_read_b64_tr_b16 a[240:241], v13 offset:40960
    v_mfma_f32_16x16x32_bf16 v[32:35], a[172:175], v[188:191], v[32:35]
    ds_read_b64_tr_b16 a[242:243], v13 offset:45056
    v_mfma_f32_16x16x32_bf16 v[36:39], a[176:179], v[176:179], v[76:79]
    ds_read_b64_tr_b16 a[248:249], v14 offset:40960
    v_mfma_f32_16x16x32_bf16 v[36:39], a[180:183], v[180:183], v[36:39]
    ds_read_b64_tr_b16 a[250:251], v14 offset:45056
    v_mfma_f32_16x16x32_bf16 v[36:39], a[184:187], v[184:187], v[36:39]
    ds_read_b64_tr_b16 a[252:253], v15 offset:40960
    v_mfma_f32_16x16x32_bf16 v[36:39], a[188:191], v[188:191], v[36:39]
    ds_read_b64_tr_b16 a[254:255], v15 offset:45056
    v_mfma_f32_16x16x32_bf16 v[40:43], a[160:163], v[192:195], v[80:83]
    v_exp_f32 v32, v32
    v_mfma_f32_16x16x32_bf16 v[40:43], a[164:167], v[196:199], v[40:43]
    v_exp_f32 v33, v33
    v_mfma_f32_16x16x32_bf16 v[40:43], a[168:171], v[200:203], v[40:43]
    v_exp_f32 v34, v34
    v_mfma_f32_16x16x32_bf16 v[40:43], a[172:175], v[204:207], v[40:43]
    v_exp_f32 v35, v35
    v_mfma_f32_16x16x32_bf16 v[44:47], a[176:179], v[192:195], v[80:83]
    v_cvt_pk_bf16_f32 v56, v32, v33
    v_cvt_pk_bf16_f32 v57, v34, v35
    v_mfma_f32_16x16x32_bf16 v[44:47], a[180:183], v[196:199], v[44:47]
    v_exp_f32 v36, v36
    v_mfma_f32_16x16x32_bf16 v[44:47], a[184:187], v[200:203], v[44:47]
    v_exp_f32 v37, v37
    v_mfma_f32_16x16x32_bf16 v[44:47], a[188:191], v[204:207], v[44:47]
    v_exp_f32 v38, v38
    v_mfma_f32_16x16x32_bf16 v[48:51], a[160:163], v[208:211], v[84:87]
    v_exp_f32 v39, v39
    v_mfma_f32_16x16x32_bf16 v[48:51], a[164:167], v[212:215], v[48:51]
    v_cvt_pk_bf16_f32 v58, v36, v37
    v_cvt_pk_bf16_f32 v59, v38, v39
    v_mfma_f32_16x16x32_bf16 v[48:51], a[168:171], v[216:219], v[48:51]
    v_exp_f32 v40, v40
    v_mfma_f32_16x16x32_bf16 v[48:51], a[172:175], v[220:223], v[48:51]
    v_exp_f32 v41, v41
    v_mfma_f32_16x16x32_bf16 v[52:55], a[176:179], v[208:211], v[84:87]
    v_exp_f32 v42, v42
    v_mfma_f32_16x16x32_bf16 v[52:55], a[180:183], v[212:215], v[52:55]
    v_exp_f32 v43, v43
    v_mfma_f32_16x16x32_bf16 v[52:55], a[184:187], v[216:219], v[52:55]
    v_exp_f32 v44, v44
    v_mfma_f32_16x16x32_bf16 v[52:55], a[188:191], v[220:223], v[52:55]
    v_exp_f32 v45, v45
    v_mfma_f32_16x16x32_bf16 v[32:35], a[160:163], v[224:227], v[88:91]
    v_exp_f32 v46, v46
    v_mfma_f32_16x16x32_bf16 v[32:35], a[164:167], v[228:231], v[32:35]
    v_exp_f32 v47, v47
    v_mfma_f32_16x16x32_bf16 v[32:35], a[168:171], v[232:235], v[32:35]
    v_cvt_pk_bf16_f32 v60, v40, v41
    v_cvt_pk_bf16_f32 v61, v42, v43
    v_mfma_f32_16x16x32_bf16 v[32:35], a[172:175], v[236:239], v[32:35]
    v_cvt_pk_bf16_f32 v62, v44, v45
    v_cvt_pk_bf16_f32 v63, v46, v47
    v_mfma_f32_16x16x32_bf16 v[36:39], a[176:179], v[224:227], v[88:91]
    v_exp_f32 v48, v48
    v_mfma_f32_16x16x32_bf16 v[36:39], a[180:183], v[228:231], v[36:39]
    v_exp_f32 v49, v49
    v_mfma_f32_16x16x32_bf16 v[36:39], a[184:187], v[232:235], v[36:39]
    v_exp_f32 v50, v50
    v_mfma_f32_16x16x32_bf16 v[36:39], a[188:191], v[236:239], v[36:39]
    s_waitcnt vmcnt(32) lgkmcnt(0)
    s_barrier
    v_mfma_f32_16x16x32_bf16 a[0:3], a[208:211], v[96:99], a[0:3]
    s_mov_b32 m0, 32768
    s_add_u32 s0, s0, 0x2000
    buffer_load_dwordx4 v16, s[12:15], s30 offen offset:0 nt lds
    v_mfma_f32_16x16x32_bf16 a[0:3], a[192:195], v[56:59], a[0:3]
    v_exp_f32 v51, v51
    v_mfma_f32_16x16x32_bf16 a[4:7], a[212:215], v[96:99], a[4:7]
    buffer_load_dwordx4 v17, s[12:15], s30 offen offset:1024 nt lds
    v_cvt_pk_bf16_f32 v64, v48, v49
    v_mfma_f32_16x16x32_bf16 a[4:7], a[196:199], v[56:59], a[4:7]
    v_exp_f32 v52, v52
    v_mfma_f32_16x16x32_bf16 a[8:11], a[216:219], v[96:99], a[8:11]
    buffer_load_dwordx4 v18, s[12:15], s30 offen offset:2048 nt lds
    v_cvt_pk_bf16_f32 v65, v50, v51
    v_mfma_f32_16x16x32_bf16 a[8:11], a[200:203], v[56:59], a[8:11]
    v_exp_f32 v53, v53
    v_mfma_f32_16x16x32_bf16 a[12:15], a[220:223], v[96:99], a[12:15]
    buffer_load_dwordx4 v19, s[12:15], s30 offen offset:3072 nt lds
    v_cvt_pk_bf16_f32 v66, v52, v53
    v_mfma_f32_16x16x32_bf16 a[12:15], a[204:207], v[56:59], a[12:15]
    v_exp_f32 v54, v54
    v_mfma_f32_16x16x32_bf16 a[32:35], a[208:211], v[100:103], a[32:35]
    s_mov_b32 m0, 36864
    s_add_u32 s49, s30, s52
    buffer_load_dwordx4 v16, s[12:15], s49 offen offset:0 nt lds
    v_mfma_f32_16x16x32_bf16 a[32:35], a[192:195], v[60:63], a[32:35]
    v_exp_f32 v55, v55
    v_mfma_f32_16x16x32_bf16 a[36:39], a[212:215], v[100:103], a[36:39]
    buffer_load_dwordx4 v17, s[12:15], s49 offen offset:1024 nt lds
    v_cvt_pk_bf16_f32 v67, v54, v55
    v_mfma_f32_16x16x32_bf16 a[36:39], a[196:199], v[60:63], a[36:39]
    v_exp_f32 v32, v32
    v_mfma_f32_16x16x32_bf16 a[40:43], a[216:219], v[100:103], a[40:43]
    buffer_load_dwordx4 v18, s[12:15], s49 offen offset:2048 nt lds
    ds_read_b128 a[160:163], v4 offset:49152
    v_mfma_f32_16x16x32_bf16 a[40:43], a[200:203], v[60:63], a[40:43]
    v_exp_f32 v33, v33
    v_mfma_f32_16x16x32_bf16 a[44:47], a[220:223], v[100:103], a[44:47]
    buffer_load_dwordx4 v19, s[12:15], s49 offen offset:3072 nt lds
    v_cvt_pk_bf16_f32 v68, v32, v33
    v_mfma_f32_16x16x32_bf16 a[44:47], a[204:207], v[60:63], a[44:47]
    v_exp_f32 v34, v34
    v_smfmac_f32_16x16x64_bf16 a[224:227], a[244:247], v[56:63], v74
    ds_read_b128 a[164:167], v5 offset:49152
    v_mfma_f32_16x16x32_bf16 a[64:67], a[208:211], v[104:107], a[64:67]
    s_mov_b32 m0, 40960
    s_add_u32 s49, s30, s53
    buffer_load_dwordx4 v20, s[16:19], s49 offen offset:0 nt lds
    v_mfma_f32_16x16x32_bf16 a[64:67], a[192:195], v[64:67], a[64:67]
    buffer_load_dwordx4 v21, s[16:19], s49 offen offset:1024 nt lds
    ds_read_b128 a[168:171], v6 offset:49152
    v_mfma_f32_16x16x32_bf16 a[68:71], a[212:215], v[104:107], a[68:71]
    v_exp_f32 v35, v35
    v_mfma_f32_16x16x32_bf16 a[68:71], a[196:199], v[64:67], a[68:71]
    buffer_load_dwordx4 v22, s[16:19], s49 offen offset:2048 nt lds
    v_cvt_pk_bf16_f32 v69, v34, v35
    v_mfma_f32_16x16x32_bf16 a[72:75], a[216:219], v[104:107], a[72:75]
    v_exp_f32 v36, v36
    v_mfma_f32_16x16x32_bf16 a[72:75], a[200:203], v[64:67], a[72:75]
    v_exp_f32 v37, v37
    v_exp_f32 v38, v38
    v_exp_f32 v39, v39
    v_mfma_f32_16x16x32_bf16 a[76:79], a[220:223], v[104:107], a[76:79]
    buffer_load_dwordx4 v23, s[16:19], s49 offen offset:3072 nt lds
    v_cvt_pk_bf16_f32 v70, v36, v37
    v_cvt_pk_bf16_f32 v71, v38, v39
    v_mfma_f32_16x16x32_bf16 a[76:79], a[204:207], v[64:67], a[76:79]
    ds_read_b128 a[172:175], v7 offset:49152
    ds_read_b128 a[176:179], v4 offset:53248
    v_mfma_f32_16x16x32_bf16 a[96:99], a[208:211], v[108:111], a[96:99]
    ds_read_b128 a[180:183], v5 offset:53248
    ds_read_b128 a[184:187], v6 offset:53248
    ds_read_b128 a[188:191], v7 offset:53248
    s_mov_b32 m0, 45056
    s_add_u32 s49, s30, s54
    buffer_load_dwordx4 v20, s[16:19], s49 offen offset:0 nt lds
    v_mfma_f32_16x16x32_bf16 a[96:99], a[192:195], v[68:71], a[96:99]
    ds_read_b64_tr_b16 a[192:193], v12 offset:57344
    buffer_load_dwordx4 v21, s[16:19], s49 offen offset:1024 nt lds
    v_mfma_f32_16x16x32_bf16 a[100:103], a[212:215], v[108:111], a[100:103]
    ds_read_b64_tr_b16 a[194:195], v12 offset:61440
    v_mfma_f32_16x16x32_bf16 a[100:103], a[196:199], v[68:71], a[100:103]
    ds_read_b64_tr_b16 a[196:197], v13 offset:57344
    buffer_load_dwordx4 v22, s[16:19], s49 offen offset:2048 nt lds
    v_mfma_f32_16x16x32_bf16 a[104:107], a[216:219], v[108:111], a[104:107]
    ds_read_b64_tr_b16 a[198:199], v13 offset:61440
    v_mfma_f32_16x16x32_bf16 a[104:107], a[200:203], v[68:71], a[104:107]
    ds_read_b64_tr_b16 a[200:201], v14 offset:57344
    buffer_load_dwordx4 v23, s[16:19], s49 offen offset:3072 nt lds
    v_mfma_f32_16x16x32_bf16 a[108:111], a[220:223], v[108:111], a[108:111]
    ds_read_b64_tr_b16 a[202:203], v14 offset:61440
    v_mfma_f32_16x16x32_bf16 a[108:111], a[204:207], v[68:71], a[108:111]
    ds_read_b64_tr_b16 a[204:205], v15 offset:57344
    v_smfmac_f32_16x16x64_bf16 a[228:231], a[244:247], v[64:71], v74
    ds_read_b64_tr_b16 a[206:207], v15 offset:61440
    s_add_u32 s49, s0, s1
    s_and_b32 s49, s49, s45
    s_and_b32 s30, s0, s44
    s_or_b32 s30, s30, s49
    s_cmp_eq_u32 s35, s27
    s_cbranch_scc1 L_ev4
L_evr4:
    s_waitcnt lgkmcnt(8)
    v_mfma_f32_16x16x32_bf16 v[32:35], a[160:163], v[176:179], v[76:79]
    ds_read_b64_tr_b16 a[208:209], v8 offset:57344
    v_mfma_f32_16x16x32_bf16 v[32:35], a[164:167], v[180:183], v[32:35]
    ds_read_b64_tr_b16 a[210:211], v8 offset:61440
    v_mfma_f32_16x16x32_bf16 v[32:35], a[168:171], v[184:187], v[32:35]
    ds_read_b64_tr_b16 a[212:213], v9 offset:57344
    v_mfma_f32_16x16x32_bf16 v[32:35], a[172:175], v[188:191], v[32:35]
    ds_read_b64_tr_b16 a[214:215], v9 offset:61440
    v_mfma_f32_16x16x32_bf16 v[36:39], a[176:179], v[176:179], v[76:79]
    ds_read_b64_tr_b16 a[216:217], v10 offset:57344
    v_mfma_f32_16x16x32_bf16 v[36:39], a[180:183], v[180:183], v[36:39]
    ds_read_b64_tr_b16 a[218:219], v10 offset:61440
    v_mfma_f32_16x16x32_bf16 v[36:39], a[184:187], v[184:187], v[36:39]
    ds_read_b64_tr_b16 a[220:221], v11 offset:57344
    v_mfma_f32_16x16x32_bf16 v[36:39], a[188:191], v[188:191], v[36:39]
    ds_read_b64_tr_b16 a[222:223], v11 offset:61440
    v_mfma_f32_16x16x32_bf16 v[40:43], a[160:163], v[192:195], v[80:83]
    v_exp_f32 v32, v32
    v_mfma_f32_16x16x32_bf16 v[40:43], a[164:167], v[196:199], v[40:43]
    v_exp_f32 v33, v33
    v_mfma_f32_16x16x32_bf16 v[40:43], a[168:171], v[200:203], v[40:43]
    v_exp_f32 v34, v34
    v_mfma_f32_16x16x32_bf16 v[40:43], a[172:175], v[204:207], v[40:43]
    v_exp_f32 v35, v35
    v_mfma_f32_16x16x32_bf16 v[44:47], a[176:179], v[192:195], v[80:83]
    v_cvt_pk_bf16_f32 v96, v32, v33
    v_cvt_pk_bf16_f32 v97, v34, v35
    v_mfma_f32_16x16x32_bf16 v[44:47], a[180:183], v[196:199], v[44:47]
    v_exp_f32 v36, v36
    v_mfma_f32_16x16x32_bf16 v[44:47], a[184:187], v[200:203], v[44:47]
    v_exp_f32 v37, v37
    v_mfma_f32_16x16x32_bf16 v[44:47], a[188:191], v[204:207], v[44:47]
    v_exp_f32 v38, v38
    v_mfma_f32_16x16x32_bf16 v[48:51], a[160:163], v[208:211], v[84:87]
    v_exp_f32 v39, v39
    v_mfma_f32_16x16x32_bf16 v[48:51], a[164:167], v[212:215], v[48:51]
    v_cvt_pk_bf16_f32 v98, v36, v37
    v_cvt_pk_bf16_f32 v99, v38, v39
    v_mfma_f32_16x16x32_bf16 v[48:51], a[168:171], v[216:219], v[48:51]
    v_exp_f32 v40, v40
    v_mfma_f32_16x16x32_bf16 v[48:51], a[172:175], v[220:223], v[48:51]
    v_exp_f32 v41, v41
    v_mfma_f32_16x16x32_bf16 v[52:55], a[176:179], v[208:211], v[84:87]
    v_exp_f32 v42, v42
    v_mfma_f32_16x16x32_bf16 v[52:55], a[180:183], v[212:215], v[52:55]
    v_exp_f32 v43, v43
    v_mfma_f32_16x16x32_bf16 v[52:55], a[184:187], v[216:219], v[52:55]
    v_exp_f32 v44, v44
    v_mfma_f32_16x16x32_bf16 v[52:55], a[188:191], v[220:223], v[52:55]
    v_exp_f32 v45, v45
    v_mfma_f32_16x16x32_bf16 v[32:35], a[160:163], v[224:227], v[88:91]
    v_exp_f32 v46, v46
    v_mfma_f32_16x16x32_bf16 v[32:35], a[164:167], v[228:231], v[32:35]
    v_exp_f32 v47, v47
    v_mfma_f32_16x16x32_bf16 v[32:35], a[168:171], v[232:235], v[32:35]
    v_cvt_pk_bf16_f32 v100, v40, v41
    v_cvt_pk_bf16_f32 v101, v42, v43
    v_mfma_f32_16x16x32_bf16 v[32:35], a[172:175], v[236:239], v[32:35]
    v_cvt_pk_bf16_f32 v102, v44, v45
    v_cvt_pk_bf16_f32 v103, v46, v47
    v_mfma_f32_16x16x32_bf16 v[36:39], a[176:179], v[224:227], v[88:91]
    v_exp_f32 v48, v48
    v_mfma_f32_16x16x32_bf16 v[36:39], a[180:183], v[228:231], v[36:39]
    v_exp_f32 v49, v49
    v_mfma_f32_16x16x32_bf16 v[36:39], a[184:187], v[232:235], v[36:39]
    v_exp_f32 v50, v50
    v_mfma_f32_16x16x32_bf16 v[36:39], a[188:191], v[236:239], v[36:39]
    s_waitcnt vmcnt(32) lgkmcnt(0)
    s_barrier
    v_mfma_f32_16x16x32_bf16 a[16:19], a[236:239], v[56:59], a[16:19]
    s_mov_b32 m0, 49152
    s_add_u32 s0, s0, 0x2000
    buffer_load_dwordx4 v16, s[12:15], s30 offen offset:0 nt lds
    v_mfma_f32_16x16x32_bf16 a[16:19], a[192:195], v[96:99], a[16:19]
    v_exp_f32 v51, v51
    v_mfma_f32_16x16x32_bf16 a[20:23], a[240:243], v[56:59], a[20:23]
    buffer_load_dwordx4 v17, s[12:15], s30 offen offset:1024 nt lds
    v_cvt_pk_bf16_f32 v104, v48, v49
    v_mfma_f32_16x16x32_bf16 a[20:23], a[196:199], v[96:99], a[20:23]
    v_exp_f32 v52, v52
    v_mfma_f32_16x16x32_bf16 a[24:27], a[248:251], v[56:59], a[24:27]
    buffer_load_dwordx4 v18, s[12:15], s30 offen offset:2048 nt lds
    v_cvt_pk_bf16_f32 v105, v50, v51
    v_mfma_f32_16x16x32_bf16 a[24:27], a[200:203], v[96:99], a[24:27]
    v_exp_f32 v53, v53
    v_mfma_f32_16x16x32_bf16 a[28:31], a[252:255], v[56:59], a[28:31]
    buffer_load_dwordx4 v19, s[12:15], s30 offen offset:3072 nt lds
    v_cvt_pk_bf16_f32 v106, v52, v53
    v_mfma_f32_16x16x32_bf16 a[28:31], a[204:207], v[96:99], a[28:31]
    v_exp_f32 v54, v54
    v_mfma_f32_16x16x32_bf16 a[48:51], a[236:239], v[60:63], a[48:51]
    s_mov_b32 m0, 53248
    s_add_u32 s49, s30, s52
    buffer_load_dwordx4 v16, s[12:15], s49 offen offset:0 nt lds
    v_mfma_f32_16x16x32_bf16 a[48:51], a[192:195], v[100:103], a[48:51]
    v_exp_f32 v55, v55
    v_mfma_f32_16x16x32_bf16 a[52:55], a[240:243], v[60:63], a[52:55]
    buffer_load_dwordx4 v17, s[12:15], s49 offen offset:1024 nt lds
    v_cvt_pk_bf16_f32 v107, v54, v55
    v_mfma_f32_16x16x32_bf16 a[52:55], a[196:199], v[100:103], a[52:55]
    v_exp_f32 v32, v32
    v_mfma_f32_16x16x32_bf16 a[56:59], a[248:251], v[60:63], a[56:59]
    buffer_load_dwordx4 v18, s[12:15], s49 offen offset:2048 nt lds
    ds_read_b128 a[160:163], v4 offset:0
    v_mfma_f32_16x16x32_bf16 a[56:59], a[200:203], v[100:103], a[56:59]
    v_exp_f32 v33, v33
    v_mfma_f32_16x16x32_bf16 a[60:63], a[252:255], v[60:63], a[60:63]
    buffer_load_dwordx4 v19, s[12:15], s49 offen offset:3072 nt lds
    v_cvt_pk_bf16_f32 v108, v32, v33
    v_mfma_f32_16x16x32_bf16 a[60:63], a[204:207], v[100:103], a[60:63]
    v_exp_f32 v34, v34
    v_smfmac_f32_16x16x64_bf16 a[224:227], a[244:247], v[96:103], v74
    ds_read_b128 a[164:167], v5 offset:0
    v_mfma_f32_16x16x32_bf16 a[80:83], a[236:239], v[64:67], a[80:83]
    s_mov_b32 m0, 57344
    s_add_u32 s49, s30, s53
    buffer_load_dwordx4 v20, s[16:19], s49 offen offset:0 nt lds
    v_mfma_f32_16x16x32_bf16 a[80:83], a[192:195], v[104:107], a[80:83]
    buffer_load_dwordx4 v21, s[16:19], s49 offen offset:1024 nt lds
    ds_read_b128 a[168:171], v6 offset:0
    v_mfma_f32_16x16x32_bf16 a[84:87], a[240:243], v[64:67], a[84:87]
    v_exp_f32 v35, v35
    v_mfma_f32_16x16x32_bf16 a[84:87], a[196:199], v[104:107], a[84:87]
    buffer_load_dwordx4 v22, s[16:19], s49 offen offset:2048 nt lds
    v_cvt_pk_bf16_f32 v109, v34, v35
    v_mfma_f32_16x16x32_bf16 a[88:91], a[248:251], v[64:67], a[88:91]
    v_exp_f32 v36, v36
    v_mfma_f32_16x16x32_bf16 a[88:91], a[200:203], v[104:107], a[88:91]
    v_exp_f32 v37, v37
    v_exp_f32 v38, v38
    v_exp_f32 v39, v39
    v_mfma_f32_16x16x32_bf16 a[92:95], a[252:255], v[64:67], a[92:95]
    buffer_load_dwordx4 v23, s[16:19], s49 offen offset:3072 nt lds
    v_cvt_pk_bf16_f32 v110, v36, v37
    v_cvt_pk_bf16_f32 v111, v38, v39
    v_mfma_f32_16x16x32_bf16 a[92:95], a[204:207], v[104:107], a[92:95]
    ds_read_b128 a[172:175], v7 offset:0
    ds_read_b128 a[176:179], v4 offset:4096
    v_mfma_f32_16x16x32_bf16 a[112:115], a[236:239], v[68:71], a[112:115]
    ds_read_b128 a[180:183], v5 offset:4096
    ds_read_b128 a[184:187], v6 offset:4096
    ds_read_b128 a[188:191], v7 offset:4096
    s_mov_b32 m0, 61440
    s_add_u32 s49, s30, s54
    buffer_load_dwordx4 v20, s[16:19], s49 offen offset:0 nt lds
    v_mfma_f32_16x16x32_bf16 a[112:115], a[192:195], v[108:111], a[112:115]
    ds_read_b64_tr_b16 a[192:193], v8 offset:8192
    buffer_load_dwordx4 v21, s[16:19], s49 offen offset:1024 nt lds
    v_mfma_f32_16x16x32_bf16 a[116:119], a[240:243], v[68:71], a[116:119]
    ds_read_b64_tr_b16 a[194:195], v8 offset:12288
    v_mfma_f32_16x16x32_bf16 a[116:119], a[196:199], v[108:111], a[116:119]
    ds_read_b64_tr_b16 a[196:197], v9 offset:8192
    buffer_load_dwordx4 v22, s[16:19], s49 offen offset:2048 nt lds
    v_mfma_f32_16x16x32_bf16 a[120:123], a[248:251], v[68:71], a[120:123]
    ds_read_b64_tr_b16 a[198:199], v9 offset:12288
    v_mfma_f32_16x16x32_bf16 a[120:123], a[200:203], v[108:111], a[120:123]
    ds_read_b64_tr_b16 a[200:201], v10 offset:8192
    buffer_load_dwordx4 v23, s[16:19], s49 offen offset:3072 nt lds
    v_mfma_f32_16x16x32_bf16 a[124:127], a[252:255], v[68:71], a[124:127]
    ds_read_b64_tr_b16 a[202:203], v10 offset:12288
    v_mfma_f32_16x16x32_bf16 a[124:127], a[204:207], v[108:111], a[124:127]
    ds_read_b64_tr_b16 a[204:205], v11 offset:8192
    v_smfmac_f32_16x16x64_bf16 a[228:231], a[244:247], v[104:111], v74
    ds_read_b64_tr_b16 a[206:207], v11 offset:12288
    s_add_u32 s49, s0, s1
    s_and_b32 s49, s49, s45
    s_and_b32 s30, s0, s44
    s_or_b32 s30, s30, s49
    s_sub_u32 s35, s35, 1
    s_bitcmp1_b32 s26, s35
    s_cbranch_scc1 L_loop4
    s_cmp_gt_u32 s35, 1
    s_cbranch_scc1 L_loopS4
    s_cmp_eq_u32 s35, 0
    s_cbranch_scc1 L_t14
    s_waitcnt lgkmcnt(8)
    v_mfma_f32_16x16x32_bf16 v[32:35], a[160:163], v[176:179], v[76:79]
    ds_read_b64_tr_b16 a[236:237], v12 offset:8192
    v_mfma_f32_16x16x32_bf16 v[32:35], a[164:167], v[180:183], v[32:35]
    ds_read_b64_tr_b16 a[238:239], v12 offset:12288
    v_mfma_f32_16x16x32_bf16 v[32:35], a[168:171], v[184:187], v[32:35]
    ds_read_b64_tr_b16 a[240:241], v13 offset:8192
    v_mfma_f32_16x16x32_bf16 v[32:35], a[172:175], v[188:191], v[32:35]
    ds_read_b64_tr_b16 a[242:243], v13 offset:12288
    v_mfma_f32_16x16x32_bf16 v[36:39], a[176:179], v[176:179], v[76:79]
    ds_read_b64_tr_b16 a[248:249], v14 offset:8192
    v_mfma_f32_16x16x32_bf16 v[36:39], a[180:183], v[180:183], v[36:39]
    ds_read_b64_tr_b16 a[250:251], v14 offset:12288
    v_mfma_f32_16x16x32_bf16 v[36:39], a[184:187], v[184:187], v[36:39]
    ds_read_b64_tr_b16 a[252:253], v15 offset:8192
    v_mfma_f32_16x16x32_bf16 v[36:39], a[188:191], v[188:191], v[36:39]
    ds_read_b64_tr_b16 a[254:255], v15 offset:12288
    v_mfma_f32_16x16x32_bf16 v[40:43], a[160:163], v[192:195], v[80:83]
    v_exp_f32 v32, v32
    v_mfma_f32_16x16x32_bf16 v[40:43], a[164:167], v[196:199], v[40:43]
    v_exp_f32 v33, v33
    v_mfma_f32_16x16x32_bf16 v[40:43], a[168:171], v[200:203], v[40:43]
    v_exp_f32 v34, v34
    v_mfma_f32_16x16x32_bf16 v[40:43], a[172:175], v[204:207], v[40:43]
    v_exp_f32 v35, v35
    v_mfma_f32_16x16x32_bf16 v[44:47], a[176:179], v[192:195], v[80:83]
    v_cvt_pk_bf16_f32 v56, v32, v33
    v_cvt_pk_bf16_f32 v57, v34, v35
    v_mfma_f32_16x16x32_bf16 v[44:47], a[180:183], v[196:199], v[44:47]
    v_exp_f32 v36, v36
    v_mfma_f32_16x16x32_bf16 v[44:47], a[184:187], v[200:203], v[44:47]
    v_exp_f32 v37, v37
    v_mfma_f32_16x16x32_bf16 v[44:47], a[188:191], v[204:207], v[44:47]
    v_exp_f32 v38, v38
    v_mfma_f32_16x16x32_bf16 v[48:51], a[160:163], v[208:211], v[84:87]
    v_exp_f32 v39, v39
    v_mfma_f32_16x16x32_bf16 v[48:51], a[164:167], v[212:215], v[48:51]
    v_cvt_pk_bf16_f32 v58, v36, v37
    v_cvt_pk_bf16_f32 v59, v38, v39
    v_mfma_f32_16x16x32_bf16 v[48:51], a[168:171], v[216:219], v[48:51]
    v_exp_f32 v40, v40
    v_mfma_f32_16x16x32_bf16 v[48:51], a[172:175], v[220:223], v[48:51]
    v_exp_f32 v41, v41
    v_mfma_f32_16x16x32_bf16 v[52:55], a[176:179], v[208:211], v[84:87]
    v_exp_f32 v42, v42
    v_mfma_f32_16x16x32_bf16 v[52:55], a[180:183], v[212:215], v[52:55]
    v_exp_f32 v43, v43
    v_mfma_f32_16x16x32_bf16 v[52:55], a[184:187], v[216:219], v[52:55]
    v_exp_f32 v44, v44
    v_mfma_f32_16x16x32_bf16 v[52:55], a[188:191], v[220:223], v[52:55]
    v_exp_f32 v45, v45
    v_mfma_f32_16x16x32_bf16 v[32:35], a[160:163], v[224:227], v[88:91]
    v_exp_f32 v46, v46
    v_mfma_f32_16x16x32_bf16 v[32:35], a[164:167], v[228:231], v[32:35]
    v_exp_f32 v47, v47
    v_mfma_f32_16x16x32_bf16 v[32:35], a[168:171], v[232:235], v[32:35]
    v_cvt_pk_bf16_f32 v60, v40, v41
    v_cvt_pk_bf16_f32 v61, v42, v43
    v_mfma_f32_16x16x32_bf16 v[32:35], a[172:175], v[236:239], v[32:35]
    v_cvt_pk_bf16_f32 v62, v44, v45
    v_cvt_pk_bf16_f32 v63, v46, v47
    v_mfma_f32_16x16x32_bf16 v[36:39], a[176:179], v[224:227], v[88:91]
    v_exp_f32 v48, v48
    v_mfma_f32_16x16x32_bf16 v[36:39], a[180:183], v[228:231], v[36:39]
    v_exp_f32 v49, v49
    v_mfma_f32_16x16x32_bf16 v[36:39], a[184:187], v[232:235], v[36:39]
    v_exp_f32 v50, v50
    v_mfma_f32_16x16x32_bf16 v[36:39], a[188:191], v[236:239], v[36:39]
    s_waitcnt vmcnt(32) lgkmcnt(0)
    s_barrier
    v_mfma_f32_16x16x32_bf16 a[0:3], a[208:211], v[96:99], a[0:3]
    s_mov_b32 m0, 0
    s_mov_b32 s49, 16384
    buffer_load_dwordx4 v24, s[4:7], s49 offen offset:0 sc1 lds
    v_mfma_f32_16x16x32_bf16 a[0:3], a[192:195], v[56:59], a[0:3]
    v_exp_f32 v51, v51
    v_mfma_f32_16x16x32_bf16 a[4:7], a[212:215], v[96:99], a[4:7]
    buffer_load_dwordx4 v24, s[4:7], s49 offen offset:1024 sc1 lds
    v_cvt_pk_bf16_f32 v64, v48, v49
    v_mfma_f32_16x16x32_bf16 a[4:7], a[196:199], v[56:59], a[4:7]
    v_exp_f32 v52, v52
    v_mfma_f32_16x16x32_bf16 a[8:11], a[216:219], v[96:99], a[8:11]
    buffer_load_dwordx4 v24, s[4:7], s49 offen offset:2048 sc1 lds
    v_cvt_pk_bf16_f32 v65, v50, v51
    v_mfma_f32_16x16x32_bf16 a[8:11], a[200:203], v[56:59], a[8:11]
    v_exp_f32 v53, v53
    v_mfma_f32_16x16x32_bf16 a[12:15], a[220:223], v[96:99], a[12:15]
    buffer_load_dwordx4 v24, s[4:7], s49 offen offset:3072 sc1 lds
    v_cvt_pk_bf16_f32 v66, v52, v53
    v_mfma_f32_16x16x32_bf16 a[12:15], a[204:207], v[56:59], a[12:15]
    v_exp_f32 v54, v54
    v_mfma_f32_16x16x32_bf16 a[32:35], a[208:211], v[100:103], a[32:35]
    s_mov_b32 m0, 4096
    s_mov_b32 s49, 20480
    buffer_load_dwordx4 v24, s[4:7], s49 offen offset:0 sc1 lds
    v_mfma_f32_16x16x32_bf16 a[32:35], a[192:195], v[60:63], a[32:35]
    v_exp_f32 v55, v55
    v_mfma_f32_16x16x32_bf16 a[36:39], a[212:215], v[100:103], a[36:39]
    buffer_load_dwordx4 v24, s[4:7], s49 offen offset:1024 sc1 lds
    v_cvt_pk_bf16_f32 v67, v54, v55
    v_mfma_f32_16x16x32_bf16 a[36:39], a[196:199], v[60:63], a[36:39]
    v_exp_f32 v32, v32
    v_mfma_f32_16x16x32_bf16 a[40:43], a[216:219], v[100:103], a[40:43]
    buffer_load_dwordx4 v24, s[4:7], s49 offen offset:2048 sc1 lds
    ds_read_b128 a[160:163], v4 offset:16384
    v_mfma_f32_16x16x32_bf16 a[40:43], a[200:203], v[60:63], a[40:43]
    v_exp_f32 v33, v33
    v_mfma_f32_16x16x32_bf16 a[44:47], a[220:223], v[100:103], a[44:47]
    buffer_load_dwordx4 v24, s[4:7], s49 offen offset:3072 sc1 lds
    v_cvt_pk_bf16_f32 v68, v32, v33
    v_mfma_f32_16x16x32_bf16 a[44:47], a[204:207], v[60:63], a[44:47]
    v_exp_f32 v34, v34
    v_smfmac_f32_16x16x64_bf16 a[224:227], a[244:247], v[56:63], v74
    ds_read_b128 a[164:167], v5 offset:16384
    v_mfma_f32_16x16x32_bf16 a[64:67], a[208:211], v[104:107], a[64:67]
    s_mov_b32 m0, 8192
    s_mov_b32 s49, 24576
    buffer_load_dwordx4 v24, s[4:7], s49 offen offset:0 sc1 lds
    v_mfma_f32_16x16x32_bf16 a[64:67], a[192:195], v[64:67], a[64:67]
    v_exp_f32 v35, v35
    v_mfma_f32_16x16x32_bf16 a[68:71], a[212:215], v[104:107], a[68:71]
    buffer_load_dwordx4 v24, s[4:7], s49 offen offset:1024 sc1 lds
    v_cvt_pk_bf16_f32 v69, v34, v35
    v_mfma_f32_16x16x32_bf16 a[68:71], a[196:199], v[64:67], a[68:71]
    v_exp_f32 v36, v36
    v_mfma_f32_16x16x32_bf16 a[72:75], a[216:219], v[104:107], a[72:75]
    v_exp_f32 v37, v37
    v_mfma_f32_16x16x32_bf16 a[72:75], a[200:203], v[64:67], a[72:75]
    buffer_load_dwordx4 v24, s[4:7], s49 offen offset:2048 sc1 lds
    v_exp_f32 v38, v38
    v_exp_f32 v39, v39
    v_mfma_f32_16x16x32_bf16 a[76:79], a[220:223], v[104:107], a[76:79]
    v_cvt_pk_bf16_f32 v70, v36, v37
    v_cvt_pk_bf16_f32 v71, v38, v39
    v_mfma_f32_16x16x32_bf16 a[76:79], a[204:207], v[64:67], a[76:79]
    buffer_load_dwordx4 v24, s[4:7], s49 offen offset:3072 sc1 lds
    ds_read_b128 a[168:171], v6 offset:16384
    v_mfma_f32_16x16x32_bf16 a[96:99], a[208:211], v[108:111], a[96:99]
    ds_read_b128 a[172:175], v7 offset:16384
    ds_read_b128 a[176:179], v4 offset:20480
    ds_read_b128 a[180:183], v5 offset:20480
    ds_read_b128 a[184:187], v6 offset:20480
    ds_read_b128 a[188:191], v7 offset:20480
    v_mfma_f32_16x16x32_bf16 a[96:99], a[192:195], v[68:71], a[96:99]
    ds_read_b64_tr_b16 a[192:193], v12 offset:24576
    s_mov_b32 m0, 12288
    s_mov_b32 s49, 28672
    buffer_load_dwordx4 v24, s[4:7], s49 offen offset:0 sc1 lds
    v_mfma_f32_16x16x32_bf16 a[100:103], a[212:215], v[108:111], a[100:103]
    ds_read_b64_tr_b16 a[194:195], v12 offset:28672
    buffer_load_dwordx4 v24, s[4:7], s49 offen offset:1024 sc1 lds
    v_mfma_f32_16x16x32_bf16 a[100:103], a[196:199], v[68:71], a[100:103]
    ds_read_b64_tr_b16 a[196:197], v13 offset:24576
    v_mfma_f32_16x16x32_bf16 a[104:107], a[216:219], v[108:111], a[104:107]
    ds_read_b64_tr_b16 a[198:199], v13 offset:28672
    buffer_load_dwordx4 v24, s[4:7], s49 offen offset:2048 sc1 lds
    v_mfma_f32_16x16x32_bf16 a[104:107], a[200:203], v[68:71], a[104:107]
    ds_read_b64_tr_b16 a[200:201], v14 offset:24576
    v_mfma_f32_16x16x32_bf16 a[108:111], a[220:223], v[108:111], a[108:111]
    ds_read_b64_tr_b16 a[202:203], v14 offset:28672
    buffer_load_dwordx4 v24, s[4:7], s49 offen offset:3072 sc1 lds
    v_mfma_f32_16x16x32_bf16 a[108:111], a[204:207], v[68:71], a[108:111]
    ds_read_b64_tr_b16 a[204:205], v15 offset:24576
    v_smfmac_f32_16x16x64_bf16 a[228:231], a[244:247], v[64:71], v74
    ds_read_b64_tr_b16 a[206:207], v15 offset:28672
    s_waitcnt lgkmcnt(8)
    v_mfma_f32_16x16x32_bf16 v[32:35], a[160:163], v[176:179], v[76:79]
    ds_read_b64_tr_b16 a[208:209], v8 offset:24576
    v_mfma_f32_16x16x32_bf16 v[32:35], a[164:167], v[180:183], v[32:35]
    ds_read_b64_tr_b16 a[210:211], v8 offset:28672
    v_mfma_f32_16x16x32_bf16 v[32:35], a[168:171], v[184:187], v[32:35]
    ds_read_b64_tr_b16 a[212:213], v9 offset:24576
    v_mfma_f32_16x16x32_bf16 v[32:35], a[172:175], v[188:191], v[32:35]
    ds_read_b64_tr_b16 a[214:215], v9 offset:28672
    v_mfma_f32_16x16x32_bf16 v[36:39], a[176:179], v[176:179], v[76:79]
    ds_read_b64_tr_b16 a[216:217], v10 offset:24576
    v_mfma_f32_16x16x32_bf16 v[36:39], a[180:183], v[180:183], v[36:39]
    ds_read_b64_tr_b16 a[218:219], v10 offset:28672
    v_mfma_f32_16x16x32_bf16 v[36:39], a[184:187], v[184:187], v[36:39]
    ds_read_b64_tr_b16 a[220:221], v11 offset:24576
    v_mfma_f32_16x16x32_bf16 v[36:39], a[188:191], v[188:191], v[36:39]
    ds_read_b64_tr_b16 a[222:223], v11 offset:28672
    v_mfma_f32_16x16x32_bf16 v[40:43], a[160:163], v[192:195], v[80:83]
    v_exp_f32 v32, v32
    v_mfma_f32_16x16x32_bf16 v[40:43], a[164:167], v[196:199], v[40:43]
    v_exp_f32 v33, v33
    v_mfma_f32_16x16x32_bf16 v[40:43], a[168:171], v[200:203], v[40:43]
    v_exp_f32 v34, v34
    v_mfma_f32_16x16x32_bf16 v[40:43], a[172:175], v[204:207], v[40:43]
    v_exp_f32 v35, v35
    v_mfma_f32_16x16x32_bf16 v[44:47], a[176:179], v[192:195], v[80:83]
    v_cvt_pk_bf16_f32 v96, v32, v33
    v_cvt_pk_bf16_f32 v97, v34, v35
    v_mfma_f32_16x16x32_bf16 v[44:47], a[180:183], v[196:199], v[44:47]
    v_exp_f32 v36, v36
    v_mfma_f32_16x16x32_bf16 v[44:47], a[184:187], v[200:203], v[44:47]
    v_exp_f32 v37, v37
    v_mfma_f32_16x16x32_bf16 v[44:47], a[188:191], v[204:207], v[44:47]
    v_exp_f32 v38, v38
    v_mfma_f32_16x16x32_bf16 v[48:51], a[160:163], v[208:211], v[84:87]
    v_exp_f32 v39, v39
    v_mfma_f32_16x16x32_bf16 v[48:51], a[164:167], v[212:215], v[48:51]
    v_cvt_pk_bf16_f32 v98, v36, v37
    v_cvt_pk_bf16_f32 v99, v38, v39
    v_mfma_f32_16x16x32_bf16 v[48:51], a[168:171], v[216:219], v[48:51]
    v_exp_f32 v40, v40
    v_mfma_f32_16x16x32_bf16 v[48:51], a[172:175], v[220:223], v[48:51]
    v_exp_f32 v41, v41
    v_mfma_f32_16x16x32_bf16 v[52:55], a[176:179], v[208:211], v[84:87]
    v_exp_f32 v42, v42
    v_mfma_f32_16x16x32_bf16 v[52:55], a[180:183], v[212:215], v[52:55]
    v_exp_f32 v43, v43
    v_mfma_f32_16x16x32_bf16 v[52:55], a[184:187], v[216:219], v[52:55]
    v_exp_f32 v44, v44
    v_mfma_f32_16x16x32_bf16 v[52:55], a[188:191], v[220:223], v[52:55]
    v_exp_f32 v45, v45
    v_mfma_f32_16x16x32_bf16 v[32:35], a[160:163], v[224:227], v[88:91]
    v_exp_f32 v46, v46
    v_mfma_f32_16x16x32_bf16 v[32:35], a[164:167], v[228:231], v[32:35]
    v_exp_f32 v47, v47
    v_mfma_f32_16x16x32_bf16 v[32:35], a[168:171], v[232:235], v[32:35]
    v_cvt_pk_bf16_f32 v100, v40, v41
    v_cvt_pk_bf16_f32 v101, v42, v43
    v_mfma_f32_16x16x32_bf16 v[32:35], a[172:175], v[236:239], v[32:35]
    v_cvt_pk_bf16_f32 v102, v44, v45
    v_cvt_pk_bf16_f32 v103, v46, v47
    v_mfma_f32_16x16x32_bf16 v[36:39], a[176:179], v[224:227], v[88:91]
    v_exp_f32 v48, v48
    v_mfma_f32_16x16x32_bf16 v[36:39], a[180:183], v[228:231], v[36:39]
    v_exp_f32 v49, v49
    v_mfma_f32_16x16x32_bf16 v[36:39], a[184:187], v[232:235], v[36:39]
    v_exp_f32 v50, v50
    v_mfma_f32_16x16x32_bf16 v[36:39], a[188:191], v[236:239], v[36:39]
    s_waitcnt vmcnt(32) lgkmcnt(0)
    s_barrier
    v_mfma_f32_16x16x32_bf16 a[16:19], a[236:239], v[56:59], a[16:19]
    s_mov_b32 m0, 16384
    s_mov_b32 s49, 81920
    buffer_load_dwordx4 v24, s[4:7], s49 offen offset:0 sc1 lds
    v_mfma_f32_16x16x32_bf16 a[16:19], a[192:195], v[96:99], a[16:19]
    v_exp_f32 v51, v51
    v_mfma_f32_16x16x32_bf16 a[20:23], a[240:243], v[56:59], a[20:23]
    buffer_load_dwordx4 v24, s[4:7], s49 offen offset:1024 sc1 lds
    v_cvt_pk_bf16_f32 v104, v48, v49
    v_mfma_f32_16x16x32_bf16 a[20:23], a[196:199], v[96:99], a[20:23]
    v_exp_f32 v52, v52
    v_mfma_f32_16x16x32_bf16 a[24:27], a[248:251], v[56:59], a[24:27]
    buffer_load_dwordx4 v24, s[4:7], s49 offen offset:2048 sc1 lds
    v_cvt_pk_bf16_f32 v105, v50, v51
    v_mfma_f32_16x16x32_bf16 a[24:27], a[200:203], v[96:99], a[24:27]
    v_exp_f32 v53, v53
    v_mfma_f32_16x16x32_bf16 a[28:31], a[252:255], v[56:59], a[28:31]
    buffer_load_dwordx4 v24, s[4:7], s49 offen offset:3072 sc1 lds
    v_cvt_pk_bf16_f32 v106, v52, v53
    v_mfma_f32_16x16x32_bf16 a[28:31], a[204:207], v[96:99], a[28:31]
    v_exp_f32 v54, v54
    v_mfma_f32_16x16x32_bf16 a[48:51], a[236:239], v[60:63], a[48:51]
    s_mov_b32 m0, 20480
    s_mov_b32 s49, 86016
    buffer_load_dwordx4 v24, s[4:7], s49 offen offset:0 sc1 lds
    v_mfma_f32_16x16x32_bf16 a[48:51], a[192:195], v[100:103], a[48:51]
    v_exp_f32 v55, v55
    v_mfma_f32_16x16x32_bf16 a[52:55], a[240:243], v[60:63], a[52:55]
    buffer_load_dwordx4 v24, s[4:7], s49 offen offset:1024 sc1 lds
    v_cvt_pk_bf16_f32 v107, v54, v55
    v_mfma_f32_16x16x32_bf16 a[52:55], a[196:199], v[100:103], a[52:55]
    v_exp_f32 v32, v32
    v_mfma_f32_16x16x32_bf16 a[56:59], a[248:251], v[60:63], a[56:59]
    buffer_load_dwordx4 v24, s[4:7], s49 offen offset:2048 sc1 lds
    ds_read_b128 a[160:163], v4 offset:32768
    v_mfma_f32_16x16x32_bf16 a[56:59], a[200:203], v[100:103], a[56:59]
    v_exp_f32 v33, v33
    v_mfma_f32_16x16x32_bf16 a[60:63], a[252:255], v[60:63], a[60:63]
    buffer_load_dwordx4 v24, s[4:7], s49 offen offset:3072 sc1 lds
    v_cvt_pk_bf16_f32 v108, v32, v33
    v_mfma_f32_16x16x32_bf16 a[60:63], a[204:207], v[100:103], a[60:63]
    v_exp_f32 v34, v34
    v_smfmac_f32_16x16x64_bf16 a[224:227], a[244:247], v[96:103], v74
    ds_read_b128 a[164:167], v5 offset:32768
    v_mfma_f32_16x16x32_bf16 a[80:83], a[236:239], v[64:67], a[80:83]
    s_mov_b32 m0, 24576
    s_mov_b32 s49, 90112
    buffer_load_dwordx4 v24, s[4:7], s49 offen offset:0 sc1 lds
    v_mfma_f32_16x16x32_bf16 a[80:83], a[192:195], v[104:107], a[80:83]
    v_exp_f32 v35, v35
    v_mfma_f32_16x16x32_bf16 a[84:87], a[240:243], v[64:67], a[84:87]
    buffer_load_dwordx4 v24, s[4:7], s49 offen offset:1024 sc1 lds
    v_cvt_pk_bf16_f32 v109, v34, v35
    v_mfma_f32_16x16x32_bf16 a[84:87], a[196:199], v[104:107], a[84:87]
    v_exp_f32 v36, v36
    v_mfma_f32_16x16x32_bf16 a[88:91], a[248:251], v[64:67], a[88:91]
    v_exp_f32 v37, v37
    v_mfma_f32_16x16x32_bf16 a[88:91], a[200:203], v[104:107], a[88:91]
    buffer_load_dwordx4 v24, s[4:7], s49 offen offset:2048 sc1 lds
    v_exp_f32 v38, v38
    v_exp_f32 v39, v39
    v_mfma_f32_16x16x32_bf16 a[92:95], a[252:255], v[64:67], a[92:95]
    v_cvt_pk_bf16_f32 v110, v36, v37
    v_cvt_pk_bf16_f32 v111, v38, v39
    v_mfma_f32_16x16x32_bf16 a[92:95], a[204:207], v[104:107], a[92:95]
    buffer_load_dwordx4 v24, s[4:7], s49 offen offset:3072 sc1 lds
    ds_read_b128 a[168:171], v6 offset:32768
    v_mfma_f32_16x16x32_bf16 a[112:115], a[236:239], v[68:71], a[112:115]
    ds_read_b128 a[172:175], v7 offset:32768
    ds_read_b128 a[176:179], v4 offset:36864
    ds_read_b128 a[180:183], v5 offset:36864
    ds_read_b128 a[184:187], v6 offset:36864
    ds_read_b128 a[188:191], v7 offset:36864
    v_mfma_f32_16x16x32_bf16 a[112:115], a[192:195], v[108:111], a[112:115]
    ds_read_b64_tr_b16 a[192:193], v8 offset:40960
    s_mov_b32 m0, 28672
    s_mov_b32 s49, 94208
    buffer_load_dwordx4 v24, s[4:7], s49 offen offset:0 sc1 lds
    v_mfma_f32_16x16x32_bf16 a[116:119], a[240:243], v[68:71], a[116:119]
    ds_read_b64_tr_b16 a[194:195], v8 offset:45056
    buffer_load_dwordx4 v24, s[4:7], s49 offen offset:1024 sc1 lds
    v_mfma_f32_16x16x32_bf16 a[116:119], a[196:199], v[108:111], a[116:119]
    ds_read_b64_tr_b16 a[196:197], v9 offset:40960
    v_mfma_f32_16x16x32_bf16 a[120:123], a[248:251], v[68:71], a[120:123]
    ds_read_b64_tr_b16 a[198:199], v9 offset:45056
    buffer_load_dwordx4 v24, s[4:7], s49 offen offset:2048 sc1 lds
    v_mfma_f32_16x16x32_bf16 a[120:123], a[200:203], v[108:111], a[120:123]
    ds_read_b64_tr_b16 a[200:201], v10 offset:40960
    v_mfma_f32_16x16x32_bf16 a[124:127], a[252:255], v[68:71], a[124:127]
    ds_read_b64_tr_b16 a[202:203], v10 offset:45056
    buffer_load_dwordx4 v24, s[4:7], s49 offen offset:3072 sc1 lds
    v_mfma_f32_16x16x32_bf16 a[124:127], a[204:207], v[108:111], a[124:127]
    ds_read_b64_tr_b16 a[204:205], v11 offset:40960
    v_smfmac_f32_16x16x64_bf16 a[228:231], a[244:247], v[104:111], v74
    ds_read_b64_tr_b16 a[206:207], v11 offset:45056
    s_waitcnt lgkmcnt(8)
    v_mfma_f32_16x16x32_bf16 v[32:35], a[160:163], v[176:179], v[76:79]
    ds_read_b64_tr_b16 a[236:237], v12 offset:40960
    v_mfma_f32_16x16x32_bf16 v[32:35], a[164:167], v[180:183], v[32:35]
    ds_read_b64_tr_b16 a[238:239], v12 offset:45056
    v_mfma_f32_16x16x32_bf16 v[32:35], a[168:171], v[184:187], v[32:35]
    ds_read_b64_tr_b16 a[240:241], v13 offset:40960
    v_mfma_f32_16x16x32_bf16 v[32:35], a[172:175], v[188:191], v[32:35]
    ds_read_b64_tr_b16 a[242:243], v13 offset:45056
    v_mfma_f32_16x16x32_bf16 v[36:39], a[176:179], v[176:179], v[76:79]
    ds_read_b64_tr_b16 a[248:249], v14 offset:40960
    v_mfma_f32_16x16x32_bf16 v[36:39], a[180:183], v[180:183], v[36:39]
    ds_read_b64_tr_b16 a[250:251], v14 offset:45056
    v_mfma_f32_16x16x32_bf16 v[36:39], a[184:187], v[184:187], v[36:39]
    ds_read_b64_tr_b16 a[252:253], v15 offset:40960
    v_mfma_f32_16x16x32_bf16 v[36:39], a[188:191], v[188:191], v[36:39]
    ds_read_b64_tr_b16 a[254:255], v15 offset:45056
    v_mfma_f32_16x16x32_bf16 v[40:43], a[160:163], v[192:195], v[80:83]
    v_exp_f32 v32, v32
    v_mfma_f32_16x16x32_bf16 v[40:43], a[164:167], v[196:199], v[40:43]
    v_exp_f32 v33, v33
    v_mfma_f32_16x16x32_bf16 v[40:43], a[168:171], v[200:203], v[40:43]
    v_exp_f32 v34, v34
    v_mfma_f32_16x16x32_bf16 v[40:43], a[172:175], v[204:207], v[40:43]
    v_exp_f32 v35, v35
    v_mfma_f32_16x16x32_bf16 v[44:47], a[176:179], v[192:195], v[80:83]
    v_cvt_pk_bf16_f32 v56, v32, v33
    v_cvt_pk_bf16_f32 v57, v34, v35
    v_mfma_f32_16x16x32_bf16 v[44:47], a[180:183], v[196:199], v[44:47]
    v_exp_f32 v36, v36
    v_mfma_f32_16x16x32_bf16 v[44:47], a[184:187], v[200:203], v[44:47]
    v_exp_f32 v37, v37
    v_mfma_f32_16x16x32_bf16 v[44:47], a[188:191], v[204:207], v[44:47]
    v_exp_f32 v38, v38
    v_mfma_f32_16x16x32_bf16 v[48:51], a[160:163], v[208:211], v[84:87]
    v_exp_f32 v39, v39
    v_mfma_f32_16x16x32_bf16 v[48:51], a[164:167], v[212:215], v[48:51]
    v_cvt_pk_bf16_f32 v58, v36, v37
    v_cvt_pk_bf16_f32 v59, v38, v39
    v_mfma_f32_16x16x32_bf16 v[48:51], a[168:171], v[216:219], v[48:51]
    v_exp_f32 v40, v40
    v_mfma_f32_16x16x32_bf16 v[48:51], a[172:175], v[220:223], v[48:51]
    v_exp_f32 v41, v41
    v_mfma_f32_16x16x32_bf16 v[52:55], a[176:179], v[208:211], v[84:87]
    v_exp_f32 v42, v42
    v_mfma_f32_16x16x32_bf16 v[52:55], a[180:183], v[212:215], v[52:55]
    v_exp_f32 v43, v43
    v_mfma_f32_16x16x32_bf16 v[52:55], a[184:187], v[216:219], v[52:55]
    v_exp_f32 v44, v44
    v_mfma_f32_16x16x32_bf16 v[52:55], a[188:191], v[220:223], v[52:55]
    v_exp_f32 v45, v45
    v_mfma_f32_16x16x32_bf16 v[32:35], a[160:163], v[224:227], v[88:91]
    v_exp_f32 v46, v46
    v_mfma_f32_16x16x32_bf16 v[32:35], a[164:167], v[228:231], v[32:35]
    v_exp_f32 v47, v47
    v_mfma_f32_16x16x32_bf16 v[32:35], a[168:171], v[232:235], v[32:35]
    v_cvt_pk_bf16_f32 v60, v40, v41
    v_cvt_pk_bf16_f32 v61, v42, v43
    v_mfma_f32_16x16x32_bf16 v[32:35], a[172:175], v[236:239], v[32:35]
    v_cvt_pk_bf16_f32 v62, v44, v45
    v_cvt_pk_bf16_f32 v63, v46, v47
    v_mfma_f32_16x16x32_bf16 v[36:39], a[176:179], v[224:227], v[88:91]
    v_exp_f32 v48, v48
    v_mfma_f32_16x16x32_bf16 v[36:39], a[180:183], v[228:231], v[36:39]
    v_exp_f32 v49, v49
    v_mfma_f32_16x16x32_bf16 v[36:39], a[184:187], v[232:235], v[36:39]
    v_exp_f32 v50, v50
    v_mfma_f32_16x16x32_bf16 v[36:39], a[188:191], v[236:239], v[36:39]
    s_waitcnt vmcnt(32) lgkmcnt(0)
    s_barrier
    v_mfma_f32_16x16x32_bf16 a[0:3], a[208:211], v[96:99], a[0:3]
    s_add_u32 m0, s96, 0
    s_add_u32 s49, s70, 256
    buffer_load_dwordx4 v24, s[8:11], s49 offen offset:0 sc1 lds
    v_mfma_f32_16x16x32_bf16 a[0:3], a[192:195], v[56:59], a[0:3]
    buffer_load_dwordx4 v24, s[8:11], s49 offen offset:1024 sc1 lds
    v_cvt_pk_bf16_f32 v64, v48, v49
    v_mfma_f32_16x16x32_bf16 a[4:7], a[212:215], v[96:99], a[4:7]
    v_exp_f32 v51, v51
    v_mfma_f32_16x16x32_bf16 a[4:7], a[196:199], v[56:59], a[4:7]
    s_add_u32 m0, s96, 2048
    s_add_u32 s49, s70, 131584
    buffer_load_dwordx4 v24, s[8:11], s49 offen offset:0 sc1 lds
    v_mfma_f32_16x16x32_bf16 a[8:11], a[216:219], v[96:99], a[8:11]
    v_exp_f32 v52, v52
    v_mfma_f32_16x16x32_bf16 a[8:11], a[200:203], v[56:59], a[8:11]
    buffer_load_dwordx4 v24, s[8:11], s49 offen offset:1024 sc1 lds
    v_cvt_pk_bf16_f32 v65, v50, v51
    v_mfma_f32_16x16x32_bf16 a[12:15], a[220:223], v[96:99], a[12:15]
    s_mov_b32 m0, 32768
    s_mov_b32 s49, 147456
    buffer_load_dwordx4 v24, s[4:7], s49 offen offset:0 sc1 lds
    v_mfma_f32_16x16x32_bf16 a[12:15], a[204:207], v[56:59], a[12:15]
    v_exp_f32 v53, v53
    v_mfma_f32_16x16x32_bf16 a[32:35], a[208:211], v[100:103], a[32:35]
    buffer_load_dwordx4 v24, s[4:7], s49 offen offset:1024 sc1 lds
    v_cvt_pk_bf16_f32 v66, v52, v53
    v_mfma_f32_16x16x32_bf16 a[32:35], a[192:195], v[60:63], a[32:35]
    v_exp_f32 v54, v54
    v_mfma_f32_16x16x32_bf16 a[36:39], a[212:215], v[100:103], a[36:39]
    buffer_load_dwordx4 v24, s[4:7], s49 offen offset:2048 sc1 lds
    ds_read_b128 a[160:163], v4 offset:49152
    v_mfma_f32_16x16x32_bf16 a[36:39], a[196:199], v[60:63], a[36:39]
    buffer_load_dwordx4 v24, s[4:7], s49 offen offset:3072 sc1 lds
    ds_read_b128 a[164:167], v5 offset:49152
    v_mfma_f32_16x16x32_bf16 a[40:43], a[216:219], v[100:103], a[40:43]
    v_exp_f32 v55, v55
    v_mfma_f32_16x16x32_bf16 a[40:43], a[200:203], v[60:63], a[40:43]
    s_mov_b32 m0, 36864
    s_mov_b32 s49, 151552
    buffer_load_dwordx4 v24, s[4:7], s49 offen offset:0 sc1 lds
    v_mfma_f32_16x16x32_bf16 a[44:47], a[220:223], v[100:103], a[44:47]
    ds_read_b128 a[168:171], v6 offset:49152
    v_cvt_pk_bf16_f32 v67, v54, v55
    v_mfma_f32_16x16x32_bf16 a[44:47], a[204:207], v[60:63], a[44:47]
    buffer_load_dwordx4 v24, s[4:7], s49 offen offset:1024 sc1 lds
    ds_read_b128 a[172:175], v7 offset:49152
    v_smfmac_f32_16x16x64_bf16 a[224:227], a[244:247], v[56:63], v74
    ds_read_b128 a[176:179], v4 offset:53248
    v_mfma_f32_16x16x32_bf16 a[64:67], a[208:211], v[104:107], a[64:67]
    buffer_load_dwordx4 v24, s[4:7], s49 offen offset:2048 sc1 lds
    ds_read_b128 a[180:183], v5 offset:53248
    v_mfma_f32_16x16x32_bf16 a[64:67], a[192:195], v[64:67], a[64:67]
    buffer_load_dwordx4 v24, s[4:7], s49 offen offset:3072 sc1 lds
    ds_read_b128 a[184:187], v6 offset:53248
    v_mfma_f32_16x16x32_bf16 a[68:71], a[212:215], v[104:107], a[68:71]
    v_exp_f32 v32, v32
    v_mfma_f32_16x16x32_bf16 a[68:71], a[196:199], v[64:67], a[68:71]
    s_mov_b32 m0, 40960
    s_mov_b32 s49, 155648
    buffer_load_dwordx4 v24, s[4:7], s49 offen offset:0 sc1 lds
    v_mfma_f32_16x16x32_bf16 a[72:75], a[216:219], v[104:107], a[72:75]
    v_exp_f32 v33, v33
    v_mfma_f32_16x16x32_bf16 a[72:75], a[200:203], v[64:67], a[72:75]
    buffer_load_dwordx4 v24, s[4:7], s49 offen offset:1024 sc1 lds
    v_exp_f32 v34, v34
    v_exp_f32 v35, v35
    v_exp_f32 v36, v36
    v_exp_f32 v37, v37
    v_exp_f32 v38, v38
    v_exp_f32 v39, v39
    v_mfma_f32_16x16x32_bf16 a[76:79], a[220:223], v[104:107], a[76:79]
    v_cvt_pk_bf16_f32 v68, v32, v33
    v_cvt_pk_bf16_f32 v69, v34, v35
    v_cvt_pk_bf16_f32 v70, v36, v37
    v_cvt_pk_bf16_f32 v71, v38, v39
    v_mfma_f32_16x16x32_bf16 a[76:79], a[204:207], v[64:67], a[76:79]
    buffer_load_dwordx4 v24, s[4:7], s49 offen offset:2048 sc1 lds
    ds_read_b128 a[188:191], v7 offset:53248
    v_mfma_f32_16x16x32_bf16 a[96:99], a[208:211], v[108:111], a[96:99]
    buffer_load_dwordx4 v24, s[4:7], s49 offen offset:3072 sc1 lds
    v_mfma_f32_16x16x32_bf16 a[96:99], a[192:195], v[68:71], a[96:99]
    ds_read_b64_tr_b16 a[192:193], v12 offset:57344
    v_mfma_f32_16x16x32_bf16 a[100:103], a[212:215], v[108:111], a[100:103]
    ds_read_b64_tr_b16 a[194:195], v12 offset:61440
    s_mov_b32 m0, 45056
    s_mov_b32 s49, 159744
    buffer_load_dwordx4 v24, s[4:7], s49 offen offset:0 sc1 lds
    v_mfma_f32_16x16x32_bf16 a[100:103], a[196:199], v[68:71], a[100:103]
    ds_read_b64_tr_b16 a[196:197], v13 offset:57344
    buffer_load_dwordx4 v24, s[4:7], s49 offen offset:1024 sc1 lds
    v_mfma_f32_16x16x32_bf16 a[104:107], a[216:219], v[108:111], a[104:107]
    ds_read_b64_tr_b16 a[198:199], v13 offset:61440
    v_mfma_f32_16x16x32_bf16 a[104:107], a[200:203], v[68:71], a[104:107]
    ds_read_b64_tr_b16 a[200:201], v14 offset:57344
    buffer_load_dwordx4 v24, s[4:7], s49 offen offset:2048 sc1 lds
    v_mfma_f32_16x16x32_bf16 a[108:111], a[220:223], v[108:111], a[108:111]
    ds_read_b64_tr_b16 a[202:203], v14 offset:61440
    v_mfma_f32_16x16x32_bf16 a[108:111], a[204:207], v[68:71], a[108:111]
    ds_read_b64_tr_b16 a[204:205], v15 offset:57344
    buffer_load_dwordx4 v24, s[4:7], s49 offen offset:3072 sc1 lds
    v_smfmac_f32_16x16x64_bf16 a[228:231], a[244:247], v[64:71], v74
    ds_read_b64_tr_b16 a[206:207], v15 offset:61440
    s_waitcnt lgkmcnt(8)
    v_mfma_f32_16x16x32_bf16 v[32:35], a[160:163], v[176:179], v[76:79]
    s_add_u32 m0, s96, 4096
    s_add_u32 s49, s70, 262912
    buffer_load_dwordx4 v24, s[8:11], s49 offen offset:0 sc1 lds
    v_mfma_f32_16x16x32_bf16 v[32:35], a[164:167], v[180:183], v[32:35]
    ds_read_b64_tr_b16 a[208:209], v8 offset:57344
    v_mfma_f32_16x16x32_bf16 v[32:35], a[168:171], v[184:187], v[32:35]
    ds_read_b64_tr_b16 a[210:211], v8 offset:61440
    v_mfma_f32_16x16x32_bf16 v[32:35], a[172:175], v[188:191], v[32:35]
    buffer_load_dwordx4 v24, s[8:11], s49 offen offset:1024 sc1 lds
    v_mfma_f32_16x16x32_bf16 v[36:39], a[176:179], v[176:179], v[76:79]
    ds_read_b64_tr_b16 a[212:213], v9 offset:57344
    v_mfma_f32_16x16x32_bf16 v[36:39], a[180:183], v[180:183], v[36:39]
    ds_read_b64_tr_b16 a[214:215], v9 offset:61440
    v_mfma_f32_16x16x32_bf16 v[36:39], a[184:187], v[184:187], v[36:39]
    ds_read_b64_tr_b16 a[216:217], v10 offset:57344
    v_mfma_f32_16x16x32_bf16 v[36:39], a[188:191], v[188:191], v[36:39]
    ds_read_b64_tr_b16 a[218:219], v10 offset:61440
    v_mfma_f32_16x16x32_bf16 v[40:43], a[160:163], v[192:195], v[80:83]
    ds_read_b64_tr_b16 a[220:221], v11 offset:57344
    ds_read_b64_tr_b16 a[222:223], v11 offset:61440
    v_mfma_f32_16x16x32_bf16 v[40:43], a[164:167], v[196:199], v[40:43]
    s_add_u32 m0, s96, 6144
    s_add_u32 s49, s70, 394240
    buffer_load_dwordx4 v24, s[8:11], s49 offen offset:0 sc1 lds
    v_mfma_f32_16x16x32_bf16 v[40:43], a[168:171], v[200:203], v[40:43]
    v_exp_f32 v32, v32
    v_mfma_f32_16x16x32_bf16 v[40:43], a[172:175], v[204:207], v[40:43]
    buffer_load_dwordx4 v24, s[8:11], s49 offen offset:1024 sc1 lds
    v_mfma_f32_16x16x32_bf16 v[44:47], a[176:179], v[192:195], v[80:83]
    v_exp_f32 v33, v33
    v_mfma_f32_16x16x32_bf16 v[44:47], a[180:183], v[196:199], v[44:47]
    v_exp_f32 v34, v34
    v_mfma_f32_16x16x32_bf16 v[44:47], a[184:187], v[200:203], v[44:47]
    v_exp_f32 v35, v35
    v_mfma_f32_16x16x32_bf16 v[44:47], a[188:191], v[204:207], v[44:47]
    s_add_u32 m0, s96, 8192
    s_add_u32 s49, s70, 525568
    buffer_load_dwordx4 v24, s[8:11], s49 offen offset:0 sc1 lds
    v_mfma_f32_16x16x32_bf16 v[48:51], a[160:163], v[208:211], v[84:87]
    v_cvt_pk_bf16_f32 v96, v32, v33
    v_cvt_pk_bf16_f32 v97, v34, v35
    v_mfma_f32_16x16x32_bf16 v[48:51], a[164:167], v[212:215], v[48:51]
    v_exp_f32 v36, v36
    v_mfma_f32_16x16x32_bf16 v[48:51], a[168:171], v[216:219], v[48:51]
    v_exp_f32 v37, v37
    v_mfma_f32_16x16x32_bf16 v[48:51], a[172:175], v[220:223], v[48:51]
    buffer_load_dwordx4 v24, s[8:11], s49 offen offset:1024 sc1 lds
    v_cvt_pk_bf16_f32 v98, v36, v37
    v_mfma_f32_16x16x32_bf16 v[52:55], a[176:179], v[208:211], v[84:87]
    v_exp_f32 v38, v38
    v_mfma_f32_16x16x32_bf16 v[52:55], a[180:183], v[212:215], v[52:55]
    v_exp_f32 v39, v39
    v_mfma_f32_16x16x32_bf16 v[52:55], a[184:187], v[216:219], v[52:55]
    v_cvt_pk_bf16_f32 v99, v38, v39
    v_mfma_f32_16x16x32_bf16 v[52:55], a[188:191], v[220:223], v[52:55]
    s_add_u32 m0, s96, 10240
    s_add_u32 s49, s71, 256
    buffer_load_dwordx4 v24, s[8:11], s49 offen offset:0 sc1 lds
    v_mfma_f32_16x16x32_bf16 v[32:35], a[160:163], v[224:227], v[88:91]
    v_exp_f32 v40, v40
    v_mfma_f32_16x16x32_bf16 v[32:35], a[164:167], v[228:231], v[32:35]
    v_exp_f32 v41, v41
    v_mfma_f32_16x16x32_bf16 v[32:35], a[168:171], v[232:235], v[32:35]
    v_exp_f32 v42, v42
    v_mfma_f32_16x16x32_bf16 v[32:35], a[172:175], v[236:239], v[32:35]
    buffer_load_dwordx4 v24, s[8:11], s49 offen offset:1024 sc1 lds
    v_cvt_pk_bf16_f32 v100, v40, v41
    v_mfma_f32_16x16x32_bf16 v[36:39], a[176:179], v[224:227], v[88:91]
    v_exp_f32 v43, v43
    v_mfma_f32_16x16x32_bf16 v[36:39], a[180:183], v[228:231], v[36:39]
    v_exp_f32 v44, v44
    v_mfma_f32_16x16x32_bf16 v[36:39], a[184:187], v[232:235], v[36:39]
    v_exp_f32 v45, v45
    v_mfma_f32_16x16x32_bf16 v[36:39], a[188:191], v[236:239], v[36:39]
    s_waitcnt lgkmcnt(0)
    s_barrier
    v_mfma_f32_16x16x32_bf16 a[16:19], a[236:239], v[56:59], a[16:19]
    s_add_u32 m0, s96, 12288
    s_add_u32 s49, s71, 131584
    buffer_load_dwordx4 v24, s[8:11], s49 offen offset:0 sc1 lds
    v_mfma_f32_16x16x32_bf16 a[16:19], a[192:195], v[96:99], a[16:19]
    buffer_load_dwordx4 v24, s[8:11], s49 offen offset:1024 sc1 lds
    v_cvt_pk_bf16_f32 v101, v42, v43
    v_mfma_f32_16x16x32_bf16 a[20:23], a[240:243], v[56:59], a[20:23]
    s_add_u32 m0, s96, 14336
    s_add_u32 s49, s71, 262912
    buffer_load_dwordx4 v24, s[8:11], s49 offen offset:0 sc1 lds
    v_mfma_f32_16x16x32_bf16 a[20:23], a[196:199], v[96:99], a[20:23]
    v_exp_f32 v46, v46
    v_mfma_f32_16x16x32_bf16 a[24:27], a[248:251], v[56:59], a[24:27]
    buffer_load_dwordx4 v24, s[8:11], s49 offen offset:1024 sc1 lds
    v_cvt_pk_bf16_f32 v102, v44, v45
    v_mfma_f32_16x16x32_bf16 a[24:27], a[200:203], v[96:99], a[24:27]
    v_exp_f32 v47, v47
    v_mfma_f32_16x16x32_bf16 a[28:31], a[252:255], v[56:59], a[28:31]
    s_add_u32 m0, s96, 16384
    s_add_u32 s49, s71, 394240
    buffer_load_dwordx4 v24, s[8:11], s49 offen offset:0 sc1 lds
    v_cvt_pk_bf16_f32 v103, v46, v47
    v_mfma_f32_16x16x32_bf16 a[28:31], a[204:207], v[96:99], a[28:31]
    buffer_load_dwordx4 v24, s[8:11], s49 offen offset:1024 sc1 lds
    v_mfma_f32_16x16x32_bf16 a[48:51], a[236:239], v[60:63], a[48:51]
    s_add_u32 m0, s96, 18432
    s_add_u32 s49, s71, 525568
    buffer_load_dwordx4 v24, s[8:11], s49 offen offset:0 sc1 lds
    v_mfma_f32_16x16x32_bf16 a[48:51], a[192:195], v[100:103], a[48:51]
    buffer_load_dwordx4 v24, s[8:11], s49 offen offset:1024 sc1 lds
    v_mfma_f32_16x16x32_bf16 a[52:55], a[240:243], v[60:63], a[52:55]
    v_exp_f32 v48, v48
    v_mfma_f32_16x16x32_bf16 a[52:55], a[196:199], v[100:103], a[52:55]
    s_mov_b32 m0, 49152
    s_mov_b32 s49, 212992
    buffer_load_dwordx4 v24, s[4:7], s49 offen offset:0 sc1 lds
    v_mfma_f32_16x16x32_bf16 a[56:59], a[248:251], v[60:63], a[56:59]
    buffer_load_dwordx4 v24, s[4:7], s49 offen offset:1024 sc1 lds
    v_mfma_f32_16x16x32_bf16 a[56:59], a[200:203], v[100:103], a[56:59]
    v_exp_f32 v49, v49
    v_mfma_f32_16x16x32_bf16 a[60:63], a[252:255], v[60:63], a[60:63]
    buffer_load_dwordx4 v24, s[4:7], s49 offen offset:2048 sc1 lds
    v_exp_f32 v50, v50
    v_exp_f32 v51, v51
    v_exp_f32 v52, v52
    v_exp_f32 v53, v53
    v_exp_f32 v54, v54
    v_exp_f32 v55, v55
    v_mfma_f32_16x16x32_bf16 a[60:63], a[204:207], v[100:103], a[60:63]
    v_cvt_pk_bf16_f32 v104, v48, v49
    v_cvt_pk_bf16_f32 v105, v50, v51
    v_cvt_pk_bf16_f32 v106, v52, v53
    v_cvt_pk_bf16_f32 v107, v54, v55
    v_smfmac_f32_16x16x64_bf16 a[224:227], a[244:247], v[96:103], v74
    buffer_load_dwordx4 v24, s[4:7], s49 offen offset:3072 sc1 lds
    v_mfma_f32_16x16x32_bf16 a[80:83], a[236:239], v[64:67], a[80:83]
    s_mov_b32 m0, 53248
    s_mov_b32 s49, 217088
    buffer_load_dwordx4 v24, s[4:7], s49 offen offset:0 sc1 lds
    v_mfma_f32_16x16x32_bf16 a[80:83], a[192:195], v[104:107], a[80:83]
    buffer_load_dwordx4 v24, s[4:7], s49 offen offset:1024 sc1 lds
    v_mfma_f32_16x16x32_bf16 a[84:87], a[240:243], v[64:67], a[84:87]
    buffer_load_dwordx4 v24, s[4:7], s49 offen offset:2048 sc1 lds
    v_mfma_f32_16x16x32_bf16 a[84:87], a[196:199], v[104:107], a[84:87]
    v_exp_f32 v32, v32
    v_mfma_f32_16x16x32_bf16 a[88:91], a[248:251], v[64:67], a[88:91]
    buffer_load_dwordx4 v24, s[4:7], s49 offen offset:3072 sc1 lds
    v_mfma_f32_16x16x32_bf16 a[88:91], a[200:203], v[104:107], a[88:91]
    v_exp_f32 v33, v33
    v_exp_f32 v34, v34
    v_exp_f32 v35, v35
    v_exp_f32 v36, v36
    v_exp_f32 v37, v37
    v_exp_f32 v38, v38
    v_exp_f32 v39, v39
    v_mfma_f32_16x16x32_bf16 a[92:95], a[252:255], v[64:67], a[92:95]
    s_mov_b32 m0, 57344
    s_mov_b32 s49, 221184
    buffer_load_dwordx4 v24, s[4:7], s49 offen offset:0 sc1 lds
    v_cvt_pk_bf16_f32 v108, v32, v33
    v_cvt_pk_bf16_f32 v109, v34, v35
    v_cvt_pk_bf16_f32 v110, v36, v37
    v_cvt_pk_bf16_f32 v111, v38, v39
    v_mfma_f32_16x16x32_bf16 a[92:95], a[204:207], v[104:107], a[92:95]
    buffer_load_dwordx4 v24, s[4:7], s49 offen offset:1024 sc1 lds
    v_mfma_f32_16x16x32_bf16 a[112:115], a[236:239], v[68:71], a[112:115]
    buffer_load_dwordx4 v24, s[4:7], s49 offen offset:2048 sc1 lds
    v_mfma_f32_16x16x32_bf16 a[112:115], a[192:195], v[108:111], a[112:115]
    buffer_load_dwordx4 v24, s[4:7], s49 offen offset:3072 sc1 lds
    v_mfma_f32_16x16x32_bf16 a[116:119], a[240:243], v[68:71], a[116:119]
    v_mfma_f32_16x16x32_bf16 a[116:119], a[196:199], v[108:111], a[116:119]
    s_mov_b32 m0, 61440
    s_mov_b32 s49, 225280
    buffer_load_dwordx4 v24, s[4:7], s49 offen offset:0 sc1 lds
    v_mfma_f32_16x16x32_bf16 a[120:123], a[248:251], v[68:71], a[120:123]
    buffer_load_dwordx4 v24, s[4:7], s49 offen offset:1024 sc1 lds
    v_mfma_f32_16x16x32_bf16 a[120:123], a[200:203], v[108:111], a[120:123]
    v_mfma_f32_16x16x32_bf16 a[124:127], a[252:255], v[68:71], a[124:127]
    buffer_load_dwordx4 v24, s[4:7], s49 offen offset:2048 sc1 lds
    v_mfma_f32_16x16x32_bf16 a[124:127], a[204:207], v[108:111], a[124:127]
    buffer_load_dwordx4 v24, s[4:7], s49 offen offset:3072 sc1 lds
    v_smfmac_f32_16x16x64_bf16 a[228:231], a[244:247], v[104:111], v74
    s_nop 0
    v_mfma_f32_16x16x32_bf16 a[0:3], a[208:211], v[96:99], a[0:3]
    v_mfma_f32_16x16x32_bf16 a[4:7], a[212:215], v[96:99], a[4:7]
    v_mfma_f32_16x16x32_bf16 a[8:11], a[216:219], v[96:99], a[8:11]
    v_mfma_f32_16x16x32_bf16 a[12:15], a[220:223], v[96:99], a[12:15]
    v_mov_b32 v1, 147460
    v_mov_b32_e64 v2, 1
    v_mfma_f32_16x16x32_bf16 a[32:35], a[208:211], v[100:103], a[32:35]
    v_accvgpr_read_b32 v32, a224
    v_accvgpr_read_b32 v33, a225
    v_mfma_f32_16x16x32_bf16 a[36:39], a[212:215], v[100:103], a[36:39]
    v_accvgpr_read_b32 v34, a226
    v_accvgpr_read_b32 v35, a227
    v_mfma_f32_16x16x32_bf16 a[40:43], a[216:219], v[100:103], a[40:43]
    v_accvgpr_read_b32 v36, a228
    v_accvgpr_read_b32 v37, a229
    v_mfma_f32_16x16x32_bf16 a[44:47], a[220:223], v[100:103], a[44:47]
    v_accvgpr_read_b32 v38, a230
    v_accvgpr_read_b32 v39, a231
    v_mfma_f32_16x16x32_bf16 a[64:67], a[208:211], v[104:107], a[64:67]
    v_add_f32 v26, v32, v33
    v_add_f32 v28, v34, v35
    v_mfma_f32_16x16x32_bf16 a[68:71], a[212:215], v[104:107], a[68:71]
    v_add_f32 v30, v36, v37
    v_add_f32 v72, v38, v39
    v_mfma_f32_16x16x32_bf16 a[72:75], a[216:219], v[104:107], a[72:75]
    v_add_f32 v3, v26, v28
    v_add_f32 v32, v30, v72
    v_mfma_f32_16x16x32_bf16 a[76:79], a[220:223], v[104:107], a[76:79]
    v_add_f32 v3, v3, v32
    v_cmp_ngt_f32 vcc, s51, v3
    v_mfma_f32_16x16x32_bf16 a[96:99], a[208:211], v[108:111], a[96:99]
    v_rcp_f32 v26, v26
    v_rcp_f32 v28, v28
    v_mfma_f32_16x16x32_bf16 a[100:103], a[212:215], v[108:111], a[100:103]
    v_rcp_f32 v30, v30
    v_rcp_f32 v72, v72
    v_mfma_f32_16x16x32_bf16 a[104:107], a[216:219], v[108:111], a[104:107]
    v_mfma_f32_16x16x32_bf16 a[108:111], a[220:223], v[108:111], a[108:111]
    s_cbranch_vccnz L_ovf14
L_nof14:
    s_waitcnt lgkmcnt(0)
    s_barrier
    s_nop 0
    ds_read_b32 v3, v1
    v_accvgpr_read_b32 v32, a0
    v_accvgpr_read_b32 v33, a1
    v_accvgpr_read_b32 v34, a2
    v_accvgpr_read_b32 v35, a3
    v_accvgpr_read_b32 v36, a4
    v_accvgpr_read_b32 v37, a5
    v_accvgpr_read_b32 v38, a6
    v_accvgpr_read_b32 v39, a7
    v_accvgpr_read_b32 v40, a8
    v_accvgpr_read_b32 v41, a9
    v_accvgpr_read_b32 v42, a10
    v_accvgpr_read_b32 v43, a11
    v_accvgpr_read_b32 v44, a12
    v_accvgpr_read_b32 v45, a13
    v_accvgpr_read_b32 v46, a14
    v_accvgpr_read_b32 v47, a15
    v_pk_mul_f32 v[32:33], v[32:33], v[26:27] op_sel_hi:[1,0]
    v_pk_mul_f32 v[34:35], v[34:35], v[26:27] op_sel_hi:[1,0]
    v_pk_mul_f32 v[36:37], v[36:37], v[26:27] op_sel_hi:[1,0]
    v_pk_mul_f32 v[38:39], v[38:39], v[26:27] op_sel_hi:[1,0]
    v_pk_mul_f32 v[40:41], v[40:41], v[26:27] op_sel_hi:[1,0]
    v_pk_mul_f32 v[42:43], v[42:43], v[26:27] op_sel_hi:[1,0]
    v_pk_mul_f32 v[44:45], v[44:45], v[26:27] op_sel_hi:[1,0]
    v_pk_mul_f32 v[46:47], v[46:47], v[26:27] op_sel_hi:[1,0]
    v_accvgpr_read_b32 v48, a16
    v_accvgpr_read_b32 v49, a17
    v_accvgpr_read_b32 v50, a18
    v_accvgpr_read_b32 v51, a19
    v_accvgpr_read_b32 v52, a20
    v_accvgpr_read_b32 v53, a21
    v_accvgpr_read_b32 v54, a22
    v_accvgpr_read_b32 v55, a23
    v_accvgpr_read_b32 v56, a24
    v_accvgpr_read_b32 v57, a25
    v_accvgpr_read_b32 v58, a26
    v_accvgpr_read_b32 v59, a27
    s_waitcnt lgkmcnt(0)
    v_readfirstlane_b32 s48, v3
    v_accvgpr_read_b32 v60, a28
    v_accvgpr_read_b32 v61, a29
    v_accvgpr_read_b32 v62, a30
    v_accvgpr_read_b32 v63, a31
    s_andn2_b32 s48, s48, s37
    s_cbranch_scc1 L_redo4
    s_add_u32 s30, s50, 4096
    s_add_u32 s31, s50, 135424
    s_add_u32 s32, s50, 266752
    s_add_u32 s33, s50, 398080
    s_mov_b32 s34, 53820160
    v_cvt_pk_bf16_f32 v84, v32, v33
    v_cvt_pk_bf16_f32 v85, v34, v35
    v_cvt_pk_bf16_f32 v86, v36, v37
    v_cvt_pk_bf16_f32 v87, v38, v39
    buffer_store_dwordx4 v[84:87], v24, s[20:23], s30 offen offset:0 sc1
    v_cvt_pk_bf16_f32 v88, v40, v41
    v_cvt_pk_bf16_f32 v89, v42, v43
    v_cvt_pk_bf16_f32 v90, v44, v45
    v_cvt_pk_bf16_f32 v91, v46, v47
    buffer_store_dwordx4 v[88:91], v24, s[20:23], s30 offen offset:1024 sc1
    v_pk_mul_f32 v[48:49], v[48:49], v[26:27] op_sel_hi:[1,0]
    v_pk_mul_f32 v[50:51], v[50:51], v[26:27] op_sel_hi:[1,0]
    v_pk_mul_f32 v[52:53], v[52:53], v[26:27] op_sel_hi:[1,0]
    v_pk_mul_f32 v[54:55], v[54:55], v[26:27] op_sel_hi:[1,0]
    v_pk_mul_f32 v[56:57], v[56:57], v[26:27] op_sel_hi:[1,0]
    v_pk_mul_f32 v[58:59], v[58:59], v[26:27] op_sel_hi:[1,0]
    v_pk_mul_f32 v[60:61], v[60:61], v[26:27] op_sel_hi:[1,0]
    v_pk_mul_f32 v[62:63], v[62:63], v[26:27] op_sel_hi:[1,0]
    v_cvt_pk_bf16_f32 v92, v48, v49
    v_cvt_pk_bf16_f32 v93, v50, v51
    v_cvt_pk_bf16_f32 v94, v52, v53
    v_cvt_pk_bf16_f32 v95, v54, v55
    buffer_store_dwordx4 v[92:95], v24, s[20:23], s30 offen offset:2048 sc1
    v_cvt_pk_bf16_f32 v96, v56, v57
    v_cvt_pk_bf16_f32 v97, v58, v59
    v_cvt_pk_bf16_f32 v98, v60, v61
    v_cvt_pk_bf16_f32 v99, v62, v63
    v_accvgpr_read_b32 v32, a32
    v_accvgpr_read_b32 v33, a33
    v_accvgpr_read_b32 v34, a34
    v_accvgpr_read_b32 v35, a35
    v_accvgpr_read_b32 v36, a36
    v_accvgpr_read_b32 v37, a37
    v_accvgpr_read_b32 v38, a38
    v_accvgpr_read_b32 v39, a39
    v_accvgpr_read_b32 v40, a40
    v_accvgpr_read_b32 v41, a41
    v_accvgpr_read_b32 v42, a42
    v_accvgpr_read_b32 v43, a43
    v_accvgpr_read_b32 v44, a44
    v_accvgpr_read_b32 v45, a45
    v_accvgpr_read_b32 v46, a46
    v_accvgpr_read_b32 v47, a47
    v_pk_mul_f32 v[32:33], v[32:33], v[28:29] op_sel_hi:[1,0]
    v_pk_mul_f32 v[34:35], v[34:35], v[28:29] op_sel_hi:[1,0]
    v_pk_mul_f32 v[36:37], v[36:37], v[28:29] op_sel_hi:[1,0]
    v_pk_mul_f32 v[38:39], v[38:39], v[28:29] op_sel_hi:[1,0]
    v_pk_mul_f32 v[40:41], v[40:41], v[28:29] op_sel_hi:[1,0]
    v_pk_mul_f32 v[42:43], v[42:43], v[28:29] op_sel_hi:[1,0]
    v_pk_mul_f32 v[44:45], v[44:45], v[28:29] op_sel_hi:[1,0]
    v_pk_mul_f32 v[46:47], v[46:47], v[28:29] op_sel_hi:[1,0]
    v_cvt_pk_bf16_f32 v100, v32, v33
    v_cvt_pk_bf16_f32 v101, v34, v35
    v_cvt_pk_bf16_f32 v102, v36, v37
    v_cvt_pk_bf16_f32 v103, v38, v39
    buffer_store_dwordx4 v[96:99], v24, s[20:23], s30 offen offset:3072 sc1
    v_cvt_pk_bf16_f32 v104, v40, v41
    v_cvt_pk_bf16_f32 v105, v42, v43
    v_cvt_pk_bf16_f32 v106, v44, v45
    v_cvt_pk_bf16_f32 v107, v46, v47
    buffer_store_dwordx4 v[100:103], v24, s[20:23], s31 offen offset:0 sc1
    v_accvgpr_read_b32 v48, a48
    v_accvgpr_read_b32 v49, a49
    v_accvgpr_read_b32 v50, a50
    v_accvgpr_read_b32 v51, a51
    v_accvgpr_read_b32 v52, a52
    v_accvgpr_read_b32 v53, a53
    v_accvgpr_read_b32 v54, a54
    v_accvgpr_read_b32 v55, a55
    v_accvgpr_read_b32 v56, a56
    v_accvgpr_read_b32 v57, a57
    v_accvgpr_read_b32 v58, a58
    v_accvgpr_read_b32 v59, a59
    v_accvgpr_read_b32 v60, a60
    v_accvgpr_read_b32 v61, a61
    v_accvgpr_read_b32 v62, a62
    v_accvgpr_read_b32 v63, a63
    v_pk_mul_f32 v[48:49], v[48:49], v[28:29] op_sel_hi:[1,0]
    v_pk_mul_f32 v[50:51], v[50:51], v[28:29] op_sel_hi:[1,0]
    v_pk_mul_f32 v[52:53], v[52:53], v[28:29] op_sel_hi:[1,0]
    v_pk_mul_f32 v[54:55], v[54:55], v[28:29] op_sel_hi:[1,0]
    v_pk_mul_f32 v[56:57], v[56:57], v[28:29] op_sel_hi:[1,0]
    v_pk_mul_f32 v[58:59], v[58:59], v[28:29] op_sel_hi:[1,0]
    v_pk_mul_f32 v[60:61], v[60:61], v[28:29] op_sel_hi:[1,0]
    v_pk_mul_f32 v[62:63], v[62:63], v[28:29] op_sel_hi:[1,0]
    v_cvt_pk_bf16_f32 v108, v48, v49
    v_cvt_pk_bf16_f32 v109, v50, v51
    v_cvt_pk_bf16_f32 v110, v52, v53
    v_cvt_pk_bf16_f32 v111, v54, v55
    buffer_store_dwordx4 v[104:107], v24, s[20:23], s31 offen offset:1024 sc1
    v_cvt_pk_bf16_f32 v84, v56, v57
    v_cvt_pk_bf16_f32 v85, v58, v59
    v_cvt_pk_bf16_f32 v86, v60, v61
    v_cvt_pk_bf16_f32 v87, v62, v63
    v_accvgpr_read_b32 v32, a64
    v_accvgpr_read_b32 v33, a65
    v_accvgpr_read_b32 v34, a66
    v_accvgpr_read_b32 v35, a67
    v_accvgpr_read_b32 v36, a68
    v_accvgpr_read_b32 v37, a69
    v_accvgpr_read_b32 v38, a70
    v_accvgpr_read_b32 v39, a71
    v_accvgpr_read_b32 v40, a72
    v_accvgpr_read_b32 v41, a73
    v_accvgpr_read_b32 v42, a74
    v_accvgpr_read_b32 v43, a75
    v_accvgpr_read_b32 v44, a76
    v_accvgpr_read_b32 v45, a77
    v_accvgpr_read_b32 v46, a78
    v_accvgpr_read_b32 v47, a79
    v_pk_mul_f32 v[32:33], v[32:33], v[30:31] op_sel_hi:[1,0]
    v_pk_mul_f32 v[34:35], v[34:35], v[30:31] op_sel_hi:[1,0]
    v_pk_mul_f32 v[36:37], v[36:37], v[30:31] op_sel_hi:[1,0]
    v_pk_mul_f32 v[38:39], v[38:39], v[30:31] op_sel_hi:[1,0]
    v_pk_mul_f32 v[40:41], v[40:41], v[30:31] op_sel_hi:[1,0]
    v_pk_mul_f32 v[42:43], v[42:43], v[30:31] op_sel_hi:[1,0]
    v_pk_mul_f32 v[44:45], v[44:45], v[30:31] op_sel_hi:[1,0]
    v_pk_mul_f32 v[46:47], v[46:47], v[30:31] op_sel_hi:[1,0]
    v_cvt_pk_bf16_f32 v88, v32, v33
    v_cvt_pk_bf16_f32 v89, v34, v35
    v_cvt_pk_bf16_f32 v90, v36, v37
    v_cvt_pk_bf16_f32 v91, v38, v39
    buffer_store_dwordx4 v[108:111], v24, s[20:23], s31 offen offset:2048 sc1
    v_cvt_pk_bf16_f32 v92, v40, v41
    v_cvt_pk_bf16_f32 v93, v42, v43
    v_cvt_pk_bf16_f32 v94, v44, v45
    v_cvt_pk_bf16_f32 v95, v46, v47
    buffer_store_dwordx4 v[84:87], v24, s[20:23], s31 offen offset:3072 sc1
    v_accvgpr_read_b32 v48, a80
    v_accvgpr_read_b32 v49, a81
    v_accvgpr_read_b32 v50, a82
    v_accvgpr_read_b32 v51, a83
    v_accvgpr_read_b32 v52, a84
    v_accvgpr_read_b32 v53, a85
    v_accvgpr_read_b32 v54, a86
    v_accvgpr_read_b32 v55, a87
    v_accvgpr_read_b32 v56, a88
    v_accvgpr_read_b32 v57, a89
    v_accvgpr_read_b32 v58, a90
    v_accvgpr_read_b32 v59, a91
    v_accvgpr_read_b32 v60, a92
    v_accvgpr_read_b32 v61, a93
    v_accvgpr_read_b32 v62, a94
    v_accvgpr_read_b32 v63, a95
    v_pk_mul_f32 v[48:49], v[48:49], v[30:31] op_sel_hi:[1,0]
    v_pk_mul_f32 v[50:51], v[50:51], v[30:31] op_sel_hi:[1,0]
    v_pk_mul_f32 v[52:53], v[52:53], v[30:31] op_sel_hi:[1,0]
    v_pk_mul_f32 v[54:55], v[54:55], v[30:31] op_sel_hi:[1,0]
    v_pk_mul_f32 v[56:57], v[56:57], v[30:31] op_sel_hi:[1,0]
    v_pk_mul_f32 v[58:59], v[58:59], v[30:31] op_sel_hi:[1,0]
    v_pk_mul_f32 v[60:61], v[60:61], v[30:31] op_sel_hi:[1,0]
    v_pk_mul_f32 v[62:63], v[62:63], v[30:31] op_sel_hi:[1,0]
    v_cvt_pk_bf16_f32 v96, v48, v49
    v_cvt_pk_bf16_f32 v97, v50, v51
    v_cvt_pk_bf16_f32 v98, v52, v53
    v_cvt_pk_bf16_f32 v99, v54, v55
    buffer_store_dwordx4 v[88:91], v24, s[20:23], s32 offen offset:0 sc1
    v_cvt_pk_bf16_f32 v100, v56, v57
    v_cvt_pk_bf16_f32 v101, v58, v59
    s_waitcnt vmcnt(9)
    s_barrier
    v_cvt_pk_bf16_f32 v102, v60, v61
    v_cvt_pk_bf16_f32 v103, v62, v63
    buffer_store_dwordx4 v[92:95], v24, s[20:23], s32 offen offset:1024 sc1
    v_accvgpr_read_b32 v32, a96
    v_accvgpr_read_b32 v33, a97
    ds_read_b128 v[176:179], v27 offset:0
    v_accvgpr_read_b32 v34, a98
    v_accvgpr_read_b32 v35, a99
    v_accvgpr_read_b32 v36, a100
    v_accvgpr_read_b32 v37, a101
    v_accvgpr_read_b32 v38, a102
    ds_read_b128 v[180:183], v27 offset:2048
    v_accvgpr_read_b32 v39, a103
    v_accvgpr_read_b32 v40, a104
    v_accvgpr_read_b32 v41, a105
    v_accvgpr_read_b32 v42, a106
    v_accvgpr_read_b32 v43, a107
    ds_read_b128 v[184:187], v27 offset:4096
    v_accvgpr_read_b32 v44, a108
    v_accvgpr_read_b32 v45, a109
    v_accvgpr_read_b32 v46, a110
    v_accvgpr_read_b32 v47, a111
    v_pk_mul_f32 v[32:33], v[32:33], v[72:73] op_sel_hi:[1,0]
    ds_read_b128 v[188:191], v27 offset:6144
    v_pk_mul_f32 v[34:35], v[34:35], v[72:73] op_sel_hi:[1,0]
    v_pk_mul_f32 v[36:37], v[36:37], v[72:73] op_sel_hi:[1,0]
    v_pk_mul_f32 v[38:39], v[38:39], v[72:73] op_sel_hi:[1,0]
    v_pk_mul_f32 v[40:41], v[40:41], v[72:73] op_sel_hi:[1,0]
    v_pk_mul_f32 v[42:43], v[42:43], v[72:73] op_sel_hi:[1,0]
    ds_read_b128 v[192:195], v27 offset:8192
    v_pk_mul_f32 v[44:45], v[44:45], v[72:73] op_sel_hi:[1,0]
    v_pk_mul_f32 v[46:47], v[46:47], v[72:73] op_sel_hi:[1,0]
    v_cvt_pk_bf16_f32 v64, v32, v33
    v_cvt_pk_bf16_f32 v65, v34, v35
    v_cvt_pk_bf16_f32 v66, v36, v37
    ds_read_b128 v[196:199], v27 offset:10240
    v_cvt_pk_bf16_f32 v67, v38, v39
    buffer_store_dwordx4 v[96:99], v24, s[20:23], s32 offen offset:2048 sc1
    v_cvt_pk_bf16_f32 v68, v40, v41
    v_cvt_pk_bf16_f32 v69, v42, v43
    v_cvt_pk_bf16_f32 v70, v44, v45
    ds_read_b128 v[200:203], v27 offset:12288
    v_cvt_pk_bf16_f32 v71, v46, v47
    buffer_store_dwordx4 v[100:103], v24, s[20:23], s32 offen offset:3072 sc1
    v_accvgpr_read_b32 v48, a112
    v_accvgpr_read_b32 v49, a113
    v_accvgpr_read_b32 v50, a114
    ds_read_b128 v[204:207], v27 offset:14336
    v_accvgpr_read_b32 v51, a115
    v_accvgpr_read_b32 v52, a116
    v_accvgpr_read_b32 v53, a117
    v_accvgpr_read_b32 v54, a118
    v_accvgpr_read_b32 v55, a119
    ds_read_b128 v[208:211], v27 offset:16384
    v_accvgpr_read_b32 v56, a120
    v_accvgpr_read_b32 v57, a121
    v_accvgpr_read_b32 v58, a122
    v_accvgpr_read_b32 v59, a123
    v_accvgpr_read_b32 v60, a124
    ds_read_b128 v[212:215], v27 offset:18432
    v_accvgpr_read_b32 v61, a125
    v_accvgpr_read_b32 v62, a126
    v_accvgpr_read_b32 v63, a127
    v_pk_mul_f32 v[48:49], v[48:49], v[72:73] op_sel_hi:[1,0]
    v_pk_mul_f32 v[50:51], v[50:51], v[72:73] op_sel_hi:[1,0]
    ds_read_b128 v[216:219], v27 offset:1024
    v_pk_mul_f32 v[52:53], v[52:53], v[72:73] op_sel_hi:[1,0]
    v_pk_mul_f32 v[54:55], v[54:55], v[72:73] op_sel_hi:[1,0]
    v_pk_mul_f32 v[56:57], v[56:57], v[72:73] op_sel_hi:[1,0]
    v_pk_mul_f32 v[58:59], v[58:59], v[72:73] op_sel_hi:[1,0]
    v_pk_mul_f32 v[60:61], v[60:61], v[72:73] op_sel_hi:[1,0]
    ds_read_b128 v[220:223], v27 offset:3072
    v_pk_mul_f32 v[62:63], v[62:63], v[72:73] op_sel_hi:[1,0]
    v_cvt_pk_bf16_f32 v76, v48, v49
    v_cvt_pk_bf16_f32 v77, v50, v51
    v_cvt_pk_bf16_f32 v78, v52, v53
    v_cvt_pk_bf16_f32 v79, v54, v55
    v_cvt_pk_bf16_f32 v80, v56, v57
    v_cvt_pk_bf16_f32 v81, v58, v59
    v_cvt_pk_bf16_f32 v82, v60, v61
    v_cvt_pk_bf16_f32 v83, v62, v63
    v_add_u32 v4, 256, v24
    v_add_u32 v5, 131584, v24
    v_add_u32 v6, 262912, v24
    v_add_u32 v7, 394240, v24
    v_add_u32 v8, 525568, v24
    s_lshl_b32 s68, s3, 16
    s_lshl_b32 s49, s3, 14
    s_and_b32 s48, s92, 0x1fff
    v_add_u32 v9, s48, v24
    v_add_u32 v13, s49, v9
    s_and_b32 s48, s93, 0x1fff
    v_add_u32 v10, s48, v24
    v_add_u32 v14, s49, v10
    s_and_b32 s48, s94, 0x1fff
    v_add_u32 v11, s48, v24
    v_add_u32 v15, s49, v11
    s_and_b32 s48, s95, 0x1fff
    v_add_u32 v12, s48, v24
    v_add_u32 v16, s49, v12
    s_waitcnt lgkmcnt(0)
    s_branch L_op
L_t15:
    v_mfma_f32_16x16x32_bf16 a[0:3], a[208:211], v[96:99], a[0:3]
    v_mfma_f32_16x16x32_bf16 a[4:7], a[212:215], v[96:99], a[4:7]
    v_mfma_f32_16x16x32_bf16 a[8:11], a[216:219], v[96:99], a[8:11]
    v_mfma_f32_16x16x32_bf16 a[12:15], a[220:223], v[96:99], a[12:15]
    v_mov_b32 v1, 147456
    v_mov_b32_e64 v2, 1
    v_mfma_f32_16x16x32_bf16 a[32:35], a[208:211], v[100:103], a[32:35]
    v_accvgpr_read_b32 v32, a224
    v_accvgpr_read_b32 v33, a225
    v_mfma_f32_16x16x32_bf16 a[36:39], a[212:215], v[100:103], a[36:39]
    v_accvgpr_read_b32 v34, a226
    v_accvgpr_read_b32 v35, a227
    v_mfma_f32_16x16x32_bf16 a[40:43], a[216:219], v[100:103], a[40:43]
    v_accvgpr_read_b32 v36, a228
    v_accvgpr_read_b32 v37, a229
    v_mfma_f32_16x16x32_bf16 a[44:47], a[220:223], v[100:103], a[44:47]
    v_accvgpr_read_b32 v38, a230
    v_accvgpr_read_b32 v39, a231
    v_mfma_f32_16x16x32_bf16 a[64:67], a[208:211], v[104:107], a[64:67]
    v_accvgpr_read_b32 v40, a232
    v_accvgpr_read_b32 v41, a233
    v_mfma_f32_16x16x32_bf16 a[68:71], a[212:215], v[104:107], a[68:71]
    v_accvgpr_read_b32 v42, a234
    v_accvgpr_read_b32 v43, a235
    v_mfma_f32_16x16x32_bf16 a[72:75], a[216:219], v[104:107], a[72:75]
    v_add_f32 v26, v32, v33
    v_add_f32 v28, v34, v35
    v_mfma_f32_16x16x32_bf16 a[76:79], a[220:223], v[104:107], a[76:79]
    v_add_f32 v30, v36, v37
    v_add_f32 v16, v38, v39
    v_mfma_f32_16x16x32_bf16 a[96:99], a[208:211], v[108:111], a[96:99]
    v_add_f32 v18, v40, v41
    v_add_f32 v3, v26, v28
    v_mfma_f32_16x16x32_bf16 a[100:103], a[212:215], v[108:111], a[100:103]
    v_add_f32 v32, v30, v16
    v_add_f32 v42, v42, v43
    v_mfma_f32_16x16x32_bf16 a[104:107], a[216:219], v[108:111], a[104:107]
    v_add_f32 v18, v18, v42
    v_add_f32 v3, v3, v18
    v_mfma_f32_16x16x32_bf16 a[108:111], a[220:223], v[108:111], a[108:111]
    v_add_f32 v3, v3, v32
    v_cmp_ngt_f32 vcc, s51, v3
    v_mfma_f32_16x16x32_bf16 a[128:131], a[208:211], v[20:23], a[128:131]
    v_rcp_f32 v26, v26
    v_rcp_f32 v28, v28
    v_mfma_f32_16x16x32_bf16 a[132:135], a[212:215], v[20:23], a[132:135]
    v_rcp_f32 v30, v30
    v_rcp_f32 v16, v16
    v_mfma_f32_16x16x32_bf16 a[136:139], a[216:219], v[20:23], a[136:139]
    v_rcp_f32_e64 v18, v18
    v_mfma_f32_16x16x32_bf16 a[140:143], a[220:223], v[20:23], a[140:143]
    s_cbranch_vccnz L_ovf05
L_nof05:
    s_waitcnt lgkmcnt(0)
    s_barrier
    s_nop 0
    ds_read_b32 v3, v1
    v_accvgpr_read_b32 v32, a0
    v_accvgpr_read_b32 v33, a1
    v_accvgpr_read_b32 v34, a2
    v_accvgpr_read_b32 v35, a3
    v_accvgpr_read_b32 v36, a4
    v_accvgpr_read_b32 v37, a5
    v_accvgpr_read_b32 v38, a6
    v_accvgpr_read_b32 v39, a7
    v_accvgpr_read_b32 v40, a8
    v_accvgpr_read_b32 v41, a9
    v_accvgpr_read_b32 v42, a10
    v_accvgpr_read_b32 v43, a11
    v_accvgpr_read_b32 v44, a12
    v_accvgpr_read_b32 v45, a13
    v_accvgpr_read_b32 v46, a14
    v_accvgpr_read_b32 v47, a15
    v_pk_mul_f32 v[32:33], v[32:33], v[26:27] op_sel_hi:[1,0]
    v_pk_mul_f32 v[34:35], v[34:35], v[26:27] op_sel_hi:[1,0]
    v_pk_mul_f32 v[36:37], v[36:37], v[26:27] op_sel_hi:[1,0]
    v_pk_mul_f32 v[38:39], v[38:39], v[26:27] op_sel_hi:[1,0]
    v_pk_mul_f32 v[40:41], v[40:41], v[26:27] op_sel_hi:[1,0]
    v_pk_mul_f32 v[42:43], v[42:43], v[26:27] op_sel_hi:[1,0]
    v_pk_mul_f32 v[44:45], v[44:45], v[26:27] op_sel_hi:[1,0]
    v_pk_mul_f32 v[46:47], v[46:47], v[26:27] op_sel_hi:[1,0]
    v_accvgpr_read_b32 v48, a16
    v_accvgpr_read_b32 v49, a17
    v_accvgpr_read_b32 v50, a18
    v_accvgpr_read_b32 v51, a19
    v_accvgpr_read_b32 v52, a20
    v_accvgpr_read_b32 v53, a21
    v_accvgpr_read_b32 v54, a22
    v_accvgpr_read_b32 v55, a23
    v_accvgpr_read_b32 v56, a24
    v_accvgpr_read_b32 v57, a25
    v_accvgpr_read_b32 v58, a26
    v_accvgpr_read_b32 v59, a27
    s_waitcnt lgkmcnt(0)
    v_readfirstlane_b32 s48, v3
    v_accvgpr_read_b32 v60, a28
    v_accvgpr_read_b32 v61, a29
    v_accvgpr_read_b32 v62, a30
    v_accvgpr_read_b32 v63, a31
    s_andn2_b32 s48, s48, s37
    s_cbranch_scc1 L_redo5
    ds_read_b128 a[208:211], v72 offset:0
    ds_read_b128 a[212:215], v72 offset:64
    ds_read_b128 a[216:219], v72 offset:128
    ds_read_b128 a[220:223], v72 offset:192
    ds_read_b128 v[176:179], v27 offset:0
    ds_read_b128 v[180:183], v27 offset:1024
    ds_read_b128 v[184:187], v27 offset:2048
    ds_read_b128 v[188:191], v27 offset:3072
    v_mov_b64 v[96:97], 0
    v_mov_b64 v[98:99], 0
    v_mov_b64 v[100:101], 0
    v_mov_b64 v[102:103], 0
    v_mov_b64 v[104:105], 0
    v_mov_b64 v[106:107], 0
    v_mov_b64 v[108:109], 0
    v_mov_b64 v[110:111], 0
    v_mov_b64 v[20:21], 0
    v_mov_b64 v[22:23], 0
    v_mfma_f32_32x32x16_bf16 a[224:239], v[96:99], v[96:99], 0
    v_mov_b64 v[192:193], v[112:113]
    v_mov_b64 v[194:195], v[114:115]
    v_mov_b64 v[196:197], v[116:117]
    v_mov_b64 v[198:199], v[118:119]
    v_mov_b64 v[200:201], v[120:121]
    v_mov_b64 v[202:203], v[122:123]
    v_mfma_f32_32x32x16_bf16 a[0:15], v[96:99], v[96:99], 0
    v_mov_b64 v[204:205], v[124:125]
    v_mov_b64 v[206:207], v[126:127]
    v_mov_b64 v[208:209], v[128:129]
    v_mov_b64 v[210:211], v[130:131]
    v_mov_b64 v[212:213], v[132:133]
    v_mov_b64 v[214:215], v[134:135]
    v_mfma_f32_32x32x16_bf16 a[16:31], v[96:99], v[96:99], 0
    v_mov_b64 v[216:217], v[136:137]
    v_mov_b64 v[218:219], v[138:139]
    v_mov_b64 v[220:221], v[140:141]
    v_mov_b64 v[222:223], v[142:143]
    v_mov_b64 v[224:225], v[144:145]
    v_mov_b64 v[226:227], v[146:147]
    v_mov_b64 v[228:229], v[148:149]
    v_mov_b64 v[230:231], v[150:151]
    v_mov_b64 v[232:233], v[152:153]
    v_mov_b64 v[234:235], v[154:155]
    v_mov_b64 v[236:237], v[156:157]
    v_mov_b64 v[238:239], v[158:159]
    v_mov_b64 v[240:241], v[160:161]
    v_mov_b64 v[242:243], v[162:163]
    v_mov_b64 v[244:245], v[164:165]
    v_mov_b64 v[246:247], v[166:167]
    v_mov_b64 v[248:249], v[168:169]
    v_mov_b64 v[250:251], v[170:171]
    v_mov_b64 v[252:253], v[172:173]
    v_mov_b64 v[254:255], v[174:175]
    s_mov_b32 s36, 1
    s_mov_b32 s26, s97
    s_mov_b32 s37, 0
    s_mov_b32 s35, 8
    v_add_u32 v1, 8192, v24
    s_waitcnt lgkmcnt(0)
    s_nop 0
    v_mfma_f32_16x16x32_bf16 v[76:79], a[208:211], v[176:179], 0
    v_cvt_pk_bf16_f32 v160, v32, v33
    v_cvt_pk_bf16_f32 v161, v34, v35
    v_mfma_f32_16x16x32_bf16 v[76:79], a[212:215], v[180:183], v[76:79]
    v_cvt_pk_bf16_f32 v162, v36, v37
    v_cvt_pk_bf16_f32 v163, v38, v39
    v_cvt_pk_bf16_f32 v164, v40, v41
    v_cvt_pk_bf16_f32 v165, v42, v43
    v_cvt_pk_bf16_f32 v166, v44, v45
    v_cvt_pk_bf16_f32 v167, v46, v47
    buffer_load_dwordx4 v[112:115], v24, s[4:7], s92 offen offset:0 sc1
    v_pk_mul_f32 v[48:49], v[48:49], v[26:27] op_sel_hi:[1,0]
    v_pk_mul_f32 v[50:51], v[50:51], v[26:27] op_sel_hi:[1,0]
    v_pk_mul_f32 v[52:53], v[52:53], v[26:27] op_sel_hi:[1,0]
    v_pk_mul_f32 v[54:55], v[54:55], v[26:27] op_sel_hi:[1,0]
    v_pk_mul_f32 v[56:57], v[56:57], v[26:27] op_sel_hi:[1,0]
    v_pk_mul_f32 v[58:59], v[58:59], v[26:27] op_sel_hi:[1,0]
    v_pk_mul_f32 v[60:61], v[60:61], v[26:27] op_sel_hi:[1,0]
    v_pk_mul_f32 v[62:63], v[62:63], v[26:27] op_sel_hi:[1,0]
    v_mfma_f32_16x16x32_bf16 v[76:79], a[216:219], v[184:187], v[76:79]
    buffer_store_dwordx4 v[160:163], v24, s[20:23], s50 offen offset:0 sc1
    v_mfma_f32_16x16x32_bf16 v[76:79], a[220:223], v[188:191], v[76:79]
    v_cvt_pk_bf16_f32 v168, v48, v49
    v_cvt_pk_bf16_f32 v169, v50, v51
    v_mfma_f32_16x16x32_bf16 v[80:83], a[208:211], v[192:195], 0
    v_cvt_pk_bf16_f32 v170, v52, v53
    v_cvt_pk_bf16_f32 v171, v54, v55
    buffer_store_dwordx4 v[164:167], v24, s[20:23], s50 offen offset:1024 sc1
    v_cvt_pk_bf16_f32 v172, v56, v57
    v_cvt_pk_bf16_f32 v173, v58, v59
    v_cvt_pk_bf16_f32 v174, v60, v61
    v_cvt_pk_bf16_f32 v175, v62, v63
    buffer_load_dwordx4 v[116:119], v24, s[4:7], s92 offen offset:1024 sc1
    v_accvgpr_read_b32 v32, a32
    v_accvgpr_read_b32 v33, a33
    v_accvgpr_read_b32 v34, a34
    v_accvgpr_read_b32 v35, a35
    v_accvgpr_read_b32 v36, a36
    v_accvgpr_read_b32 v37, a37
    v_accvgpr_read_b32 v38, a38
    v_accvgpr_read_b32 v39, a39
    v_accvgpr_read_b32 v40, a40
    v_accvgpr_read_b32 v41, a41
    v_accvgpr_read_b32 v42, a42
    v_accvgpr_read_b32 v43, a43
    v_accvgpr_read_b32 v44, a44
    v_accvgpr_read_b32 v45, a45
    v_accvgpr_read_b32 v46, a46
    v_accvgpr_read_b32 v47, a47
    v_pk_mul_f32 v[32:33], v[32:33], v[28:29] op_sel_hi:[1,0]
    v_pk_mul_f32 v[34:35], v[34:35], v[28:29] op_sel_hi:[1,0]
    v_pk_mul_f32 v[36:37], v[36:37], v[28:29] op_sel_hi:[1,0]
    v_pk_mul_f32 v[38:39], v[38:39], v[28:29] op_sel_hi:[1,0]
    v_pk_mul_f32 v[40:41], v[40:41], v[28:29] op_sel_hi:[1,0]
    v_pk_mul_f32 v[42:43], v[42:43], v[28:29] op_sel_hi:[1,0]
    v_pk_mul_f32 v[44:45], v[44:45], v[28:29] op_sel_hi:[1,0]
    v_pk_mul_f32 v[46:47], v[46:47], v[28:29] op_sel_hi:[1,0]
    v_mfma_f32_32x32x16_bf16 a[32:47], v[96:99], v[96:99], 0
    buffer_store_dwordx4 v[168:171], v24, s[20:23], s50 offen offset:2048 sc1
    v_cvt_pk_bf16_f32 v160, v32, v33
    v_cvt_pk_bf16_f32 v161, v34, v35
    v_mfma_f32_16x16x32_bf16 v[80:83], a[212:215], v[196:199], v[80:83]
    v_cvt_pk_bf16_f32 v162, v36, v37
    v_cvt_pk_bf16_f32 v163, v38, v39
    v_mfma_f32_16x16x32_bf16 v[80:83], a[216:219], v[200:203], v[80:83]
    buffer_store_dwordx4 v[172:175], v24, s[20:23], s50 offen offset:3072 sc1
    v_cvt_pk_bf16_f32 v164, v40, v41
    v_cvt_pk_bf16_f32 v165, v42, v43
    v_cvt_pk_bf16_f32 v166, v44, v45
    v_cvt_pk_bf16_f32 v167, v46, v47
    buffer_load_dwordx4 v[120:123], v24, s[4:7], s93 offen offset:0 sc1
    v_accvgpr_read_b32 v48, a48
    v_accvgpr_read_b32 v49, a49
    v_accvgpr_read_b32 v50, a50
    v_accvgpr_read_b32 v51, a51
    v_accvgpr_read_b32 v52, a52
    v_accvgpr_read_b32 v53, a53
    v_accvgpr_read_b32 v54, a54
    v_accvgpr_read_b32 v55, a55
    buffer_load_dwordx4 v[124:127], v24, s[4:7], s93 offen offset:1024 sc1
    v_accvgpr_read_b32 v56, a56
    v_accvgpr_read_b32 v57, a57
    v_accvgpr_read_b32 v58, a58
    v_accvgpr_read_b32 v59, a59
    v_accvgpr_read_b32 v60, a60
    v_accvgpr_read_b32 v61, a61
    v_accvgpr_read_b32 v62, a62
    v_accvgpr_read_b32 v63, a63
    v_pk_mul_f32 v[48:49], v[48:49], v[28:29] op_sel_hi:[1,0]
    v_pk_mul_f32 v[50:51], v[50:51], v[28:29] op_sel_hi:[1,0]
    v_pk_mul_f32 v[52:53], v[52:53], v[28:29] op_sel_hi:[1,0]
    v_pk_mul_f32 v[54:55], v[54:55], v[28:29] op_sel_hi:[1,0]
    v_pk_mul_f32 v[56:57], v[56:57], v[28:29] op_sel_hi:[1,0]
    v_pk_mul_f32 v[58:59], v[58:59], v[28:29] op_sel_hi:[1,0]
    v_pk_mul_f32 v[60:61], v[60:61], v[28:29] op_sel_hi:[1,0]
    v_pk_mul_f32 v[62:63], v[62:63], v[28:29] op_sel_hi:[1,0]
    v_mfma_f32_32x32x16_bf16 a[48:63], v[96:99], v[96:99], 0
    ds_write_b128 v27, v[160:163] offset:4096
    v_cvt_pk_bf16_f32 v168, v48, v49
    v_cvt_pk_bf16_f32 v169, v50, v51
    v_mfma_f32_16x16x32_bf16 v[80:83], a[220:223], v[204:207], v[80:83]
    v_cvt_pk_bf16_f32 v170, v52, v53
    v_cvt_pk_bf16_f32 v171, v54, v55
    v_mfma_f32_16x16x32_bf16 v[84:87], a[208:211], v[208:211], 0
    ds_write_b128 v27, v[164:167] offset:5120
    v_mfma_f32_16x16x32_bf16 v[84:87], a[212:215], v[212:215], v[84:87]
    v_cvt_pk_bf16_f32 v172, v56, v57
    v_cvt_pk_bf16_f32 v173, v58, v59
    v_cvt_pk_bf16_f32 v174, v60, v61
    v_cvt_pk_bf16_f32 v175, v62, v63
    buffer_load_dwordx4 v[128:131], v24, s[4:7], s94 offen offset:0 sc1
    v_accvgpr_read_b32 v32, a64
    v_accvgpr_read_b32 v33, a65
    v_accvgpr_read_b32 v34, a66
    v_accvgpr_read_b32 v35, a67
    v_accvgpr_read_b32 v36, a68
    v_accvgpr_read_b32 v37, a69
    v_accvgpr_read_b32 v38, a70
    v_accvgpr_read_b32 v39, a71
    v_accvgpr_read_b32 v40, a72
    v_accvgpr_read_b32 v41, a73
    v_accvgpr_read_b32 v42, a74
    v_accvgpr_read_b32 v43, a75
    v_accvgpr_read_b32 v44, a76
    v_accvgpr_read_b32 v45, a77
    v_accvgpr_read_b32 v46, a78
    v_accvgpr_read_b32 v47, a79
    v_pk_mul_f32 v[32:33], v[32:33], v[30:31] op_sel_hi:[1,0]
    v_pk_mul_f32 v[34:35], v[34:35], v[30:31] op_sel_hi:[1,0]
    v_pk_mul_f32 v[36:37], v[36:37], v[30:31] op_sel_hi:[1,0]
    v_pk_mul_f32 v[38:39], v[38:39], v[30:31] op_sel_hi:[1,0]
    v_pk_mul_f32 v[40:41], v[40:41], v[30:31] op_sel_hi:[1,0]
    v_pk_mul_f32 v[42:43], v[42:43], v[30:31] op_sel_hi:[1,0]
    v_pk_mul_f32 v[44:45], v[44:45], v[30:31] op_sel_hi:[1,0]
    v_pk_mul_f32 v[46:47], v[46:47], v[30:31] op_sel_hi:[1,0]
    v_mfma_f32_32x32x16_bf16 a[64:79], v[96:99], v[96:99], 0
    ds_write_b128 v27, v[168:171] offset:6144
    v_cvt_pk_bf16_f32 v160, v32, v33
    v_cvt_pk_bf16_f32 v161, v34, v35
    v_mfma_f32_16x16x32_bf16 v[84:87], a[216:219], v[216:219], v[84:87]
    v_cvt_pk_bf16_f32 v162, v36, v37
    v_cvt_pk_bf16_f32 v163, v38, v39
    v_mfma_f32_16x16x32_bf16 v[84:87], a[220:223], v[220:223], v[84:87]
    ds_write_b128 v27, v[172:175] offset:7168
    v_cvt_pk_bf16_f32 v164, v40, v41
    v_cvt_pk_bf16_f32 v165, v42, v43
    v_cvt_pk_bf16_f32 v166, v44, v45
    v_cvt_pk_bf16_f32 v167, v46, v47
    buffer_load_dwordx4 v[132:135], v24, s[4:7], s94 offen offset:1024 sc1
    v_accvgpr_read_b32 v48, a80
    v_accvgpr_read_b32 v49, a81
    v_accvgpr_read_b32 v50, a82
    v_accvgpr_read_b32 v51, a83
    v_accvgpr_read_b32 v52, a84
    v_accvgpr_read_b32 v53, a85
    v_accvgpr_read_b32 v54, a86
    v_accvgpr_read_b32 v55, a87
    v_accvgpr_read_b32 v56, a88
    v_accvgpr_read_b32 v57, a89
    v_accvgpr_read_b32 v58, a90
    v_accvgpr_read_b32 v59, a91
    v_accvgpr_read_b32 v60, a92
    v_accvgpr_read_b32 v61, a93
    v_accvgpr_read_b32 v62, a94
    v_accvgpr_read_b32 v63, a95
    v_pk_mul_f32 v[48:49], v[48:49], v[30:31] op_sel_hi:[1,0]
    v_pk_mul_f32 v[50:51], v[50:51], v[30:31] op_sel_hi:[1,0]
    v_pk_mul_f32 v[52:53], v[52:53], v[30:31] op_sel_hi:[1,0]
    v_pk_mul_f32 v[54:55], v[54:55], v[30:31] op_sel_hi:[1,0]
    v_pk_mul_f32 v[56:57], v[56:57], v[30:31] op_sel_hi:[1,0]
    v_pk_mul_f32 v[58:59], v[58:59], v[30:31] op_sel_hi:[1,0]
    v_pk_mul_f32 v[60:61], v[60:61], v[30:31] op_sel_hi:[1,0]
    v_pk_mul_f32 v[62:63], v[62:63], v[30:31] op_sel_hi:[1,0]
    v_mfma_f32_32x32x16_bf16 a[80:95], v[96:99], v[96:99], 0
    ds_write_b128 v27, v[160:163] offset:8192
    v_cvt_pk_bf16_f32 v168, v48, v49
    v_cvt_pk_bf16_f32 v169, v50, v51
    v_mfma_f32_16x16x32_bf16 v[88:91], a[208:211], v[224:227], 0
    v_cvt_pk_bf16_f32 v170, v52, v53
    v_cvt_pk_bf16_f32 v171, v54, v55
    v_mfma_f32_16x16x32_bf16 v[88:91], a[212:215], v[228:231], v[88:91]
    ds_write_b128 v27, v[164:167] offset:9216
    v_mfma_f32_16x16x32_bf16 v[88:91], a[216:219], v[232:235], v[88:91]
    v_cvt_pk_bf16_f32 v172, v56, v57
    v_cvt_pk_bf16_f32 v173, v58, v59
    v_cvt_pk_bf16_f32 v174, v60, v61
    v_cvt_pk_bf16_f32 v175, v62, v63
    buffer_load_dwordx4 v[136:139], v24, s[4:7], s95 offen offset:0 sc1
    v_accvgpr_read_b32 v32, a96
    v_accvgpr_read_b32 v33, a97
    v_accvgpr_read_b32 v34, a98
    v_accvgpr_read_b32 v35, a99
    v_accvgpr_read_b32 v36, a100
    v_accvgpr_read_b32 v37, a101
    v_accvgpr_read_b32 v38, a102
    v_accvgpr_read_b32 v39, a103
    buffer_load_dwordx4 v[140:143], v24, s[4:7], s95 offen offset:1024 sc1
    v_accvgpr_read_b32 v40, a104
    v_accvgpr_read_b32 v41, a105
    v_accvgpr_read_b32 v42, a106
    v_accvgpr_read_b32 v43, a107
    v_accvgpr_read_b32 v44, a108
    v_accvgpr_read_b32 v45, a109
    v_accvgpr_read_b32 v46, a110
    v_accvgpr_read_b32 v47, a111
    v_pk_mul_f32 v[32:33], v[32:33], v[16:17] op_sel_hi:[1,0]
    v_pk_mul_f32 v[34:35], v[34:35], v[16:17] op_sel_hi:[1,0]
    v_pk_mul_f32 v[36:37], v[36:37], v[16:17] op_sel_hi:[1,0]
    v_pk_mul_f32 v[38:39], v[38:39], v[16:17] op_sel_hi:[1,0]
    v_pk_mul_f32 v[40:41], v[40:41], v[16:17] op_sel_hi:[1,0]
    v_pk_mul_f32 v[42:43], v[42:43], v[16:17] op_sel_hi:[1,0]
    v_pk_mul_f32 v[44:45], v[44:45], v[16:17] op_sel_hi:[1,0]
    v_pk_mul_f32 v[46:47], v[46:47], v[16:17] op_sel_hi:[1,0]
    v_mfma_f32_32x32x16_bf16 a[96:111], v[96:99], v[96:99], 0
    ds_write_b128 v27, v[168:171] offset:10240
    v_cvt_pk_bf16_f32 v160, v32, v33
    v_cvt_pk_bf16_f32 v161, v34, v35
    v_mfma_f32_16x16x32_bf16 v[88:91], a[220:223], v[236:239], v[88:91]
    v_cvt_pk_bf16_f32 v162, v36, v37
    v_cvt_pk_bf16_f32 v163, v38, v39
    v_mfma_f32_16x16x32_bf16 v[92:95], a[208:211], v[240:243], 0
    ds_write_b128 v27, v[172:175] offset:11264
    v_cvt_pk_bf16_f32 v164, v40, v41
    v_cvt_pk_bf16_f32 v165, v42, v43
    v_cvt_pk_bf16_f32 v166, v44, v45
    v_cvt_pk_bf16_f32 v167, v46, v47
    buffer_load_dwordx4 v[144:147], v1, s[4:7], s92 offen offset:0 sc1
    v_accvgpr_read_b32 v48, a112
    v_accvgpr_read_b32 v49, a113
    v_accvgpr_read_b32 v50, a114
    v_accvgpr_read_b32 v51, a115
    v_accvgpr_read_b32 v52, a116
    v_accvgpr_read_b32 v53, a117
    v_accvgpr_read_b32 v54, a118
    v_accvgpr_read_b32 v55, a119
    v_accvgpr_read_b32 v56, a120
    v_accvgpr_read_b32 v57, a121
    v_accvgpr_read_b32 v58, a122
    v_accvgpr_read_b32 v59, a123
    v_accvgpr_read_b32 v60, a124
    v_accvgpr_read_b32 v61, a125
    v_accvgpr_read_b32 v62, a126
    v_accvgpr_read_b32 v63, a127
    v_pk_mul_f32 v[48:49], v[48:49], v[16:17] op_sel_hi:[1,0]
    v_pk_mul_f32 v[50:51], v[50:51], v[16:17] op_sel_hi:[1,0]
    v_pk_mul_f32 v[52:53], v[52:53], v[16:17] op_sel_hi:[1,0]
    v_pk_mul_f32 v[54:55], v[54:55], v[16:17] op_sel_hi:[1,0]
    v_pk_mul_f32 v[56:57], v[56:57], v[16:17] op_sel_hi:[1,0]
    v_pk_mul_f32 v[58:59], v[58:59], v[16:17] op_sel_hi:[1,0]
    v_pk_mul_f32 v[60:61], v[60:61], v[16:17] op_sel_hi:[1,0]
    v_pk_mul_f32 v[62:63], v[62:63], v[16:17] op_sel_hi:[1,0]
    v_mfma_f32_32x32x16_bf16 a[112:127], v[96:99], v[96:99], 0
    ds_write_b128 v27, v[160:163] offset:12288
    v_cvt_pk_bf16_f32 v168, v48, v49
    v_cvt_pk_bf16_f32 v169, v50, v51
    v_mfma_f32_16x16x32_bf16 v[92:95], a[212:215], v[244:247], v[92:95]
    v_cvt_pk_bf16_f32 v170, v52, v53
    v_cvt_pk_bf16_f32 v171, v54, v55
    v_mfma_f32_16x16x32_bf16 v[92:95], a[216:219], v[248:251], v[92:95]
    ds_write_b128 v27, v[164:167] offset:13312
    v_mfma_f32_16x16x32_bf16 v[92:95], a[220:223], v[252:255], v[92:95]
    v_cvt_pk_bf16_f32 v172, v56, v57
    v_cvt_pk_bf16_f32 v173, v58, v59
    v_cvt_pk_bf16_f32 v174, v60, v61
    v_cvt_pk_bf16_f32 v175, v62, v63
    buffer_load_dwordx4 v[148:151], v1, s[4:7], s92 offen offset:1024 sc1
    v_accvgpr_read_b32 v32, a128
    v_accvgpr_read_b32 v33, a129
    v_accvgpr_read_b32 v34, a130
    v_accvgpr_read_b32 v35, a131
    v_accvgpr_read_b32 v36, a132
    v_accvgpr_read_b32 v37, a133
    v_accvgpr_read_b32 v38, a134
    v_accvgpr_read_b32 v39, a135
    v_accvgpr_read_b32 v40, a136
    v_accvgpr_read_b32 v41, a137
    v_accvgpr_read_b32 v42, a138
    v_accvgpr_read_b32 v43, a139
    v_accvgpr_read_b32 v44, a140
    v_accvgpr_read_b32 v45, a141
    v_accvgpr_read_b32 v46, a142
    v_accvgpr_read_b32 v47, a143
    v_pk_mul_f32 v[32:33], v[32:33], v[18:19] op_sel_hi:[1,0]
    v_pk_mul_f32 v[34:35], v[34:35], v[18:19] op_sel_hi:[1,0]
    v_pk_mul_f32 v[36:37], v[36:37], v[18:19] op_sel_hi:[1,0]
    v_pk_mul_f32 v[38:39], v[38:39], v[18:19] op_sel_hi:[1,0]
    v_pk_mul_f32 v[40:41], v[40:41], v[18:19] op_sel_hi:[1,0]
    v_pk_mul_f32 v[42:43], v[42:43], v[18:19] op_sel_hi:[1,0]
    v_pk_mul_f32 v[44:45], v[44:45], v[18:19] op_sel_hi:[1,0]
    v_pk_mul_f32 v[46:47], v[46:47], v[18:19] op_sel_hi:[1,0]
    v_mfma_f32_32x32x16_bf16 a[128:143], v[96:99], v[96:99], 0
    ds_write_b128 v27, v[168:171] offset:14336
    v_cvt_pk_bf16_f32 v160, v32, v33
    v_cvt_pk_bf16_f32 v161, v34, v35
    v_cvt_pk_bf16_f32 v162, v36, v37
    v_cvt_pk_bf16_f32 v163, v38, v39
    ds_write_b128 v27, v[172:175] offset:15360
    v_cvt_pk_bf16_f32 v164, v40, v41
    v_cvt_pk_bf16_f32 v165, v42, v43
    v_cvt_pk_bf16_f32 v166, v44, v45
    v_cvt_pk_bf16_f32 v167, v46, v47
    buffer_load_dwordx4 v[152:155], v1, s[4:7], s93 offen offset:0 sc1
    v_accvgpr_read_b32 v48, a144
    v_accvgpr_read_b32 v49, a145
    v_accvgpr_read_b32 v50, a146
    v_accvgpr_read_b32 v51, a147
    v_accvgpr_read_b32 v52, a148
    v_accvgpr_read_b32 v53, a149
    v_accvgpr_read_b32 v54, a150
    v_accvgpr_read_b32 v55, a151
    buffer_load_dwordx4 v[156:159], v1, s[4:7], s93 offen offset:1024 sc1
    v_accvgpr_read_b32 v56, a152
    v_accvgpr_read_b32 v57, a153
    v_accvgpr_read_b32 v58, a154
    v_accvgpr_read_b32 v59, a155
    v_accvgpr_read_b32 v60, a156
    v_accvgpr_read_b32 v61, a157
    v_accvgpr_read_b32 v62, a158
    v_accvgpr_read_b32 v63, a159
    v_pk_mul_f32 v[48:49], v[48:49], v[18:19] op_sel_hi:[1,0]
    v_pk_mul_f32 v[50:51], v[50:51], v[18:19] op_sel_hi:[1,0]
    v_pk_mul_f32 v[52:53], v[52:53], v[18:19] op_sel_hi:[1,0]
    v_pk_mul_f32 v[54:55], v[54:55], v[18:19] op_sel_hi:[1,0]
    v_pk_mul_f32 v[56:57], v[56:57], v[18:19] op_sel_hi:[1,0]
    v_pk_mul_f32 v[58:59], v[58:59], v[18:19] op_sel_hi:[1,0]
    v_pk_mul_f32 v[60:61], v[60:61], v[18:19] op_sel_hi:[1,0]
    v_pk_mul_f32 v[62:63], v[62:63], v[18:19] op_sel_hi:[1,0]
    v_mfma_f32_32x32x16_bf16 a[144:159], v[96:99], v[96:99], 0
    v_cvt_pk_bf16_f32 v168, v48, v49
    v_cvt_pk_bf16_f32 v169, v50, v51
    v_cvt_pk_bf16_f32 v170, v52, v53
    v_cvt_pk_bf16_f32 v171, v54, v55
    v_cvt_pk_bf16_f32 v172, v56, v57
    v_cvt_pk_bf16_f32 v173, v58, v59
    v_cvt_pk_bf16_f32 v174, v60, v61
    v_cvt_pk_bf16_f32 v175, v62, v63
    v_max3_f32 v76, v76, v77, v78
    v_max3_f32 v80, v80, v81, v82
    v_max3_f32 v84, v84, v85, v86
    v_max3_f32 v88, v88, v89, v90
    v_max3_f32 v92, v92, v93, v94
    v_max_f32 v76, v76, v79
    v_max_f32 v80, v80, v83
    v_max_f32 v84, v84, v87
    v_max_f32 v88, v88, v91
    v_max_f32_e64 v92, v92, v95
    v_pk_mul_f32 v[78:79], v[76:77], -1.0 op_sel_hi:[0,0]
    v_pk_mul_f32 v[82:83], v[80:81], -1.0 op_sel_hi:[0,0]
    v_pk_mul_f32 v[86:87], v[84:85], -1.0 op_sel_hi:[0,0]
    v_pk_mul_f32 v[90:91], v[88:89], -1.0 op_sel_hi:[0,0]
    v_pk_mul_f32 v[94:95], v[92:93], -1.0 op_sel_hi:[0,0]
    v_pk_mul_f32 v[76:77], v[76:77], -1.0 op_sel_hi:[0,0]
    v_pk_mul_f32 v[80:81], v[80:81], -1.0 op_sel_hi:[0,0]
    v_pk_mul_f32 v[84:85], v[84:85], -1.0 op_sel_hi:[0,0]
    v_pk_mul_f32 v[88:89], v[88:89], -1.0 op_sel_hi:[0,0]
    v_pk_mul_f32 v[92:93], v[92:93], -1.0 op_sel_hi:[0,0]
    s_nop 0
    s_nop 0
    s_nop 0
    s_nop 0
    s_nop 0
L_loopS5:
    s_waitcnt lgkmcnt(8)
    v_mfma_f32_16x16x32_bf16 v[32:35], a[160:163], v[176:179], v[76:79]
    ds_read_b64_tr_b16 a[236:237], v12 offset:8192
    v_mfma_f32_16x16x32_bf16 v[32:35], a[164:167], v[180:183], v[32:35]
    ds_read_b64_tr_b16 a[238:239], v12 offset:12288
    v_mfma_f32_16x16x32_bf16 v[32:35], a[168:171], v[184:187], v[32:35]
    ds_read_b64_tr_b16 a[240:241], v13 offset:8192
    v_mfma_f32_16x16x32_bf16 v[32:35], a[172:175], v[188:191], v[32:35]
    ds_read_b64_tr_b16 a[242:243], v13 offset:12288
    v_mfma_f32_16x16x32_bf16 v[36:39], a[176:179], v[176:179], v[76:79]
    ds_read_b64_tr_b16 a[248:249], v14 offset:8192
    v_mfma_f32_16x16x32_bf16 v[36:39], a[180:183], v[180:183], v[36:39]
    ds_read_b64_tr_b16 a[250:251], v14 offset:12288
    v_mfma_f32_16x16x32_bf16 v[36:39], a[184:187], v[184:187], v[36:39]
    ds_read_b64_tr_b16 a[252:253], v15 offset:8192
    v_mfma_f32_16x16x32_bf16 v[36:39], a[188:191], v[188:191], v[36:39]
    ds_read_b64_tr_b16 a[254:255], v15 offset:12288
    v_mfma_f32_16x16x32_bf16 v[40:43], a[160:163], v[192:195], v[80:83]
    v_exp_f32 v32, v32
    v_mfma_f32_16x16x32_bf16 v[40:43], a[164:167], v[196:199], v[40:43]
    v_exp_f32 v33, v33
    v_mfma_f32_16x16x32_bf16 v[40:43], a[168:171], v[200:203], v[40:43]
    v_exp_f32 v34, v34
    v_mfma_f32_16x16x32_bf16 v[40:43], a[172:175], v[204:207], v[40:43]
    v_exp_f32 v35, v35
    v_mfma_f32_16x16x32_bf16 v[44:47], a[176:179], v[192:195], v[80:83]
    v_cvt_pk_bf16_f32 v56, v32, v33
    v_cvt_pk_bf16_f32 v57, v34, v35
    v_mfma_f32_16x16x32_bf16 v[44:47], a[180:183], v[196:199], v[44:47]
    v_exp_f32 v36, v36
    v_mfma_f32_16x16x32_bf16 v[44:47], a[184:187], v[200:203], v[44:47]
    buffer_store_dwordx4 v[160:163], v24, s[20:23], s68 offen offset:0 sc1
    v_mfma_f32_16x16x32_bf16 v[44:47], a[188:191], v[204:207], v[44:47]
    v_exp_f32 v37, v37
    v_mfma_f32_16x16x32_bf16 v[48:51], a[160:163], v[208:211], v[84:87]
    v_exp_f32 v38, v38
    v_mfma_f32_16x16x32_bf16 v[48:51], a[164:167], v[212:215], v[48:51]
    v_exp_f32 v39, v39
    v_mfma_f32_16x16x32_bf16 v[48:51], a[168:171], v[216:219], v[48:51]
    v_cvt_pk_bf16_f32 v58, v36, v37
    v_cvt_pk_bf16_f32 v59, v38, v39
    v_mfma_f32_16x16x32_bf16 v[48:51], a[172:175], v[220:223], v[48:51]
    v_exp_f32 v40, v40
    v_mfma_f32_16x16x32_bf16 v[52:55], a[176:179], v[208:211], v[84:87]
    v_exp_f32 v41, v41
    v_mfma_f32_16x16x32_bf16 v[52:55], a[180:183], v[212:215], v[52:55]
    v_exp_f32 v42, v42
    v_mfma_f32_16x16x32_bf16 v[52:55], a[184:187], v[216:219], v[52:55]
    v_exp_f32 v43, v43
    v_mfma_f32_16x16x32_bf16 v[52:55], a[188:191], v[220:223], v[52:55]
    v_cvt_pk_bf16_f32 v60, v40, v41
    v_cvt_pk_bf16_f32 v61, v42, v43
    v_mfma_f32_16x16x32_bf16 v[32:35], a[160:163], v[224:227], v[88:91]
    v_exp_f32 v44, v44
    v_mfma_f32_16x16x32_bf16 v[32:35], a[164:167], v[228:231], v[32:35]
    v_exp_f32 v45, v45
    v_mfma_f32_16x16x32_bf16 v[32:35], a[168:171], v[232:235], v[32:35]
    v_exp_f32 v46, v46
    v_mfma_f32_16x16x32_bf16 v[32:35], a[172:175], v[236:239], v[32:35]
    v_exp_f32 v47, v47
    v_mfma_f32_16x16x32_bf16 v[36:39], a[176:179], v[224:227], v[88:91]
    v_cvt_pk_bf16_f32 v62, v44, v45
    v_cvt_pk_bf16_f32 v63, v46, v47
    v_mfma_f32_16x16x32_bf16 v[36:39], a[180:183], v[228:231], v[36:39]
    v_exp_f32 v48, v48
    v_mfma_f32_16x16x32_bf16 v[36:39], a[184:187], v[232:235], v[36:39]
    v_exp_f32 v49, v49
    v_mfma_f32_16x16x32_bf16 v[36:39], a[188:191], v[236:239], v[36:39]
    v_exp_f32 v50, v50
    v_mfma_f32_16x16x32_bf16 v[40:43], a[160:163], v[240:243], v[92:95]
    v_exp_f32 v51, v51
    v_mfma_f32_16x16x32_bf16 v[40:43], a[164:167], v[244:247], v[40:43]
    v_exp_f32 v52, v52
    v_mfma_f32_16x16x32_bf16 v[40:43], a[168:171], v[248:251], v[40:43]
    v_exp_f32 v53, v53
    v_mfma_f32_16x16x32_bf16 v[40:43], a[172:175], v[252:255], v[40:43]
    v_exp_f32 v54, v54
    v_mfma_f32_16x16x32_bf16 v[44:47], a[176:179], v[240:243], v[92:95]
    v_exp_f32 v55, v55
    v_mfma_f32_16x16x32_bf16 v[44:47], a[180:183], v[244:247], v[44:47]
    v_cvt_pk_bf16_f32 v64, v48, v49
    v_cvt_pk_bf16_f32 v65, v50, v51
    v_mfma_f32_16x16x32_bf16 v[44:47], a[184:187], v[248:251], v[44:47]
    v_cvt_pk_bf16_f32 v66, v52, v53
    v_cvt_pk_bf16_f32 v67, v54, v55
    v_mfma_f32_16x16x32_bf16 v[44:47], a[188:191], v[252:255], v[44:47]
    s_waitcnt lgkmcnt(0)
    s_barrier
    v_mfma_f32_16x16x32_bf16 a[0:3], a[208:211], v[96:99], a[0:3]
    v_exp_f32 v32, v32
    v_mfma_f32_16x16x32_bf16 a[0:3], a[192:195], v[56:59], a[0:3]
    v_exp_f32 v33, v33
    v_mfma_f32_16x16x32_bf16 a[4:7], a[212:215], v[96:99], a[4:7]
    v_exp_f32 v34, v34
    v_mfma_f32_16x16x32_bf16 a[4:7], a[196:199], v[56:59], a[4:7]
    v_exp_f32 v35, v35
    v_mfma_f32_16x16x32_bf16 a[8:11], a[216:219], v[96:99], a[8:11]
    v_exp_f32 v36, v36
    v_mfma_f32_16x16x32_bf16 a[8:11], a[200:203], v[56:59], a[8:11]
    v_exp_f32 v37, v37
    v_mfma_f32_16x16x32_bf16 a[12:15], a[220:223], v[96:99], a[12:15]
    v_exp_f32 v38, v38
    v_mfma_f32_16x16x32_bf16 a[12:15], a[204:207], v[56:59], a[12:15]
    v_exp_f32 v39, v39
    v_mfma_f32_16x16x32_bf16 a[32:35], a[208:211], v[100:103], a[32:35]
    v_cvt_pk_bf16_f32 v68, v32, v33
    v_cvt_pk_bf16_f32 v69, v34, v35
    v_mfma_f32_16x16x32_bf16 a[32:35], a[192:195], v[60:63], a[32:35]
    v_cvt_pk_bf16_f32 v70, v36, v37
    v_cvt_pk_bf16_f32 v71, v38, v39
    v_mfma_f32_16x16x32_bf16 a[36:39], a[212:215], v[100:103], a[36:39]
    v_exp_f32 v40, v40
    v_mfma_f32_16x16x32_bf16 a[36:39], a[196:199], v[60:63], a[36:39]
    v_exp_f32 v41, v41
    v_mfma_f32_16x16x32_bf16 a[40:43], a[216:219], v[100:103], a[40:43]
    v_exp_f32 v42, v42
    v_mfma_f32_16x16x32_bf16 a[40:43], a[200:203], v[60:63], a[40:43]
    v_exp_f32 v43, v43
    v_mfma_f32_16x16x32_bf16 a[44:47], a[220:223], v[100:103], a[44:47]
    v_exp_f32 v44, v44
    v_mfma_f32_16x16x32_bf16 a[44:47], a[204:207], v[60:63], a[44:47]
    v_exp_f32 v45, v45
    v_smfmac_f32_16x16x64_bf16 a[224:227], a[244:247], v[56:63], v74
    v_cvt_pk_bf16_f32 v16, v40, v41
    v_mfma_f32_16x16x32_bf16 a[64:67], a[208:211], v[104:107], a[64:67]
    v_exp_f32 v46, v46
    v_mfma_f32_16x16x32_bf16 a[64:67], a[192:195], v[64:67], a[64:67]
    v_exp_f32 v47, v47
    v_mfma_f32_16x16x32_bf16 a[68:71], a[212:215], v[104:107], a[68:71]
    v_cvt_pk_bf16_f32 v17, v42, v43
    v_cvt_pk_bf16_f32 v18, v44, v45
    v_mfma_f32_16x16x32_bf16 a[68:71], a[196:199], v[64:67], a[68:71]
    v_cvt_pk_bf16_f32 v19, v46, v47
    v_mfma_f32_16x16x32_bf16 a[72:75], a[216:219], v[104:107], a[72:75]
    ds_read_b128 a[160:163], v4 offset:16384
    v_mfma_f32_16x16x32_bf16 a[72:75], a[200:203], v[64:67], a[72:75]
    ds_read_b128 a[164:167], v5 offset:16384
    v_mfma_f32_16x16x32_bf16 a[76:79], a[220:223], v[104:107], a[76:79]
    ds_read_b128 a[168:171], v6 offset:16384
    v_mfma_f32_16x16x32_bf16 a[76:79], a[204:207], v[64:67], a[76:79]
    ds_read_b128 a[172:175], v7 offset:16384
    v_mfma_f32_16x16x32_bf16 a[96:99], a[208:211], v[108:111], a[96:99]
    ds_read_b128 a[176:179], v4 offset:20480
    v_mfma_f32_16x16x32_bf16 a[96:99], a[192:195], v[68:71], a[96:99]
    ds_read_b128 a[180:183], v5 offset:20480
    v_mfma_f32_16x16x32_bf16 a[100:103], a[212:215], v[108:111], a[100:103]
    ds_read_b128 a[184:187], v6 offset:20480
    v_mfma_f32_16x16x32_bf16 a[100:103], a[196:199], v[68:71], a[100:103]
    ds_read_b128 a[188:191], v7 offset:20480
    v_mfma_f32_16x16x32_bf16 a[104:107], a[216:219], v[108:111], a[104:107]
    v_mfma_f32_16x16x32_bf16 a[104:107], a[200:203], v[68:71], a[104:107]
    v_mfma_f32_16x16x32_bf16 a[108:111], a[220:223], v[108:111], a[108:111]
    v_mfma_f32_16x16x32_bf16 a[108:111], a[204:207], v[68:71], a[108:111]
    v_mfma_f32_16x16x32_bf16 a[128:131], a[208:211], v[20:23], a[128:131]
    v_mfma_f32_16x16x32_bf16 a[128:131], a[192:195], v[16:19], a[128:131]
    ds_read_b64_tr_b16 a[192:193], v12 offset:24576
    v_mfma_f32_16x16x32_bf16 a[132:135], a[212:215], v[20:23], a[132:135]
    ds_read_b64_tr_b16 a[194:195], v12 offset:28672
    v_mfma_f32_16x16x32_bf16 a[132:135], a[196:199], v[16:19], a[132:135]
    ds_read_b64_tr_b16 a[196:197], v13 offset:24576
    v_mfma_f32_16x16x32_bf16 a[136:139], a[216:219], v[20:23], a[136:139]
    ds_read_b64_tr_b16 a[198:199], v13 offset:28672
    v_mfma_f32_16x16x32_bf16 a[136:139], a[200:203], v[16:19], a[136:139]
    ds_read_b64_tr_b16 a[200:201], v14 offset:24576
    v_mfma_f32_16x16x32_bf16 a[140:143], a[220:223], v[20:23], a[140:143]
    ds_read_b64_tr_b16 a[202:203], v14 offset:28672
    v_mfma_f32_16x16x32_bf16 a[140:143], a[204:207], v[16:19], a[140:143]
    ds_read_b64_tr_b16 a[204:205], v15 offset:24576
    v_smfmac_f32_16x16x64_bf16 a[228:231], a[244:247], v[64:71], v74
    ds_read_b64_tr_b16 a[206:207], v15 offset:28672
    s_waitcnt lgkmcnt(8)
    v_mfma_f32_16x16x32_bf16 v[32:35], a[160:163], v[176:179], v[76:79]
    ds_read_b64_tr_b16 a[208:209], v8 offset:24576
    v_mfma_f32_16x16x32_bf16 v[32:35], a[164:167], v[180:183], v[32:35]
    ds_read_b64_tr_b16 a[210:211], v8 offset:28672
    v_mfma_f32_16x16x32_bf16 v[32:35], a[168:171], v[184:187], v[32:35]
    ds_read_b64_tr_b16 a[212:213], v9 offset:24576
    v_mfma_f32_16x16x32_bf16 v[32:35], a[172:175], v[188:191], v[32:35]
    ds_read_b64_tr_b16 a[214:215], v9 offset:28672
    v_mfma_f32_16x16x32_bf16 v[36:39], a[176:179], v[176:179], v[76:79]
    ds_read_b64_tr_b16 a[216:217], v10 offset:24576
    v_mfma_f32_16x16x32_bf16 v[36:39], a[180:183], v[180:183], v[36:39]
    ds_read_b64_tr_b16 a[218:219], v10 offset:28672
    v_mfma_f32_16x16x32_bf16 v[36:39], a[184:187], v[184:187], v[36:39]
    ds_read_b64_tr_b16 a[220:221], v11 offset:24576
    v_mfma_f32_16x16x32_bf16 v[36:39], a[188:191], v[188:191], v[36:39]
    ds_read_b64_tr_b16 a[222:223], v11 offset:28672
    v_mfma_f32_16x16x32_bf16 v[40:43], a[160:163], v[192:195], v[80:83]
    v_exp_f32 v32, v32
    v_mfma_f32_16x16x32_bf16 v[40:43], a[164:167], v[196:199], v[40:43]
    v_exp_f32 v33, v33
    v_mfma_f32_16x16x32_bf16 v[40:43], a[168:171], v[200:203], v[40:43]
    v_exp_f32 v34, v34
    v_mfma_f32_16x16x32_bf16 v[40:43], a[172:175], v[204:207], v[40:43]
    v_exp_f32 v35, v35
    v_mfma_f32_16x16x32_bf16 v[44:47], a[176:179], v[192:195], v[80:83]
    v_cvt_pk_bf16_f32 v96, v32, v33
    v_cvt_pk_bf16_f32 v97, v34, v35
    v_mfma_f32_16x16x32_bf16 v[44:47], a[180:183], v[196:199], v[44:47]
    v_exp_f32 v36, v36
    v_mfma_f32_16x16x32_bf16 v[44:47], a[184:187], v[200:203], v[44:47]
    buffer_store_dwordx4 v[164:167], v24, s[20:23], s68 offen offset:1024 sc1
    v_mfma_f32_16x16x32_bf16 v[44:47], a[188:191], v[204:207], v[44:47]
    v_exp_f32 v37, v37
    v_mfma_f32_16x16x32_bf16 v[48:51], a[160:163], v[208:211], v[84:87]
    v_exp_f32 v38, v38
    v_mfma_f32_16x16x32_bf16 v[48:51], a[164:167], v[212:215], v[48:51]
    v_exp_f32 v39, v39
    v_mfma_f32_16x16x32_bf16 v[48:51], a[168:171], v[216:219], v[48:51]
    v_cvt_pk_bf16_f32 v98, v36, v37
    v_cvt_pk_bf16_f32 v99, v38, v39
    v_mfma_f32_16x16x32_bf16 v[48:51], a[172:175], v[220:223], v[48:51]
    v_exp_f32 v40, v40
    v_mfma_f32_16x16x32_bf16 v[52:55], a[176:179], v[208:211], v[84:87]
    v_exp_f32 v41, v41
    v_mfma_f32_16x16x32_bf16 v[52:55], a[180:183], v[212:215], v[52:55]
    v_exp_f32 v42, v42
    v_mfma_f32_16x16x32_bf16 v[52:55], a[184:187], v[216:219], v[52:55]
    v_exp_f32 v43, v43
    v_mfma_f32_16x16x32_bf16 v[52:55], a[188:191], v[220:223], v[52:55]
    v_cvt_pk_bf16_f32 v100, v40, v41
    v_cvt_pk_bf16_f32 v101, v42, v43
    v_mfma_f32_16x16x32_bf16 v[32:35], a[160:163], v[224:227], v[88:91]
    v_exp_f32 v44, v44
    v_mfma_f32_16x16x32_bf16 v[32:35], a[164:167], v[228:231], v[32:35]
    v_exp_f32 v45, v45
    v_mfma_f32_16x16x32_bf16 v[32:35], a[168:171], v[232:235], v[32:35]
    v_exp_f32 v46, v46
    v_mfma_f32_16x16x32_bf16 v[32:35], a[172:175], v[236:239], v[32:35]
    v_exp_f32 v47, v47
    v_mfma_f32_16x16x32_bf16 v[36:39], a[176:179], v[224:227], v[88:91]
    v_cvt_pk_bf16_f32 v102, v44, v45
    v_cvt_pk_bf16_f32 v103, v46, v47
    v_mfma_f32_16x16x32_bf16 v[36:39], a[180:183], v[228:231], v[36:39]
    v_exp_f32 v48, v48
    v_mfma_f32_16x16x32_bf16 v[36:39], a[184:187], v[232:235], v[36:39]
    v_exp_f32 v49, v49
    v_mfma_f32_16x16x32_bf16 v[36:39], a[188:191], v[236:239], v[36:39]
    v_exp_f32 v50, v50
    v_mfma_f32_16x16x32_bf16 v[40:43], a[160:163], v[240:243], v[92:95]
    v_exp_f32 v51, v51
    v_mfma_f32_16x16x32_bf16 v[40:43], a[164:167], v[244:247], v[40:43]
    v_exp_f32 v52, v52
    v_mfma_f32_16x16x32_bf16 v[40:43], a[168:171], v[248:251], v[40:43]
    v_exp_f32 v53, v53
    v_mfma_f32_16x16x32_bf16 v[40:43], a[172:175], v[252:255], v[40:43]
    v_exp_f32 v54, v54
    v_mfma_f32_16x16x32_bf16 v[44:47], a[176:179], v[240:243], v[92:95]
    v_exp_f32 v55, v55
    v_mfma_f32_16x16x32_bf16 v[44:47], a[180:183], v[244:247], v[44:47]
    v_cvt_pk_bf16_f32 v104, v48, v49
    v_cvt_pk_bf16_f32 v105, v50, v51
    v_mfma_f32_16x16x32_bf16 v[44:47], a[184:187], v[248:251], v[44:47]
    v_cvt_pk_bf16_f32 v106, v52, v53
    v_cvt_pk_bf16_f32 v107, v54, v55
    v_mfma_f32_16x16x32_bf16 v[44:47], a[188:191], v[252:255], v[44:47]
    s_waitcnt lgkmcnt(0)
    s_barrier
    v_mfma_f32_16x16x32_bf16 a[16:19], a[236:239], v[56:59], a[16:19]
    v_exp_f32 v32, v32
    v_mfma_f32_16x16x32_bf16 a[16:19], a[192:195], v[96:99], a[16:19]
    v_exp_f32 v33, v33
    v_mfma_f32_16x16x32_bf16 a[20:23], a[240:243], v[56:59], a[20:23]
    v_exp_f32 v34, v34
    v_mfma_f32_16x16x32_bf16 a[20:23], a[196:199], v[96:99], a[20:23]
    v_exp_f32 v35, v35
    v_mfma_f32_16x16x32_bf16 a[24:27], a[248:251], v[56:59], a[24:27]
    v_exp_f32 v36, v36
    v_mfma_f32_16x16x32_bf16 a[24:27], a[200:203], v[96:99], a[24:27]
    v_exp_f32 v37, v37
    v_mfma_f32_16x16x32_bf16 a[28:31], a[252:255], v[56:59], a[28:31]
    v_exp_f32 v38, v38
    v_mfma_f32_16x16x32_bf16 a[28:31], a[204:207], v[96:99], a[28:31]
    v_exp_f32 v39, v39
    v_mfma_f32_16x16x32_bf16 a[48:51], a[236:239], v[60:63], a[48:51]
    v_cvt_pk_bf16_f32 v108, v32, v33
    v_cvt_pk_bf16_f32 v109, v34, v35
    v_mfma_f32_16x16x32_bf16 a[48:51], a[192:195], v[100:103], a[48:51]
    v_cvt_pk_bf16_f32 v110, v36, v37
    v_cvt_pk_bf16_f32 v111, v38, v39
    v_mfma_f32_16x16x32_bf16 a[52:55], a[240:243], v[60:63], a[52:55]
    v_exp_f32 v40, v40
    v_mfma_f32_16x16x32_bf16 a[52:55], a[196:199], v[100:103], a[52:55]
    v_exp_f32 v41, v41
    v_mfma_f32_16x16x32_bf16 a[56:59], a[248:251], v[60:63], a[56:59]
    v_exp_f32 v42, v42
    v_mfma_f32_16x16x32_bf16 a[56:59], a[200:203], v[100:103], a[56:59]
    v_exp_f32 v43, v43
    v_mfma_f32_16x16x32_bf16 a[60:63], a[252:255], v[60:63], a[60:63]
    v_exp_f32 v44, v44
    v_mfma_f32_16x16x32_bf16 a[60:63], a[204:207], v[100:103], a[60:63]
    v_exp_f32 v45, v45
    v_smfmac_f32_16x16x64_bf16 a[224:227], a[244:247], v[96:103], v74
    v_cvt_pk_bf16_f32 v20, v40, v41
    v_mfma_f32_16x16x32_bf16 a[80:83], a[236:239], v[64:67], a[80:83]
    v_exp_f32 v46, v46
    v_mfma_f32_16x16x32_bf16 a[80:83], a[192:195], v[104:107], a[80:83]
    v_exp_f32 v47, v47
    v_mfma_f32_16x16x32_bf16 a[84:87], a[240:243], v[64:67], a[84:87]
    v_cvt_pk_bf16_f32 v21, v42, v43
    v_cvt_pk_bf16_f32 v22, v44, v45
    v_mfma_f32_16x16x32_bf16 a[84:87], a[196:199], v[104:107], a[84:87]
    v_cvt_pk_bf16_f32 v23, v46, v47
    v_mfma_f32_16x16x32_bf16 a[88:91], a[248:251], v[64:67], a[88:91]
    ds_read_b128 a[160:163], v4 offset:32768
    v_mfma_f32_16x16x32_bf16 a[88:91], a[200:203], v[104:107], a[88:91]
    ds_read_b128 a[164:167], v5 offset:32768
    v_mfma_f32_16x16x32_bf16 a[92:95], a[252:255], v[64:67], a[92:95]
    ds_read_b128 a[168:171], v6 offset:32768
    v_mfma_f32_16x16x32_bf16 a[92:95], a[204:207], v[104:107], a[92:95]
    ds_read_b128 a[172:175], v7 offset:32768
    v_mfma_f32_16x16x32_bf16 a[112:115], a[236:239], v[68:71], a[112:115]
    ds_read_b128 a[176:179], v4 offset:36864
    v_mfma_f32_16x16x32_bf16 a[112:115], a[192:195], v[108:111], a[112:115]
    ds_read_b128 a[180:183], v5 offset:36864
    v_mfma_f32_16x16x32_bf16 a[116:119], a[240:243], v[68:71], a[116:119]
    ds_read_b128 a[184:187], v6 offset:36864
    v_mfma_f32_16x16x32_bf16 a[116:119], a[196:199], v[108:111], a[116:119]
    ds_read_b128 a[188:191], v7 offset:36864
    v_mfma_f32_16x16x32_bf16 a[120:123], a[248:251], v[68:71], a[120:123]
    v_mfma_f32_16x16x32_bf16 a[120:123], a[200:203], v[108:111], a[120:123]
    v_mfma_f32_16x16x32_bf16 a[124:127], a[252:255], v[68:71], a[124:127]
    v_mfma_f32_16x16x32_bf16 a[124:127], a[204:207], v[108:111], a[124:127]
    v_mfma_f32_16x16x32_bf16 a[144:147], a[236:239], v[16:19], a[144:147]
    v_mfma_f32_16x16x32_bf16 a[144:147], a[192:195], v[20:23], a[144:147]
    ds_read_b64_tr_b16 a[192:193], v8 offset:40960
    v_mfma_f32_16x16x32_bf16 a[148:151], a[240:243], v[16:19], a[148:151]
    ds_read_b64_tr_b16 a[194:195], v8 offset:45056
    v_mfma_f32_16x16x32_bf16 a[148:151], a[196:199], v[20:23], a[148:151]
    ds_read_b64_tr_b16 a[196:197], v9 offset:40960
    v_mfma_f32_16x16x32_bf16 a[152:155], a[248:251], v[16:19], a[152:155]
    ds_read_b64_tr_b16 a[198:199], v9 offset:45056
    v_mfma_f32_16x16x32_bf16 a[152:155], a[200:203], v[20:23], a[152:155]
    ds_read_b64_tr_b16 a[200:201], v10 offset:40960
    v_mfma_f32_16x16x32_bf16 a[156:159], a[252:255], v[16:19], a[156:159]
    ds_read_b64_tr_b16 a[202:203], v10 offset:45056
    v_mfma_f32_16x16x32_bf16 a[156:159], a[204:207], v[20:23], a[156:159]
    ds_read_b64_tr_b16 a[204:205], v11 offset:40960
    v_smfmac_f32_16x16x64_bf16 a[228:231], a[244:247], v[104:111], v74
    ds_read_b64_tr_b16 a[206:207], v11 offset:45056
    v_smfmac_f32_16x16x64_bf16 a[232:235], a[244:247], v[16:23], v74
    s_waitcnt lgkmcnt(8)
    v_mfma_f32_16x16x32_bf16 v[32:35], a[160:163], v[176:179], v[76:79]
    ds_read_b64_tr_b16 a[236:237], v12 offset:40960
    v_mfma_f32_16x16x32_bf16 v[32:35], a[164:167], v[180:183], v[32:35]
    ds_read_b64_tr_b16 a[238:239], v12 offset:45056
    v_mfma_f32_16x16x32_bf16 v[32:35], a[168:171], v[184:187], v[32:35]
    ds_read_b64_tr_b16 a[240:241], v13 offset:40960
    v_mfma_f32_16x16x32_bf16 v[32:35], a[172:175], v[188:191], v[32:35]
    ds_read_b64_tr_b16 a[242:243], v13 offset:45056
    v_mfma_f32_16x16x32_bf16 v[36:39], a[176:179], v[176:179], v[76:79]
    ds_read_b64_tr_b16 a[248:249], v14 offset:40960
    v_mfma_f32_16x16x32_bf16 v[36:39], a[180:183], v[180:183], v[36:39]
    ds_read_b64_tr_b16 a[250:251], v14 offset:45056
    v_mfma_f32_16x16x32_bf16 v[36:39], a[184:187], v[184:187], v[36:39]
    ds_read_b64_tr_b16 a[252:253], v15 offset:40960
    v_mfma_f32_16x16x32_bf16 v[36:39], a[188:191], v[188:191], v[36:39]
    ds_read_b64_tr_b16 a[254:255], v15 offset:45056
    v_mfma_f32_16x16x32_bf16 v[40:43], a[160:163], v[192:195], v[80:83]
    v_exp_f32 v32, v32
    v_mfma_f32_16x16x32_bf16 v[40:43], a[164:167], v[196:199], v[40:43]
    v_exp_f32 v33, v33
    v_mfma_f32_16x16x32_bf16 v[40:43], a[168:171], v[200:203], v[40:43]
    v_exp_f32 v34, v34
    v_mfma_f32_16x16x32_bf16 v[40:43], a[172:175], v[204:207], v[40:43]
    v_exp_f32 v35, v35
    v_mfma_f32_16x16x32_bf16 v[44:47], a[176:179], v[192:195], v[80:83]
    v_cvt_pk_bf16_f32 v56, v32, v33
    v_cvt_pk_bf16_f32 v57, v34, v35
    v_mfma_f32_16x16x32_bf16 v[44:47], a[180:183], v[196:199], v[44:47]
    v_exp_f32 v36, v36
    v_mfma_f32_16x16x32_bf16 v[44:47], a[184:187], v[200:203], v[44:47]
    buffer_store_dwordx4 v[168:171], v24, s[20:23], s68 offen offset:2048 sc1
    v_mfma_f32_16x16x32_bf16 v[44:47], a[188:191], v[204:207], v[44:47]
    v_exp_f32 v37, v37
    v_mfma_f32_16x16x32_bf16 v[48:51], a[160:163], v[208:211], v[84:87]
    v_exp_f32 v38, v38
    v_mfma_f32_16x16x32_bf16 v[48:51], a[164:167], v[212:215], v[48:51]
    v_exp_f32 v39, v39
    v_mfma_f32_16x16x32_bf16 v[48:51], a[168:171], v[216:219], v[48:51]
    v_cvt_pk_bf16_f32 v58, v36, v37
    v_cvt_pk_bf16_f32 v59, v38, v39
    v_mfma_f32_16x16x32_bf16 v[48:51], a[172:175], v[220:223], v[48:51]
    v_exp_f32 v40, v40
    v_mfma_f32_16x16x32_bf16 v[52:55], a[176:179], v[208:211], v[84:87]
    v_exp_f32 v41, v41
    v_mfma_f32_16x16x32_bf16 v[52:55], a[180:183], v[212:215], v[52:55]
    v_exp_f32 v42, v42
    v_mfma_f32_16x16x32_bf16 v[52:55], a[184:187], v[216:219], v[52:55]
    v_exp_f32 v43, v43
    v_mfma_f32_16x16x32_bf16 v[52:55], a[188:191], v[220:223], v[52:55]
    v_cvt_pk_bf16_f32 v60, v40, v41
    v_cvt_pk_bf16_f32 v61, v42, v43
    v_mfma_f32_16x16x32_bf16 v[32:35], a[160:163], v[224:227], v[88:91]
    v_exp_f32 v44, v44
    v_mfma_f32_16x16x32_bf16 v[32:35], a[164:167], v[228:231], v[32:35]
    v_exp_f32 v45, v45
    v_mfma_f32_16x16x32_bf16 v[32:35], a[168:171], v[232:235], v[32:35]
    v_exp_f32 v46, v46
    v_mfma_f32_16x16x32_bf16 v[32:35], a[172:175], v[236:239], v[32:35]
    v_exp_f32 v47, v47
    v_mfma_f32_16x16x32_bf16 v[36:39], a[176:179], v[224:227], v[88:91]
    v_cvt_pk_bf16_f32 v62, v44, v45
    v_cvt_pk_bf16_f32 v63, v46, v47
    v_mfma_f32_16x16x32_bf16 v[36:39], a[180:183], v[228:231], v[36:39]
    v_exp_f32 v48, v48
    v_mfma_f32_16x16x32_bf16 v[36:39], a[184:187], v[232:235], v[36:39]
    v_exp_f32 v49, v49
    v_mfma_f32_16x16x32_bf16 v[36:39], a[188:191], v[236:239], v[36:39]
    v_exp_f32 v50, v50
    v_mfma_f32_16x16x32_bf16 v[40:43], a[160:163], v[240:243], v[92:95]
    v_exp_f32 v51, v51
    v_mfma_f32_16x16x32_bf16 v[40:43], a[164:167], v[244:247], v[40:43]
    v_exp_f32 v52, v52
    v_mfma_f32_16x16x32_bf16 v[40:43], a[168:171], v[248:251], v[40:43]
    v_exp_f32 v53, v53
    v_mfma_f32_16x16x32_bf16 v[40:43], a[172:175], v[252:255], v[40:43]
    v_exp_f32 v54, v54
    v_mfma_f32_16x16x32_bf16 v[44:47], a[176:179], v[240:243], v[92:95]
    v_exp_f32 v55, v55
    v_mfma_f32_16x16x32_bf16 v[44:47], a[180:183], v[244:247], v[44:47]
    v_cvt_pk_bf16_f32 v64, v48, v49
    v_cvt_pk_bf16_f32 v65, v50, v51
    v_mfma_f32_16x16x32_bf16 v[44:47], a[184:187], v[248:251], v[44:47]
    v_cvt_pk_bf16_f32 v66, v52, v53
    v_cvt_pk_bf16_f32 v67, v54, v55
    v_mfma_f32_16x16x32_bf16 v[44:47], a[188:191], v[252:255], v[44:47]
    s_waitcnt lgkmcnt(0)
    s_barrier
    v_mfma_f32_16x16x32_bf16 a[0:3], a[208:211], v[96:99], a[0:3]
    v_exp_f32 v32, v32
    v_mfma_f32_16x16x32_bf16 a[0:3], a[192:195], v[56:59], a[0:3]
    v_exp_f32 v33, v33
    v_mfma_f32_16x16x32_bf16 a[4:7], a[212:215], v[96:99], a[4:7]
    v_exp_f32 v34, v34
    v_mfma_f32_16x16x32_bf16 a[4:7], a[196:199], v[56:59], a[4:7]
    v_exp_f32 v35, v35
    v_mfma_f32_16x16x32_bf16 a[8:11], a[216:219], v[96:99], a[8:11]
    v_exp_f32 v36, v36
    v_mfma_f32_16x16x32_bf16 a[8:11], a[200:203], v[56:59], a[8:11]
    v_exp_f32 v37, v37
    v_mfma_f32_16x16x32_bf16 a[12:15], a[220:223], v[96:99], a[12:15]
    v_exp_f32 v38, v38
    v_mfma_f32_16x16x32_bf16 a[12:15], a[204:207], v[56:59], a[12:15]
    v_exp_f32 v39, v39
    v_mfma_f32_16x16x32_bf16 a[32:35], a[208:211], v[100:103], a[32:35]
    v_cvt_pk_bf16_f32 v68, v32, v33
    v_cvt_pk_bf16_f32 v69, v34, v35
    v_mfma_f32_16x16x32_bf16 a[32:35], a[192:195], v[60:63], a[32:35]
    v_cvt_pk_bf16_f32 v70, v36, v37
    v_cvt_pk_bf16_f32 v71, v38, v39
    v_mfma_f32_16x16x32_bf16 a[36:39], a[212:215], v[100:103], a[36:39]
    v_exp_f32 v40, v40
    v_mfma_f32_16x16x32_bf16 a[36:39], a[196:199], v[60:63], a[36:39]
    v_exp_f32 v41, v41
    v_mfma_f32_16x16x32_bf16 a[40:43], a[216:219], v[100:103], a[40:43]
    v_exp_f32 v42, v42
    v_mfma_f32_16x16x32_bf16 a[40:43], a[200:203], v[60:63], a[40:43]
    v_exp_f32 v43, v43
    v_mfma_f32_16x16x32_bf16 a[44:47], a[220:223], v[100:103], a[44:47]
    v_exp_f32 v44, v44
    v_mfma_f32_16x16x32_bf16 a[44:47], a[204:207], v[60:63], a[44:47]
    v_exp_f32 v45, v45
    v_smfmac_f32_16x16x64_bf16 a[224:227], a[244:247], v[56:63], v74
    v_cvt_pk_bf16_f32 v16, v40, v41
    v_mfma_f32_16x16x32_bf16 a[64:67], a[208:211], v[104:107], a[64:67]
    v_exp_f32 v46, v46
    v_mfma_f32_16x16x32_bf16 a[64:67], a[192:195], v[64:67], a[64:67]
    v_exp_f32 v47, v47
    v_mfma_f32_16x16x32_bf16 a[68:71], a[212:215], v[104:107], a[68:71]
    v_cvt_pk_bf16_f32 v17, v42, v43
    v_cvt_pk_bf16_f32 v18, v44, v45
    v_mfma_f32_16x16x32_bf16 a[68:71], a[196:199], v[64:67], a[68:71]
    v_cvt_pk_bf16_f32 v19, v46, v47
    v_mfma_f32_16x16x32_bf16 a[72:75], a[216:219], v[104:107], a[72:75]
    ds_read_b128 a[160:163], v4 offset:49152
    v_mfma_f32_16x16x32_bf16 a[72:75], a[200:203], v[64:67], a[72:75]
    ds_read_b128 a[164:167], v5 offset:49152
    v_mfma_f32_16x16x32_bf16 a[76:79], a[220:223], v[104:107], a[76:79]
    ds_read_b128 a[168:171], v6 offset:49152
    v_mfma_f32_16x16x32_bf16 a[76:79], a[204:207], v[64:67], a[76:79]
    ds_read_b128 a[172:175], v7 offset:49152
    v_mfma_f32_16x16x32_bf16 a[96:99], a[208:211], v[108:111], a[96:99]
    ds_read_b128 a[176:179], v4 offset:53248
    v_mfma_f32_16x16x32_bf16 a[96:99], a[192:195], v[68:71], a[96:99]
    ds_read_b128 a[180:183], v5 offset:53248
    v_mfma_f32_16x16x32_bf16 a[100:103], a[212:215], v[108:111], a[100:103]
    ds_read_b128 a[184:187], v6 offset:53248
    v_mfma_f32_16x16x32_bf16 a[100:103], a[196:199], v[68:71], a[100:103]
    ds_read_b128 a[188:191], v7 offset:53248
    v_mfma_f32_16x16x32_bf16 a[104:107], a[216:219], v[108:111], a[104:107]
    ds_read_b128 v[160:163], v25 offset:0
    v_mfma_f32_16x16x32_bf16 a[104:107], a[200:203], v[68:71], a[104:107]
    ds_read_b128 v[164:167], v25 offset:1024
    v_mfma_f32_16x16x32_bf16 a[108:111], a[220:223], v[108:111], a[108:111]
    v_mfma_f32_16x16x32_bf16 a[108:111], a[204:207], v[68:71], a[108:111]
    v_mfma_f32_16x16x32_bf16 a[128:131], a[208:211], v[20:23], a[128:131]
    v_mfma_f32_16x16x32_bf16 a[128:131], a[192:195], v[16:19], a[128:131]
    ds_read_b64_tr_b16 a[192:193], v12 offset:57344
    v_mfma_f32_16x16x32_bf16 a[132:135], a[212:215], v[20:23], a[132:135]
    ds_read_b64_tr_b16 a[194:195], v12 offset:61440
    v_mfma_f32_16x16x32_bf16 a[132:135], a[196:199], v[16:19], a[132:135]
    ds_read_b64_tr_b16 a[196:197], v13 offset:57344
    v_mfma_f32_16x16x32_bf16 a[136:139], a[216:219], v[20:23], a[136:139]
    ds_read_b64_tr_b16 a[198:199], v13 offset:61440
    v_mfma_f32_16x16x32_bf16 a[136:139], a[200:203], v[16:19], a[136:139]
    ds_read_b64_tr_b16 a[200:201], v14 offset:57344
    v_mfma_f32_16x16x32_bf16 a[140:143], a[220:223], v[20:23], a[140:143]
    ds_read_b64_tr_b16 a[202:203], v14 offset:61440
    v_mfma_f32_16x16x32_bf16 a[140:143], a[204:207], v[16:19], a[140:143]
    ds_read_b64_tr_b16 a[204:205], v15 offset:57344
    v_smfmac_f32_16x16x64_bf16 a[228:231], a[244:247], v[64:71], v74
    ds_read_b64_tr_b16 a[206:207], v15 offset:61440
    s_waitcnt lgkmcnt(8)
    v_mfma_f32_16x16x32_bf16 v[32:35], a[160:163], v[176:179], v[76:79]
    ds_read_b64_tr_b16 a[208:209], v8 offset:57344
    v_mfma_f32_16x16x32_bf16 v[32:35], a[164:167], v[180:183], v[32:35]
    ds_read_b64_tr_b16 a[210:211], v8 offset:61440
    v_mfma_f32_16x16x32_bf16 v[32:35], a[168:171], v[184:187], v[32:35]
    ds_read_b64_tr_b16 a[212:213], v9 offset:57344
    v_mfma_f32_16x16x32_bf16 v[32:35], a[172:175], v[188:191], v[32:35]
    ds_read_b64_tr_b16 a[214:215], v9 offset:61440
    v_mfma_f32_16x16x32_bf16 v[36:39], a[176:179], v[176:179], v[76:79]
    ds_read_b64_tr_b16 a[216:217], v10 offset:57344
    v_mfma_f32_16x16x32_bf16 v[36:39], a[180:183], v[180:183], v[36:39]
    ds_read_b64_tr_b16 a[218:219], v10 offset:61440
    v_mfma_f32_16x16x32_bf16 v[36:39], a[184:187], v[184:187], v[36:39]
    ds_read_b64_tr_b16 a[220:221], v11 offset:57344
    v_mfma_f32_16x16x32_bf16 v[36:39], a[188:191], v[188:191], v[36:39]
    ds_read_b64_tr_b16 a[222:223], v11 offset:61440
    v_mfma_f32_16x16x32_bf16 v[40:43], a[160:163], v[192:195], v[80:83]
    v_exp_f32 v32, v32
    v_mfma_f32_16x16x32_bf16 v[40:43], a[164:167], v[196:199], v[40:43]
    v_exp_f32 v33, v33
    v_mfma_f32_16x16x32_bf16 v[40:43], a[168:171], v[200:203], v[40:43]
    v_exp_f32 v34, v34
    v_mfma_f32_16x16x32_bf16 v[40:43], a[172:175], v[204:207], v[40:43]
    v_exp_f32 v35, v35
    v_mfma_f32_16x16x32_bf16 v[44:47], a[176:179], v[192:195], v[80:83]
    v_cvt_pk_bf16_f32 v96, v32, v33
    v_cvt_pk_bf16_f32 v97, v34, v35
    v_mfma_f32_16x16x32_bf16 v[44:47], a[180:183], v[196:199], v[44:47]
    v_exp_f32 v36, v36
    v_mfma_f32_16x16x32_bf16 v[44:47], a[184:187], v[200:203], v[44:47]
    buffer_store_dwordx4 v[172:175], v24, s[20:23], s68 offen offset:3072 sc1
    s_sub_u32 s68, s68, 131328
    v_mfma_f32_16x16x32_bf16 v[44:47], a[188:191], v[204:207], v[44:47]
    v_exp_f32 v37, v37
    v_mfma_f32_16x16x32_bf16 v[48:51], a[160:163], v[208:211], v[84:87]
    v_exp_f32 v38, v38
    v_mfma_f32_16x16x32_bf16 v[48:51], a[164:167], v[212:215], v[48:51]
    v_exp_f32 v39, v39
    v_mfma_f32_16x16x32_bf16 v[48:51], a[168:171], v[216:219], v[48:51]
    v_cvt_pk_bf16_f32 v98, v36, v37
    v_cvt_pk_bf16_f32 v99, v38, v39
    v_mfma_f32_16x16x32_bf16 v[48:51], a[172:175], v[220:223], v[48:51]
    v_exp_f32 v40, v40
    v_mfma_f32_16x16x32_bf16 v[52:55], a[176:179], v[208:211], v[84:87]
    v_exp_f32 v41, v41
    v_mfma_f32_16x16x32_bf16 v[52:55], a[180:183], v[212:215], v[52:55]
    v_exp_f32 v42, v42
    v_mfma_f32_16x16x32_bf16 v[52:55], a[184:187], v[216:219], v[52:55]
    v_exp_f32 v43, v43
    v_mfma_f32_16x16x32_bf16 v[52:55], a[188:191], v[220:223], v[52:55]
    v_cvt_pk_bf16_f32 v100, v40, v41
    v_cvt_pk_bf16_f32 v101, v42, v43
    v_mfma_f32_16x16x32_bf16 v[32:35], a[160:163], v[224:227], v[88:91]
    v_exp_f32 v44, v44
    v_mfma_f32_16x16x32_bf16 v[32:35], a[164:167], v[228:231], v[32:35]
    v_exp_f32 v45, v45
    v_mfma_f32_16x16x32_bf16 v[32:35], a[168:171], v[232:235], v[32:35]
    v_exp_f32 v46, v46
    v_mfma_f32_16x16x32_bf16 v[32:35], a[172:175], v[236:239], v[32:35]
    v_exp_f32 v47, v47
    v_mfma_f32_16x16x32_bf16 v[36:39], a[176:179], v[224:227], v[88:91]
    v_cvt_pk_bf16_f32 v102, v44, v45
    v_cvt_pk_bf16_f32 v103, v46, v47
    v_mfma_f32_16x16x32_bf16 v[36:39], a[180:183], v[228:231], v[36:39]
    v_exp_f32 v48, v48
    v_mfma_f32_16x16x32_bf16 v[36:39], a[184:187], v[232:235], v[36:39]
    v_exp_f32 v49, v49
    v_mfma_f32_16x16x32_bf16 v[36:39], a[188:191], v[236:239], v[36:39]
    v_exp_f32 v50, v50
    v_mfma_f32_16x16x32_bf16 v[40:43], a[160:163], v[240:243], v[92:95]
    v_exp_f32 v51, v51
    v_mfma_f32_16x16x32_bf16 v[40:43], a[164:167], v[244:247], v[40:43]
    v_exp_f32 v52, v52
    v_mfma_f32_16x16x32_bf16 v[40:43], a[168:171], v[248:251], v[40:43]
    v_exp_f32 v53, v53
    v_mfma_f32_16x16x32_bf16 v[40:43], a[172:175], v[252:255], v[40:43]
    v_exp_f32 v54, v54
    v_mfma_f32_16x16x32_bf16 v[44:47], a[176:179], v[240:243], v[92:95]
    v_exp_f32 v55, v55
    v_mfma_f32_16x16x32_bf16 v[44:47], a[180:183], v[244:247], v[44:47]
    v_cvt_pk_bf16_f32 v104, v48, v49
    v_cvt_pk_bf16_f32 v105, v50, v51
    v_mfma_f32_16x16x32_bf16 v[44:47], a[184:187], v[248:251], v[44:47]
    v_cvt_pk_bf16_f32 v106, v52, v53
    v_cvt_pk_bf16_f32 v107, v54, v55
    v_mfma_f32_16x16x32_bf16 v[44:47], a[188:191], v[252:255], v[44:47]
    s_waitcnt lgkmcnt(0)
    s_barrier
    v_mfma_f32_16x16x32_bf16 a[16:19], a[236:239], v[56:59], a[16:19]
    v_exp_f32 v32, v32
    v_mfma_f32_16x16x32_bf16 a[16:19], a[192:195], v[96:99], a[16:19]
    v_exp_f32 v33, v33
    v_mfma_f32_16x16x32_bf16 a[20:23], a[240:243], v[56:59], a[20:23]
    v_exp_f32 v34, v34
    v_mfma_f32_16x16x32_bf16 a[20:23], a[196:199], v[96:99], a[20:23]
    v_exp_f32 v35, v35
    v_mfma_f32_16x16x32_bf16 a[24:27], a[248:251], v[56:59], a[24:27]
    v_exp_f32 v36, v36
    v_mfma_f32_16x16x32_bf16 a[24:27], a[200:203], v[96:99], a[24:27]
    v_exp_f32 v37, v37
    v_mfma_f32_16x16x32_bf16 a[28:31], a[252:255], v[56:59], a[28:31]
    v_exp_f32 v38, v38
    v_mfma_f32_16x16x32_bf16 a[28:31], a[204:207], v[96:99], a[28:31]
    v_exp_f32 v39, v39
    v_mfma_f32_16x16x32_bf16 a[48:51], a[236:239], v[60:63], a[48:51]
    v_cvt_pk_bf16_f32 v108, v32, v33
    v_cvt_pk_bf16_f32 v109, v34, v35
    v_mfma_f32_16x16x32_bf16 a[48:51], a[192:195], v[100:103], a[48:51]
    v_cvt_pk_bf16_f32 v110, v36, v37
    v_cvt_pk_bf16_f32 v111, v38, v39
    v_mfma_f32_16x16x32_bf16 a[52:55], a[240:243], v[60:63], a[52:55]
    v_exp_f32 v40, v40
    v_mfma_f32_16x16x32_bf16 a[52:55], a[196:199], v[100:103], a[52:55]
    v_exp_f32 v41, v41
    v_mfma_f32_16x16x32_bf16 a[56:59], a[248:251], v[60:63], a[56:59]
    v_exp_f32 v42, v42
    v_mfma_f32_16x16x32_bf16 a[56:59], a[200:203], v[100:103], a[56:59]
    v_exp_f32 v43, v43
    v_mfma_f32_16x16x32_bf16 a[60:63], a[252:255], v[60:63], a[60:63]
    v_exp_f32 v44, v44
    v_mfma_f32_16x16x32_bf16 a[60:63], a[204:207], v[100:103], a[60:63]
    v_exp_f32 v45, v45
    v_smfmac_f32_16x16x64_bf16 a[224:227], a[244:247], v[96:103], v74
    v_cvt_pk_bf16_f32 v20, v40, v41
    v_mfma_f32_16x16x32_bf16 a[80:83], a[236:239], v[64:67], a[80:83]
    v_exp_f32 v46, v46
    v_mfma_f32_16x16x32_bf16 a[80:83], a[192:195], v[104:107], a[80:83]
    v_exp_f32 v47, v47
    v_mfma_f32_16x16x32_bf16 a[84:87], a[240:243], v[64:67], a[84:87]
    v_cvt_pk_bf16_f32 v21, v42, v43
    v_cvt_pk_bf16_f32 v22, v44, v45
    v_mfma_f32_16x16x32_bf16 a[84:87], a[196:199], v[104:107], a[84:87]
    v_cvt_pk_bf16_f32 v23, v46, v47
    v_mfma_f32_16x16x32_bf16 a[88:91], a[248:251], v[64:67], a[88:91]
    ds_read_b128 a[160:163], v4 offset:0
    v_mfma_f32_16x16x32_bf16 a[88:91], a[200:203], v[104:107], a[88:91]
    ds_read_b128 a[164:167], v5 offset:0
    v_mfma_f32_16x16x32_bf16 a[92:95], a[252:255], v[64:67], a[92:95]
    ds_read_b128 a[168:171], v6 offset:0
    v_mfma_f32_16x16x32_bf16 a[92:95], a[204:207], v[104:107], a[92:95]
    ds_read_b128 a[172:175], v7 offset:0
    v_mfma_f32_16x16x32_bf16 a[112:115], a[236:239], v[68:71], a[112:115]
    ds_read_b128 a[176:179], v4 offset:4096
    v_mfma_f32_16x16x32_bf16 a[112:115], a[192:195], v[108:111], a[112:115]
    ds_read_b128 a[180:183], v5 offset:4096
    v_mfma_f32_16x16x32_bf16 a[116:119], a[240:243], v[68:71], a[116:119]
    ds_read_b128 a[184:187], v6 offset:4096
    v_mfma_f32_16x16x32_bf16 a[116:119], a[196:199], v[108:111], a[116:119]
    ds_read_b128 a[188:191], v7 offset:4096
    v_mfma_f32_16x16x32_bf16 a[120:123], a[248:251], v[68:71], a[120:123]
    ds_read_b128 v[168:171], v25 offset:2048
    v_mfma_f32_16x16x32_bf16 a[120:123], a[200:203], v[108:111], a[120:123]
    ds_read_b128 v[172:175], v25 offset:3072
    v_mfma_f32_16x16x32_bf16 a[124:127], a[252:255], v[68:71], a[124:127]
    v_subrev_u32 v25, 4096, v25
    v_mfma_f32_16x16x32_bf16 a[124:127], a[204:207], v[108:111], a[124:127]
    s_sub_u32 s35, s35, 1
    s_bitcmp0_b32 s26, s35
    v_mfma_f32_16x16x32_bf16 a[144:147], a[236:239], v[16:19], a[144:147]
    v_mfma_f32_16x16x32_bf16 a[144:147], a[192:195], v[20:23], a[144:147]
    ds_read_b64_tr_b16 a[192:193], v8 offset:8192
    v_mfma_f32_16x16x32_bf16 a[148:151], a[240:243], v[16:19], a[148:151]
    ds_read_b64_tr_b16 a[194:195], v8 offset:12288
    v_mfma_f32_16x16x32_bf16 a[148:151], a[196:199], v[20:23], a[148:151]
    ds_read_b64_tr_b16 a[196:197], v9 offset:8192
    v_mfma_f32_16x16x32_bf16 a[152:155], a[248:251], v[16:19], a[152:155]
    ds_read_b64_tr_b16 a[198:199], v9 offset:12288
    v_mfma_f32_16x16x32_bf16 a[152:155], a[200:203], v[20:23], a[152:155]
    ds_read_b64_tr_b16 a[200:201], v10 offset:8192
    v_mfma_f32_16x16x32_bf16 a[156:159], a[252:255], v[16:19], a[156:159]
    ds_read_b64_tr_b16 a[202:203], v10 offset:12288
    v_mfma_f32_16x16x32_bf16 a[156:159], a[204:207], v[20:23], a[156:159]
    ds_read_b64_tr_b16 a[204:205], v11 offset:8192
    v_smfmac_f32_16x16x64_bf16 a[228:231], a[244:247], v[104:111], v74
    ds_read_b64_tr_b16 a[206:207], v11 offset:12288
    v_smfmac_f32_16x16x64_bf16 a[232:235], a[244:247], v[16:23], v74
    s_cbranch_scc1 L_loopS5
    s_branch L_loop5
L_ovf05:
    s_nop 0
    ds_write_b32 v1, v2
    s_branch L_nof05
L_ovf15:
    s_nop 0
    ds_write_b32 v1, v2
    s_branch L_nof15
L_redo5:
    s_mov_b32 s37, 1
    s_waitcnt vmcnt(0) lgkmcnt(0)
    s_barrier
    s_mov_b32 s12, s24
    s_mov_b32 s13, s25
    s_mov_b32 s14, 0x80000
    s_mov_b32 s16, s28
    s_mov_b32 s17, s29
    s_mov_b32 s18, 0x80000
    s_mov_b32 s0, 0
    s_mov_b32 s30, s1
    s_mov_b32 s44, 0xfffc0000
    s_mov_b32 s45, 0x3e000
    s_movk_i32 s31, 0x2000
    s_movk_i32 s32, 0x2000
    s_movk_i32 s52, 0x1000
    s_mov_b32 s53, 0
    s_movk_i32 s54, 0x1000
    s_lshl_b32 s0, s36, 18
    s_lshl_b32 s26, 0xfe, s36
    s_add_u32 s49, s0, s1
    s_and_b32 s49, s49, s45
    s_and_b32 s30, s0, s44
    s_or_b32 s30, s30, s49
    v_and_b32 v1, 15, v0
    v_lshlrev_b32 v1, 8, v1
    v_and_b32 v2, 48, v0
    v_add_u32 v1, v1, v2
    s_lshl_b32 s48, s36, 18
    s_mov_b32 s35, 64
    v_mov_b32 v76, 0xff800000
    v_mov_b32 v77, 0xff800000
    v_mov_b32 v78, 0xff800000
    v_mov_b32 v79, 0xff800000
    v_mov_b32 v80, 0xff800000
L_rl5:
    buffer_load_dwordx4 a[160:163], v1, s[12:15], s48 offen offset:0
    buffer_load_dwordx4 a[164:167], v1, s[12:15], s48 offen offset:64
    buffer_load_dwordx4 a[168:171], v1, s[12:15], s48 offen offset:128
    buffer_load_dwordx4 a[172:175], v1, s[12:15], s48 offen offset:192
    s_waitcnt vmcnt(0)
    s_nop 0
    v_mfma_f32_16x16x32_bf16 v[56:59], a[160:163], v[176:179], 0
    v_mfma_f32_16x16x32_bf16 v[56:59], a[164:167], v[180:183], v[56:59]
    v_mfma_f32_16x16x32_bf16 v[56:59], a[168:171], v[184:187], v[56:59]
    v_mfma_f32_16x16x32_bf16 v[56:59], a[172:175], v[188:191], v[56:59]
    v_mfma_f32_16x16x32_bf16 v[60:63], a[160:163], v[192:195], 0
    v_mfma_f32_16x16x32_bf16 v[60:63], a[164:167], v[196:199], v[60:63]
    v_mfma_f32_16x16x32_bf16 v[60:63], a[168:171], v[200:203], v[60:63]
    v_mfma_f32_16x16x32_bf16 v[60:63], a[172:175], v[204:207], v[60:63]
    v_mfma_f32_16x16x32_bf16 v[64:67], a[160:163], v[208:211], 0
    v_mfma_f32_16x16x32_bf16 v[64:67], a[164:167], v[212:215], v[64:67]
    v_mfma_f32_16x16x32_bf16 v[64:67], a[168:171], v[216:219], v[64:67]
    v_mfma_f32_16x16x32_bf16 v[64:67], a[172:175], v[220:223], v[64:67]
    v_mfma_f32_16x16x32_bf16 v[68:71], a[160:163], v[224:227], 0
    v_mfma_f32_16x16x32_bf16 v[68:71], a[164:167], v[228:231], v[68:71]
    v_mfma_f32_16x16x32_bf16 v[68:71], a[168:171], v[232:235], v[68:71]
    v_mfma_f32_16x16x32_bf16 v[68:71], a[172:175], v[236:239], v[68:71]
    v_mfma_f32_16x16x32_bf16 v[16:19], a[160:163], v[240:243], 0
    v_mfma_f32_16x16x32_bf16 v[16:19], a[164:167], v[244:247], v[16:19]
    v_mfma_f32_16x16x32_bf16 v[16:19], a[168:171], v[248:251], v[16:19]
    v_mfma_f32_16x16x32_bf16 v[16:19], a[172:175], v[252:255], v[16:19]
    s_nop 7
    s_nop 0
    v_max3_f32 v76, v76, v56, v57
    v_max3_f32 v76, v76, v58, v59
    v_max3_f32 v77, v77, v60, v61
    v_max3_f32 v77, v77, v62, v63
    v_max3_f32 v78, v78, v64, v65
    v_max3_f32 v78, v78, v66, v67
    v_max3_f32 v79, v79, v68, v69
    v_max3_f32 v79, v79, v70, v71
    v_max3_f32 v80, v80, v16, v17
    v_max3_f32 v80, v80, v18, v19
    s_add_u32 s48, s48, 0x1000
    s_sub_u32 s35, s35, 1
    s_cmp_lg_u32 s35, 0
    s_cbranch_scc1 L_rl5
    v_mov_b32 v56, v76
    v_mov_b32 v60, v77
    v_mov_b32 v64, v78
    v_mov_b32 v68, v79
    v_mov_b32 v16, v80
    v_mov_b32 v57, v56
    v_mov_b32 v61, v60
    v_mov_b32 v65, v64
    v_mov_b32 v69, v68
    v_mov_b32 v17, v16
    v_permlane32_swap_b32 v56, v57
    v_permlane32_swap_b32 v60, v61
    v_permlane32_swap_b32 v64, v65
    v_permlane32_swap_b32 v68, v69
    v_permlane32_swap_b32 v16, v17
    v_max_f32 v56, v56, v57
    v_max_f32 v60, v60, v61
    v_max_f32 v64, v64, v65
    v_max_f32 v68, v68, v69
    v_max_f32 v16, v16, v17
    v_mov_b32 v57, v56
    v_mov_b32 v61, v60
    v_mov_b32 v65, v64
    v_mov_b32 v69, v68
    v_mov_b32 v17, v16
    v_permlane16_swap_b32 v56, v57
    v_permlane16_swap_b32 v60, v61
    v_permlane16_swap_b32 v64, v65
    v_permlane16_swap_b32 v68, v69
    v_permlane16_swap_b32 v16, v17
    v_max_f32 v56, v56, v57
    v_max_f32 v60, v60, v61
    v_max_f32 v64, v64, v65
    v_max_f32 v68, v68, v69
    v_max_f32 v16, v16, v17
    v_xor_b32 v76, 0x80000000, v56
    v_xor_b32 v77, 0x80000000, v56
    v_xor_b32 v78, 0x80000000, v56
    v_xor_b32 v79, 0x80000000, v56
    v_xor_b32 v80, 0x80000000, v60
    v_xor_b32 v81, 0x80000000, v60
    v_xor_b32 v82, 0x80000000, v60
    v_xor_b32 v83, 0x80000000, v60
    v_xor_b32 v84, 0x80000000, v64
    v_xor_b32 v85, 0x80000000, v64
    v_xor_b32 v86, 0x80000000, v64
    v_xor_b32 v87, 0x80000000, v64
    v_xor_b32 v88, 0x80000000, v68
    v_xor_b32 v89, 0x80000000, v68
    v_xor_b32 v90, 0x80000000, v68
    v_xor_b32 v91, 0x80000000, v68
    v_xor_b32 v92, 0x80000000, v16
    v_xor_b32 v93, 0x80000000, v16
    v_xor_b32 v94, 0x80000000, v16
    v_xor_b32 v95, 0x80000000, v16
    v_mov_b64 v[96:97], 0
    v_mov_b64 v[98:99], 0
    v_mov_b64 v[100:101], 0
    v_mov_b64 v[102:103], 0
    v_mov_b64 v[104:105], 0
    v_mov_b64 v[106:107], 0
    v_mov_b64 v[108:109], 0
    v_mov_b64 v[110:111], 0
    v_mov_b64 v[20:21], 0
    v_mov_b64 v[22:23], 0
    v_mfma_f32_32x32x16_bf16 a[0:15], v[96:99], v[96:99], 0
    v_mfma_f32_32x32x16_bf16 a[16:31], v[96:99], v[96:99], 0
    v_mfma_f32_32x32x16_bf16 a[32:47], v[96:99], v[96:99], 0
    v_mfma_f32_32x32x16_bf16 a[48:63], v[96:99], v[96:99], 0
    v_mfma_f32_32x32x16_bf16 a[64:79], v[96:99], v[96:99], 0
    v_mfma_f32_32x32x16_bf16 a[80:95], v[96:99], v[96:99], 0
    v_mfma_f32_32x32x16_bf16 a[96:111], v[96:99], v[96:99], 0
    v_mfma_f32_32x32x16_bf16 a[112:127], v[96:99], v[96:99], 0
    v_mfma_f32_32x32x16_bf16 a[128:143], v[96:99], v[96:99], 0
    v_mfma_f32_32x32x16_bf16 a[144:159], v[96:99], v[96:99], 0
    v_mfma_f32_32x32x16_bf16 a[224:239], v[96:99], v[96:99], 0
    s_waitcnt vmcnt(0)
    s_barrier
    ds_read_b128 a[160:163], v4 offset:0
    ds_read_b128 a[164:167], v5 offset:0
    ds_read_b128 a[168:171], v6 offset:0
    ds_read_b128 a[172:175], v7 offset:0
    ds_read_b128 a[176:179], v4 offset:4096
    ds_read_b128 a[180:183], v5 offset:4096
    ds_read_b128 a[184:187], v6 offset:4096
    ds_read_b128 a[188:191], v7 offset:4096
    ds_read_b64_tr_b16 a[192:193], v8 offset:8192
    ds_read_b64_tr_b16 a[194:195], v8 offset:12288
    ds_read_b64_tr_b16 a[196:197], v9 offset:8192
    ds_read_b64_tr_b16 a[198:199], v9 offset:12288
    ds_read_b64_tr_b16 a[200:201], v10 offset:8192
    ds_read_b64_tr_b16 a[202:203], v10 offset:12288
    ds_read_b64_tr_b16 a[204:205], v11 offset:8192
    ds_read_b64_tr_b16 a[206:207], v11 offset:12288
    s_mov_b32 s35, 8
    s_nop 7
    s_branch L_loop5
L_qs4:
    s_mov_b32 s12, s24
    s_mov_b32 s13, s25
    s_nop 0
    s_mov_b32 s14, 0x80000
    s_mov_b32 s16, s28
    s_mov_b32 s17, s29
    s_mov_b32 s18, 0x80000
    s_mov_b32 s0, 0
    s_mov_b32 s30, s1
    s_mov_b32 s44, 0xfffc0000
    s_mov_b32 s45, 0x3e000
    s_movk_i32 s31, 0x2000
    s_movk_i32 s32, 0x2000
    s_movk_i32 s52, 0x1000
    s_mov_b32 s53, 0
    s_movk_i32 s54, 0x1000
    v_mov_b32 v16, v240
    v_mov_b32 v20, v244
    v_mov_b32 v17, v241
    v_mov_b32 v21, v245
    v_mov_b32 v18, v242
    v_mov_b32 v22, v246
    v_mov_b32 v19, v243
    v_mov_b32 v23, v247
    s_branch L_qn4
L_t14:
    v_mfma_f32_16x16x32_bf16 a[0:3], a[208:211], v[96:99], a[0:3]
    v_mfma_f32_16x16x32_bf16 a[4:7], a[212:215], v[96:99], a[4:7]
    v_mfma_f32_16x16x32_bf16 a[8:11], a[216:219], v[96:99], a[8:11]
    v_mfma_f32_16x16x32_bf16 a[12:15], a[220:223], v[96:99], a[12:15]
    v_mov_b32 v1, 147456
    v_mov_b32_e64 v2, 1
    v_mfma_f32_16x16x32_bf16 a[32:35], a[208:211], v[100:103], a[32:35]
    v_accvgpr_read_b32 v32, a224
    v_accvgpr_read_b32 v33, a225
    v_mfma_f32_16x16x32_bf16 a[36:39], a[212:215], v[100:103], a[36:39]
    v_accvgpr_read_b32 v34, a226
    v_accvgpr_read_b32 v35, a227
    v_mfma_f32_16x16x32_bf16 a[40:43], a[216:219], v[100:103], a[40:43]
    v_accvgpr_read_b32 v36, a228
    v_accvgpr_read_b32 v37, a229
    v_mfma_f32_16x16x32_bf16 a[44:47], a[220:223], v[100:103], a[44:47]
    v_accvgpr_read_b32 v38, a230
    v_accvgpr_read_b32 v39, a231
    v_mfma_f32_16x16x32_bf16 a[64:67], a[208:211], v[104:107], a[64:67]
    v_add_f32 v26, v32, v33
    v_add_f32 v28, v34, v35
    v_mfma_f32_16x16x32_bf16 a[68:71], a[212:215], v[104:107], a[68:71]
    v_add_f32 v30, v36, v37
    v_add_f32 v72, v38, v39
    v_mfma_f32_16x16x32_bf16 a[72:75], a[216:219], v[104:107], a[72:75]
    v_add_f32 v3, v26, v28
    v_add_f32 v32, v30, v72
    v_mfma_f32_16x16x32_bf16 a[76:79], a[220:223], v[104:107], a[76:79]
    v_add_f32 v3, v3, v32
    v_cmp_ngt_f32 vcc, s51, v3
    v_mfma_f32_16x16x32_bf16 a[96:99], a[208:211], v[108:111], a[96:99]
    v_rcp_f32 v26, v26
    v_rcp_f32 v28, v28
    v_mfma_f32_16x16x32_bf16 a[100:103], a[212:215], v[108:111], a[100:103]
    v_rcp_f32 v30, v30
    v_rcp_f32 v72, v72
    v_mfma_f32_16x16x32_bf16 a[104:107], a[216:219], v[108:111], a[104:107]
    v_mfma_f32_16x16x32_bf16 a[108:111], a[220:223], v[108:111], a[108:111]
    s_cbranch_vccnz L_ovf04
L_nof04:
    s_waitcnt lgkmcnt(0)
    s_barrier
    s_nop 0
    ds_read_b32 v3, v1
    v_accvgpr_read_b32 v32, a0
    v_accvgpr_read_b32 v33, a1
    v_accvgpr_read_b32 v34, a2
    v_accvgpr_read_b32 v35, a3
    v_accvgpr_read_b32 v36, a4
    v_accvgpr_read_b32 v37, a5
    v_accvgpr_read_b32 v38, a6
    v_accvgpr_read_b32 v39, a7
    v_accvgpr_read_b32 v40, a8
    v_accvgpr_read_b32 v41, a9
    v_accvgpr_read_b32 v42, a10
    v_accvgpr_read_b32 v43, a11
    v_accvgpr_read_b32 v44, a12
    v_accvgpr_read_b32 v45, a13
    v_accvgpr_read_b32 v46, a14
    v_accvgpr_read_b32 v47, a15
    v_pk_mul_f32 v[32:33], v[32:33], v[26:27] op_sel_hi:[1,0]
    v_pk_mul_f32 v[34:35], v[34:35], v[26:27] op_sel_hi:[1,0]
    v_pk_mul_f32 v[36:37], v[36:37], v[26:27] op_sel_hi:[1,0]
    v_pk_mul_f32 v[38:39], v[38:39], v[26:27] op_sel_hi:[1,0]
    v_pk_mul_f32 v[40:41], v[40:41], v[26:27] op_sel_hi:[1,0]
    v_pk_mul_f32 v[42:43], v[42:43], v[26:27] op_sel_hi:[1,0]
    v_pk_mul_f32 v[44:45], v[44:45], v[26:27] op_sel_hi:[1,0]
    v_pk_mul_f32 v[46:47], v[46:47], v[26:27] op_sel_hi:[1,0]
    v_accvgpr_read_b32 v48, a16
    v_accvgpr_read_b32 v49, a17
    v_accvgpr_read_b32 v50, a18
    v_accvgpr_read_b32 v51, a19
    v_accvgpr_read_b32 v52, a20
    v_accvgpr_read_b32 v53, a21
    v_accvgpr_read_b32 v54, a22
    v_accvgpr_read_b32 v55, a23
    v_accvgpr_read_b32 v56, a24
    v_accvgpr_read_b32 v57, a25
    v_accvgpr_read_b32 v58, a26
    v_accvgpr_read_b32 v59, a27
    s_waitcnt lgkmcnt(0)
    v_readfirstlane_b32 s48, v3
    v_accvgpr_read_b32 v60, a28
    v_accvgpr_read_b32 v61, a29
    v_accvgpr_read_b32 v62, a30
    v_accvgpr_read_b32 v63, a31
    s_andn2_b32 s48, s48, s37
    s_cbranch_scc1 L_redo4
    ds_read_b128 a[208:211], v92 offset:0
    ds_read_b128 a[212:215], v92 offset:64
    ds_read_b128 a[216:219], v92 offset:128
    ds_read_b128 a[220:223], v92 offset:192
    ds_read_b128 v[176:179], v27 offset:0
    ds_read_b128 v[180:183], v27 offset:1024
    ds_read_b128 v[184:187], v27 offset:2048
    ds_read_b128 v[188:191], v27 offset:3072
    v_mov_b64 v[96:97], 0
    v_mov_b64 v[98:99], 0
    v_mov_b64 v[100:101], 0
    v_mov_b64 v[102:103], 0
    v_mov_b64 v[104:105], 0
    v_mov_b64 v[106:107], 0
    v_mov_b64 v[108:109], 0
    v_mov_b64 v[110:111], 0
    v_mfma_f32_32x32x16_bf16 a[224:239], v[96:99], v[96:99], 0
    v_mov_b64 v[192:193], v[112:113]
    v_mov_b64 v[194:195], v[114:115]
    v_mov_b64 v[196:197], v[116:117]
    v_mov_b64 v[198:199], v[118:119]
    v_mov_b64 v[200:201], v[120:121]
    v_mov_b64 v[202:203], v[122:123]
    v_mfma_f32_32x32x16_bf16 a[0:15], v[96:99], v[96:99], 0
    v_mov_b64 v[204:205], v[124:125]
    v_mov_b64 v[206:207], v[126:127]
    v_mov_b64 v[208:209], v[128:129]
    v_mov_b64 v[210:211], v[130:131]
    v_mov_b64 v[212:213], v[132:133]
    v_mov_b64 v[214:215], v[134:135]
    v_mfma_f32_32x32x16_bf16 a[16:31], v[96:99], v[96:99], 0
    v_mov_b64 v[216:217], v[136:137]
    v_mov_b64 v[218:219], v[138:139]
    v_mov_b64 v[220:221], v[140:141]
    v_mov_b64 v[222:223], v[142:143]
    v_mov_b64 v[224:225], v[144:145]
    v_mov_b64 v[226:227], v[146:147]
    v_mov_b64 v[228:229], v[148:149]
    v_mov_b64 v[230:231], v[150:151]
    v_mov_b64 v[232:233], v[152:153]
    v_mov_b64 v[234:235], v[154:155]
    v_mov_b64 v[236:237], v[156:157]
    v_mov_b64 v[238:239], v[158:159]
    s_mov_b32 s36, 1
    s_mov_b32 s26, s97
    s_mov_b32 s37, 0
    s_mov_b32 s35, 8
    s_mov_b32 s27, 4
    s_nop 0
    v_add_u32 v1, 8192, v24
    s_waitcnt lgkmcnt(0)
    s_nop 0
    v_mfma_f32_16x16x32_bf16 v[76:79], a[208:211], v[176:179], 0
    v_cvt_pk_bf16_f32 v160, v32, v33
    v_cvt_pk_bf16_f32 v161, v34, v35
    v_mfma_f32_16x16x32_bf16 v[76:79], a[212:215], v[180:183], v[76:79]
    v_cvt_pk_bf16_f32 v162, v36, v37
    v_cvt_pk_bf16_f32 v163, v38, v39
    v_cvt_pk_bf16_f32 v164, v40, v41
    v_cvt_pk_bf16_f32 v165, v42, v43
    v_cvt_pk_bf16_f32 v166, v44, v45
    v_cvt_pk_bf16_f32 v167, v46, v47
    buffer_load_dwordx4 v[112:115], v24, s[4:7], s92 offen offset:0 sc1
    v_pk_mul_f32 v[48:49], v[48:49], v[26:27] op_sel_hi:[1,0]
    v_pk_mul_f32 v[50:51], v[50:51], v[26:27] op_sel_hi:[1,0]
    v_pk_mul_f32 v[52:53], v[52:53], v[26:27] op_sel_hi:[1,0]
    v_pk_mul_f32 v[54:55], v[54:55], v[26:27] op_sel_hi:[1,0]
    v_pk_mul_f32 v[56:57], v[56:57], v[26:27] op_sel_hi:[1,0]
    v_pk_mul_f32 v[58:59], v[58:59], v[26:27] op_sel_hi:[1,0]
    v_pk_mul_f32 v[60:61], v[60:61], v[26:27] op_sel_hi:[1,0]
    v_pk_mul_f32 v[62:63], v[62:63], v[26:27] op_sel_hi:[1,0]
    v_mfma_f32_16x16x32_bf16 v[76:79], a[216:219], v[184:187], v[76:79]
    buffer_store_dwordx4 v[160:163], v24, s[20:23], s50 offen offset:0 sc1
    v_mfma_f32_16x16x32_bf16 v[76:79], a[220:223], v[188:191], v[76:79]
    v_cvt_pk_bf16_f32 v168, v48, v49
    v_cvt_pk_bf16_f32 v169, v50, v51
    v_mfma_f32_16x16x32_bf16 v[80:83], a[208:211], v[192:195], 0
    v_cvt_pk_bf16_f32 v170, v52, v53
    v_cvt_pk_bf16_f32 v171, v54, v55
    buffer_store_dwordx4 v[164:167], v24, s[20:23], s50 offen offset:1024 sc1
    v_cvt_pk_bf16_f32 v172, v56, v57
    v_cvt_pk_bf16_f32 v173, v58, v59
    v_cvt_pk_bf16_f32 v174, v60, v61
    v_cvt_pk_bf16_f32 v175, v62, v63
    buffer_load_dwordx4 v[116:119], v24, s[4:7], s92 offen offset:1024 sc1
    v_accvgpr_read_b32 v32, a32
    v_accvgpr_read_b32 v33, a33
    v_accvgpr_read_b32 v34, a34
    v_accvgpr_read_b32 v35, a35
    v_accvgpr_read_b32 v36, a36
    v_accvgpr_read_b32 v37, a37
    v_accvgpr_read_b32 v38, a38
    v_accvgpr_read_b32 v39, a39
    buffer_load_dwordx4 v[120:123], v24, s[4:7], s93 offen offset:0 sc1
    v_accvgpr_read_b32 v40, a40
    v_accvgpr_read_b32 v41, a41
    v_accvgpr_read_b32 v42, a42
    v_accvgpr_read_b32 v43, a43
    v_accvgpr_read_b32 v44, a44
    v_accvgpr_read_b32 v45, a45
    v_accvgpr_read_b32 v46, a46
    v_accvgpr_read_b32 v47, a47
    v_pk_mul_f32 v[32:33], v[32:33], v[28:29] op_sel_hi:[1,0]
    v_pk_mul_f32 v[34:35], v[34:35], v[28:29] op_sel_hi:[1,0]
    v_pk_mul_f32 v[36:37], v[36:37], v[28:29] op_sel_hi:[1,0]
    v_pk_mul_f32 v[38:39], v[38:39], v[28:29] op_sel_hi:[1,0]
    v_pk_mul_f32 v[40:41], v[40:41], v[28:29] op_sel_hi:[1,0]
    v_pk_mul_f32 v[42:43], v[42:43], v[28:29] op_sel_hi:[1,0]
    v_pk_mul_f32 v[44:45], v[44:45], v[28:29] op_sel_hi:[1,0]
    v_pk_mul_f32 v[46:47], v[46:47], v[28:29] op_sel_hi:[1,0]
    v_mfma_f32_32x32x16_bf16 a[32:47], v[96:99], v[96:99], 0
    buffer_store_dwordx4 v[168:171], v24, s[20:23], s50 offen offset:2048 sc1
    v_cvt_pk_bf16_f32 v160, v32, v33
    v_cvt_pk_bf16_f32 v161, v34, v35
    v_mfma_f32_16x16x32_bf16 v[80:83], a[212:215], v[196:199], v[80:83]
    v_cvt_pk_bf16_f32 v162, v36, v37
    v_cvt_pk_bf16_f32 v163, v38, v39
    v_mfma_f32_16x16x32_bf16 v[80:83], a[216:219], v[200:203], v[80:83]
    buffer_store_dwordx4 v[172:175], v24, s[20:23], s50 offen offset:3072 sc1
    v_mfma_f32_16x16x32_bf16 v[80:83], a[220:223], v[204:207], v[80:83]
    v_cvt_pk_bf16_f32 v164, v40, v41
    v_cvt_pk_bf16_f32 v165, v42, v43
    v_cvt_pk_bf16_f32 v166, v44, v45
    v_cvt_pk_bf16_f32 v167, v46, v47
    buffer_load_dwordx4 v[124:127], v24, s[4:7], s93 offen offset:1024 sc1
    v_accvgpr_read_b32 v48, a48
    v_accvgpr_read_b32 v49, a49
    v_accvgpr_read_b32 v50, a50
    v_accvgpr_read_b32 v51, a51
    v_accvgpr_read_b32 v52, a52
    v_accvgpr_read_b32 v53, a53
    v_accvgpr_read_b32 v54, a54
    v_accvgpr_read_b32 v55, a55
    buffer_load_dwordx4 v[128:131], v24, s[4:7], s94 offen offset:0 sc1
    v_accvgpr_read_b32 v56, a56
    v_accvgpr_read_b32 v57, a57
    v_accvgpr_read_b32 v58, a58
    v_accvgpr_read_b32 v59, a59
    v_accvgpr_read_b32 v60, a60
    v_accvgpr_read_b32 v61, a61
    v_accvgpr_read_b32 v62, a62
    v_accvgpr_read_b32 v63, a63
    v_pk_mul_f32 v[48:49], v[48:49], v[28:29] op_sel_hi:[1,0]
    v_pk_mul_f32 v[50:51], v[50:51], v[28:29] op_sel_hi:[1,0]
    v_pk_mul_f32 v[52:53], v[52:53], v[28:29] op_sel_hi:[1,0]
    v_pk_mul_f32 v[54:55], v[54:55], v[28:29] op_sel_hi:[1,0]
    v_pk_mul_f32 v[56:57], v[56:57], v[28:29] op_sel_hi:[1,0]
    v_pk_mul_f32 v[58:59], v[58:59], v[28:29] op_sel_hi:[1,0]
    v_pk_mul_f32 v[60:61], v[60:61], v[28:29] op_sel_hi:[1,0]
    v_pk_mul_f32 v[62:63], v[62:63], v[28:29] op_sel_hi:[1,0]
    v_mfma_f32_32x32x16_bf16 a[48:63], v[96:99], v[96:99], 0
    ds_write_b128 v27, v[160:163] offset:4096
    v_cvt_pk_bf16_f32 v168, v48, v49
    v_cvt_pk_bf16_f32 v169, v50, v51
    v_mfma_f32_16x16x32_bf16 v[84:87], a[208:211], v[208:211], 0
    v_cvt_pk_bf16_f32 v170, v52, v53
    v_cvt_pk_bf16_f32 v171, v54, v55
    v_mfma_f32_16x16x32_bf16 v[84:87], a[212:215], v[212:215], v[84:87]
    ds_write_b128 v27, v[164:167] offset:5120
    v_cvt_pk_bf16_f32 v172, v56, v57
    v_cvt_pk_bf16_f32 v173, v58, v59
    v_cvt_pk_bf16_f32 v174, v60, v61
    v_cvt_pk_bf16_f32 v175, v62, v63
    buffer_load_dwordx4 v[132:135], v24, s[4:7], s94 offen offset:1024 sc1
    v_accvgpr_read_b32 v32, a64
    v_accvgpr_read_b32 v33, a65
    v_accvgpr_read_b32 v34, a66
    v_accvgpr_read_b32 v35, a67
    v_accvgpr_read_b32 v36, a68
    v_accvgpr_read_b32 v37, a69
    v_accvgpr_read_b32 v38, a70
    v_accvgpr_read_b32 v39, a71
    v_accvgpr_read_b32 v40, a72
    v_accvgpr_read_b32 v41, a73
    v_accvgpr_read_b32 v42, a74
    v_accvgpr_read_b32 v43, a75
    v_accvgpr_read_b32 v44, a76
    v_accvgpr_read_b32 v45, a77
    v_accvgpr_read_b32 v46, a78
    v_accvgpr_read_b32 v47, a79
    v_pk_mul_f32 v[32:33], v[32:33], v[30:31] op_sel_hi:[1,0]
    v_pk_mul_f32 v[34:35], v[34:35], v[30:31] op_sel_hi:[1,0]
    v_pk_mul_f32 v[36:37], v[36:37], v[30:31] op_sel_hi:[1,0]
    v_pk_mul_f32 v[38:39], v[38:39], v[30:31] op_sel_hi:[1,0]
    v_pk_mul_f32 v[40:41], v[40:41], v[30:31] op_sel_hi:[1,0]
    v_pk_mul_f32 v[42:43], v[42:43], v[30:31] op_sel_hi:[1,0]
    v_pk_mul_f32 v[44:45], v[44:45], v[30:31] op_sel_hi:[1,0]
    v_pk_mul_f32 v[46:47], v[46:47], v[30:31] op_sel_hi:[1,0]
    v_mfma_f32_32x32x16_bf16 a[64:79], v[96:99], v[96:99], 0
    ds_write_b128 v27, v[168:171] offset:6144
    v_cvt_pk_bf16_f32 v160, v32, v33
    v_cvt_pk_bf16_f32 v161, v34, v35
    v_mfma_f32_16x16x32_bf16 v[84:87], a[216:219], v[216:219], v[84:87]
    v_cvt_pk_bf16_f32 v162, v36, v37
    v_cvt_pk_bf16_f32 v163, v38, v39
    v_mfma_f32_16x16x32_bf16 v[84:87], a[220:223], v[220:223], v[84:87]
    ds_write_b128 v27, v[172:175] offset:7168
    v_mfma_f32_16x16x32_bf16 v[88:91], a[208:211], v[224:227], 0
    v_cvt_pk_bf16_f32 v164, v40, v41
    v_cvt_pk_bf16_f32 v165, v42, v43
    v_cvt_pk_bf16_f32 v166, v44, v45
    v_cvt_pk_bf16_f32 v167, v46, v47
    buffer_load_dwordx4 v[136:139], v24, s[4:7], s95 offen offset:0 sc1
    v_accvgpr_read_b32 v48, a80
    v_accvgpr_read_b32 v49, a81
    v_accvgpr_read_b32 v50, a82
    v_accvgpr_read_b32 v51, a83
    v_accvgpr_read_b32 v52, a84
    v_accvgpr_read_b32 v53, a85
    v_accvgpr_read_b32 v54, a86
    v_accvgpr_read_b32 v55, a87
    buffer_load_dwordx4 v[140:143], v24, s[4:7], s95 offen offset:1024 sc1
    v_accvgpr_read_b32 v56, a88
    v_accvgpr_read_b32 v57, a89
    v_accvgpr_read_b32 v58, a90
    v_accvgpr_read_b32 v59, a91
    v_accvgpr_read_b32 v60, a92
    v_accvgpr_read_b32 v61, a93
    v_accvgpr_read_b32 v62, a94
    v_accvgpr_read_b32 v63, a95
    v_pk_mul_f32 v[48:49], v[48:49], v[30:31] op_sel_hi:[1,0]
    v_pk_mul_f32 v[50:51], v[50:51], v[30:31] op_sel_hi:[1,0]
    v_pk_mul_f32 v[52:53], v[52:53], v[30:31] op_sel_hi:[1,0]
    v_pk_mul_f32 v[54:55], v[54:55], v[30:31] op_sel_hi:[1,0]
    v_pk_mul_f32 v[56:57], v[56:57], v[30:31] op_sel_hi:[1,0]
    v_pk_mul_f32 v[58:59], v[58:59], v[30:31] op_sel_hi:[1,0]
    v_pk_mul_f32 v[60:61], v[60:61], v[30:31] op_sel_hi:[1,0]
    v_pk_mul_f32 v[62:63], v[62:63], v[30:31] op_sel_hi:[1,0]
    v_mfma_f32_32x32x16_bf16 a[80:95], v[96:99], v[96:99], 0
    ds_write_b128 v27, v[160:163] offset:8192
    v_cvt_pk_bf16_f32 v168, v48, v49
    v_cvt_pk_bf16_f32 v169, v50, v51
    v_mfma_f32_16x16x32_bf16 v[88:91], a[212:215], v[228:231], v[88:91]
    v_cvt_pk_bf16_f32 v170, v52, v53
    v_cvt_pk_bf16_f32 v171, v54, v55
    v_mfma_f32_16x16x32_bf16 v[88:91], a[216:219], v[232:235], v[88:91]
    ds_write_b128 v27, v[164:167] offset:9216
    v_mfma_f32_16x16x32_bf16 v[88:91], a[220:223], v[236:239], v[88:91]
    v_cvt_pk_bf16_f32 v172, v56, v57
    v_cvt_pk_bf16_f32 v173, v58, v59
    v_cvt_pk_bf16_f32 v174, v60, v61
    v_cvt_pk_bf16_f32 v175, v62, v63
    buffer_load_dwordx4 v[144:147], v1, s[4:7], s92 offen offset:0 sc1
    v_accvgpr_read_b32 v32, a96
    v_accvgpr_read_b32 v33, a97
    v_accvgpr_read_b32 v34, a98
    v_accvgpr_read_b32 v35, a99
    v_accvgpr_read_b32 v36, a100
    v_accvgpr_read_b32 v37, a101
    v_accvgpr_read_b32 v38, a102
    v_accvgpr_read_b32 v39, a103
    buffer_load_dwordx4 v[148:151], v1, s[4:7], s92 offen offset:1024 sc1
    v_accvgpr_read_b32 v40, a104
    v_accvgpr_read_b32 v41, a105
    v_accvgpr_read_b32 v42, a106
    v_accvgpr_read_b32 v43, a107
    v_accvgpr_read_b32 v44, a108
    v_accvgpr_read_b32 v45, a109
    v_accvgpr_read_b32 v46, a110
    v_accvgpr_read_b32 v47, a111
    v_pk_mul_f32 v[32:33], v[32:33], v[72:73] op_sel_hi:[1,0]
    v_pk_mul_f32 v[34:35], v[34:35], v[72:73] op_sel_hi:[1,0]
    v_pk_mul_f32 v[36:37], v[36:37], v[72:73] op_sel_hi:[1,0]
    v_pk_mul_f32 v[38:39], v[38:39], v[72:73] op_sel_hi:[1,0]
    v_pk_mul_f32 v[40:41], v[40:41], v[72:73] op_sel_hi:[1,0]
    v_pk_mul_f32 v[42:43], v[42:43], v[72:73] op_sel_hi:[1,0]
    v_pk_mul_f32 v[44:45], v[44:45], v[72:73] op_sel_hi:[1,0]
    v_pk_mul_f32 v[46:47], v[46:47], v[72:73] op_sel_hi:[1,0]
    v_mfma_f32_32x32x16_bf16 a[96:111], v[96:99], v[96:99], 0
    ds_write_b128 v27, v[168:171] offset:10240
    v_cvt_pk_bf16_f32 v160, v32, v33
    v_cvt_pk_bf16_f32 v161, v34, v35
    v_cvt_pk_bf16_f32 v162, v36, v37
    v_cvt_pk_bf16_f32 v163, v38, v39
    ds_write_b128 v27, v[172:175] offset:11264
    v_cvt_pk_bf16_f32 v164, v40, v41
    v_cvt_pk_bf16_f32 v165, v42, v43
    v_cvt_pk_bf16_f32 v166, v44, v45
    v_cvt_pk_bf16_f32 v167, v46, v47
    buffer_load_dwordx4 v[152:155], v1, s[4:7], s93 offen offset:0 sc1
    v_accvgpr_read_b32 v48, a112
    v_accvgpr_read_b32 v49, a113
    v_accvgpr_read_b32 v50, a114
    v_accvgpr_read_b32 v51, a115
    v_accvgpr_read_b32 v52, a116
    v_accvgpr_read_b32 v53, a117
    v_accvgpr_read_b32 v54, a118
    v_accvgpr_read_b32 v55, a119
    buffer_load_dwordx4 v[156:159], v1, s[4:7], s93 offen offset:1024 sc1
    v_accvgpr_read_b32 v56, a120
    v_accvgpr_read_b32 v57, a121
    v_accvgpr_read_b32 v58, a122
    v_accvgpr_read_b32 v59, a123
    v_accvgpr_read_b32 v60, a124
    v_accvgpr_read_b32 v61, a125
    v_accvgpr_read_b32 v62, a126
    v_accvgpr_read_b32 v63, a127
    v_pk_mul_f32 v[48:49], v[48:49], v[72:73] op_sel_hi:[1,0]
    v_pk_mul_f32 v[50:51], v[50:51], v[72:73] op_sel_hi:[1,0]
    v_pk_mul_f32 v[52:53], v[52:53], v[72:73] op_sel_hi:[1,0]
    v_pk_mul_f32 v[54:55], v[54:55], v[72:73] op_sel_hi:[1,0]
    v_pk_mul_f32 v[56:57], v[56:57], v[72:73] op_sel_hi:[1,0]
    v_pk_mul_f32 v[58:59], v[58:59], v[72:73] op_sel_hi:[1,0]
    v_pk_mul_f32 v[60:61], v[60:61], v[72:73] op_sel_hi:[1,0]
    v_pk_mul_f32 v[62:63], v[62:63], v[72:73] op_sel_hi:[1,0]
    v_mfma_f32_32x32x16_bf16 a[112:127], v[96:99], v[96:99], 0
    v_cvt_pk_bf16_f32 v168, v48, v49
    v_cvt_pk_bf16_f32 v169, v50, v51
    v_cvt_pk_bf16_f32 v170, v52, v53
    v_cvt_pk_bf16_f32 v171, v54, v55
    v_cvt_pk_bf16_f32 v172, v56, v57
    v_cvt_pk_bf16_f32 v173, v58, v59
    v_cvt_pk_bf16_f32 v174, v60, v61
    v_cvt_pk_bf16_f32 v175, v62, v63
    v_max3_f32 v76, v76, v77, v78
    v_max3_f32 v80, v80, v81, v82
    v_max3_f32 v84, v84, v85, v86
    v_max3_f32 v88, v88, v89, v90
    v_max_f32 v76, v76, v79
    v_max_f32 v80, v80, v83
    v_max_f32 v84, v84, v87
    v_max_f32 v88, v88, v91
    v_pk_mul_f32 v[78:79], v[76:77], -1.0 op_sel_hi:[0,0]
    v_pk_mul_f32 v[82:83], v[80:81], -1.0 op_sel_hi:[0,0]
    v_pk_mul_f32 v[86:87], v[84:85], -1.0 op_sel_hi:[0,0]
    v_pk_mul_f32 v[90:91], v[88:89], -1.0 op_sel_hi:[0,0]
    v_pk_mul_f32 v[76:77], v[76:77], -1.0 op_sel_hi:[0,0]
    v_pk_mul_f32 v[80:81], v[80:81], -1.0 op_sel_hi:[0,0]
    v_pk_mul_f32 v[84:85], v[84:85], -1.0 op_sel_hi:[0,0]
    v_pk_mul_f32 v[88:89], v[88:89], -1.0 op_sel_hi:[0,0]
    s_nop 0
    s_nop 0
    s_nop 0
    s_nop 0
    s_nop 0
    s_nop 0
    s_nop 0
L_loopS4:
    s_waitcnt lgkmcnt(8)
    v_mfma_f32_16x16x32_bf16 v[32:35], a[160:163], v[176:179], v[76:79]
    ds_read_b64_tr_b16 a[236:237], v12 offset:8192
    v_mfma_f32_16x16x32_bf16 v[32:35], a[164:167], v[180:183], v[32:35]
    ds_read_b64_tr_b16 a[238:239], v12 offset:12288
    v_mfma_f32_16x16x32_bf16 v[32:35], a[168:171], v[184:187], v[32:35]
    ds_read_b64_tr_b16 a[240:241], v13 offset:8192
    v_mfma_f32_16x16x32_bf16 v[32:35], a[172:175], v[188:191], v[32:35]
    ds_read_b64_tr_b16 a[242:243], v13 offset:12288
    v_mfma_f32_16x16x32_bf16 v[36:39], a[176:179], v[176:179], v[76:79]
    ds_read_b64_tr_b16 a[248:249], v14 offset:8192
    v_mfma_f32_16x16x32_bf16 v[36:39], a[180:183], v[180:183], v[36:39]
    ds_read_b64_tr_b16 a[250:251], v14 offset:12288
    v_mfma_f32_16x16x32_bf16 v[36:39], a[184:187], v[184:187], v[36:39]
    ds_read_b64_tr_b16 a[252:253], v15 offset:8192
    v_mfma_f32_16x16x32_bf16 v[36:39], a[188:191], v[188:191], v[36:39]
    ds_read_b64_tr_b16 a[254:255], v15 offset:12288
    v_mfma_f32_16x16x32_bf16 v[40:43], a[160:163], v[192:195], v[80:83]
    v_exp_f32 v32, v32
    v_mfma_f32_16x16x32_bf16 v[40:43], a[164:167], v[196:199], v[40:43]
    v_exp_f32 v33, v33
    v_mfma_f32_16x16x32_bf16 v[40:43], a[168:171], v[200:203], v[40:43]
    v_exp_f32 v34, v34
    v_mfma_f32_16x16x32_bf16 v[40:43], a[172:175], v[204:207], v[40:43]
    v_exp_f32 v35, v35
    v_mfma_f32_16x16x32_bf16 v[44:47], a[176:179], v[192:195], v[80:83]
    v_cvt_pk_bf16_f32 v56, v32, v33
    v_cvt_pk_bf16_f32 v57, v34, v35
    v_mfma_f32_16x16x32_bf16 v[44:47], a[180:183], v[196:199], v[44:47]
    v_exp_f32 v36, v36
    v_mfma_f32_16x16x32_bf16 v[44:47], a[184:187], v[200:203], v[44:47]
    buffer_store_dwordx4 v[160:163], v24, s[20:23], s68 offen offset:0 sc1
    v_mfma_f32_16x16x32_bf16 v[44:47], a[188:191], v[204:207], v[44:47]
    v_exp_f32 v37, v37
    v_mfma_f32_16x16x32_bf16 v[48:51], a[160:163], v[208:211], v[84:87]
    v_exp_f32 v38, v38
    v_mfma_f32_16x16x32_bf16 v[48:51], a[164:167], v[212:215], v[48:51]
    v_exp_f32 v39, v39
    v_mfma_f32_16x16x32_bf16 v[48:51], a[168:171], v[216:219], v[48:51]
    v_cvt_pk_bf16_f32 v58, v36, v37
    v_cvt_pk_bf16_f32 v59, v38, v39
    v_mfma_f32_16x16x32_bf16 v[48:51], a[172:175], v[220:223], v[48:51]
    v_exp_f32 v40, v40
    v_mfma_f32_16x16x32_bf16 v[52:55], a[176:179], v[208:211], v[84:87]
    v_exp_f32 v41, v41
    v_mfma_f32_16x16x32_bf16 v[52:55], a[180:183], v[212:215], v[52:55]
    v_exp_f32 v42, v42
    v_mfma_f32_16x16x32_bf16 v[52:55], a[184:187], v[216:219], v[52:55]
    v_exp_f32 v43, v43
    v_mfma_f32_16x16x32_bf16 v[52:55], a[188:191], v[220:223], v[52:55]
    v_exp_f32 v44, v44
    v_mfma_f32_16x16x32_bf16 v[32:35], a[160:163], v[224:227], v[88:91]
    v_exp_f32 v45, v45
    v_mfma_f32_16x16x32_bf16 v[32:35], a[164:167], v[228:231], v[32:35]
    v_exp_f32 v46, v46
    v_mfma_f32_16x16x32_bf16 v[32:35], a[168:171], v[232:235], v[32:35]
    v_exp_f32 v47, v47
    v_mfma_f32_16x16x32_bf16 v[32:35], a[172:175], v[236:239], v[32:35]
    v_cvt_pk_bf16_f32 v60, v40, v41
    v_cvt_pk_bf16_f32 v61, v42, v43
    v_mfma_f32_16x16x32_bf16 v[36:39], a[176:179], v[224:227], v[88:91]
    v_cvt_pk_bf16_f32 v62, v44, v45
    v_cvt_pk_bf16_f32 v63, v46, v47
    v_mfma_f32_16x16x32_bf16 v[36:39], a[180:183], v[228:231], v[36:39]
    v_exp_f32 v48, v48
    v_mfma_f32_16x16x32_bf16 v[36:39], a[184:187], v[232:235], v[36:39]
    v_exp_f32 v49, v49
    v_mfma_f32_16x16x32_bf16 v[36:39], a[188:191], v[236:239], v[36:39]
    s_waitcnt vmcnt(32) lgkmcnt(0)
    s_barrier
    v_mfma_f32_16x16x32_bf16 a[0:3], a[208:211], v[96:99], a[0:3]
    s_mov_b32 m0, 0
    s_add_u32 s0, s0, 0x2000
    buffer_load_dwordx4 v16, s[12:15], s30 offen offset:0 nt lds
    v_mfma_f32_16x16x32_bf16 a[0:3], a[192:195], v[56:59], a[0:3]
    v_exp_f32 v50, v50
    v_mfma_f32_16x16x32_bf16 a[4:7], a[212:215], v[96:99], a[4:7]
    buffer_load_dwordx4 v17, s[12:15], s30 offen offset:1024 nt lds
    v_cvt_pk_bf16_f32 v64, v48, v49
    v_mfma_f32_16x16x32_bf16 a[4:7], a[196:199], v[56:59], a[4:7]
    v_exp_f32 v51, v51
    v_mfma_f32_16x16x32_bf16 a[8:11], a[216:219], v[96:99], a[8:11]
    buffer_load_dwordx4 v18, s[12:15], s30 offen offset:2048 nt lds
    v_cvt_pk_bf16_f32 v65, v50, v51
    v_mfma_f32_16x16x32_bf16 a[8:11], a[200:203], v[56:59], a[8:11]
    v_exp_f32 v52, v52
    v_mfma_f32_16x16x32_bf16 a[12:15], a[220:223], v[96:99], a[12:15]
    buffer_load_dwordx4 v19, s[12:15], s30 offen offset:3072 nt lds
    ds_read_b128 a[160:163], v4 offset:16384
    v_mfma_f32_16x16x32_bf16 a[12:15], a[204:207], v[56:59], a[12:15]
    v_exp_f32 v53, v53
    v_mfma_f32_16x16x32_bf16 a[32:35], a[208:211], v[100:103], a[32:35]
    s_mov_b32 m0, 4096
    s_add_u32 s49, s30, s52
    buffer_load_dwordx4 v16, s[12:15], s49 offen offset:0 nt lds
    v_mfma_f32_16x16x32_bf16 a[32:35], a[192:195], v[60:63], a[32:35]
    v_exp_f32 v54, v54
    v_mfma_f32_16x16x32_bf16 a[36:39], a[212:215], v[100:103], a[36:39]
    buffer_load_dwordx4 v17, s[12:15], s49 offen offset:1024 nt lds
    v_cvt_pk_bf16_f32 v66, v52, v53
    v_mfma_f32_16x16x32_bf16 a[36:39], a[196:199], v[60:63], a[36:39]
    v_exp_f32 v55, v55
    v_mfma_f32_16x16x32_bf16 a[40:43], a[216:219], v[100:103], a[40:43]
    buffer_load_dwordx4 v18, s[12:15], s49 offen offset:2048 nt lds
    v_cvt_pk_bf16_f32 v67, v54, v55
    v_mfma_f32_16x16x32_bf16 a[40:43], a[200:203], v[60:63], a[40:43]
    v_exp_f32 v32, v32
    v_mfma_f32_16x16x32_bf16 a[44:47], a[220:223], v[100:103], a[44:47]
    buffer_load_dwordx4 v19, s[12:15], s49 offen offset:3072 nt lds
    ds_read_b128 a[164:167], v5 offset:16384
    v_mfma_f32_16x16x32_bf16 a[44:47], a[204:207], v[60:63], a[44:47]
    v_exp_f32 v33, v33
    v_smfmac_f32_16x16x64_bf16 a[224:227], a[244:247], v[56:63], v74
    v_cvt_pk_bf16_f32 v68, v32, v33
    v_mfma_f32_16x16x32_bf16 a[64:67], a[208:211], v[104:107], a[64:67]
    s_mov_b32 m0, 8192
    s_add_u32 s49, s30, s53
    buffer_load_dwordx4 v20, s[16:19], s49 offen offset:0 nt lds
    v_mfma_f32_16x16x32_bf16 a[64:67], a[192:195], v[64:67], a[64:67]
    buffer_load_dwordx4 v21, s[16:19], s49 offen offset:1024 nt lds
    ds_read_b128 a[168:171], v6 offset:16384
    v_mfma_f32_16x16x32_bf16 a[68:71], a[212:215], v[104:107], a[68:71]
    v_exp_f32 v34, v34
    v_mfma_f32_16x16x32_bf16 a[68:71], a[196:199], v[64:67], a[68:71]
    buffer_load_dwordx4 v22, s[16:19], s49 offen offset:2048 nt lds
    ds_read_b128 a[172:175], v7 offset:16384
    v_mfma_f32_16x16x32_bf16 a[72:75], a[216:219], v[104:107], a[72:75]
    v_exp_f32 v35, v35
    v_mfma_f32_16x16x32_bf16 a[72:75], a[200:203], v[64:67], a[72:75]
    v_exp_f32 v36, v36
    v_exp_f32 v37, v37
    v_exp_f32 v38, v38
    v_exp_f32 v39, v39
    v_mfma_f32_16x16x32_bf16 a[76:79], a[220:223], v[104:107], a[76:79]
    buffer_load_dwordx4 v23, s[16:19], s49 offen offset:3072 nt lds
    v_cvt_pk_bf16_f32 v69, v34, v35
    v_cvt_pk_bf16_f32 v70, v36, v37
    v_cvt_pk_bf16_f32 v71, v38, v39
    v_mfma_f32_16x16x32_bf16 a[76:79], a[204:207], v[64:67], a[76:79]
    ds_read_b128 a[176:179], v4 offset:20480
    ds_read_b128 a[180:183], v5 offset:20480
    v_mfma_f32_16x16x32_bf16 a[96:99], a[208:211], v[108:111], a[96:99]
    ds_read_b128 a[184:187], v6 offset:20480
    ds_read_b128 a[188:191], v7 offset:20480
    s_mov_b32 m0, 12288
    s_add_u32 s49, s30, s54
    buffer_load_dwordx4 v20, s[16:19], s49 offen offset:0 nt lds
    v_mfma_f32_16x16x32_bf16 a[96:99], a[192:195], v[68:71], a[96:99]
    ds_read_b64_tr_b16 a[192:193], v12 offset:24576
    buffer_load_dwordx4 v21, s[16:19], s49 offen offset:1024 nt lds
    v_mfma_f32_16x16x32_bf16 a[100:103], a[212:215], v[108:111], a[100:103]
    ds_read_b64_tr_b16 a[194:195], v12 offset:28672
    v_mfma_f32_16x16x32_bf16 a[100:103], a[196:199], v[68:71], a[100:103]
    ds_read_b64_tr_b16 a[196:197], v13 offset:24576
    buffer_load_dwordx4 v22, s[16:19], s49 offen offset:2048 nt lds
    v_mfma_f32_16x16x32_bf16 a[104:107], a[216:219], v[108:111], a[104:107]
    ds_read_b64_tr_b16 a[198:199], v13 offset:28672
    v_mfma_f32_16x16x32_bf16 a[104:107], a[200:203], v[68:71], a[104:107]
    ds_read_b64_tr_b16 a[200:201], v14 offset:24576
    buffer_load_dwordx4 v23, s[16:19], s49 offen offset:3072 nt lds
    v_mfma_f32_16x16x32_bf16 a[108:111], a[220:223], v[108:111], a[108:111]
    ds_read_b64_tr_b16 a[202:203], v14 offset:28672
    v_mfma_f32_16x16x32_bf16 a[108:111], a[204:207], v[68:71], a[108:111]
    ds_read_b64_tr_b16 a[204:205], v15 offset:24576
    v_smfmac_f32_16x16x64_bf16 a[228:231], a[244:247], v[64:71], v74
    ds_read_b64_tr_b16 a[206:207], v15 offset:28672
    s_add_u32 s49, s0, s1
    s_and_b32 s49, s49, s45
    s_and_b32 s30, s0, s44
    s_or_b32 s30, s30, s49
    s_waitcnt lgkmcnt(8)
    v_mfma_f32_16x16x32_bf16 v[32:35], a[160:163], v[176:179], v[76:79]
    ds_read_b64_tr_b16 a[208:209], v8 offset:24576
    v_mfma_f32_16x16x32_bf16 v[32:35], a[164:167], v[180:183], v[32:35]
    ds_read_b64_tr_b16 a[210:211], v8 offset:28672
    v_mfma_f32_16x16x32_bf16 v[32:35], a[168:171], v[184:187], v[32:35]
    ds_read_b64_tr_b16 a[212:213], v9 offset:24576
    v_mfma_f32_16x16x32_bf16 v[32:35], a[172:175], v[188:191], v[32:35]
    ds_read_b64_tr_b16 a[214:215], v9 offset:28672
    v_mfma_f32_16x16x32_bf16 v[36:39], a[176:179], v[176:179], v[76:79]
    ds_read_b64_tr_b16 a[216:217], v10 offset:24576
    v_mfma_f32_16x16x32_bf16 v[36:39], a[180:183], v[180:183], v[36:39]
    ds_read_b64_tr_b16 a[218:219], v10 offset:28672
    v_mfma_f32_16x16x32_bf16 v[36:39], a[184:187], v[184:187], v[36:39]
    ds_read_b64_tr_b16 a[220:221], v11 offset:24576
    v_mfma_f32_16x16x32_bf16 v[36:39], a[188:191], v[188:191], v[36:39]
    ds_read_b64_tr_b16 a[222:223], v11 offset:28672
    v_mfma_f32_16x16x32_bf16 v[40:43], a[160:163], v[192:195], v[80:83]
    v_exp_f32 v32, v32
    v_mfma_f32_16x16x32_bf16 v[40:43], a[164:167], v[196:199], v[40:43]
    v_exp_f32 v33, v33
    v_mfma_f32_16x16x32_bf16 v[40:43], a[168:171], v[200:203], v[40:43]
    v_exp_f32 v34, v34
    v_mfma_f32_16x16x32_bf16 v[40:43], a[172:175], v[204:207], v[40:43]
    v_exp_f32 v35, v35
    v_mfma_f32_16x16x32_bf16 v[44:47], a[176:179], v[192:195], v[80:83]
    v_cvt_pk_bf16_f32 v96, v32, v33
    v_cvt_pk_bf16_f32 v97, v34, v35
    v_mfma_f32_16x16x32_bf16 v[44:47], a[180:183], v[196:199], v[44:47]
    v_exp_f32 v36, v36
    v_mfma_f32_16x16x32_bf16 v[44:47], a[184:187], v[200:203], v[44:47]
    buffer_store_dwordx4 v[164:167], v24, s[20:23], s68 offen offset:1024 sc1
    v_mfma_f32_16x16x32_bf16 v[44:47], a[188:191], v[204:207], v[44:47]
    v_exp_f32 v37, v37
    v_mfma_f32_16x16x32_bf16 v[48:51], a[160:163], v[208:211], v[84:87]
    v_exp_f32 v38, v38
    v_mfma_f32_16x16x32_bf16 v[48:51], a[164:167], v[212:215], v[48:51]
    v_exp_f32 v39, v39
    v_mfma_f32_16x16x32_bf16 v[48:51], a[168:171], v[216:219], v[48:51]
    v_cvt_pk_bf16_f32 v98, v36, v37
    v_cvt_pk_bf16_f32 v99, v38, v39
    v_mfma_f32_16x16x32_bf16 v[48:51], a[172:175], v[220:223], v[48:51]
    v_exp_f32 v40, v40
    v_mfma_f32_16x16x32_bf16 v[52:55], a[176:179], v[208:211], v[84:87]
    v_exp_f32 v41, v41
    v_mfma_f32_16x16x32_bf16 v[52:55], a[180:183], v[212:215], v[52:55]
    v_exp_f32 v42, v42
    v_mfma_f32_16x16x32_bf16 v[52:55], a[184:187], v[216:219], v[52:55]
    v_exp_f32 v43, v43
    v_mfma_f32_16x16x32_bf16 v[52:55], a[188:191], v[220:223], v[52:55]
    v_exp_f32 v44, v44
    v_mfma_f32_16x16x32_bf16 v[32:35], a[160:163], v[224:227], v[88:91]
    v_exp_f32 v45, v45
    v_mfma_f32_16x16x32_bf16 v[32:35], a[164:167], v[228:231], v[32:35]
    v_exp_f32 v46, v46
    v_mfma_f32_16x16x32_bf16 v[32:35], a[168:171], v[232:235], v[32:35]
    v_exp_f32 v47, v47
    v_mfma_f32_16x16x32_bf16 v[32:35], a[172:175], v[236:239], v[32:35]
    v_cvt_pk_bf16_f32 v100, v40, v41
    v_cvt_pk_bf16_f32 v101, v42, v43
    v_mfma_f32_16x16x32_bf16 v[36:39], a[176:179], v[224:227], v[88:91]
    v_cvt_pk_bf16_f32 v102, v44, v45
    v_cvt_pk_bf16_f32 v103, v46, v47
    v_mfma_f32_16x16x32_bf16 v[36:39], a[180:183], v[228:231], v[36:39]
    v_exp_f32 v48, v48
    v_mfma_f32_16x16x32_bf16 v[36:39], a[184:187], v[232:235], v[36:39]
    v_exp_f32 v49, v49
    v_mfma_f32_16x16x32_bf16 v[36:39], a[188:191], v[236:239], v[36:39]
    s_waitcnt vmcnt(32) lgkmcnt(0)
    s_barrier
    v_mfma_f32_16x16x32_bf16 a[16:19], a[236:239], v[56:59], a[16:19]
    s_mov_b32 m0, 16384
    s_add_u32 s0, s0, 0x2000
    buffer_load_dwordx4 v16, s[12:15], s30 offen offset:0 nt lds
    v_mfma_f32_16x16x32_bf16 a[16:19], a[192:195], v[96:99], a[16:19]
    v_exp_f32 v50, v50
    v_mfma_f32_16x16x32_bf16 a[20:23], a[240:243], v[56:59], a[20:23]
    buffer_load_dwordx4 v17, s[12:15], s30 offen offset:1024 nt lds
    v_cvt_pk_bf16_f32 v104, v48, v49
    v_mfma_f32_16x16x32_bf16 a[20:23], a[196:199], v[96:99], a[20:23]
    v_exp_f32 v51, v51
    v_mfma_f32_16x16x32_bf16 a[24:27], a[248:251], v[56:59], a[24:27]
    buffer_load_dwordx4 v18, s[12:15], s30 offen offset:2048 nt lds
    v_cvt_pk_bf16_f32 v105, v50, v51
    v_mfma_f32_16x16x32_bf16 a[24:27], a[200:203], v[96:99], a[24:27]
    v_exp_f32 v52, v52
    v_mfma_f32_16x16x32_bf16 a[28:31], a[252:255], v[56:59], a[28:31]
    buffer_load_dwordx4 v19, s[12:15], s30 offen offset:3072 nt lds
    ds_read_b128 a[160:163], v4 offset:32768
    v_mfma_f32_16x16x32_bf16 a[28:31], a[204:207], v[96:99], a[28:31]
    v_exp_f32 v53, v53
    v_mfma_f32_16x16x32_bf16 a[48:51], a[236:239], v[60:63], a[48:51]
    s_mov_b32 m0, 20480
    s_add_u32 s49, s30, s52
    buffer_load_dwordx4 v16, s[12:15], s49 offen offset:0 nt lds
    v_mfma_f32_16x16x32_bf16 a[48:51], a[192:195], v[100:103], a[48:51]
    v_exp_f32 v54, v54
    v_mfma_f32_16x16x32_bf16 a[52:55], a[240:243], v[60:63], a[52:55]
    buffer_load_dwordx4 v17, s[12:15], s49 offen offset:1024 nt lds
    v_cvt_pk_bf16_f32 v106, v52, v53
    v_mfma_f32_16x16x32_bf16 a[52:55], a[196:199], v[100:103], a[52:55]
    v_exp_f32 v55, v55
    v_mfma_f32_16x16x32_bf16 a[56:59], a[248:251], v[60:63], a[56:59]
    buffer_load_dwordx4 v18, s[12:15], s49 offen offset:2048 nt lds
    v_cvt_pk_bf16_f32 v107, v54, v55
    v_mfma_f32_16x16x32_bf16 a[56:59], a[200:203], v[100:103], a[56:59]
    v_exp_f32 v32, v32
    v_mfma_f32_16x16x32_bf16 a[60:63], a[252:255], v[60:63], a[60:63]
    buffer_load_dwordx4 v19, s[12:15], s49 offen offset:3072 nt lds
    ds_read_b128 a[164:167], v5 offset:32768
    v_mfma_f32_16x16x32_bf16 a[60:63], a[204:207], v[100:103], a[60:63]
    v_exp_f32 v33, v33
    v_smfmac_f32_16x16x64_bf16 a[224:227], a[244:247], v[96:103], v74
    v_cvt_pk_bf16_f32 v108, v32, v33
    v_mfma_f32_16x16x32_bf16 a[80:83], a[236:239], v[64:67], a[80:83]
    s_mov_b32 m0, 24576
    s_add_u32 s49, s30, s53
    buffer_load_dwordx4 v20, s[16:19], s49 offen offset:0 nt lds
    v_mfma_f32_16x16x32_bf16 a[80:83], a[192:195], v[104:107], a[80:83]
    buffer_load_dwordx4 v21, s[16:19], s49 offen offset:1024 nt lds
    ds_read_b128 a[168:171], v6 offset:32768
    v_mfma_f32_16x16x32_bf16 a[84:87], a[240:243], v[64:67], a[84:87]
    v_exp_f32 v34, v34
    v_mfma_f32_16x16x32_bf16 a[84:87], a[196:199], v[104:107], a[84:87]
    buffer_load_dwordx4 v22, s[16:19], s49 offen offset:2048 nt lds
    ds_read_b128 a[172:175], v7 offset:32768
    v_mfma_f32_16x16x32_bf16 a[88:91], a[248:251], v[64:67], a[88:91]
    v_exp_f32 v35, v35
    v_mfma_f32_16x16x32_bf16 a[88:91], a[200:203], v[104:107], a[88:91]
    v_exp_f32 v36, v36
    v_exp_f32 v37, v37
    v_exp_f32 v38, v38
    v_exp_f32 v39, v39
    v_mfma_f32_16x16x32_bf16 a[92:95], a[252:255], v[64:67], a[92:95]
    buffer_load_dwordx4 v23, s[16:19], s49 offen offset:3072 nt lds
    v_cvt_pk_bf16_f32 v109, v34, v35
    v_cvt_pk_bf16_f32 v110, v36, v37
    v_cvt_pk_bf16_f32 v111, v38, v39
    v_mfma_f32_16x16x32_bf16 a[92:95], a[204:207], v[104:107], a[92:95]
    ds_read_b128 a[176:179], v4 offset:36864
    ds_read_b128 a[180:183], v5 offset:36864
    v_mfma_f32_16x16x32_bf16 a[112:115], a[236:239], v[68:71], a[112:115]
    ds_read_b128 a[184:187], v6 offset:36864
    ds_read_b128 a[188:191], v7 offset:36864
    s_mov_b32 m0, 28672
    s_add_u32 s49, s30, s54
    buffer_load_dwordx4 v20, s[16:19], s49 offen offset:0 nt lds
    v_mfma_f32_16x16x32_bf16 a[112:115], a[192:195], v[108:111], a[112:115]
    ds_read_b64_tr_b16 a[192:193], v8 offset:40960
    buffer_load_dwordx4 v21, s[16:19], s49 offen offset:1024 nt lds
    v_mfma_f32_16x16x32_bf16 a[116:119], a[240:243], v[68:71], a[116:119]
    ds_read_b64_tr_b16 a[194:195], v8 offset:45056
    v_mfma_f32_16x16x32_bf16 a[116:119], a[196:199], v[108:111], a[116:119]
    ds_read_b64_tr_b16 a[196:197], v9 offset:40960
    buffer_load_dwordx4 v22, s[16:19], s49 offen offset:2048 nt lds
    v_mfma_f32_16x16x32_bf16 a[120:123], a[248:251], v[68:71], a[120:123]
    ds_read_b64_tr_b16 a[198:199], v9 offset:45056
    v_mfma_f32_16x16x32_bf16 a[120:123], a[200:203], v[108:111], a[120:123]
    ds_read_b64_tr_b16 a[200:201], v10 offset:40960
    buffer_load_dwordx4 v23, s[16:19], s49 offen offset:3072 nt lds
    v_mfma_f32_16x16x32_bf16 a[124:127], a[252:255], v[68:71], a[124:127]
    ds_read_b64_tr_b16 a[202:203], v10 offset:45056
    v_mfma_f32_16x16x32_bf16 a[124:127], a[204:207], v[108:111], a[124:127]
    ds_read_b64_tr_b16 a[204:205], v11 offset:40960
    v_smfmac_f32_16x16x64_bf16 a[228:231], a[244:247], v[104:111], v74
    ds_read_b64_tr_b16 a[206:207], v11 offset:45056
    s_add_u32 s49, s0, s1
    s_and_b32 s49, s49, s45
    s_and_b32 s30, s0, s44
    s_or_b32 s30, s30, s49
    s_waitcnt lgkmcnt(8)
    v_mfma_f32_16x16x32_bf16 v[32:35], a[160:163], v[176:179], v[76:79]
    ds_read_b64_tr_b16 a[236:237], v12 offset:40960
    v_mfma_f32_16x16x32_bf16 v[32:35], a[164:167], v[180:183], v[32:35]
    ds_read_b64_tr_b16 a[238:239], v12 offset:45056
    v_mfma_f32_16x16x32_bf16 v[32:35], a[168:171], v[184:187], v[32:35]
    ds_read_b64_tr_b16 a[240:241], v13 offset:40960
    v_mfma_f32_16x16x32_bf16 v[32:35], a[172:175], v[188:191], v[32:35]
    ds_read_b64_tr_b16 a[242:243], v13 offset:45056
    v_mfma_f32_16x16x32_bf16 v[36:39], a[176:179], v[176:179], v[76:79]
    ds_read_b64_tr_b16 a[248:249], v14 offset:40960
    v_mfma_f32_16x16x32_bf16 v[36:39], a[180:183], v[180:183], v[36:39]
    ds_read_b64_tr_b16 a[250:251], v14 offset:45056
    v_mfma_f32_16x16x32_bf16 v[36:39], a[184:187], v[184:187], v[36:39]
    ds_read_b64_tr_b16 a[252:253], v15 offset:40960
    v_mfma_f32_16x16x32_bf16 v[36:39], a[188:191], v[188:191], v[36:39]
    ds_read_b64_tr_b16 a[254:255], v15 offset:45056
    v_mfma_f32_16x16x32_bf16 v[40:43], a[160:163], v[192:195], v[80:83]
    v_exp_f32 v32, v32
    v_mfma_f32_16x16x32_bf16 v[40:43], a[164:167], v[196:199], v[40:43]
    v_exp_f32 v33, v33
    v_mfma_f32_16x16x32_bf16 v[40:43], a[168:171], v[200:203], v[40:43]
    v_exp_f32 v34, v34
    v_mfma_f32_16x16x32_bf16 v[40:43], a[172:175], v[204:207], v[40:43]
    v_exp_f32 v35, v35
    v_mfma_f32_16x16x32_bf16 v[44:47], a[176:179], v[192:195], v[80:83]
    v_cvt_pk_bf16_f32 v56, v32, v33
    v_cvt_pk_bf16_f32 v57, v34, v35
    v_mfma_f32_16x16x32_bf16 v[44:47], a[180:183], v[196:199], v[44:47]
    v_exp_f32 v36, v36
    v_mfma_f32_16x16x32_bf16 v[44:47], a[184:187], v[200:203], v[44:47]
    buffer_store_dwordx4 v[168:171], v24, s[20:23], s68 offen offset:2048 sc1
    v_mfma_f32_16x16x32_bf16 v[44:47], a[188:191], v[204:207], v[44:47]
    v_exp_f32 v37, v37
    v_mfma_f32_16x16x32_bf16 v[48:51], a[160:163], v[208:211], v[84:87]
    v_exp_f32 v38, v38
    v_mfma_f32_16x16x32_bf16 v[48:51], a[164:167], v[212:215], v[48:51]
    v_exp_f32 v39, v39
    v_mfma_f32_16x16x32_bf16 v[48:51], a[168:171], v[216:219], v[48:51]
    v_cvt_pk_bf16_f32 v58, v36, v37
    v_cvt_pk_bf16_f32 v59, v38, v39
    v_mfma_f32_16x16x32_bf16 v[48:51], a[172:175], v[220:223], v[48:51]
    v_exp_f32 v40, v40
    v_mfma_f32_16x16x32_bf16 v[52:55], a[176:179], v[208:211], v[84:87]
    v_exp_f32 v41, v41
    v_mfma_f32_16x16x32_bf16 v[52:55], a[180:183], v[212:215], v[52:55]
    v_exp_f32 v42, v42
    v_mfma_f32_16x16x32_bf16 v[52:55], a[184:187], v[216:219], v[52:55]
    v_exp_f32 v43, v43
    v_mfma_f32_16x16x32_bf16 v[52:55], a[188:191], v[220:223], v[52:55]
    v_exp_f32 v44, v44
    v_mfma_f32_16x16x32_bf16 v[32:35], a[160:163], v[224:227], v[88:91]
    v_exp_f32 v45, v45
    v_mfma_f32_16x16x32_bf16 v[32:35], a[164:167], v[228:231], v[32:35]
    v_exp_f32 v46, v46
    v_mfma_f32_16x16x32_bf16 v[32:35], a[168:171], v[232:235], v[32:35]
    v_exp_f32 v47, v47
    v_mfma_f32_16x16x32_bf16 v[32:35], a[172:175], v[236:239], v[32:35]
    v_cvt_pk_bf16_f32 v60, v40, v41
    v_cvt_pk_bf16_f32 v61, v42, v43
    v_mfma_f32_16x16x32_bf16 v[36:39], a[176:179], v[224:227], v[88:91]
    v_cvt_pk_bf16_f32 v62, v44, v45
    v_cvt_pk_bf16_f32 v63, v46, v47
    v_mfma_f32_16x16x32_bf16 v[36:39], a[180:183], v[228:231], v[36:39]
    v_exp_f32 v48, v48
    v_mfma_f32_16x16x32_bf16 v[36:39], a[184:187], v[232:235], v[36:39]
    v_exp_f32 v49, v49
    v_mfma_f32_16x16x32_bf16 v[36:39], a[188:191], v[236:239], v[36:39]
    s_waitcnt vmcnt(32) lgkmcnt(0)
    s_barrier
    v_mfma_f32_16x16x32_bf16 a[0:3], a[208:211], v[96:99], a[0:3]
    s_mov_b32 m0, 32768
    s_add_u32 s0, s0, 0x2000
    buffer_load_dwordx4 v16, s[12:15], s30 offen offset:0 nt lds
    v_mfma_f32_16x16x32_bf16 a[0:3], a[192:195], v[56:59], a[0:3]
    v_exp_f32 v50, v50
    v_mfma_f32_16x16x32_bf16 a[4:7], a[212:215], v[96:99], a[4:7]
    buffer_load_dwordx4 v17, s[12:15], s30 offen offset:1024 nt lds
    v_cvt_pk_bf16_f32 v64, v48, v49
    v_mfma_f32_16x16x32_bf16 a[4:7], a[196:199], v[56:59], a[4:7]
    v_exp_f32 v51, v51
    v_mfma_f32_16x16x32_bf16 a[8:11], a[216:219], v[96:99], a[8:11]
    buffer_load_dwordx4 v18, s[12:15], s30 offen offset:2048 nt lds
    v_cvt_pk_bf16_f32 v65, v50, v51
    v_mfma_f32_16x16x32_bf16 a[8:11], a[200:203], v[56:59], a[8:11]
    v_exp_f32 v52, v52
    v_mfma_f32_16x16x32_bf16 a[12:15], a[220:223], v[96:99], a[12:15]
    buffer_load_dwordx4 v19, s[12:15], s30 offen offset:3072 nt lds
    ds_read_b128 a[160:163], v4 offset:49152
    v_mfma_f32_16x16x32_bf16 a[12:15], a[204:207], v[56:59], a[12:15]
    v_exp_f32 v53, v53
    v_mfma_f32_16x16x32_bf16 a[32:35], a[208:211], v[100:103], a[32:35]
    s_mov_b32 m0, 36864
    s_add_u32 s49, s30, s52
    buffer_load_dwordx4 v16, s[12:15], s49 offen offset:0 nt lds
    v_mfma_f32_16x16x32_bf16 a[32:35], a[192:195], v[60:63], a[32:35]
    v_exp_f32 v54, v54
    v_mfma_f32_16x16x32_bf16 a[36:39], a[212:215], v[100:103], a[36:39]
    buffer_load_dwordx4 v17, s[12:15], s49 offen offset:1024 nt lds
    v_cvt_pk_bf16_f32 v66, v52, v53
    v_mfma_f32_16x16x32_bf16 a[36:39], a[196:199], v[60:63], a[36:39]
    v_exp_f32 v55, v55
    v_mfma_f32_16x16x32_bf16 a[40:43], a[216:219], v[100:103], a[40:43]
    buffer_load_dwordx4 v18, s[12:15], s49 offen offset:2048 nt lds
    v_cvt_pk_bf16_f32 v67, v54, v55
    v_mfma_f32_16x16x32_bf16 a[40:43], a[200:203], v[60:63], a[40:43]
    v_exp_f32 v32, v32
    v_mfma_f32_16x16x32_bf16 a[44:47], a[220:223], v[100:103], a[44:47]
    buffer_load_dwordx4 v19, s[12:15], s49 offen offset:3072 nt lds
    ds_read_b128 a[164:167], v5 offset:49152
    v_mfma_f32_16x16x32_bf16 a[44:47], a[204:207], v[60:63], a[44:47]
    v_exp_f32 v33, v33
    v_smfmac_f32_16x16x64_bf16 a[224:227], a[244:247], v[56:63], v74
    v_cvt_pk_bf16_f32 v68, v32, v33
    v_mfma_f32_16x16x32_bf16 a[64:67], a[208:211], v[104:107], a[64:67]
    s_mov_b32 m0, 40960
    s_add_u32 s49, s30, s53
    buffer_load_dwordx4 v20, s[16:19], s49 offen offset:0 nt lds
    v_mfma_f32_16x16x32_bf16 a[64:67], a[192:195], v[64:67], a[64:67]
    buffer_load_dwordx4 v21, s[16:19], s49 offen offset:1024 nt lds
    ds_read_b128 a[168:171], v6 offset:49152
    v_mfma_f32_16x16x32_bf16 a[68:71], a[212:215], v[104:107], a[68:71]
    v_exp_f32 v34, v34
    v_mfma_f32_16x16x32_bf16 a[68:71], a[196:199], v[64:67], a[68:71]
    buffer_load_dwordx4 v22, s[16:19], s49 offen offset:2048 nt lds
    ds_read_b128 a[172:175], v7 offset:49152
    v_mfma_f32_16x16x32_bf16 a[72:75], a[216:219], v[104:107], a[72:75]
    v_exp_f32 v35, v35
    v_mfma_f32_16x16x32_bf16 a[72:75], a[200:203], v[64:67], a[72:75]
    v_exp_f32 v36, v36
    v_exp_f32 v37, v37
    v_exp_f32 v38, v38
    v_exp_f32 v39, v39
    v_mfma_f32_16x16x32_bf16 a[76:79], a[220:223], v[104:107], a[76:79]
    buffer_load_dwordx4 v23, s[16:19], s49 offen offset:3072 nt lds
    v_cvt_pk_bf16_f32 v69, v34, v35
    v_cvt_pk_bf16_f32 v70, v36, v37
    v_cvt_pk_bf16_f32 v71, v38, v39
    v_mfma_f32_16x16x32_bf16 a[76:79], a[204:207], v[64:67], a[76:79]
    ds_read_b128 a[176:179], v4 offset:53248
    ds_read_b128 a[180:183], v5 offset:53248
    v_mfma_f32_16x16x32_bf16 a[96:99], a[208:211], v[108:111], a[96:99]
    ds_read_b128 a[184:187], v6 offset:53248
    ds_read_b128 a[188:191], v7 offset:53248
    s_mov_b32 m0, 45056
    s_add_u32 s49, s30, s54
    buffer_load_dwordx4 v20, s[16:19], s49 offen offset:0 nt lds
    ds_read_b128 v[160:163], v25 offset:0
    ds_read_b128 v[164:167], v25 offset:1024
    v_mfma_f32_16x16x32_bf16 a[96:99], a[192:195], v[68:71], a[96:99]
    ds_read_b64_tr_b16 a[192:193], v12 offset:57344
    buffer_load_dwordx4 v21, s[16:19], s49 offen offset:1024 nt lds
    v_mfma_f32_16x16x32_bf16 a[100:103], a[212:215], v[108:111], a[100:103]
    ds_read_b64_tr_b16 a[194:195], v12 offset:61440
    v_mfma_f32_16x16x32_bf16 a[100:103], a[196:199], v[68:71], a[100:103]
    ds_read_b64_tr_b16 a[196:197], v13 offset:57344
    buffer_load_dwordx4 v22, s[16:19], s49 offen offset:2048 nt lds
    v_mfma_f32_16x16x32_bf16 a[104:107], a[216:219], v[108:111], a[104:107]
    ds_read_b64_tr_b16 a[198:199], v13 offset:61440
    v_mfma_f32_16x16x32_bf16 a[104:107], a[200:203], v[68:71], a[104:107]
    ds_read_b64_tr_b16 a[200:201], v14 offset:57344
    buffer_load_dwordx4 v23, s[16:19], s49 offen offset:3072 nt lds
    v_mfma_f32_16x16x32_bf16 a[108:111], a[220:223], v[108:111], a[108:111]
    ds_read_b64_tr_b16 a[202:203], v14 offset:61440
    v_mfma_f32_16x16x32_bf16 a[108:111], a[204:207], v[68:71], a[108:111]
    ds_read_b64_tr_b16 a[204:205], v15 offset:57344
    v_smfmac_f32_16x16x64_bf16 a[228:231], a[244:247], v[64:71], v74
    ds_read_b64_tr_b16 a[206:207], v15 offset:61440
    s_add_u32 s49, s0, s1
    s_and_b32 s49, s49, s45
    s_and_b32 s30, s0, s44
    s_or_b32 s30, s30, s49
    s_waitcnt lgkmcnt(8)
    v_mfma_f32_16x16x32_bf16 v[32:35], a[160:163], v[176:179], v[76:79]
    ds_read_b64_tr_b16 a[208:209], v8 offset:57344
    v_mfma_f32_16x16x32_bf16 v[32:35], a[164:167], v[180:183], v[32:35]
    ds_read_b64_tr_b16 a[210:211], v8 offset:61440
    v_mfma_f32_16x16x32_bf16 v[32:35], a[168:171], v[184:187], v[32:35]
    ds_read_b64_tr_b16 a[212:213], v9 offset:57344
    v_mfma_f32_16x16x32_bf16 v[32:35], a[172:175], v[188:191], v[32:35]
    ds_read_b64_tr_b16 a[214:215], v9 offset:61440
    v_mfma_f32_16x16x32_bf16 v[36:39], a[176:179], v[176:179], v[76:79]
    ds_read_b64_tr_b16 a[216:217], v10 offset:57344
    v_mfma_f32_16x16x32_bf16 v[36:39], a[180:183], v[180:183], v[36:39]
    ds_read_b64_tr_b16 a[218:219], v10 offset:61440
    v_mfma_f32_16x16x32_bf16 v[36:39], a[184:187], v[184:187], v[36:39]
    ds_read_b64_tr_b16 a[220:221], v11 offset:57344
    v_mfma_f32_16x16x32_bf16 v[36:39], a[188:191], v[188:191], v[36:39]
    ds_read_b64_tr_b16 a[222:223], v11 offset:61440
    v_mfma_f32_16x16x32_bf16 v[40:43], a[160:163], v[192:195], v[80:83]
    v_exp_f32 v32, v32
    v_mfma_f32_16x16x32_bf16 v[40:43], a[164:167], v[196:199], v[40:43]
    v_exp_f32 v33, v33
    v_mfma_f32_16x16x32_bf16 v[40:43], a[168:171], v[200:203], v[40:43]
    v_exp_f32 v34, v34
    v_mfma_f32_16x16x32_bf16 v[40:43], a[172:175], v[204:207], v[40:43]
    v_exp_f32 v35, v35
    v_mfma_f32_16x16x32_bf16 v[44:47], a[176:179], v[192:195], v[80:83]
    v_cvt_pk_bf16_f32 v96, v32, v33
    v_cvt_pk_bf16_f32 v97, v34, v35
    v_mfma_f32_16x16x32_bf16 v[44:47], a[180:183], v[196:199], v[44:47]
    v_exp_f32 v36, v36
    v_mfma_f32_16x16x32_bf16 v[44:47], a[184:187], v[200:203], v[44:47]
    buffer_store_dwordx4 v[172:175], v24, s[20:23], s68 offen offset:3072 sc1
    s_sub_u32 s68, s68, 131328
    v_mfma_f32_16x16x32_bf16 v[44:47], a[188:191], v[204:207], v[44:47]
    v_exp_f32 v37, v37
    v_mfma_f32_16x16x32_bf16 v[48:51], a[160:163], v[208:211], v[84:87]
    v_exp_f32 v38, v38
    v_mfma_f32_16x16x32_bf16 v[48:51], a[164:167], v[212:215], v[48:51]
    v_exp_f32 v39, v39
    v_mfma_f32_16x16x32_bf16 v[48:51], a[168:171], v[216:219], v[48:51]
    v_cvt_pk_bf16_f32 v98, v36, v37
    v_cvt_pk_bf16_f32 v99, v38, v39
    v_mfma_f32_16x16x32_bf16 v[48:51], a[172:175], v[220:223], v[48:51]
    v_exp_f32 v40, v40
    v_mfma_f32_16x16x32_bf16 v[52:55], a[176:179], v[208:211], v[84:87]
    v_exp_f32 v41, v41
    v_mfma_f32_16x16x32_bf16 v[52:55], a[180:183], v[212:215], v[52:55]
    v_exp_f32 v42, v42
    v_mfma_f32_16x16x32_bf16 v[52:55], a[184:187], v[216:219], v[52:55]
    v_exp_f32 v43, v43
    v_mfma_f32_16x16x32_bf16 v[52:55], a[188:191], v[220:223], v[52:55]
    v_exp_f32 v44, v44
    v_mfma_f32_16x16x32_bf16 v[32:35], a[160:163], v[224:227], v[88:91]
    v_exp_f32 v45, v45
    v_mfma_f32_16x16x32_bf16 v[32:35], a[164:167], v[228:231], v[32:35]
    v_exp_f32 v46, v46
    v_mfma_f32_16x16x32_bf16 v[32:35], a[168:171], v[232:235], v[32:35]
    v_exp_f32 v47, v47
    v_mfma_f32_16x16x32_bf16 v[32:35], a[172:175], v[236:239], v[32:35]
    v_cvt_pk_bf16_f32 v100, v40, v41
    v_cvt_pk_bf16_f32 v101, v42, v43
    v_mfma_f32_16x16x32_bf16 v[36:39], a[176:179], v[224:227], v[88:91]
    v_cvt_pk_bf16_f32 v102, v44, v45
    v_cvt_pk_bf16_f32 v103, v46, v47
    v_mfma_f32_16x16x32_bf16 v[36:39], a[180:183], v[228:231], v[36:39]
    v_exp_f32 v48, v48
    v_mfma_f32_16x16x32_bf16 v[36:39], a[184:187], v[232:235], v[36:39]
    v_exp_f32 v49, v49
    v_mfma_f32_16x16x32_bf16 v[36:39], a[188:191], v[236:239], v[36:39]
    s_waitcnt vmcnt(32) lgkmcnt(0)
    s_barrier
    v_mfma_f32_16x16x32_bf16 a[16:19], a[236:239], v[56:59], a[16:19]
    s_mov_b32 m0, 49152
    s_add_u32 s0, s0, 0x2000
    buffer_load_dwordx4 v16, s[12:15], s30 offen offset:0 nt lds
    v_mfma_f32_16x16x32_bf16 a[16:19], a[192:195], v[96:99], a[16:19]
    v_exp_f32 v50, v50
    v_mfma_f32_16x16x32_bf16 a[20:23], a[240:243], v[56:59], a[20:23]
    buffer_load_dwordx4 v17, s[12:15], s30 offen offset:1024 nt lds
    v_cvt_pk_bf16_f32 v104, v48, v49
    v_mfma_f32_16x16x32_bf16 a[20:23], a[196:199], v[96:99], a[20:23]
    v_exp_f32 v51, v51
    v_mfma_f32_16x16x32_bf16 a[24:27], a[248:251], v[56:59], a[24:27]
    buffer_load_dwordx4 v18, s[12:15], s30 offen offset:2048 nt lds
    v_cvt_pk_bf16_f32 v105, v50, v51
    v_mfma_f32_16x16x32_bf16 a[24:27], a[200:203], v[96:99], a[24:27]
    v_exp_f32 v52, v52
    v_mfma_f32_16x16x32_bf16 a[28:31], a[252:255], v[56:59], a[28:31]
    buffer_load_dwordx4 v19, s[12:15], s30 offen offset:3072 nt lds
    ds_read_b128 a[160:163], v4 offset:0
    v_mfma_f32_16x16x32_bf16 a[28:31], a[204:207], v[96:99], a[28:31]
    v_exp_f32 v53, v53
    v_mfma_f32_16x16x32_bf16 a[48:51], a[236:239], v[60:63], a[48:51]
    s_mov_b32 m0, 53248
    s_add_u32 s49, s30, s52
    buffer_load_dwordx4 v16, s[12:15], s49 offen offset:0 nt lds
    v_mfma_f32_16x16x32_bf16 a[48:51], a[192:195], v[100:103], a[48:51]
    v_exp_f32 v54, v54
    v_mfma_f32_16x16x32_bf16 a[52:55], a[240:243], v[60:63], a[52:55]
    buffer_load_dwordx4 v17, s[12:15], s49 offen offset:1024 nt lds
    v_cvt_pk_bf16_f32 v106, v52, v53
    v_mfma_f32_16x16x32_bf16 a[52:55], a[196:199], v[100:103], a[52:55]
    v_exp_f32 v55, v55
    v_mfma_f32_16x16x32_bf16 a[56:59], a[248:251], v[60:63], a[56:59]
    buffer_load_dwordx4 v18, s[12:15], s49 offen offset:2048 nt lds
    v_cvt_pk_bf16_f32 v107, v54, v55
    v_mfma_f32_16x16x32_bf16 a[56:59], a[200:203], v[100:103], a[56:59]
    v_exp_f32 v32, v32
    v_mfma_f32_16x16x32_bf16 a[60:63], a[252:255], v[60:63], a[60:63]
    buffer_load_dwordx4 v19, s[12:15], s49 offen offset:3072 nt lds
    ds_read_b128 a[164:167], v5 offset:0
    v_mfma_f32_16x16x32_bf16 a[60:63], a[204:207], v[100:103], a[60:63]
    v_exp_f32 v33, v33
    v_smfmac_f32_16x16x64_bf16 a[224:227], a[244:247], v[96:103], v74
    v_cvt_pk_bf16_f32 v108, v32, v33
    v_mfma_f32_16x16x32_bf16 a[80:83], a[236:239], v[64:67], a[80:83]
    s_mov_b32 m0, 57344
    s_add_u32 s49, s30, s53
    buffer_load_dwordx4 v20, s[16:19], s49 offen offset:0 nt lds
    v_mfma_f32_16x16x32_bf16 a[80:83], a[192:195], v[104:107], a[80:83]
    buffer_load_dwordx4 v21, s[16:19], s49 offen offset:1024 nt lds
    ds_read_b128 a[168:171], v6 offset:0
    v_mfma_f32_16x16x32_bf16 a[84:87], a[240:243], v[64:67], a[84:87]
    v_exp_f32 v34, v34
    v_mfma_f32_16x16x32_bf16 a[84:87], a[196:199], v[104:107], a[84:87]
    buffer_load_dwordx4 v22, s[16:19], s49 offen offset:2048 nt lds
    ds_read_b128 a[172:175], v7 offset:0
    v_mfma_f32_16x16x32_bf16 a[88:91], a[248:251], v[64:67], a[88:91]
    v_exp_f32 v35, v35
    v_mfma_f32_16x16x32_bf16 a[88:91], a[200:203], v[104:107], a[88:91]
    v_exp_f32 v36, v36
    v_exp_f32 v37, v37
    v_exp_f32 v38, v38
    v_exp_f32 v39, v39
    v_mfma_f32_16x16x32_bf16 a[92:95], a[252:255], v[64:67], a[92:95]
    buffer_load_dwordx4 v23, s[16:19], s49 offen offset:3072 nt lds
    v_cvt_pk_bf16_f32 v109, v34, v35
    v_cvt_pk_bf16_f32 v110, v36, v37
    v_cvt_pk_bf16_f32 v111, v38, v39
    v_mfma_f32_16x16x32_bf16 a[92:95], a[204:207], v[104:107], a[92:95]
    ds_read_b128 a[176:179], v4 offset:4096
    ds_read_b128 a[180:183], v5 offset:4096
    v_mfma_f32_16x16x32_bf16 a[112:115], a[236:239], v[68:71], a[112:115]
    ds_read_b128 a[184:187], v6 offset:4096
    ds_read_b128 a[188:191], v7 offset:4096
    s_mov_b32 m0, 61440
    s_add_u32 s49, s30, s54
    buffer_load_dwordx4 v20, s[16:19], s49 offen offset:0 nt lds
    ds_read_b128 v[168:171], v25 offset:2048
    ds_read_b128 v[172:175], v25 offset:3072
    v_mfma_f32_16x16x32_bf16 a[112:115], a[192:195], v[108:111], a[112:115]
    ds_read_b64_tr_b16 a[192:193], v8 offset:8192
    buffer_load_dwordx4 v21, s[16:19], s49 offen offset:1024 nt lds
    v_mfma_f32_16x16x32_bf16 a[116:119], a[240:243], v[68:71], a[116:119]
    ds_read_b64_tr_b16 a[194:195], v8 offset:12288
    v_subrev_u32 v25, 4096, v25
    v_mfma_f32_16x16x32_bf16 a[116:119], a[196:199], v[108:111], a[116:119]
    ds_read_b64_tr_b16 a[196:197], v9 offset:8192
    buffer_load_dwordx4 v22, s[16:19], s49 offen offset:2048 nt lds
    v_mfma_f32_16x16x32_bf16 a[120:123], a[248:251], v[68:71], a[120:123]
    ds_read_b64_tr_b16 a[198:199], v9 offset:12288
    v_mfma_f32_16x16x32_bf16 a[120:123], a[200:203], v[108:111], a[120:123]
    ds_read_b64_tr_b16 a[200:201], v10 offset:8192
    buffer_load_dwordx4 v23, s[16:19], s49 offen offset:3072 nt lds
    v_mfma_f32_16x16x32_bf16 a[124:127], a[252:255], v[68:71], a[124:127]
    ds_read_b64_tr_b16 a[202:203], v10 offset:12288
    v_mfma_f32_16x16x32_bf16 a[124:127], a[204:207], v[108:111], a[124:127]
    ds_read_b64_tr_b16 a[204:205], v11 offset:8192
    v_smfmac_f32_16x16x64_bf16 a[228:231], a[244:247], v[104:111], v74
    ds_read_b64_tr_b16 a[206:207], v11 offset:12288
    s_add_u32 s49, s0, s1
    s_and_b32 s49, s49, s45
    s_and_b32 s30, s0, s44
    s_or_b32 s30, s30, s49
    s_sub_u32 s35, s35, 1
    s_bitcmp0_b32 s26, s35
    s_cbranch_scc1 L_loopS4
    s_branch L_loop4
L_ovf04:
    ds_write_b32 v1, v2
    s_branch L_nof04
L_ovf14:
    s_nop 0
    ds_write_b32 v1, v2
    s_branch L_nof14
L_ev4:
    s_cmp_eq_u32 s36, 1
    s_cbranch_scc1 L_ev1
    s_cmp_eq_u32 s27, 3
    s_cbranch_scc1 L_evp0
    s_cmp_eq_u32 s27, 2
    s_cbranch_scc1 L_evw0
    s_lshl_b32 s48, s62, 3
    s_add_u32 s48, s48, s63
    s_lshl_b32 s48, s48, 2
    v_mov_b32 v1, s48
    v_mov_b32 v2, 1
    s_mov_b64 exec, 1
    s_nop 0
    global_atomic_add v1, v2, s[56:57] sc1
    s_mov_b64 exec, -1
    s_mov_b32 s27, 3
    s_branch L_evr4
L_evp0:
    s_getpc_b64 s[98:99]
L_pc0:
    s_sub_u32 s98, s98, L_pc0-concat_heads__mha_block_cached__gqa_block_cached__near_ridge_kernel
    s_subb_u32 s99, s99, 0
    s_nop 0
    s_bfe_u32 s48, s2, 0x40003
    s_lshl_b32 s48, s48, 13
    s_nop 0
    v_lshl_add_u32 v3, v24, 3, s48
    v_min_u32 v3, CODE_SIZE, v3
    global_load_dword v93, v3, s[98:99]
    s_lshl_b32 s48, s62, 5
    s_add_u32 s48, s48, 0
    v_and_b32_e64 v29, 7, v0
    v_lshl_add_u32 v29, v29, 2, s48
    global_load_dword v31, v29, s[56:57] sc0 sc1
    s_mov_b32 s27, 2
    s_branch L_evr4
L_evw0:
    s_mov_b32 s27, -1
    s_nop 0
    s_mov_b32 s49, 0x20000
    s_waitcnt vmcnt(48)
L_pw0:
    v_cmp_gt_u32 vcc, 16, v31
    s_sub_u32 s49, s49, 1
    s_cmp_eq_u32 s49, 0
    s_cbranch_scc1 L_evr4
    s_nop 2
    s_cbranch_vccz L_evr4
    s_nop 0
    global_load_dword v31, v29, s[56:57] sc0 sc1
    s_sleep 4
    s_waitcnt vmcnt(0)
    s_branch L_pw0
L_ev1:
    s_cmp_eq_u32 s27, 3
    s_cbranch_scc1 L_evp1
    s_cmp_eq_u32 s27, 2
    s_cbranch_scc1 L_evw1
    s_lshl_b32 s48, s62, 3
    s_add_u32 s48, s48, s63
    s_lshl_b32 s48, s48, 7
    s_lshl_b32 s49, s64, 1
    s_add_u32 s48, s48, s49
    s_add_u32 s48, s48, 53820160
    v_lshl_add_u32 v1, v24, 2, s48
    v_mov_b32 v2, 16
    s_mov_b64 exec, 1
    global_store_dword v1, v2, s[60:61] sc0 sc1
    s_mov_b64 exec, -1
    s_mov_b32 s27, 3
    s_branch L_evr4
L_evp1:
    s_getpc_b64 s[98:99]
L_pc1:
    s_sub_u32 s98, s98, L_pc1-concat_heads__mha_block_cached__gqa_block_cached__near_ridge_kernel
    s_subb_u32 s99, s99, 0
    s_nop 0
    s_bfe_u32 s48, s2, 0x40003
    s_lshl_b32 s48, s48, 13
    s_nop 0
    v_lshl_add_u32 v3, v24, 3, s48
    v_min_u32 v3, CODE_SIZE, v3
    global_load_dword v93, v3, s[98:99]
    s_lshl_b32 s48, s62, 3
    s_add_u32 s48, s48, s65
    s_lshl_b32 s48, s48, 7
    s_nop 0
    s_add_u32 s48, s48, 53820160
    s_and_b32 s49, s66, 1
    s_lshl_b32 s49, s49, 5
    s_add_u32 s48, s48, s49
    v_and_b32 v29, 7, v0
    v_lshl_add_u32 v29, v29, 2, s48
    global_load_dword v31, v29, s[60:61] sc0 sc1
    s_mov_b32 s27, 2
    s_branch L_evr4
L_evw1:
    s_mov_b32 s27, -1
    s_nop 0
    s_mov_b32 s49, 0x20000
    s_waitcnt vmcnt(48)
L_pw1:
    v_cmp_gt_u32 vcc, 16, v31
    s_sub_u32 s49, s49, 1
    s_cmp_eq_u32 s49, 0
    s_cbranch_scc1 L_evr4
    s_nop 2
    s_cbranch_vccz L_evr4
    s_nop 0
    global_load_dword v31, v29, s[60:61] sc0 sc1
    s_sleep 4
    s_waitcnt vmcnt(0)
    s_branch L_pw1
L_redo4:
    s_mov_b32 s37, 1
    s_waitcnt vmcnt(0) lgkmcnt(0)
    s_barrier
    s_mov_b32 s12, s24
    s_mov_b32 s13, s25
    s_mov_b32 s14, 0x80000
    s_mov_b32 s16, s28
    s_mov_b32 s17, s29
    s_mov_b32 s18, 0x80000
    s_mov_b32 s0, 0
    s_mov_b32 s30, s1
    s_mov_b32 s44, 0xfffc0000
    s_mov_b32 s45, 0x3e000
    s_movk_i32 s31, 0x2000
    s_movk_i32 s32, 0x2000
    s_movk_i32 s52, 0x1000
    s_mov_b32 s53, 0
    s_movk_i32 s54, 0x1000
    s_lshl_b32 s0, s36, 18
    s_lshl_b32 s26, 0xfe, s36
    s_add_u32 s49, s0, s1
    s_and_b32 s49, s49, s45
    s_and_b32 s30, s0, s44
    s_or_b32 s30, s30, s49
    s_mov_b32 m0, 0
    s_nop 0
    s_add_u32 s0, s0, 0x2000
    buffer_load_dwordx4 v16, s[12:15], s30 offen offset:0 nt lds
    buffer_load_dwordx4 v17, s[12:15], s30 offen offset:1024 nt lds
    buffer_load_dwordx4 v18, s[12:15], s30 offen offset:2048 nt lds
    buffer_load_dwordx4 v19, s[12:15], s30 offen offset:3072 nt lds
    s_mov_b32 m0, 4096
    s_add_u32 s49, s30, s52
    s_nop 0
    buffer_load_dwordx4 v16, s[12:15], s49 offen offset:0 nt lds
    buffer_load_dwordx4 v17, s[12:15], s49 offen offset:1024 nt lds
    buffer_load_dwordx4 v18, s[12:15], s49 offen offset:2048 nt lds
    buffer_load_dwordx4 v19, s[12:15], s49 offen offset:3072 nt lds
    s_mov_b32 m0, 8192
    s_add_u32 s49, s30, s53
    s_nop 0
    buffer_load_dwordx4 v20, s[16:19], s49 offen offset:0 nt lds
    buffer_load_dwordx4 v21, s[16:19], s49 offen offset:1024 nt lds
    buffer_load_dwordx4 v22, s[16:19], s49 offen offset:2048 nt lds
    buffer_load_dwordx4 v23, s[16:19], s49 offen offset:3072 nt lds
    s_mov_b32 m0, 12288
    s_add_u32 s49, s30, s54
    s_nop 0
    buffer_load_dwordx4 v20, s[16:19], s49 offen offset:0 nt lds
    buffer_load_dwordx4 v21, s[16:19], s49 offen offset:1024 nt lds
    buffer_load_dwordx4 v22, s[16:19], s49 offen offset:2048 nt lds
    buffer_load_dwordx4 v23, s[16:19], s49 offen offset:3072 nt lds
    s_add_u32 s49, s0, s1
    s_and_b32 s49, s49, s45
    s_and_b32 s30, s0, s44
    s_or_b32 s30, s30, s49
    s_waitcnt vmcnt(16)
    s_nop 0
    s_mov_b32 m0, 16384
    s_add_u32 s0, s0, 0x2000
    buffer_load_dwordx4 v16, s[12:15], s30 offen offset:0 nt lds
    buffer_load_dwordx4 v17, s[12:15], s30 offen offset:1024 nt lds
    buffer_load_dwordx4 v18, s[12:15], s30 offen offset:2048 nt lds
    buffer_load_dwordx4 v19, s[12:15], s30 offen offset:3072 nt lds
    s_mov_b32 m0, 20480
    s_add_u32 s49, s30, s52
    s_nop 0
    buffer_load_dwordx4 v16, s[12:15], s49 offen offset:0 nt lds
    buffer_load_dwordx4 v17, s[12:15], s49 offen offset:1024 nt lds
    buffer_load_dwordx4 v18, s[12:15], s49 offen offset:2048 nt lds
    buffer_load_dwordx4 v19, s[12:15], s49 offen offset:3072 nt lds
    s_mov_b32 m0, 24576
    s_add_u32 s49, s30, s53
    s_nop 0
    buffer_load_dwordx4 v20, s[16:19], s49 offen offset:0 nt lds
    buffer_load_dwordx4 v21, s[16:19], s49 offen offset:1024 nt lds
    buffer_load_dwordx4 v22, s[16:19], s49 offen offset:2048 nt lds
    buffer_load_dwordx4 v23, s[16:19], s49 offen offset:3072 nt lds
    s_mov_b32 m0, 28672
    s_add_u32 s49, s30, s54
    s_nop 0
    buffer_load_dwordx4 v20, s[16:19], s49 offen offset:0 nt lds
    buffer_load_dwordx4 v21, s[16:19], s49 offen offset:1024 nt lds
    buffer_load_dwordx4 v22, s[16:19], s49 offen offset:2048 nt lds
    buffer_load_dwordx4 v23, s[16:19], s49 offen offset:3072 nt lds
    s_add_u32 s49, s0, s1
    s_and_b32 s49, s49, s45
    s_and_b32 s30, s0, s44
    s_or_b32 s30, s30, s49
    s_waitcnt vmcnt(16)
    s_nop 0
    s_mov_b32 m0, 32768
    s_add_u32 s0, s0, 0x2000
    buffer_load_dwordx4 v16, s[12:15], s30 offen offset:0 nt lds
    buffer_load_dwordx4 v17, s[12:15], s30 offen offset:1024 nt lds
    buffer_load_dwordx4 v18, s[12:15], s30 offen offset:2048 nt lds
    buffer_load_dwordx4 v19, s[12:15], s30 offen offset:3072 nt lds
    s_mov_b32 m0, 36864
    s_add_u32 s49, s30, s52
    s_nop 0
    buffer_load_dwordx4 v16, s[12:15], s49 offen offset:0 nt lds
    buffer_load_dwordx4 v17, s[12:15], s49 offen offset:1024 nt lds
    buffer_load_dwordx4 v18, s[12:15], s49 offen offset:2048 nt lds
    buffer_load_dwordx4 v19, s[12:15], s49 offen offset:3072 nt lds
    s_mov_b32 m0, 40960
    s_add_u32 s49, s30, s53
    s_nop 0
    buffer_load_dwordx4 v20, s[16:19], s49 offen offset:0 nt lds
    buffer_load_dwordx4 v21, s[16:19], s49 offen offset:1024 nt lds
    buffer_load_dwordx4 v22, s[16:19], s49 offen offset:2048 nt lds
    buffer_load_dwordx4 v23, s[16:19], s49 offen offset:3072 nt lds
    s_mov_b32 m0, 45056
    s_add_u32 s49, s30, s54
    s_nop 0
    buffer_load_dwordx4 v20, s[16:19], s49 offen offset:0 nt lds
    buffer_load_dwordx4 v21, s[16:19], s49 offen offset:1024 nt lds
    buffer_load_dwordx4 v22, s[16:19], s49 offen offset:2048 nt lds
    buffer_load_dwordx4 v23, s[16:19], s49 offen offset:3072 nt lds
    s_add_u32 s49, s0, s1
    s_and_b32 s49, s49, s45
    s_and_b32 s30, s0, s44
    s_or_b32 s30, s30, s49
    s_waitcnt vmcnt(16)
    s_nop 0
    s_mov_b32 m0, 49152
    s_add_u32 s0, s0, 0x2000
    buffer_load_dwordx4 v16, s[12:15], s30 offen offset:0 nt lds
    buffer_load_dwordx4 v17, s[12:15], s30 offen offset:1024 nt lds
    buffer_load_dwordx4 v18, s[12:15], s30 offen offset:2048 nt lds
    buffer_load_dwordx4 v19, s[12:15], s30 offen offset:3072 nt lds
    s_mov_b32 m0, 53248
    s_add_u32 s49, s30, s52
    s_nop 0
    buffer_load_dwordx4 v16, s[12:15], s49 offen offset:0 nt lds
    buffer_load_dwordx4 v17, s[12:15], s49 offen offset:1024 nt lds
    buffer_load_dwordx4 v18, s[12:15], s49 offen offset:2048 nt lds
    buffer_load_dwordx4 v19, s[12:15], s49 offen offset:3072 nt lds
    s_mov_b32 m0, 57344
    s_add_u32 s49, s30, s53
    s_nop 0
    buffer_load_dwordx4 v20, s[16:19], s49 offen offset:0 nt lds
    buffer_load_dwordx4 v21, s[16:19], s49 offen offset:1024 nt lds
    buffer_load_dwordx4 v22, s[16:19], s49 offen offset:2048 nt lds
    buffer_load_dwordx4 v23, s[16:19], s49 offen offset:3072 nt lds
    s_mov_b32 m0, 61440
    s_add_u32 s49, s30, s54
    s_nop 0
    buffer_load_dwordx4 v20, s[16:19], s49 offen offset:0 nt lds
    buffer_load_dwordx4 v21, s[16:19], s49 offen offset:1024 nt lds
    buffer_load_dwordx4 v22, s[16:19], s49 offen offset:2048 nt lds
    buffer_load_dwordx4 v23, s[16:19], s49 offen offset:3072 nt lds
    s_add_u32 s49, s0, s1
    s_and_b32 s49, s49, s45
    s_and_b32 s30, s0, s44
    s_or_b32 s30, s30, s49
    s_waitcnt vmcnt(16)
    v_and_b32 v1, 15, v0
    v_lshlrev_b32 v1, 8, v1
    v_and_b32 v2, 48, v0
    v_add_u32 v1, v1, v2
    s_lshl_b32 s48, s36, 18
    s_mov_b32 s35, 64
    s_nop 0
    v_mov_b32 v76, 0xff800000
    v_mov_b32 v77, 0xff800000
    v_mov_b32 v78, 0xff800000
    v_mov_b32 v79, 0xff800000
L_rl4:
    buffer_load_dwordx4 a[160:163], v1, s[12:15], s48 offen offset:0
    buffer_load_dwordx4 a[164:167], v1, s[12:15], s48 offen offset:64
    buffer_load_dwordx4 a[168:171], v1, s[12:15], s48 offen offset:128
    buffer_load_dwordx4 a[172:175], v1, s[12:15], s48 offen offset:192
    s_waitcnt vmcnt(0)
    s_nop 0
    v_mfma_f32_16x16x32_bf16 v[56:59], a[160:163], v[176:179], 0
    v_mfma_f32_16x16x32_bf16 v[56:59], a[164:167], v[180:183], v[56:59]
    v_mfma_f32_16x16x32_bf16 v[56:59], a[168:171], v[184:187], v[56:59]
    v_mfma_f32_16x16x32_bf16 v[56:59], a[172:175], v[188:191], v[56:59]
    v_mfma_f32_16x16x32_bf16 v[60:63], a[160:163], v[192:195], 0
    v_mfma_f32_16x16x32_bf16 v[60:63], a[164:167], v[196:199], v[60:63]
    v_mfma_f32_16x16x32_bf16 v[60:63], a[168:171], v[200:203], v[60:63]
    v_mfma_f32_16x16x32_bf16 v[60:63], a[172:175], v[204:207], v[60:63]
    v_mfma_f32_16x16x32_bf16 v[64:67], a[160:163], v[208:211], 0
    v_mfma_f32_16x16x32_bf16 v[64:67], a[164:167], v[212:215], v[64:67]
    v_mfma_f32_16x16x32_bf16 v[64:67], a[168:171], v[216:219], v[64:67]
    v_mfma_f32_16x16x32_bf16 v[64:67], a[172:175], v[220:223], v[64:67]
    v_mfma_f32_16x16x32_bf16 v[68:71], a[160:163], v[224:227], 0
    v_mfma_f32_16x16x32_bf16 v[68:71], a[164:167], v[228:231], v[68:71]
    v_mfma_f32_16x16x32_bf16 v[68:71], a[168:171], v[232:235], v[68:71]
    v_mfma_f32_16x16x32_bf16 v[68:71], a[172:175], v[236:239], v[68:71]
    s_nop 7
    s_nop 0
    v_max3_f32 v76, v76, v56, v57
    v_max3_f32 v76, v76, v58, v59
    v_max3_f32 v77, v77, v60, v61
    v_max3_f32 v77, v77, v62, v63
    v_max3_f32 v78, v78, v64, v65
    v_max3_f32 v78, v78, v66, v67
    v_max3_f32 v79, v79, v68, v69
    v_max3_f32 v79, v79, v70, v71
    s_add_u32 s48, s48, 0x1000
    s_sub_u32 s35, s35, 1
    s_cmp_lg_u32 s35, 0
    s_cbranch_scc1 L_rl4
    v_mov_b32 v56, v76
    v_mov_b32 v60, v77
    v_mov_b32 v64, v78
    v_mov_b32 v68, v79
    v_mov_b32 v57, v56
    v_mov_b32 v61, v60
    v_mov_b32 v65, v64
    v_mov_b32 v69, v68
    v_permlane32_swap_b32 v56, v57
    v_permlane32_swap_b32 v60, v61
    v_permlane32_swap_b32 v64, v65
    v_permlane32_swap_b32 v68, v69
    v_max_f32 v56, v56, v57
    v_max_f32 v60, v60, v61
    v_max_f32 v64, v64, v65
    v_max_f32 v68, v68, v69
    v_mov_b32 v57, v56
    v_mov_b32 v61, v60
    v_mov_b32 v65, v64
    v_mov_b32 v69, v68
    v_permlane16_swap_b32 v56, v57
    v_permlane16_swap_b32 v60, v61
    v_permlane16_swap_b32 v64, v65
    v_permlane16_swap_b32 v68, v69
    v_max_f32 v56, v56, v57
    v_max_f32 v60, v60, v61
    v_max_f32 v64, v64, v65
    v_max_f32_e64 v68, v68, v69
    v_xor_b32 v76, 0x80000000, v56
    v_xor_b32 v77, 0x80000000, v56
    v_xor_b32 v78, 0x80000000, v56
    v_xor_b32 v79, 0x80000000, v56
    v_xor_b32 v80, 0x80000000, v60
    v_xor_b32 v81, 0x80000000, v60
    v_xor_b32 v82, 0x80000000, v60
    v_xor_b32 v83, 0x80000000, v60
    v_xor_b32 v84, 0x80000000, v64
    v_xor_b32 v85, 0x80000000, v64
    v_xor_b32 v86, 0x80000000, v64
    v_xor_b32 v87, 0x80000000, v64
    v_xor_b32 v88, 0x80000000, v68
    v_xor_b32 v89, 0x80000000, v68
    v_xor_b32 v90, 0x80000000, v68
    v_xor_b32 v91, 0x80000000, v68
    v_mov_b64 v[96:97], 0
    v_mov_b64 v[98:99], 0
    v_mov_b64 v[100:101], 0
    v_mov_b64 v[102:103], 0
    v_mov_b64 v[104:105], 0
    v_mov_b64 v[106:107], 0
    v_mov_b64 v[108:109], 0
    v_mov_b64 v[110:111], 0
    v_mfma_f32_32x32x16_bf16 a[0:15], v[96:99], v[96:99], 0
    v_mfma_f32_32x32x16_bf16 a[16:31], v[96:99], v[96:99], 0
    v_mfma_f32_32x32x16_bf16 a[32:47], v[96:99], v[96:99], 0
    v_mfma_f32_32x32x16_bf16 a[48:63], v[96:99], v[96:99], 0
    v_mfma_f32_32x32x16_bf16 a[64:79], v[96:99], v[96:99], 0
    v_mfma_f32_32x32x16_bf16 a[80:95], v[96:99], v[96:99], 0
    v_mfma_f32_32x32x16_bf16 a[96:111], v[96:99], v[96:99], 0
    v_mfma_f32_32x32x16_bf16 a[112:127], v[96:99], v[96:99], 0
    v_mfma_f32_32x32x16_bf16 a[224:239], v[96:99], v[96:99], 0
    s_waitcnt vmcnt(0)
    s_barrier
    ds_read_b128 a[160:163], v4 offset:0
    ds_read_b128 a[164:167], v5 offset:0
    ds_read_b128 a[168:171], v6 offset:0
    ds_read_b128 a[172:175], v7 offset:0
    ds_read_b128 a[176:179], v4 offset:4096
    ds_read_b128 a[180:183], v5 offset:4096
    ds_read_b128 a[184:187], v6 offset:4096
    ds_read_b128 a[188:191], v7 offset:4096
    ds_read_b64_tr_b16 a[192:193], v8 offset:8192
    ds_read_b64_tr_b16 a[194:195], v8 offset:12288
    ds_read_b64_tr_b16 a[196:197], v9 offset:8192
    ds_read_b64_tr_b16 a[198:199], v9 offset:12288
    ds_read_b64_tr_b16 a[200:201], v10 offset:8192
    ds_read_b64_tr_b16 a[202:203], v10 offset:12288
    ds_read_b64_tr_b16 a[204:205], v11 offset:8192
    ds_read_b64_tr_b16 a[206:207], v11 offset:12288
    s_mov_b32 s35, 8
    s_nop 7
    s_branch L_loop4
L_code_end:
.set CODE_SIZE, L_code_end - concat_heads__mha_block_cached__gqa_block_cached__near_ridge_kernel - 256
.section .rodata,"a"
.p2align 6
.amdhsa_kernel concat_heads__mha_block_cached__gqa_block_cached__near_ridge_kernel
  .amdhsa_next_free_vgpr 512
  .amdhsa_next_free_sgpr 102
  .amdhsa_accum_offset 256
  .amdhsa_group_segment_fixed_size 0
  .amdhsa_kernarg_size 104
  .amdhsa_user_sgpr_count 2
  .amdhsa_user_sgpr_kernarg_segment_ptr 1
  .amdhsa_system_sgpr_workgroup_id_x 1
.end_amdhsa_kernel
```
